```python
import torch

def _softmax(x, axis=-1):
    return torch.softmax(x, dim=axis)
def _gelu(x):
    return torch.nn.functional.gelu(x, approximate="tanh")
def _silu(x):
    return torch.nn.functional.silu(x)
def _sigmoid(x):
    return torch.sigmoid(x)
def _layernorm(x, axis=-1, eps=1e-5):
    m = x.mean(dim=axis, keepdim=True)
    v = x.var(dim=axis, keepdim=True, unbiased=False)
    return (x - m) / torch.sqrt(v + eps)
def _scatter_add(tgt, idx, src, axis=0):
    return tgt.clone().index_add_(axis, idx, src)
def _segment_sum(src, seg, n):
    out = torch.zeros((n,) + src.shape[1:], dtype=src.dtype)
    return out.index_add_(0, seg, src)
def _pad(x, pw):
    flat = tuple(v for pair in reversed(pw) for v in pair)
    return torch.nn.functional.pad(x, flat)

kernel_name = 'interleave_layers__grouped_kv_mqa__glu_gated_swiglu__prompt'

def setup_inputs():

    _w = (lambda a: (lambda t: t.to(torch.bfloat16) if t.is_floating_point() else t)(torch.as_tensor(a)))
    def _A_setup():
        B, S, D, H = 1, 2048, 512, 32
        Dh = D // H
        return {
            "x": _w((lambda *s: torch.randn(*s, dtype=torch.bfloat16) * 0.05)(B, S, D)),
            "wq": _w((lambda *s: torch.randn(*s, dtype=torch.bfloat16) * 0.05)(D, H * Dh)),
            "wk": _w((lambda *s: torch.randn(*s, dtype=torch.bfloat16) * 0.05)(D, Dh)),
            "wv": _w((lambda *s: torch.randn(*s, dtype=torch.bfloat16) * 0.05)(D, Dh)),
            "wo": _w((lambda *s: torch.randn(*s, dtype=torch.bfloat16) * 0.05)(H * Dh, D)),
        }
    _A_in = _A_setup()

    def _B_setup():
        B, S, D, F = 1, 2048, 512, 1792
        return {
            "x": _w((lambda *s: torch.randn(*s, dtype=torch.bfloat16) * 0.05)(B, S, D)),
            "w1": _w((lambda *s: torch.randn(*s, dtype=torch.bfloat16) * 0.4)(D, F) * (2.0 / D) ** 0.5),
            "w3": _w((lambda *s: torch.randn(*s, dtype=torch.bfloat16) * 0.4)(D, F) * (2.0 / D) ** 0.5),
            "w2": _w((lambda *s: torch.randn(*s, dtype=torch.bfloat16) * 0.4)(F, D) * (2.0 / F) ** 0.5),
        }
    _B_in = _B_setup()

    return {
        "A_x": _A_in["x"],
        "A_wq": _A_in["wq"],
        "A_wk": _A_in["wk"],
        "A_wv": _A_in["wv"],
        "A_wo": _A_in["wo"],
        "B_x": _B_in["x"],
        "B_w1": _B_in["w1"],
        "B_w3": _B_in["w3"],
        "B_w2": _B_in["w2"],
    }

def reference(A_x, A_wq, A_wk, A_wv, A_wo, B_x, B_w1, B_w3, B_w2):
    def _A_ref(x, wq, wk, wv, wo):
        B, S, D = x.shape
        H = 32
        Dh = D // H
        q = (lambda x, *d: x.permute(*d))((x @ wq).reshape(B, S, H, Dh), 0, 2, 1, 3)
        k = x @ wk
        v = x @ wv
        scores = torch.einsum("bhqd,bkd->bhqk", q, k) * (Dh ** -0.5)
        p = _softmax(scores, axis=-1)
        o = torch.einsum("bhqk,bkd->bhqd", p, v)
        return (lambda x, *d: x.permute(*d))(o, 0, 2, 1, 3).reshape(B, S, H * Dh) @ wo

    def _B_ref(x, w1, w3, w2):
        gate = torch.einsum("bsd,df->bsf", x, w1)
        up = torch.einsum("bsd,df->bsf", x, w3)
        h = _silu(gate) * up
        out = torch.einsum("bsf,fd->bsd", h, w2)
        return out

    x = A_x
    x = x + _A_ref(_layernorm(x, axis=-1), A_wq, A_wk, A_wv, A_wo)
    x = x + _B_ref(_layernorm(x, axis=-1), B_w1, B_w3, B_w2)
    x = x + _A_ref(_layernorm(x, axis=-1), A_wq, A_wk, A_wv, A_wo)
    x = x + _B_ref(_layernorm(x, axis=-1), B_w1, B_w3, B_w2)
    return x
```

```asm
; @launch grid=(256,1,1) block=(512,1,1) lds=163840
.amdgcn_target "amdgcn-amd-amdhsa--gfx950"
.text
.globl interleave_layers__grouped_kv_mqa__glu_gated_swiglu__prompt_kernel
.p2align 8
.type interleave_layers__grouped_kv_mqa__glu_gated_swiglu__prompt_kernel,@function
interleave_layers__grouped_kv_mqa__glu_gated_swiglu__prompt_kernel:
  s_cmp_ge_u32 s2, 256
  s_cbranch_scc1 main_end
  s_load_dwordx2 s[4:5], s[0:1], 88
  s_load_dwordx8 s[68:75], s[0:1], 0
  s_load_dwordx4 s[84:87], s[0:1], 72
  s_load_dwordx2 s[76:77], s[0:1], 32
  s_load_dwordx4 s[60:63], s[0:1], 48
  s_load_dwordx2 s[78:79], s[0:1], 64
  s_getreg_b32 s95, hwreg(HW_REG_XCC_ID, 0, 3)
  v_lshrrev_b32 v1, 6, v0
  v_and_b32 v3, 31, v0
  v_readfirstlane_b32 s14, v1
  v_and_b32 v1, 63, v0
  v_lshlrev_b32 v2, 4, v1
  v_lshrrev_b32 v4, 5, v1
  s_waitcnt lgkmcnt(0)
  s_and_b32 s12, s2, 7
  s_lshr_b32 s13, s2, 3
  s_mov_b32 s80, s68
  s_mov_b32 s81, s69
  s_mov_b32 s82, 0x200000
  s_mov_b32 s83, 0x20000
  s_and_b32 s22, s13, 7
  s_lshl_b32 s23, s12, 3
  s_add_u32 s22, s22, s23
  s_lshl_b32 s22, s22, 15
  s_lshl_b32 s23, s14, 12
  s_add_u32 s22, s22, s23
  s_add_u32 m0, s23, 131072
  s_and_b32 s23, s14, 3
  s_lshl_b32 s23, s23, 6
  v_xor_b32 v5, s23, v2
  buffer_load_dwordx4 v5, s[80:83], s22 offen offset:0 lds
  v_xor_b32 v17, 16, v5
  buffer_load_dwordx4 v17, s[80:83], s22 offen offset:1024 lds
  v_xor_b32 v18, 32, v5
  buffer_load_dwordx4 v18, s[80:83], s22 offen offset:2048 lds
  v_xor_b32 v19, 48, v5
  buffer_load_dwordx4 v19, s[80:83], s22 offen offset:3072 lds
  s_mov_b32 s8, s4
  s_mov_b32 s9, s5
  s_mov_b32 s10, 0x10000000
  s_mov_b32 s11, 0x20000
  s_lshl_b32 s36, s12, 3
  s_and_b32 s37, s13, 7
  s_add_u32 s36, s36, s37
  s_lshr_b32 s35, s13, 3
  s_lshl_b32 s37, s35, 2
  s_and_b32 s39, s14, 3
  s_add_u32 s37, s37, s39
  s_lshr_b32 s38, s14, 2
  s_lshl_b32 s40, s12, 4
  s_add_u32 s40, s40, s37
  s_lshl_b32 s40, s40, 1
  s_add_u32 s40, s40, s38
  s_mul_i32 s40, s40, 17408
  s_add_u32 s40, s40, 37748736
  s_mul_i32 s41, s12, 33792
  s_add_u32 s41, s41, 262144
  s_mov_b32 s88, s86
  s_mov_b32 s89, s87
  s_mov_b32 s90, 0x100
  s_mov_b32 s91, 0x20000
  s_mov_b32 s86, 0x200000
  s_mov_b32 s87, 0x20000
  s_sub_u32 s95, s95, s12
  s_and_b32 s95, s95, 7
  s_lshl_b32 s98, s12, 11
  s_add_u32 s98, s98, 7274496
  s_lshl_b32 s99, s13, 2
  s_mov_b32 s92, 0
  s_and_b32 s33, s13, 15
  s_mul_i32 s33, s33, 236544
  s_add_u32 s33, s33, 1114112
  s_lshr_b32 s22, s13, 4
  s_mul_i32 s22, s22, 3072
  s_add_u32 s33, s33, s22
  s_mul_i32 s22, s14, 7168
  s_add_u32 s33, s33, s22
  s_mov_b32 s28, s72
  s_mov_b32 s29, s73
  s_mov_b32 s30, 0x4000
  s_mov_b32 s31, 0x20000
  s_mov_b32 s16, s74
  s_mov_b32 s17, s75
  s_mov_b32 s18, 0x4000
  s_mov_b32 s19, 0x20000
  s_mov_b32 s44, s70
  s_mov_b32 s45, s71
  s_mov_b32 s46, 0x80000
  s_mov_b32 s47, 0x20000
  v_lshlrev_b32 v240, 7, v1
  s_and_b32 s22, s14, 1
  s_lshl_b32 s22, s22, 13
  s_lshl_b32 s23, s35, 2
  s_lshr_b32 s24, s14, 1
  s_add_u32 s23, s23, s24
  s_cmp_eq_u32 s23, 12
  s_cselect_b64 exec, -1, 0
  buffer_load_dword v241, v240, s[28:31], s22 offen
  s_cmp_eq_u32 s23, 13
  s_cselect_b64 exec, -1, 0
  buffer_load_dword v241, v240, s[16:19], s22 offen
  s_mov_b64 exec, -1
  s_lshl_b32 s22, s14, 12
  s_add_u32 s22, s22, 98304
  s_lshl_b32 s23, s14, 11
  s_mov_b32 m0, s22
  s_cmp_eq_u32 s35, 0
  s_cselect_b64 exec, -1, 0
  buffer_load_dwordx4 v2, s[28:31], s23 offen lds
  buffer_load_dwordx4 v2, s[28:31], s23 offen offset:1024 lds
  s_add_u32 m0, s22, 2048
  s_nop 0
  buffer_load_dwordx4 v2, s[16:19], s23 offen lds
  buffer_load_dwordx4 v2, s[16:19], s23 offen offset:1024 lds
  s_mov_b64 exec, -1
  s_add_u32 s24, s2, s14
  s_cmp_lg_u32 s24, 0
  s_cbranch_scc1 nonce_1
  s_memrealtime s[24:25]
  v_mov_b32 v14, 0
  s_waitcnt lgkmcnt(0)
  s_or_b32 s24, s24, 1
  v_mov_b32 v12, s24
  s_mov_b64 exec, 1
  buffer_store_dword v12, v14, s[88:91], 0 offen sc1
  s_mov_b64 exec, -1
nonce_1:
  v_bfe_u32 v6, v1, 2, 2
  v_lshl_add_u32 v6, v4, 2, v6
  v_and_b32 v7, 3, v1
  v_lshlrev_b32 v7, 3, v7
  v_bfe_u32 v11, v1, 4, 1
  v_lshl_add_u32 v123, v6, 6, v7
  v_lshl_add_u32 v123, v11, 5, v123
  v_lshl_add_u32 v6, v6, 5, v7
  v_lshl_add_u32 v6, v11, 11, v6
  v_add_u32 v6, s22, v6
  v_lshrrev_b32 v7, 2, v1
  v_lshlrev_b32 v7, 10, v7
  v_and_b32 v11, 3, v1
  v_lshl_add_u32 v7, v11, 4, v7
  s_lshl_b32 s42, s14, 13
  s_add_u32 s42, s42, 8192
  v_add_u32 v123, s42, v123
  s_lshl_b32 s43, s38, 18
  s_lshl_b32 s22, s37, 6
  s_add_u32 s43, s43, s22
  s_sub_u32 s23, s13, 8
  s_lshl_b32 s23, s23, 3
  s_add_u32 s23, s23, s14
  s_mul_i32 s23, s23, 3072
  s_cmp_lg_u32 s35, 0
  s_cselect_b64 exec, -1, 0
  buffer_load_dwordx4 v[244:247], v2, s[44:47], s23 offen offset:0
  buffer_load_dwordx4 v[248:251], v2, s[44:47], s23 offen offset:1024
  buffer_load_dwordx4 v[252:255], v2, s[44:47], s23 offen offset:2048
  s_mov_b64 exec, -1
  s_sub_u32 s4, s13, 8
  s_lshl_b32 s4, s4, 3
  s_add_u32 s4, s4, s12
  s_cmp_eq_u32 s35, 0
  s_cselect_b32 s4, 255, s4
  s_cmp_lt_u32 s4, 112
  s_cbranch_scc1 wu_w13
  s_movk_i32 s16, 1024
  s_movk_i32 s17, 32
  s_movk_i32 s18, 64
  s_movk_i32 s19, 2048
  s_movk_i32 s3, 2112
  s_mov_b32 s50, 0
  s_cmp_lt_u32 s4, 128
  s_cbranch_scc0 wu_w2
  s_mov_b32 s52, s76
  s_mov_b32 s53, s77
  s_mov_b32 s54, 0x80000
  s_mov_b32 s55, 0x20000
  s_mov_b32 s56, s76
  s_mov_b32 s57, s77
  s_mov_b32 s58, 0x80000
  s_mov_b32 s59, 0x20000
  s_sub_u32 s22, s4, 112
  s_and_b32 s23, s22, 3
  s_lshr_b32 s22, s22, 2
  s_lshl_b32 s24, s23, 3
  s_add_u32 s24, s24, s14
  s_lshl_b32 s64, s24, 14
  s_lshl_b32 s25, s22, 8
  s_add_u32 s64, s64, s25
  s_add_u32 s66, s64, 128
  s_lshl_b32 s25, s22, 7
  s_add_u32 s25, s25, s24
  s_lshl_b32 s60, s25, 10
  s_add_u32 s60, s60, 589824
  s_add_u32 s61, s60, 32768
  s_add_u32 s62, s60, 65536
  s_add_u32 s63, s60, 98304
  s_mov_b32 s51, 1
  s_branch wu_go
wu_w2:
  s_mov_b32 s52, s78
  s_mov_b32 s53, s79
  s_mov_b32 s54, 0x1c0000
  s_mov_b32 s55, 0x20000
  s_mov_b32 s56, s78
  s_mov_b32 s57, s79
  s_mov_b32 s58, 0x1c0000
  s_mov_b32 s59, 0x20000
  s_sub_u32 s22, s4, 128
  s_min_u32 s22, s22, 55
  s_and_b32 s23, s22, 3
  s_lshr_b32 s22, s22, 2
  s_lshl_b32 s24, s22, 3
  s_add_u32 s24, s24, s14
  s_lshl_b32 s64, s24, 14
  s_lshl_b32 s25, s23, 8
  s_add_u32 s64, s64, s25
  s_add_u32 s66, s64, 128
  s_mul_i32 s25, s24, 2341
  s_lshr_b32 s25, s25, 16
  s_mul_i32 s22, s25, 28
  s_sub_u32 s22, s24, s22
  s_lshl_b32 s22, s22, 10
  s_mul_i32 s25, s25, 57344
  s_add_u32 s60, s25, s22
  s_mul_i32 s25, s23, 458752
  s_add_u32 s60, s60, s25
  s_add_u32 s60, s60, 4915200
  s_add_u32 s61, s60, 28672
  s_add_u32 s62, s60, 229376
  s_add_u32 s63, s60, 258048
  s_cmp_lt_u32 s4, 184
  s_cselect_b32 s51, 1, 0
  s_branch wu_go
wu_w13:
  s_mov_b32 s52, s60
  s_mov_b32 s53, s61
  s_mov_b32 s54, 0x1c0000
  s_mov_b32 s55, 0x20000
  s_mov_b32 s56, s62
  s_mov_b32 s57, s63
  s_mov_b32 s58, 0x1c0000
  s_mov_b32 s59, 0x20000
  s_movk_i32 s16, 3584
  s_movk_i32 s17, 2048
  s_movk_i32 s18, 32
  s_movk_i32 s19, 64
  s_movk_i32 s3, 96
  s_and_b32 s23, s4, 3
  s_lshr_b32 s22, s4, 2
  s_lshl_b32 s24, s23, 3
  s_add_u32 s24, s24, s14
  s_mul_i32 s64, s24, 57344
  s_lshl_b32 s25, s22, 7
  s_add_u32 s64, s64, s25
  s_mov_b32 s66, s64
  s_lshl_b32 s28, s22, 2
  s_mul_i32 s29, s28, 9363
  s_lshr_b32 s29, s29, 16
  s_mul_i32 s30, s29, 7
  s_sub_u32 s30, s28, s30
  s_mul_i32 s29, s29, 33
  s_add_u32 s29, s29, s24
  s_mul_i32 s29, s29, 7
  s_add_u32 s29, s29, s30
  s_lshl_b32 s60, s29, 10
  s_add_u32 s60, s60, 1114112
  s_lshl_b32 s28, s22, 2
  s_add_u32 s28, s28, 1
  s_mul_i32 s29, s28, 9363
  s_lshr_b32 s29, s29, 16
  s_mul_i32 s30, s29, 7
  s_sub_u32 s30, s28, s30
  s_mul_i32 s29, s29, 33
  s_add_u32 s29, s29, s24
  s_mul_i32 s29, s29, 7
  s_add_u32 s29, s29, s30
  s_lshl_b32 s61, s29, 10
  s_add_u32 s61, s61, 1114112
  s_lshl_b32 s28, s22, 2
  s_add_u32 s28, s28, 2
  s_mul_i32 s29, s28, 9363
  s_lshr_b32 s29, s29, 16
  s_mul_i32 s30, s29, 7
  s_sub_u32 s30, s28, s30
  s_mul_i32 s29, s29, 33
  s_add_u32 s29, s29, s24
  s_mul_i32 s29, s29, 7
  s_add_u32 s29, s29, s30
  s_lshl_b32 s62, s29, 10
  s_add_u32 s62, s62, 1114112
  s_lshl_b32 s28, s22, 2
  s_add_u32 s28, s28, 3
  s_mul_i32 s29, s28, 9363
  s_lshr_b32 s29, s29, 16
  s_mul_i32 s30, s29, 7
  s_sub_u32 s30, s28, s30
  s_mul_i32 s29, s29, 33
  s_add_u32 s29, s29, s24
  s_mul_i32 s29, s29, 7
  s_add_u32 s29, s29, s30
  s_lshl_b32 s63, s29, 10
  s_add_u32 s63, s63, 1114112
  s_lshl_b32 s28, s22, 2
  s_add_u32 s28, s28, s39
  s_mul_i32 s29, s28, 9363
  s_lshr_b32 s29, s29, 16
  s_mul_i32 s30, s29, 7
  s_sub_u32 s30, s28, s30
  s_mul_i32 s29, s29, 33
  s_add_u32 s29, s29, 32
  s_mul_i32 s29, s29, 7
  s_add_u32 s29, s29, s30
  s_lshl_b32 s50, s29, 10
  s_add_u32 s50, s50, 1114112
  s_lshr_b32 s28, s23, 1
  s_lshl_b32 s28, s28, 9
  s_and_b32 s29, s23, 1
  s_lshl_b32 s29, s29, 3
  s_add_u32 s50, s50, s28
  s_add_u32 s50, s50, s29
  s_mov_b32 s51, 2
wu_go:
  s_lshl_b32 s22, s16, 3
  s_add_u32 s65, s64, s22
  s_add_u32 s67, s66, s22
  v_lshrrev_b32 v128, 3, v1
  v_mul_lo_u32 v128, v128, s16
  v_and_b32 v129, 7, v1
  v_lshl_add_u32 v128, v129, 4, v128
  v_bfe_u32 v129, v1, 2, 2
  v_lshl_add_u32 v129, v4, 2, v129
  v_lshlrev_b32 v129, 7, v129
  v_and_b32 v130, 3, v1
  v_lshl_add_u32 v129, v130, 3, v129
  v_bfe_u32 v130, v1, 4, 1
  v_mul_lo_u32 v130, v130, s17
  s_lshl_b32 s22, s14, 12
  s_add_u32 s22, s22, 98304
  v_add3_u32 v129, v129, v130, s22
  v_add_u32 v130, s18, v129
  v_add_u32 v131, s19, v129
  v_add_u32 v132, s3, v129
  s_lshl_b32 s26, s38, 13
  s_lshl_b32 s27, s39, 11
  s_add_u32 s26, s26, s27
  s_and_b32 s27, s39, 1
  s_lshl_b32 s27, s27, 11
  s_lshl_b32 s28, s38, 12
  s_add_u32 s27, s27, s28
  s_add_u32 s27, s27, 16252928
  s_lshr_b32 s48, s39, 1
  s_add_u32 s48, s48, s12
  s_lshl_b32 s28, s38, 14
  s_add_u32 s28, s28, 131072
  s_lshl_b32 s28, s38, 13
  v_add_u32 v124, s28, v2
  v_and_b32 v125, 15, v1
  v_lshlrev_b32 v125, 4, v125
  v_lshl_add_u32 v125, v4, 8, v125
  s_add_u32 s28, s28, 16384
  v_add_u32 v125, s28, v125
  v_add_u32 v126, 0x10000, v124
  v_add_u32 v127, 0x10000, v125
  s_lshl_b32 s28, s14, 12
  s_add_u32 s28, s28, 98304
  v_add_u32 v8, s28, v2
  s_xor_b32 s28, s28, 16384
  v_add_u32 v9, s28, v2
  v_mov_b32 v12, 0
  v_mov_b32 v13, 0
  v_mov_b32 v14, 0
  v_mov_b32 v92, 0x3f803f80
  v_mov_b32 v93, 0x3f803f80
  v_mov_b32 v94, 0x3f803f80
  v_mov_b32 v95, 0x3f803f80
  v_and_b32 v11, 15, v3
  v_lshlrev_b32 v10, 10, v3
  v_lshl_add_u32 v10, v11, 4, v10
  v_lshl_add_u32 v10, v4, 3, v10
  v_add_u32 v10, 131072, v10
  s_and_b32 s22, s14, 1
  s_lshl_b32 s22, s22, 7
  s_lshr_b32 s23, s14, 1
  s_lshl_b32 s23, s23, 8
  v_xor_b32 v11, s22, v10
  v_add_u32 v11, s23, v11
  s_lshl_b32 s22, s38, 9
  v_add_u32 v10, s22, v10
  s_waitcnt vmcnt(9)
  s_barrier
  buffer_load_dword v121, v14, s[88:91], 0 offen sc1
  s_cmp_eq_u32 s35, 0
  s_cbranch_scc1 att0_nokvkv
  s_lshl_b32 s23, s35, 3
  s_add_u32 s23, s23, s14
  s_cmp_lt_u32 s23, 2
  s_cselect_b64 exec, 0, -1
  s_add_u32 m0, s42, 0
  s_add_u32 s22, s43, 0
  buffer_load_dwordx4 v7, s[44:47], s22 offen lds
  s_add_u32 m0, s42, 1024
  s_add_u32 s22, s43, 16384
  buffer_load_dwordx4 v7, s[44:47], s22 offen lds
  s_add_u32 m0, s42, 2048
  s_add_u32 s22, s43, 32768
  buffer_load_dwordx4 v7, s[44:47], s22 offen lds
  s_add_u32 m0, s42, 3072
  s_add_u32 s22, s43, 49152
  buffer_load_dwordx4 v7, s[44:47], s22 offen lds
  s_add_u32 m0, s42, 4096
  s_add_u32 s22, s43, 65536
  buffer_load_dwordx4 v7, s[44:47], s22 offen lds
  s_add_u32 m0, s42, 5120
  s_add_u32 s22, s43, 81920
  buffer_load_dwordx4 v7, s[44:47], s22 offen lds
  s_add_u32 m0, s42, 6144
  s_add_u32 s22, s43, 98304
  buffer_load_dwordx4 v7, s[44:47], s22 offen lds
  s_add_u32 m0, s42, 7168
  s_add_u32 s22, s43, 114688
  buffer_load_dwordx4 v7, s[44:47], s22 offen lds
  s_mov_b64 exec, -1
  v_lshlrev_b32 v240, 7, v1
  s_cmp_eq_u32 s14, 5
  s_cselect_b64 exec, 0xffff, 0
  buffer_load_dword v241, v240, s[8:11], s98 offen sc1
  s_mov_b64 exec, -1
  s_lshl_b32 s22, s14, 12
  s_add_u32 s22, s22, 98304
  s_cmp_lg_u32 s51, 0
  s_cselect_b64 exec, -1, 0
  s_add_u32 m0, s22, 0
  s_nop 0
  buffer_load_dwordx4 v128, s[52:55], s64 offen lds
  s_add_u32 m0, s22, 1024
  s_nop 0
  buffer_load_dwordx4 v128, s[52:55], s65 offen lds
  s_add_u32 m0, s22, 2048
  s_nop 0
  buffer_load_dwordx4 v128, s[56:59], s66 offen lds
  s_add_u32 m0, s22, 3072
  s_nop 0
  buffer_load_dwordx4 v128, s[56:59], s67 offen lds
  s_mov_b64 exec, -1
  v_xor_b32 v40, 0, v11
  v_xor_b32 v41, 16, v11
  v_xor_b32 v42, 32, v11
  v_xor_b32 v43, 48, v11
  v_xor_b32 v44, 64, v11
  v_xor_b32 v45, 80, v11
  v_xor_b32 v46, 96, v11
  v_xor_b32 v47, 112, v11
  ds_read_b64 v[16:17], v40
  ds_read_b64 v[18:19], v41
  ds_read_b64 v[20:21], v42
  ds_read_b64 v[22:23], v43
  ds_read_b64 v[24:25], v44
  ds_read_b64 v[26:27], v45
  ds_read_b64 v[28:29], v46
  ds_read_b64 v[30:31], v47
  s_waitcnt lgkmcnt(0)
  v_dot2c_f32_bf16 v12, v16, v92
  v_dot2c_f32_bf16 v13, v16, v16
  v_dot2c_f32_bf16 v12, v17, v92
  v_dot2c_f32_bf16 v13, v17, v17
  v_dot2c_f32_bf16 v12, v18, v92
  v_dot2c_f32_bf16 v13, v18, v18
  v_dot2c_f32_bf16 v12, v19, v92
  v_dot2c_f32_bf16 v13, v19, v19
  v_dot2c_f32_bf16 v12, v20, v92
  v_dot2c_f32_bf16 v13, v20, v20
  v_dot2c_f32_bf16 v12, v21, v92
  v_dot2c_f32_bf16 v13, v21, v21
  v_dot2c_f32_bf16 v12, v22, v92
  v_dot2c_f32_bf16 v13, v22, v22
  v_dot2c_f32_bf16 v12, v23, v92
  v_dot2c_f32_bf16 v13, v23, v23
  v_dot2c_f32_bf16 v12, v24, v92
  v_dot2c_f32_bf16 v13, v24, v24
  v_dot2c_f32_bf16 v12, v25, v92
  v_dot2c_f32_bf16 v13, v25, v25
  v_dot2c_f32_bf16 v12, v26, v92
  v_dot2c_f32_bf16 v13, v26, v26
  v_dot2c_f32_bf16 v12, v27, v92
  v_dot2c_f32_bf16 v13, v27, v27
  v_dot2c_f32_bf16 v12, v28, v92
  v_dot2c_f32_bf16 v13, v28, v28
  v_dot2c_f32_bf16 v12, v29, v92
  v_dot2c_f32_bf16 v13, v29, v29
  v_dot2c_f32_bf16 v12, v30, v92
  v_dot2c_f32_bf16 v13, v30, v30
  v_dot2c_f32_bf16 v12, v31, v92
  v_dot2c_f32_bf16 v13, v31, v31
  v_lshlrev_b32 v5, 6, v3
  s_lshl_b32 s23, s14, 3
  v_add_u32 v11, s23, v5
  v_mov_b32 v40, v12
  v_mov_b32 v41, v13
  s_nop 1
  v_permlane32_swap_b32 v12, v40
  v_permlane32_swap_b32 v13, v41
  s_nop 1
  v_add_f32 v12, v12, v40
  v_add_f32 v13, v13, v41
  ds_write_b64 v11, v[12:13] offset:2048
  s_branch att0_nokv0
att0_nokvkv:
  v_xor_b32 v40, 0, v11
  v_xor_b32 v41, 16, v11
  v_xor_b32 v42, 32, v11
  v_xor_b32 v43, 48, v11
  v_xor_b32 v44, 64, v11
  v_xor_b32 v45, 80, v11
  v_xor_b32 v46, 96, v11
  v_xor_b32 v47, 112, v11
  ds_read_b64 v[16:17], v40
  ds_read_b64 v[18:19], v41
  ds_read_b64 v[20:21], v42
  ds_read_b64 v[22:23], v43
  ds_read_b64 v[24:25], v44
  ds_read_b64 v[26:27], v45
  ds_read_b64 v[28:29], v46
  ds_read_b64 v[30:31], v47
  s_waitcnt lgkmcnt(0)
  v_dot2c_f32_bf16 v12, v16, v92
  v_dot2c_f32_bf16 v13, v16, v16
  v_dot2c_f32_bf16 v12, v17, v92
  v_dot2c_f32_bf16 v13, v17, v17
  v_dot2c_f32_bf16 v12, v18, v92
  v_dot2c_f32_bf16 v13, v18, v18
  v_dot2c_f32_bf16 v12, v19, v92
  v_dot2c_f32_bf16 v13, v19, v19
  v_dot2c_f32_bf16 v12, v20, v92
  v_dot2c_f32_bf16 v13, v20, v20
  v_dot2c_f32_bf16 v12, v21, v92
  v_dot2c_f32_bf16 v13, v21, v21
  v_dot2c_f32_bf16 v12, v22, v92
  v_dot2c_f32_bf16 v13, v22, v22
  v_dot2c_f32_bf16 v12, v23, v92
  v_dot2c_f32_bf16 v13, v23, v23
  v_dot2c_f32_bf16 v12, v24, v92
  v_dot2c_f32_bf16 v13, v24, v24
  v_dot2c_f32_bf16 v12, v25, v92
  v_dot2c_f32_bf16 v13, v25, v25
  v_dot2c_f32_bf16 v12, v26, v92
  v_dot2c_f32_bf16 v13, v26, v26
  v_dot2c_f32_bf16 v12, v27, v92
  v_dot2c_f32_bf16 v13, v27, v27
  v_dot2c_f32_bf16 v12, v28, v92
  v_dot2c_f32_bf16 v13, v28, v28
  v_dot2c_f32_bf16 v12, v29, v92
  v_dot2c_f32_bf16 v13, v29, v29
  v_dot2c_f32_bf16 v12, v30, v92
  v_dot2c_f32_bf16 v13, v30, v30
  v_dot2c_f32_bf16 v12, v31, v92
  v_dot2c_f32_bf16 v13, v31, v31
  v_lshlrev_b32 v5, 6, v3
  s_lshl_b32 s23, s14, 3
  v_add_u32 v11, s23, v5
  v_mov_b32 v40, v12
  v_mov_b32 v41, v13
  s_nop 1
  v_permlane32_swap_b32 v12, v40
  v_permlane32_swap_b32 v13, v41
  s_nop 1
  v_add_f32 v12, v12, v40
  v_add_f32 v13, v13, v41
  ds_write_b64 v11, v[12:13] offset:2048
  s_waitcnt vmcnt(4)
  ds_read_b64_tr_b16 v[32:33], v6 offset:0
  ds_read_b64_tr_b16 v[34:35], v6 offset:256
  ds_read_b64_tr_b16 v[36:37], v6 offset:512
  ds_read_b64_tr_b16 v[38:39], v6 offset:768
  ds_read_b64_tr_b16 v[40:41], v6 offset:1024
  ds_read_b64_tr_b16 v[42:43], v6 offset:1280
  ds_read_b64_tr_b16 v[44:45], v6 offset:1536
  ds_read_b64_tr_b16 v[46:47], v6 offset:1792
  v_lshl_add_u32 v11, v4, 2, v11
  s_waitcnt lgkmcnt(6)
  v_mfma_f32_32x32x16_bf16 v[48:63], v[32:35], v[16:19], 0
  s_waitcnt lgkmcnt(4)
  v_mfma_f32_32x32x16_bf16 v[48:63], v[36:39], v[20:23], v[48:63]
  s_waitcnt lgkmcnt(2)
  v_mfma_f32_32x32x16_bf16 v[48:63], v[40:43], v[24:27], v[48:63]
  s_waitcnt lgkmcnt(0)
  v_mfma_f32_32x32x16_bf16 v[48:63], v[44:47], v[28:31], v[48:63]
  v_dot2c_f32_bf16 v14, v32, v92
  v_dot2c_f32_bf16 v14, v33, v92
  v_dot2c_f32_bf16 v14, v34, v92
  v_dot2c_f32_bf16 v14, v35, v92
  v_dot2c_f32_bf16 v14, v36, v92
  v_dot2c_f32_bf16 v14, v37, v92
  v_dot2c_f32_bf16 v14, v38, v92
  v_dot2c_f32_bf16 v14, v39, v92
  v_dot2c_f32_bf16 v14, v40, v92
  v_dot2c_f32_bf16 v14, v41, v92
  v_dot2c_f32_bf16 v14, v42, v92
  v_dot2c_f32_bf16 v14, v43, v92
  v_dot2c_f32_bf16 v14, v44, v92
  v_dot2c_f32_bf16 v14, v45, v92
  v_dot2c_f32_bf16 v14, v46, v92
  v_dot2c_f32_bf16 v14, v47, v92
  s_cmp_lg_u32 s13, 0
  s_cbranch_scc1 nosave_2
  s_lshl_b32 s22, s14, 12
  s_add_u32 s22, s22, s41
  buffer_store_dwordx4 v[32:35], v2, s[8:11], s22 offen offset:0 sc1
  buffer_store_dwordx4 v[36:39], v2, s[8:11], s22 offen offset:1024 sc1
  buffer_store_dwordx4 v[40:43], v2, s[8:11], s22 offen offset:2048 sc1
  buffer_store_dwordx4 v[44:47], v2, s[8:11], s22 offen offset:3072 sc1
nosave_2:
  ds_write_b128 v8, v[48:51] offset:0
  ds_write_b128 v8, v[52:55] offset:1024
  ds_write_b128 v8, v[56:59] offset:2048
  ds_write_b128 v8, v[60:63] offset:3072
  ds_write_b32 v11, v14 offset:0
att0_nokv0:
  s_waitcnt lgkmcnt(0)
  s_barrier
  s_sub_u32 s22, s14, 2
  s_lshl_b32 s23, s35, 3
  s_add_u32 s22, s22, s23
  s_cmp_ge_u32 s22, 6
  s_cbranch_scc1 late_3
  s_lshl_b32 s23, s35, 3
  s_add_u32 s23, s23, s14
  s_cmp_lt_u32 s23, 2
  s_cselect_b64 exec, 0, -1
  s_add_u32 m0, s42, 0
  s_add_u32 s22, s43, 0
  buffer_load_dwordx4 v7, s[44:47], s22 offen lds
  s_add_u32 m0, s42, 1024
  s_add_u32 s22, s43, 16384
  buffer_load_dwordx4 v7, s[44:47], s22 offen lds
  s_add_u32 m0, s42, 2048
  s_add_u32 s22, s43, 32768
  buffer_load_dwordx4 v7, s[44:47], s22 offen lds
  s_add_u32 m0, s42, 3072
  s_add_u32 s22, s43, 49152
  buffer_load_dwordx4 v7, s[44:47], s22 offen lds
  s_add_u32 m0, s42, 4096
  s_add_u32 s22, s43, 65536
  buffer_load_dwordx4 v7, s[44:47], s22 offen lds
  s_add_u32 m0, s42, 5120
  s_add_u32 s22, s43, 81920
  buffer_load_dwordx4 v7, s[44:47], s22 offen lds
  s_add_u32 m0, s42, 6144
  s_add_u32 s22, s43, 98304
  buffer_load_dwordx4 v7, s[44:47], s22 offen lds
  s_add_u32 m0, s42, 7168
  s_add_u32 s22, s43, 114688
  buffer_load_dwordx4 v7, s[44:47], s22 offen lds
  s_mov_b64 exec, -1
  v_lshlrev_b32 v240, 7, v1
  s_cmp_eq_u32 s14, 5
  s_cselect_b64 exec, 0xffff, 0
  buffer_load_dword v241, v240, s[8:11], s98 offen sc1
  s_mov_b64 exec, -1
  s_lshl_b32 s22, s14, 12
  s_add_u32 s22, s22, 98304
  s_cmp_lg_u32 s51, 0
  s_cselect_b64 exec, -1, 0
  s_add_u32 m0, s22, 0
  s_nop 0
  buffer_load_dwordx4 v128, s[52:55], s64 offen lds
  s_add_u32 m0, s22, 1024
  s_nop 0
  buffer_load_dwordx4 v128, s[52:55], s65 offen lds
  s_add_u32 m0, s22, 2048
  s_nop 0
  buffer_load_dwordx4 v128, s[56:59], s66 offen lds
  s_add_u32 m0, s22, 3072
  s_nop 0
  buffer_load_dwordx4 v128, s[56:59], s67 offen lds
  s_mov_b64 exec, -1
late_3:
  ds_read_b128 v[16:19], v5 offset:2048
  ds_read_b128 v[20:23], v5 offset:2064
  ds_read_b128 v[24:27], v5 offset:2080
  ds_read_b128 v[28:31], v5 offset:2096
  ds_read_b128 v[64:67], v5 offset:0
  ds_read_b128 v[68:71], v5 offset:16
  ds_read_b128 v[72:75], v5 offset:32
  ds_read_b128 v[76:79], v5 offset:48
  s_waitcnt lgkmcnt(4)
  v_add_f32 v16, v16, v24
  v_add_f32 v17, v17, v25
  v_add_f32 v18, v18, v26
  v_add_f32 v19, v19, v27
  v_add_f32 v20, v20, v28
  v_add_f32 v21, v21, v29
  v_add_f32 v22, v22, v30
  v_add_f32 v23, v23, v31
  v_add_f32 v16, v16, v20
  v_add_f32 v17, v17, v21
  v_add_f32 v18, v18, v22
  v_add_f32 v19, v19, v23
  v_add_f32 v16, v16, v18
  v_add_f32 v17, v17, v19
  v_mul_f32 v16, 0x3b000000, v16
  v_mul_f32 v17, 0x3b000000, v17
  v_fma_f32 v17, -v16, v16, v17
  v_max_f32 v17, 0, v17
  v_add_f32 v17, 0x3727c5ac, v17
  v_rsq_f32 v122, v17
  v_and_b32 v18, 0xffff0000, v16
  v_sub_f32 v19, v16, v18
  v_cvt_pk_bf16_f32 v36, -v18, -v18
  v_cvt_pk_bf16_f32 v37, -v19, 0
  v_mov_b32 v38, v36
  v_mov_b32 v39, v37
  s_lshl_b32 s22, s35, 3
  s_add_u32 s22, s22, s14
  s_cmp_ge_u32 s22, 2
  s_cbranch_scc1 att0_nokv
  s_waitcnt lgkmcnt(0)
  v_add_f32 v64, v64, v72
  v_add_f32 v65, v65, v73
  v_add_f32 v66, v66, v74
  v_add_f32 v67, v67, v75
  v_add_f32 v68, v68, v76
  v_add_f32 v69, v69, v77
  v_add_f32 v70, v70, v78
  v_add_f32 v71, v71, v79
  v_add_f32 v64, v64, v68
  v_add_f32 v65, v65, v69
  v_add_f32 v66, v66, v70
  v_add_f32 v67, v67, v71
  v_add_f32 v64, v64, v66
  v_add_f32 v65, v65, v67
  v_add_f32 v64, v64, v65
  v_cmp_eq_u32 vcc, 0, v4
  v_mov_b32 v114, 0
  v_mov_b32 v115, 0
  v_cndmask_b32 v64, 0, v64, vcc
  v_and_b32 v65, 0xffff0000, v64
  v_sub_f32 v66, v64, v65
  v_cvt_pk_bf16_f32 v112, v65, v66
  v_cvt_pk_bf16_f32 v113, v65, 0
  s_add_u32 s22, s13, s14
  s_cmp_lg_u32 s22, 0
  s_cbranch_scc1 nosave_4
  s_add_u32 s22, s41, 32768
  buffer_store_dwordx4 v[112:115], v2, s[8:11], s22 offen sc1
nosave_4:
  v_mov_b32 v116, v7
  v_mfma_f32_32x32x16_bf16 v[48:63], v[112:115], v[36:39], 0
  s_lshl_b32 s20, s14, 11
  s_add_u32 s20, s20, 98304
  v_add_u32 v5, s20, v2
  ds_read_b128 v[72:75], v5 offset:0
  ds_read_b128 v[76:79], v5 offset:1024
  ds_read_b128 v[80:83], v5 offset:4096
  ds_read_b128 v[84:87], v5 offset:5120
  ds_read_b128 v[88:91], v5 offset:8192
  ds_read_b128 v[92:95], v5 offset:9216
  ds_read_b128 v[96:99], v5 offset:12288
  ds_read_b128 v[100:103], v5 offset:13312
  s_waitcnt lgkmcnt(0)
  v_add_f32 v64, v72, v80
  v_add_f32 v65, v73, v81
  v_add_f32 v66, v74, v82
  v_add_f32 v67, v75, v83
  v_add_f32 v68, v76, v84
  v_add_f32 v69, v77, v85
  v_add_f32 v70, v78, v86
  v_add_f32 v71, v79, v87
  v_add_f32 v88, v88, v96
  v_add_f32 v89, v89, v97
  v_add_f32 v90, v90, v98
  v_add_f32 v91, v91, v99
  v_add_f32 v92, v92, v100
  v_add_f32 v93, v93, v101
  v_add_f32 v94, v94, v102
  v_add_f32 v95, v95, v103
  v_add_f32 v64, v64, v88
  v_add_f32 v65, v65, v89
  v_add_f32 v66, v66, v90
  v_add_f32 v67, v67, v91
  v_add_f32 v68, v68, v92
  v_add_f32 v69, v69, v93
  v_add_f32 v70, v70, v94
  v_add_f32 v71, v71, v95
  ds_read_b128 v[72:75], v5 offset:16384
  ds_read_b128 v[76:79], v5 offset:17408
  ds_read_b128 v[80:83], v5 offset:20480
  ds_read_b128 v[84:87], v5 offset:21504
  ds_read_b128 v[88:91], v5 offset:24576
  ds_read_b128 v[92:95], v5 offset:25600
  ds_read_b128 v[96:99], v5 offset:28672
  ds_read_b128 v[100:103], v5 offset:29696
  s_waitcnt lgkmcnt(0)
  v_add_f32 v72, v72, v80
  v_add_f32 v73, v73, v81
  v_add_f32 v74, v74, v82
  v_add_f32 v75, v75, v83
  v_add_f32 v76, v76, v84
  v_add_f32 v77, v77, v85
  v_add_f32 v78, v78, v86
  v_add_f32 v79, v79, v87
  v_add_f32 v88, v88, v96
  v_add_f32 v89, v89, v97
  v_add_f32 v90, v90, v98
  v_add_f32 v91, v91, v99
  v_add_f32 v92, v92, v100
  v_add_f32 v93, v93, v101
  v_add_f32 v94, v94, v102
  v_add_f32 v95, v95, v103
  v_add_f32 v64, v64, v72
  v_add_f32 v65, v65, v73
  v_add_f32 v66, v66, v74
  v_add_f32 v67, v67, v75
  v_add_f32 v68, v68, v76
  v_add_f32 v69, v69, v77
  v_add_f32 v70, v70, v78
  v_add_f32 v71, v71, v79
  v_add_f32 v64, v64, v88
  v_add_f32 v65, v65, v89
  v_add_f32 v66, v66, v90
  v_add_f32 v67, v67, v91
  v_add_f32 v68, v68, v92
  v_add_f32 v69, v69, v93
  v_add_f32 v70, v70, v94
  v_add_f32 v71, v71, v95
  s_lshl_b32 s21, s36, 10
  s_add_u32 s21, s21, 16252928
  s_lshl_b32 s22, s36, 7
  s_add_u32 s22, s22, 6815744
  s_lshl_b32 s23, s99, 2
  s_add_u32 s23, s23, s98
  s_cmp_eq_u32 s14, 1
  s_cbranch_scc1 kvfinV_5
  v_add_f32 v64, v64, v48
  v_add_f32 v65, v65, v49
  v_add_f32 v66, v66, v50
  v_add_f32 v67, v67, v51
  v_add_f32 v68, v68, v52
  v_add_f32 v69, v69, v53
  v_add_f32 v70, v70, v54
  v_add_f32 v71, v71, v55
  v_mul_f32 v64, v64, v122
  v_mul_f32 v65, v65, v122
  v_mul_f32 v66, v66, v122
  v_mul_f32 v67, v67, v122
  v_mul_f32 v68, v68, v122
  v_mul_f32 v69, v69, v122
  v_mul_f32 v70, v70, v122
  v_mul_f32 v71, v71, v122
  v_cvt_pk_bf16_f32 v72, v64, v65
  v_cvt_pk_bf16_f32 v73, v66, v67
  v_cvt_pk_bf16_f32 v74, v68, v69
  v_cvt_pk_bf16_f32 v75, v70, v71
  buffer_store_dwordx4 v[72:75], v2, s[8:11], s21 offen sc1
  v_mul_f32 v76, v64, v64
  v_fmac_f32 v76, v65, v65
  v_fmac_f32 v76, v66, v66
  v_fmac_f32 v76, v67, v67
  v_fmac_f32 v76, v68, v68
  v_fmac_f32 v76, v69, v69
  v_fmac_f32 v76, v70, v70
  v_fmac_f32 v76, v71, v71
  v_mov_b32 v77, v76
  s_nop 1
  v_permlane32_swap_b32 v76, v77
  s_nop 1
  v_add_f32 v76, v76, v77
  s_nop 1
  v_max_f32_dpp v76, v76, v76 row_shr:1 row_mask:0xf bank_mask:0xf
  s_nop 1
  v_max_f32_dpp v76, v76, v76 row_shr:2 row_mask:0xf bank_mask:0xf
  s_nop 1
  v_max_f32_dpp v76, v76, v76 row_shr:4 row_mask:0xf bank_mask:0xf
  s_nop 1
  v_max_f32_dpp v76, v76, v76 row_shr:8 row_mask:0xf bank_mask:0xf
  s_nop 1
  v_max_f32_dpp v76, v76, v76 row_bcast:15 row_mask:0xa bank_mask:0xf
  s_nop 1
  v_max_f32_dpp v76, v76, v76 row_bcast:31 row_mask:0xc bank_mask:0xf
  v_mov_b32 v78, 0
  s_mov_b32 s24, 0
  s_mov_b32 s25, 0x80000000
  s_mov_b64 exec, s[24:25]
  s_mov_b64 s[30:31], exec
  s_mov_b32 s29, s22
  s_mov_b64 exec, -1
  v_mov_b32 v7, v116
  s_add_u32 m0, s42, 0
  s_add_u32 s22, s43, 0
  buffer_load_dwordx4 v7, s[44:47], s22 offen lds
  s_add_u32 m0, s42, 1024
  s_add_u32 s22, s43, 16384
  buffer_load_dwordx4 v7, s[44:47], s22 offen lds
  s_add_u32 m0, s42, 2048
  s_add_u32 s22, s43, 32768
  buffer_load_dwordx4 v7, s[44:47], s22 offen lds
  s_add_u32 m0, s42, 3072
  s_add_u32 s22, s43, 49152
  buffer_load_dwordx4 v7, s[44:47], s22 offen lds
  s_add_u32 m0, s42, 4096
  s_add_u32 s22, s43, 65536
  buffer_load_dwordx4 v7, s[44:47], s22 offen lds
  s_add_u32 m0, s42, 5120
  s_add_u32 s22, s43, 81920
  buffer_load_dwordx4 v7, s[44:47], s22 offen lds
  s_add_u32 m0, s42, 6144
  s_add_u32 s22, s43, 98304
  buffer_load_dwordx4 v7, s[44:47], s22 offen lds
  s_add_u32 m0, s42, 7168
  s_add_u32 s22, s43, 114688
  buffer_load_dwordx4 v7, s[44:47], s22 offen lds
  s_mov_b64 exec, s[30:31]
  s_mov_b32 s22, s29
  s_waitcnt vmcnt(8)
  s_mov_b32 s93, 0x80000
nonce_6:
  v_readfirstlane_b32 s94, v121
  s_sub_u32 s93, s93, 1
  s_cmp_lg_u32 s94, 0
  s_cbranch_scc1 nonce_6_ok
  s_cmp_eq_u32 s93, 0
  s_cbranch_scc1 nonce_6_ok
  buffer_load_dword v121, v78, s[88:91], 0 offen sc1
  s_waitcnt vmcnt(0)
  s_branch nonce_6
nonce_6_ok:
  v_mov_b32 v77, s94
  buffer_store_dwordx2 v[76:77], v78, s[8:11], s23 offen offset:896
  buffer_store_dwordx2 v[76:77], v78, s[8:11], s22 offen offset:0 sc1
  s_mov_b64 exec, -1
  s_branch att0_nokv_r
kvfinV_5:
  v_add_f32 v64, v64, v56
  v_add_f32 v65, v65, v57
  v_add_f32 v66, v66, v58
  v_add_f32 v67, v67, v59
  v_add_f32 v68, v68, v60
  v_add_f32 v69, v69, v61
  v_add_f32 v70, v70, v62
  v_add_f32 v71, v71, v63
  v_mul_f32 v64, v64, v122
  v_mul_f32 v65, v65, v122
  v_mul_f32 v66, v66, v122
  v_mul_f32 v67, v67, v122
  v_mul_f32 v68, v68, v122
  v_mul_f32 v69, v69, v122
  v_mul_f32 v70, v70, v122
  v_mul_f32 v71, v71, v122
  v_cvt_pk_bf16_f32 v72, v64, v65
  v_cvt_pk_bf16_f32 v73, v66, v67
  v_cvt_pk_bf16_f32 v74, v68, v69
  v_cvt_pk_bf16_f32 v75, v70, v71
  v_lshlrev_b32 v5, 5, v3
  v_lshl_add_u32 v5, v4, 3, v5
  ds_write_b64 v5, v[72:73] offset:4096
  ds_write_b64 v5, v[74:75] offset:4112
  v_lshlrev_b32 v6, 9, v4
  v_bfe_u32 v7, v1, 4, 1
  v_lshl_add_u32 v6, v7, 7, v6
  v_bfe_u32 v7, v1, 2, 2
  v_lshl_add_u32 v6, v7, 5, v6
  v_and_b32 v7, 3, v1
  v_lshl_add_u32 v6, v7, 3, v6
  v_max3_f32 v76, abs(v64), abs(v65), abs(v66)
  v_max3_f32 v76, abs(v67), abs(v68), v76
  v_max3_f32 v76, abs(v69), abs(v70), v76
  v_max_f32 v76, v76, abs(v71)
  s_waitcnt lgkmcnt(0)
  ds_read_b64_tr_b16 v[80:81], v6 offset:4096
  ds_read_b64_tr_b16 v[82:83], v6 offset:4352
  s_nop 1
  v_max_f32_dpp v76, v76, v76 row_shr:1 row_mask:0xf bank_mask:0xf
  s_nop 1
  v_max_f32_dpp v76, v76, v76 row_shr:2 row_mask:0xf bank_mask:0xf
  s_nop 1
  v_max_f32_dpp v76, v76, v76 row_shr:4 row_mask:0xf bank_mask:0xf
  s_nop 1
  v_max_f32_dpp v76, v76, v76 row_shr:8 row_mask:0xf bank_mask:0xf
  s_nop 1
  v_max_f32_dpp v76, v76, v76 row_bcast:15 row_mask:0xa bank_mask:0xf
  s_nop 1
  v_max_f32_dpp v76, v76, v76 row_bcast:31 row_mask:0xc bank_mask:0xf
  s_add_u32 s21, s21, 65536
  s_waitcnt lgkmcnt(0)
  buffer_store_dwordx4 v[80:83], v2, s[8:11], s21 offen sc1
  v_mov_b32 v78, 0
  s_mov_b32 s24, 0
  s_mov_b32 s25, 0x80000000
  s_mov_b64 exec, s[24:25]
  s_mov_b64 s[30:31], exec
  s_mov_b32 s29, s22
  s_mov_b64 exec, -1
  v_mov_b32 v7, v116
  s_add_u32 m0, s42, 0
  s_add_u32 s22, s43, 0
  buffer_load_dwordx4 v7, s[44:47], s22 offen lds
  s_add_u32 m0, s42, 1024
  s_add_u32 s22, s43, 16384
  buffer_load_dwordx4 v7, s[44:47], s22 offen lds
  s_add_u32 m0, s42, 2048
  s_add_u32 s22, s43, 32768
  buffer_load_dwordx4 v7, s[44:47], s22 offen lds
  s_add_u32 m0, s42, 3072
  s_add_u32 s22, s43, 49152
  buffer_load_dwordx4 v7, s[44:47], s22 offen lds
  s_add_u32 m0, s42, 4096
  s_add_u32 s22, s43, 65536
  buffer_load_dwordx4 v7, s[44:47], s22 offen lds
  s_add_u32 m0, s42, 5120
  s_add_u32 s22, s43, 81920
  buffer_load_dwordx4 v7, s[44:47], s22 offen lds
  s_add_u32 m0, s42, 6144
  s_add_u32 s22, s43, 98304
  buffer_load_dwordx4 v7, s[44:47], s22 offen lds
  s_add_u32 m0, s42, 7168
  s_add_u32 s22, s43, 114688
  buffer_load_dwordx4 v7, s[44:47], s22 offen lds
  s_mov_b64 exec, s[30:31]
  s_mov_b32 s22, s29
  s_waitcnt vmcnt(8)
  s_mov_b32 s93, 0x80000
nonce_7:
  v_readfirstlane_b32 s94, v121
  s_sub_u32 s93, s93, 1
  s_cmp_lg_u32 s94, 0
  s_cbranch_scc1 nonce_7_ok
  s_cmp_eq_u32 s93, 0
  s_cbranch_scc1 nonce_7_ok
  buffer_load_dword v121, v78, s[88:91], 0 offen sc1
  s_waitcnt vmcnt(0)
  s_branch nonce_7
nonce_7_ok:
  v_mov_b32 v77, s94
  buffer_store_dwordx2 v[76:77], v78, s[8:11], s23 offen offset:904
  buffer_store_dwordx2 v[76:77], v78, s[8:11], s22 offen offset:8 sc1
  s_mov_b64 exec, -1
  s_branch att0_nokv_r
att0_nokv_r:
  s_waitcnt vmcnt(7)
  ds_read_b64_tr_b16 v[144:145], v123 offset:0
  ds_read_b64_tr_b16 v[146:147], v123 offset:512
  s_waitcnt vmcnt(6)
  ds_read_b64_tr_b16 v[148:149], v123 offset:1024
  ds_read_b64_tr_b16 v[150:151], v123 offset:1536
  s_waitcnt lgkmcnt(2)
  s_add_u32 m0, s42, 0
  s_add_u32 s22, s43, 131072
  buffer_load_dwordx4 v7, s[44:47], s22 offen lds
  s_waitcnt vmcnt(6)
  ds_read_b64_tr_b16 v[152:153], v123 offset:2048
  ds_read_b64_tr_b16 v[154:155], v123 offset:2560
  s_waitcnt lgkmcnt(2)
  s_add_u32 m0, s42, 1024
  s_add_u32 s22, s43, 147456
  buffer_load_dwordx4 v7, s[44:47], s22 offen lds
  s_waitcnt vmcnt(6)
  ds_read_b64_tr_b16 v[156:157], v123 offset:3072
  ds_read_b64_tr_b16 v[158:159], v123 offset:3584
  s_waitcnt lgkmcnt(2)
  s_add_u32 m0, s42, 2048
  s_add_u32 s22, s43, 163840
  buffer_load_dwordx4 v7, s[44:47], s22 offen lds
  s_waitcnt vmcnt(6)
  ds_read_b64_tr_b16 v[160:161], v123 offset:4096
  ds_read_b64_tr_b16 v[162:163], v123 offset:4608
  s_waitcnt lgkmcnt(2)
  s_add_u32 m0, s42, 3072
  s_add_u32 s22, s43, 180224
  buffer_load_dwordx4 v7, s[44:47], s22 offen lds
  s_waitcnt vmcnt(6)
  ds_read_b64_tr_b16 v[164:165], v123 offset:5120
  ds_read_b64_tr_b16 v[166:167], v123 offset:5632
  s_waitcnt lgkmcnt(2)
  s_add_u32 m0, s42, 4096
  s_add_u32 s22, s43, 196608
  buffer_load_dwordx4 v7, s[44:47], s22 offen lds
  s_waitcnt vmcnt(6)
  ds_read_b64_tr_b16 v[168:169], v123 offset:6144
  ds_read_b64_tr_b16 v[170:171], v123 offset:6656
  s_waitcnt lgkmcnt(2)
  s_add_u32 m0, s42, 5120
  s_add_u32 s22, s43, 212992
  buffer_load_dwordx4 v7, s[44:47], s22 offen lds
  s_waitcnt vmcnt(6)
  ds_read_b64_tr_b16 v[172:173], v123 offset:7168
  ds_read_b64_tr_b16 v[174:175], v123 offset:7680
  s_waitcnt lgkmcnt(2)
  s_add_u32 m0, s42, 6144
  s_add_u32 s22, s43, 229376
  buffer_load_dwordx4 v7, s[44:47], s22 offen lds
  s_waitcnt lgkmcnt(0)
  s_add_u32 m0, s42, 7168
  s_add_u32 s22, s43, 245760
  buffer_load_dwordx4 v7, s[44:47], s22 offen lds
  v_mov_b32 v92, 0x3f803f80
  v_mov_b32 v93, 0x3f803f80
  v_mov_b32 v94, 0x3f803f80
  v_mov_b32 v95, 0x3f803f80
  s_branch att0_nokv_j
att0_nokv:
  s_waitcnt vmcnt(12)
  ds_read_b64_tr_b16 v[144:145], v123 offset:0
  ds_read_b64_tr_b16 v[146:147], v123 offset:512
  s_waitcnt vmcnt(11)
  ds_read_b64_tr_b16 v[148:149], v123 offset:1024
  ds_read_b64_tr_b16 v[150:151], v123 offset:1536
  s_waitcnt lgkmcnt(2)
  s_add_u32 m0, s42, 0
  s_add_u32 s22, s43, 131072
  buffer_load_dwordx4 v7, s[44:47], s22 offen lds
  s_waitcnt vmcnt(11)
  ds_read_b64_tr_b16 v[152:153], v123 offset:2048
  ds_read_b64_tr_b16 v[154:155], v123 offset:2560
  s_waitcnt lgkmcnt(2)
  s_add_u32 m0, s42, 1024
  s_add_u32 s22, s43, 147456
  buffer_load_dwordx4 v7, s[44:47], s22 offen lds
  s_waitcnt vmcnt(11)
  ds_read_b64_tr_b16 v[156:157], v123 offset:3072
  ds_read_b64_tr_b16 v[158:159], v123 offset:3584
  s_waitcnt lgkmcnt(2)
  s_add_u32 m0, s42, 2048
  s_add_u32 s22, s43, 163840
  buffer_load_dwordx4 v7, s[44:47], s22 offen lds
  s_waitcnt vmcnt(11)
  ds_read_b64_tr_b16 v[160:161], v123 offset:4096
  ds_read_b64_tr_b16 v[162:163], v123 offset:4608
  s_waitcnt lgkmcnt(2)
  s_add_u32 m0, s42, 3072
  s_add_u32 s22, s43, 180224
  buffer_load_dwordx4 v7, s[44:47], s22 offen lds
  s_waitcnt vmcnt(11)
  ds_read_b64_tr_b16 v[164:165], v123 offset:5120
  ds_read_b64_tr_b16 v[166:167], v123 offset:5632
  s_waitcnt lgkmcnt(2)
  s_add_u32 m0, s42, 4096
  s_add_u32 s22, s43, 196608
  buffer_load_dwordx4 v7, s[44:47], s22 offen lds
  s_waitcnt vmcnt(11)
  ds_read_b64_tr_b16 v[168:169], v123 offset:6144
  ds_read_b64_tr_b16 v[170:171], v123 offset:6656
  s_waitcnt lgkmcnt(2)
  s_add_u32 m0, s42, 5120
  s_add_u32 s22, s43, 212992
  buffer_load_dwordx4 v7, s[44:47], s22 offen lds
  s_waitcnt vmcnt(11)
  ds_read_b64_tr_b16 v[172:173], v123 offset:7168
  ds_read_b64_tr_b16 v[174:175], v123 offset:7680
  s_waitcnt lgkmcnt(2)
  s_add_u32 m0, s42, 6144
  s_add_u32 s22, s43, 229376
  buffer_load_dwordx4 v7, s[44:47], s22 offen lds
  s_waitcnt lgkmcnt(0)
  s_add_u32 m0, s42, 7168
  s_add_u32 s22, s43, 245760
  buffer_load_dwordx4 v7, s[44:47], s22 offen lds
att0_nokv_j:
  s_waitcnt lgkmcnt(0)
  v_mul_f32 v122, 0x3eb8aa3b, v122
  v_mov_b32 v14, 0
  s_mov_b32 s93, 0x80000
nonce_8:
  v_readfirstlane_b32 s94, v121
  s_sub_u32 s93, s93, 1
  s_cmp_lg_u32 s94, 0
  s_cbranch_scc1 nonce_8_ok
  s_cmp_eq_u32 s93, 0
  s_cbranch_scc1 nonce_8_ok
  buffer_load_dword v121, v14, s[88:91], 0 offen sc1
  s_waitcnt vmcnt(0)
  s_branch nonce_8
nonce_8_ok:
  v_xor_b32 v32, 0, v10
  ds_read_b64 v[48:49], v32 offset:0
  v_xor_b32 v33, 16, v10
  ds_read_b64 v[50:51], v33 offset:0
  v_xor_b32 v34, 32, v10
  ds_read_b64 v[52:53], v34 offset:0
  v_xor_b32 v35, 48, v10
  ds_read_b64 v[54:55], v35 offset:0
  v_xor_b32 v32, 64, v10
  ds_read_b64 v[56:57], v32 offset:0
  v_xor_b32 v33, 80, v10
  ds_read_b64 v[58:59], v33 offset:0
  v_xor_b32 v34, 96, v10
  ds_read_b64 v[60:61], v34 offset:0
  v_xor_b32 v35, 112, v10
  ds_read_b64 v[62:63], v35 offset:0
  s_waitcnt lgkmcnt(6)
  v_mfma_f32_32x32x16_bf16 v[16:31], v[144:147], v[48:51], 0
  v_mfma_f32_32x32x16_bf16 v[64:79], v[92:95], v[144:147], 0
  v_xor_b32 v32, 128, v10
  ds_read_b64 v[48:49], v32 offset:0
  v_xor_b32 v33, 144, v10
  ds_read_b64 v[50:51], v33 offset:0
  s_waitcnt lgkmcnt(6)
  v_mfma_f32_32x32x16_bf16 v[16:31], v[148:151], v[52:55], v[16:31]
  v_mfma_f32_32x32x16_bf16 v[64:79], v[92:95], v[148:151], v[64:79]
  v_xor_b32 v34, 160, v10
  ds_read_b64 v[52:53], v34 offset:0
  v_xor_b32 v35, 176, v10
  ds_read_b64 v[54:55], v35 offset:0
  s_waitcnt lgkmcnt(6)
  v_mfma_f32_32x32x16_bf16 v[16:31], v[152:155], v[56:59], v[16:31]
  v_mfma_f32_32x32x16_bf16 v[64:79], v[92:95], v[152:155], v[64:79]
  v_xor_b32 v32, 192, v10
  ds_read_b64 v[56:57], v32 offset:0
  v_xor_b32 v33, 208, v10
  ds_read_b64 v[58:59], v33 offset:0
  s_waitcnt lgkmcnt(6)
  v_mfma_f32_32x32x16_bf16 v[16:31], v[156:159], v[60:63], v[16:31]
  v_mfma_f32_32x32x16_bf16 v[64:79], v[92:95], v[156:159], v[64:79]
  v_xor_b32 v34, 224, v10
  ds_read_b64 v[60:61], v34 offset:0
  v_xor_b32 v35, 240, v10
  ds_read_b64 v[62:63], v35 offset:0
  s_waitcnt lgkmcnt(6)
  v_mfma_f32_32x32x16_bf16 v[16:31], v[160:163], v[48:51], v[16:31]
  v_mfma_f32_32x32x16_bf16 v[64:79], v[92:95], v[160:163], v[64:79]
  v_xor_b32 v32, 0, v10
  ds_read_b64 v[48:49], v32 offset:256
  v_xor_b32 v33, 16, v10
  ds_read_b64 v[50:51], v33 offset:256
  s_waitcnt lgkmcnt(6)
  v_mfma_f32_32x32x16_bf16 v[16:31], v[164:167], v[52:55], v[16:31]
  v_mfma_f32_32x32x16_bf16 v[64:79], v[92:95], v[164:167], v[64:79]
  s_waitcnt vmcnt(7)
  ds_read_b64_tr_b16 v[176:177], v123 offset:0
  ds_read_b64_tr_b16 v[178:179], v123 offset:512
  v_xor_b32 v34, 32, v10
  ds_read_b64 v[52:53], v34 offset:256
  v_xor_b32 v35, 48, v10
  ds_read_b64 v[54:55], v35 offset:256
  s_waitcnt lgkmcnt(8)
  v_mfma_f32_32x32x16_bf16 v[16:31], v[168:171], v[56:59], v[16:31]
  v_mfma_f32_32x32x16_bf16 v[64:79], v[92:95], v[168:171], v[64:79]
  s_waitcnt vmcnt(6)
  ds_read_b64_tr_b16 v[180:181], v123 offset:1024
  ds_read_b64_tr_b16 v[182:183], v123 offset:1536
  v_xor_b32 v32, 64, v10
  ds_read_b64 v[56:57], v32 offset:256
  v_xor_b32 v33, 80, v10
  ds_read_b64 v[58:59], v33 offset:256
  s_waitcnt lgkmcnt(10)
  v_mfma_f32_32x32x16_bf16 v[16:31], v[172:175], v[60:63], v[16:31]
  v_mfma_f32_32x32x16_bf16 v[64:79], v[92:95], v[172:175], v[64:79]
  s_waitcnt vmcnt(5)
  ds_read_b64_tr_b16 v[184:185], v123 offset:2048
  ds_read_b64_tr_b16 v[186:187], v123 offset:2560
  v_xor_b32 v34, 96, v10
  ds_read_b64 v[60:61], v34 offset:256
  v_xor_b32 v35, 112, v10
  ds_read_b64 v[62:63], v35 offset:256
  s_waitcnt lgkmcnt(10)
  v_mfma_f32_32x32x16_bf16 v[16:31], v[176:179], v[48:51], v[16:31]
  v_mfma_f32_32x32x16_bf16 v[64:79], v[92:95], v[176:179], v[64:79]
  s_waitcnt vmcnt(4)
  ds_read_b64_tr_b16 v[188:189], v123 offset:3072
  ds_read_b64_tr_b16 v[190:191], v123 offset:3584
  v_xor_b32 v32, 128, v10
  ds_read_b64 v[48:49], v32 offset:256
  v_xor_b32 v33, 144, v10
  ds_read_b64 v[50:51], v33 offset:256
  s_waitcnt lgkmcnt(10)
  v_mfma_f32_32x32x16_bf16 v[16:31], v[180:183], v[52:55], v[16:31]
  v_mfma_f32_32x32x16_bf16 v[64:79], v[92:95], v[180:183], v[64:79]
  s_waitcnt vmcnt(3)
  ds_read_b64_tr_b16 v[192:193], v123 offset:4096
  ds_read_b64_tr_b16 v[194:195], v123 offset:4608
  v_xor_b32 v34, 160, v10
  ds_read_b64 v[52:53], v34 offset:256
  v_xor_b32 v35, 176, v10
  ds_read_b64 v[54:55], v35 offset:256
  s_waitcnt lgkmcnt(10)
  v_mfma_f32_32x32x16_bf16 v[16:31], v[184:187], v[56:59], v[16:31]
  v_mfma_f32_32x32x16_bf16 v[64:79], v[92:95], v[184:187], v[64:79]
  s_waitcnt vmcnt(2)
  ds_read_b64_tr_b16 v[196:197], v123 offset:5120
  ds_read_b64_tr_b16 v[198:199], v123 offset:5632
  v_xor_b32 v32, 192, v10
  ds_read_b64 v[56:57], v32 offset:256
  v_xor_b32 v33, 208, v10
  ds_read_b64 v[58:59], v33 offset:256
  s_waitcnt lgkmcnt(10)
  v_mfma_f32_32x32x16_bf16 v[16:31], v[188:191], v[60:63], v[16:31]
  v_mfma_f32_32x32x16_bf16 v[64:79], v[92:95], v[188:191], v[64:79]
  s_waitcnt vmcnt(1)
  ds_read_b64_tr_b16 v[200:201], v123 offset:6144
  ds_read_b64_tr_b16 v[202:203], v123 offset:6656
  v_xor_b32 v34, 224, v10
  ds_read_b64 v[60:61], v34 offset:256
  v_xor_b32 v35, 240, v10
  ds_read_b64 v[62:63], v35 offset:256
  s_waitcnt lgkmcnt(10)
  v_mfma_f32_32x32x16_bf16 v[16:31], v[192:195], v[48:51], v[16:31]
  v_mfma_f32_32x32x16_bf16 v[64:79], v[92:95], v[192:195], v[64:79]
  s_waitcnt vmcnt(0)
  ds_read_b64_tr_b16 v[204:205], v123 offset:7168
  ds_read_b64_tr_b16 v[206:207], v123 offset:7680
  s_waitcnt lgkmcnt(8)
  v_mfma_f32_32x32x16_bf16 v[16:31], v[196:199], v[52:55], v[16:31]
  v_mfma_f32_32x32x16_bf16 v[64:79], v[92:95], v[196:199], v[64:79]
  s_waitcnt lgkmcnt(4)
  v_mfma_f32_32x32x16_bf16 v[16:31], v[200:203], v[56:59], v[16:31]
  v_mfma_f32_32x32x16_bf16 v[64:79], v[92:95], v[200:203], v[64:79]
  s_waitcnt lgkmcnt(0)
  v_mfma_f32_32x32x16_bf16 v[16:31], v[204:207], v[60:63], v[16:31]
  v_mfma_f32_32x32x16_bf16 v[64:79], v[92:95], v[204:207], v[64:79]
  v_and_b32 v7, 27, v3
  v_cmp_eq_u32 vcc, 0, v7
  v_mov_b32 v7, 0x3f803f80
  s_mov_b32 s20, 0xffff0000
  s_mov_b32 s21, 0xffff0000
  v_cndmask_b32 v7, 0, v7, vcc
  v_mov_b32 v104, v7
  v_mov_b32 v105, v7
  v_mov_b32 v106, v7
  v_mov_b32 v107, v7
  v_mov_b32 v108, v7
  v_mov_b32 v109, v7
  v_mov_b32 v110, v7
  v_mov_b32 v111, v7
  v_mov_b32 v112, v7
  v_mov_b32 v113, v7
  v_mov_b32 v114, v7
  v_mov_b32 v115, v7
  v_mov_b32 v116, v7
  v_mov_b32 v117, v7
  v_mov_b32 v118, v7
  v_mov_b32 v119, v7
  v_cmp_eq_u32 vcc, 0, v4
  v_mov_b32 v210, 0
  v_mov_b32 v211, 0
  v_cndmask_b32 v12, 0, v64, vcc
  v_and_b32 v13, 0xffff0000, v12
  v_sub_f32 v14, v12, v13
  v_cvt_pk_bf16_f32 v208, v13, v14
  v_cvt_pk_bf16_f32 v209, v13, 0
  v_mov_b32 v14, 0
  s_nop 0
  v_mfma_f32_32x32x16_bf16 v[16:31], v[208:211], v[36:39], v[16:31]
  s_cmp_eq_u32 s51, 0
  s_cbranch_scc1 nowu_9
  ds_read_b64_tr_b16 v[216:217], v129
  ds_read_b64_tr_b16 v[218:219], v129 offset:1024
  ds_read_b64_tr_b16 v[220:221], v130
  ds_read_b64_tr_b16 v[222:223], v130 offset:1024
  ds_read_b64_tr_b16 v[224:225], v131
  ds_read_b64_tr_b16 v[226:227], v131 offset:1024
  ds_read_b64_tr_b16 v[228:229], v132
  ds_read_b64_tr_b16 v[230:231], v132 offset:1024
  v_mov_b32 v236, 0x3f803f80
  v_mov_b32 v232, 0
  v_mov_b32 v233, 0
  v_mov_b32 v234, 0
  v_mov_b32 v235, 0
  v_lshlrev_b32 v237, 2, v1
  s_lshl_b32 s22, s14, 10
  s_add_u32 s22, s22, 73728
  v_add_u32 v237, s22, v237
  s_waitcnt lgkmcnt(0)
  v_dot2c_f32_bf16 v232, v216, v236
  v_dot2c_f32_bf16 v233, v220, v236
  v_dot2c_f32_bf16 v234, v224, v236
  v_dot2c_f32_bf16 v235, v228, v236
  v_dot2c_f32_bf16 v232, v217, v236
  v_dot2c_f32_bf16 v233, v221, v236
  v_dot2c_f32_bf16 v234, v225, v236
  v_dot2c_f32_bf16 v235, v229, v236
  v_dot2c_f32_bf16 v232, v218, v236
  v_dot2c_f32_bf16 v233, v222, v236
  v_dot2c_f32_bf16 v234, v226, v236
  v_dot2c_f32_bf16 v235, v230, v236
  v_dot2c_f32_bf16 v232, v219, v236
  v_dot2c_f32_bf16 v233, v223, v236
  v_dot2c_f32_bf16 v234, v227, v236
  v_dot2c_f32_bf16 v235, v231, v236
  s_nop 2
  ds_write_b32 v237, v232 offset:0
  ds_write_b32 v237, v233 offset:256
  ds_write_b32 v237, v234 offset:512
  ds_write_b32 v237, v235 offset:768
nowu_9:
  s_cmp_lg_u32 s14, 0
  s_cbranch_scc1 att0_gw
  v_mov_b32 v13, 94208
  v_mov_b32 v12, 0
  ds_write_b32 v13, v12 offset:20
  v_and_b32 v12, 7, v1
  v_lshlrev_b32 v12, 4, v12
  s_add_u32 s28, s98, 896
  s_mov_b32 s93, 64
att0_gw_loc:
  buffer_load_dwordx4 v[32:35], v12, s[8:11], s28 offen sc1
  s_sub_u32 s93, s93, 1
  s_waitcnt vmcnt(0)
  v_cmp_ne_u32 s[24:25], s94, v33
  v_cmp_ne_u32 vcc, s94, v35
  s_or_b64 vcc, vcc, s[24:25]
  s_cmp_eq_u32 s93, 0
  s_cbranch_scc1 att0_gw_loc_x
  s_cbranch_vccz att0_gw_loc_x
  s_branch att0_gw_loc
att0_gw_loc_x:
  s_cbranch_vccnz att0_gw_far
  v_max_u32_dpp v32, v32, v32 row_shr:1 row_mask:0xf bank_mask:0xf
  v_max_u32_dpp v34, v34, v34 row_shr:1 row_mask:0xf bank_mask:0xf
  s_nop 0
  v_max_u32_dpp v32, v32, v32 row_shr:2 row_mask:0xf bank_mask:0xf
  v_max_u32_dpp v34, v34, v34 row_shr:2 row_mask:0xf bank_mask:0xf
  s_nop 0
  v_max_u32_dpp v32, v32, v32 row_shr:4 row_mask:0xf bank_mask:0xf
  v_max_u32_dpp v34, v34, v34 row_shr:4 row_mask:0xf bank_mask:0xf
  s_nop 0
  v_max_u32_dpp v32, v32, v32 row_shr:8 row_mask:0xf bank_mask:0xf
  v_max_u32_dpp v34, v34, v34 row_shr:8 row_mask:0xf bank_mask:0xf
  s_nop 0
  v_max_u32_dpp v32, v32, v32 row_bcast:15 row_mask:0xa bank_mask:0xf
  v_max_u32_dpp v34, v34, v34 row_bcast:15 row_mask:0xa bank_mask:0xf
  s_nop 0
  v_max_u32_dpp v32, v32, v32 row_bcast:31 row_mask:0xc bank_mask:0xf
  v_max_u32_dpp v34, v34, v34 row_bcast:31 row_mask:0xc bank_mask:0xf
  s_nop 0
  v_readlane_b32 s22, v32, 63
  v_readlane_b32 s23, v34, 63
  s_nop 1
  v_mov_b32 v32, s22
  v_mov_b32 v34, s23
  s_branch att0_gw_w
att0_gw_far:
  v_mov_b32 v10, 0
  s_getreg_b32 s28, hwreg(HW_REG_XCC_ID, 0, 3)
  s_lshl_b32 s28, s28, 7
  s_add_u32 s28, s28, 6881280
  v_lshlrev_b32 v11, 7, v1
  s_mov_b32 s29, 6815744
  s_mov_b32 s93, 524288
att0_gw_d_p:
  buffer_load_dwordx4 v[32:35], v11, s[8:11], s29 offen sc1
  s_sub_u32 s93, s93, 1
  s_waitcnt vmcnt(0)
  v_cmp_ne_u32 s[24:25], s94, v33
  v_cmp_ne_u32 vcc, s94, v35
  s_or_b64 vcc, vcc, s[24:25]
  s_cmp_eq_u32 s93, 0
  s_cbranch_scc1 att0_gw_d_p_x
  s_cbranch_vccz att0_gw_d_p_x
  s_sleep 1
  s_branch att0_gw_d_p
att0_gw_d_p_x:
  v_max_u32_dpp v32, v32, v32 row_shr:1 row_mask:0xf bank_mask:0xf
  v_max_u32_dpp v34, v34, v34 row_shr:1 row_mask:0xf bank_mask:0xf
  s_nop 0
  v_max_u32_dpp v32, v32, v32 row_shr:2 row_mask:0xf bank_mask:0xf
  v_max_u32_dpp v34, v34, v34 row_shr:2 row_mask:0xf bank_mask:0xf
  s_nop 0
  v_max_u32_dpp v32, v32, v32 row_shr:4 row_mask:0xf bank_mask:0xf
  v_max_u32_dpp v34, v34, v34 row_shr:4 row_mask:0xf bank_mask:0xf
  s_nop 0
  v_max_u32_dpp v32, v32, v32 row_shr:8 row_mask:0xf bank_mask:0xf
  v_max_u32_dpp v34, v34, v34 row_shr:8 row_mask:0xf bank_mask:0xf
  s_nop 0
  v_max_u32_dpp v32, v32, v32 row_bcast:15 row_mask:0xa bank_mask:0xf
  v_max_u32_dpp v34, v34, v34 row_bcast:15 row_mask:0xa bank_mask:0xf
  s_nop 0
  v_max_u32_dpp v32, v32, v32 row_bcast:31 row_mask:0xc bank_mask:0xf
  v_max_u32_dpp v34, v34, v34 row_bcast:31 row_mask:0xc bank_mask:0xf
  s_nop 0
  v_readlane_b32 s22, v32, 63
  v_readlane_b32 s23, v34, 63
  s_nop 1
  v_mov_b32 v32, s22
  v_mov_b32 v34, s23
  s_cmp_eq_u32 s13, 8
  s_cselect_b64 exec, 1, 0
  buffer_store_dwordx4 v[32:35], v10, s[8:11], s28 offen
  s_mov_b64 exec, -1
att0_gw_d_w:
  v_mov_b32 v10, 94224
  ds_write_b128 v10, v[32:35]
att0_gw_w:
  ds_write_b128 v13, v[32:35]
att0_gw:
  s_waitcnt lgkmcnt(0)
  s_barrier
  s_add_u32 s28, s48, 0
  s_and_b32 s28, s28, 7
  s_lshl_b32 s28, s28, 13
  s_add_u32 s28, s28, s27
  s_add_u32 m0, s26, 0
  s_cmp_lt_u32 s39, 2
  s_cselect_b64 exec, -1, 0
  buffer_load_dwordx4 v2, s[8:11], s28 offen lds
  buffer_load_dwordx4 v2, s[8:11], s28 offen offset:1024 lds
  s_add_u32 m0, s26, 16384
  s_add_u32 s28, s28, 65536
  buffer_load_dwordx4 v2, s[8:11], s28 offen lds
  buffer_load_dwordx4 v2, s[8:11], s28 offen offset:1024 lds
  s_mov_b64 exec, -1
  v_lshlrev_b32 v244, 7, v1
  s_mov_b32 s29, 6815744
  s_cmp_eq_u32 s14, 4
  s_cselect_b64 exec, -1, 0
  buffer_load_dwordx4 v[240:243], v244, s[8:11], s29 offen sc1
  s_mov_b64 exec, -1
  v_mov_b32 v13, 94208
  ds_read2_b32 v[120:121], v13 offset0:0 offset1:2
  ds_write_b128 v8, v[16:19] offset:0
  ds_write_b128 v8, v[20:23] offset:1024
  ds_write_b128 v8, v[24:27] offset:2048
  ds_write_b128 v8, v[28:31] offset:3072
  v_mov_b32 v237, 134144
  v_mov_b32 v236, 0
  ds_write_b32 v237, v236
  s_lshl_b32 s22, s38, 1
  s_sub_i32 s22, s51, s22
  s_cmp_lg_u32 s22, 2
  s_cbranch_scc1 cs_10
  v_lshlrev_b32 v237, 2, v3
  s_lshl_b32 s22, s14, 8
  s_add_u32 s22, s22, 73728
  v_add_u32 v237, s22, v237
  ds_read2_b32 v[240:241], v237 offset0:0 offset1:32
  v_add_u32 v237, 1024, v237
  ds_read2_b32 v[242:243], v237 offset0:0 offset1:32
  v_add_u32 v237, 1024, v237
  ds_read2_b32 v[244:245], v237 offset0:0 offset1:32
  v_add_u32 v237, 1024, v237
  ds_read2_b32 v[246:247], v237 offset0:0 offset1:32
  v_add_u32 v237, 1024, v237
  ds_read2_b32 v[248:249], v237 offset0:0 offset1:32
  v_add_u32 v237, 1024, v237
  ds_read2_b32 v[250:251], v237 offset0:0 offset1:32
  v_add_u32 v237, 1024, v237
  ds_read2_b32 v[252:253], v237 offset0:0 offset1:32
  v_add_u32 v237, 1024, v237
  ds_read2_b32 v[254:255], v237 offset0:0 offset1:32
  s_waitcnt lgkmcnt(0)
  v_add_f32 v240, v240, v248
  v_add_f32 v241, v241, v249
  v_add_f32 v242, v242, v250
  v_add_f32 v243, v243, v251
  v_add_f32 v244, v244, v252
  v_add_f32 v245, v245, v253
  v_add_f32 v246, v246, v254
  v_add_f32 v247, v247, v255
  v_add_f32 v240, v240, v244
  v_add_f32 v241, v241, v245
  v_add_f32 v242, v242, v246
  v_add_f32 v243, v243, v247
  v_add_f32 v240, v240, v242
  v_add_f32 v241, v241, v243
  v_add_f32 v240, v240, v241
  v_and_b32 v241, 0xffff0000, v240
  v_sub_f32 v242, v240, v241
  v_cvt_pk_bf16_f32 v244, v241, v242
  v_cvt_pk_bf16_f32 v245, v241, 0
cs_10:
  s_waitcnt lgkmcnt(0)
  s_barrier
  ds_read_b128 v[32:35], v9 offset:0
  ds_read_b128 v[36:39], v9 offset:1024
  ds_read_b128 v[40:43], v9 offset:2048
  ds_read_b128 v[44:47], v9 offset:3072
  s_lshl_b32 s28, s14, 12
  s_add_u32 s29, s28, 131072
  v_add_u32 v8, s29, v2
  s_xor_b32 s29, s29, 16384
  v_add_u32 v9, s29, v2
  s_and_b32 s32, s13, 7
  s_lshl_b32 s32, s32, 3
  s_add_u32 s32, s32, s14
  s_mul_i32 s32, s32, 28672
  s_add_u32 s32, s32, 4915200
  s_and_b32 s46, s13, 7
  s_lshl_b32 s46, s46, 1
  s_and_b32 s47, s14, 1
  s_add_u32 s46, s46, s47
  s_lshl_b32 s46, s46, 2
  s_lshr_b32 s47, s14, 1
  s_add_u32 s46, s46, s47
  s_lshl_b32 s46, s46, 13
  s_add_u32 s46, s46, 589824
  s_add_u32 s47, s46, 4096
  s_waitcnt lgkmcnt(0)
  v_add_f32 v16, v16, v32
  v_add_f32 v17, v17, v33
  v_add_f32 v18, v18, v34
  v_add_f32 v19, v19, v35
  v_add_f32 v20, v20, v36
  v_add_f32 v21, v21, v37
  v_add_f32 v22, v22, v38
  v_add_f32 v23, v23, v39
  v_add_f32 v24, v24, v40
  v_add_f32 v25, v25, v41
  v_add_f32 v26, v26, v42
  v_add_f32 v27, v27, v43
  v_add_f32 v28, v28, v44
  v_add_f32 v29, v29, v45
  v_add_f32 v30, v30, v46
  v_add_f32 v31, v31, v47
  v_mul_f32 v16, v16, v122
  v_mul_f32 v17, v17, v122
  v_mul_f32 v18, v18, v122
  v_mul_f32 v19, v19, v122
  v_mul_f32 v20, v20, v122
  v_mul_f32 v21, v21, v122
  v_mul_f32 v22, v22, v122
  v_mul_f32 v23, v23, v122
  v_mul_f32 v24, v24, v122
  v_mul_f32 v25, v25, v122
  v_mul_f32 v26, v26, v122
  v_mul_f32 v27, v27, v122
  v_mul_f32 v28, v28, v122
  v_mul_f32 v29, v29, v122
  v_mul_f32 v30, v30, v122
  v_mul_f32 v31, v31, v122
  v_cvt_pk_bf16_f32 v80, v16, v17
  v_cvt_pk_bf16_f32 v81, v18, v19
  v_cvt_pk_bf16_f32 v82, v20, v21
  v_cvt_pk_bf16_f32 v83, v22, v23
  v_cvt_pk_bf16_f32 v84, v24, v25
  v_cvt_pk_bf16_f32 v85, v26, v27
  v_cvt_pk_bf16_f32 v86, v28, v29
  v_cvt_pk_bf16_f32 v87, v30, v31
  v_mul_f32 v10, v16, v16
  v_mul_f32 v11, v24, v24
  v_fmac_f32 v10, v17, v17
  v_fmac_f32 v11, v25, v25
  v_fmac_f32 v10, v18, v18
  v_fmac_f32 v11, v26, v26
  v_fmac_f32 v10, v19, v19
  v_fmac_f32 v11, v27, v27
  v_fmac_f32 v10, v20, v20
  v_fmac_f32 v11, v28, v28
  v_fmac_f32 v10, v21, v21
  v_fmac_f32 v11, v29, v29
  v_fmac_f32 v10, v22, v22
  v_fmac_f32 v11, v30, v30
  v_fmac_f32 v10, v23, v23
  v_fmac_f32 v11, v31, v31
  v_mov_b32 v12, v10
  v_mov_b32 v13, v11
  s_nop 1
  v_permlane32_swap_b32 v10, v12
  v_permlane32_swap_b32 v11, v13
  s_nop 1
  v_add_f32 v10, v10, v12
  v_add_f32 v11, v11, v13
  v_max_f32 v10, v10, v11
  v_mov_b32 v122, v10
  v_mov_b32 v12, 0x53800000
  v_cmp_nle_f32 s[30:31], v121, v12
  v_mov_b32 v13, 0x45610000
  v_mul_f32 v12, v120, v122
  v_cmp_nle_f32 vcc, v12, v13
  s_or_b64 s[30:31], s[30:31], vcc
  s_waitcnt vmcnt(1)
  s_barrier
  ds_read_b128 v[96:99], v124
  ds_read_b128 v[100:103], v124 offset:1024
  s_mov_b64 exec, s[20:21]
  ds_read_b128 v[104:107], v125
  ds_read_b128 v[108:111], v125 offset:512
  s_mov_b64 exec, -1
  s_waitcnt lgkmcnt(3)
  v_mfma_f32_32x32x16_bf16 v[16:31], v[96:99], v[80:83], 0
  s_cmp_lg_u64 s[30:31], 0
  s_cbranch_scc1 att0_slow
  s_nop 9
  v_exp_f32 v16, v16
  v_exp_f32 v17, v17
  v_exp_f32 v18, v18
  v_exp_f32 v19, v19
  v_exp_f32 v20, v20
  v_exp_f32 v21, v21
  v_mfma_f32_32x32x16_bf16 v[32:47], v[96:99], v[84:87], 0
  s_waitcnt lgkmcnt(0)
  s_cmp_lg_u32 s14, 4
  s_cbranch_scc1 gwp_11
  v_mov_b32 v12, 94224
  ds_read_b32 v13, v12 offset:4
  s_waitcnt lgkmcnt(0)
  v_readfirstlane_b32 s22, v13
  s_cmp_eq_u32 s22, s94
  s_cbranch_scc1 gwp_11
  v_mov_b32 v12, 0
  s_getreg_b32 s28, hwreg(HW_REG_XCC_ID, 0, 3)
  s_lshl_b32 s28, s28, 7
  s_add_u32 s28, s28, 6881280
  s_waitcnt vmcnt(0)
  v_cmp_ne_u32 s[24:25], s94, v241
  v_cmp_ne_u32 vcc, s94, v243
  s_or_b64 vcc, vcc, s[24:25]
  s_cbranch_vccz gwp_11_q_p_x
  s_cmp_eq_u32 s13, 8
  s_cbranch_scc1 gwp_11_q_g
  s_mov_b32 s93, 48
gwp_11_q_l:
  buffer_load_dwordx4 v[240:243], v12, s[8:11], s28 offen sc1
  s_sub_u32 s93, s93, 1
  s_waitcnt vmcnt(0)
  v_cmp_ne_u32 s[24:25], s94, v241
  v_cmp_ne_u32 vcc, s94, v243
  s_or_b64 vcc, vcc, s[24:25]
  s_cmp_eq_u32 s93, 0
  s_cbranch_scc1 gwp_11_q_l_x
  s_cbranch_vccz gwp_11_q_l_x
  s_branch gwp_11_q_l
gwp_11_q_l_x:
  s_cbranch_vccz gwp_11_q_w
gwp_11_q_g:
  v_lshlrev_b32 v13, 7, v1
  s_mov_b32 s29, 6815744
  s_mov_b32 s93, 524288
gwp_11_q_p:
  buffer_load_dwordx4 v[240:243], v13, s[8:11], s29 offen sc1
  s_sub_u32 s93, s93, 1
  s_waitcnt vmcnt(0)
  v_cmp_ne_u32 s[24:25], s94, v241
  v_cmp_ne_u32 vcc, s94, v243
  s_or_b64 vcc, vcc, s[24:25]
  s_cmp_eq_u32 s93, 0
  s_cbranch_scc1 gwp_11_q_p_x
  s_cbranch_vccz gwp_11_q_p_x
  s_sleep 1
  s_branch gwp_11_q_p
gwp_11_q_p_x:
  v_max_u32_dpp v240, v240, v240 row_shr:1 row_mask:0xf bank_mask:0xf
  v_max_u32_dpp v242, v242, v242 row_shr:1 row_mask:0xf bank_mask:0xf
  s_nop 0
  v_max_u32_dpp v240, v240, v240 row_shr:2 row_mask:0xf bank_mask:0xf
  v_max_u32_dpp v242, v242, v242 row_shr:2 row_mask:0xf bank_mask:0xf
  s_nop 0
  v_max_u32_dpp v240, v240, v240 row_shr:4 row_mask:0xf bank_mask:0xf
  v_max_u32_dpp v242, v242, v242 row_shr:4 row_mask:0xf bank_mask:0xf
  s_nop 0
  v_max_u32_dpp v240, v240, v240 row_shr:8 row_mask:0xf bank_mask:0xf
  v_max_u32_dpp v242, v242, v242 row_shr:8 row_mask:0xf bank_mask:0xf
  s_nop 0
  v_max_u32_dpp v240, v240, v240 row_bcast:15 row_mask:0xa bank_mask:0xf
  v_max_u32_dpp v242, v242, v242 row_bcast:15 row_mask:0xa bank_mask:0xf
  s_nop 0
  v_max_u32_dpp v240, v240, v240 row_bcast:31 row_mask:0xc bank_mask:0xf
  v_max_u32_dpp v242, v242, v242 row_bcast:31 row_mask:0xc bank_mask:0xf
  s_nop 0
  v_readlane_b32 s22, v240, 63
  v_readlane_b32 s23, v242, 63
  s_nop 1
  v_mov_b32 v240, s22
  v_mov_b32 v242, s23
  s_cmp_eq_u32 s13, 8
  s_cselect_b64 exec, 1, 0
  buffer_store_dwordx4 v[240:243], v12, s[8:11], s28 offen
  s_mov_b64 exec, -1
gwp_11_q_w:
  v_mov_b32 v12, 94224
  ds_write_b128 v12, v[240:243]
gwp_11:
  s_cmp_lg_u32 s51, 0
  s_cselect_b64 exec, -1, 0
  buffer_store_dwordx4 v[216:219], v2, s[8:11], s60 offen sc1
  buffer_store_dwordx4 v[220:223], v2, s[8:11], s61 offen sc1
  buffer_store_dwordx4 v[224:227], v2, s[8:11], s62 offen sc1
  buffer_store_dwordx4 v[228:231], v2, s[8:11], s63 offen sc1
  s_mov_b64 exec, -1
  v_lshlrev_b32 v237, 4, v3
  s_lshl_b32 s22, s38, 1
  s_sub_i32 s22, s51, s22
  s_cmp_eq_u32 s22, 2
  s_cselect_b64 exec, -1, 0
  buffer_store_dwordx2 v[244:245], v237, s[8:11], s50 offen sc1
  s_mov_b64 exec, -1
  s_cmp_eq_u32 s38, 0
  s_cbranch_scc1 prio_12
  s_setprio 1
prio_12:
  ds_read_b128 v[96:99], v124 offset:2048
  s_mov_b64 exec, s[20:21]
  ds_read_b128 v[112:115], v125 offset:1024
  ds_read_b128 v[116:119], v125 offset:1536
  s_mov_b64 exec, -1
  v_exp_f32 v22, v22
  v_exp_f32 v23, v23
  v_cvt_pk_bf16_f32 v88, v16, v17
  v_cvt_pk_bf16_f32 v89, v18, v19
  v_cvt_pk_bf16_f32 v90, v20, v21
  v_cvt_pk_bf16_f32 v91, v22, v23
  v_exp_f32 v24, v24
  v_exp_f32 v25, v25
  v_mfma_f32_32x32x16_bf16 v[48:63], v[104:107], v[88:91], 0
  v_exp_f32 v26, v26
  v_exp_f32 v27, v27
  v_exp_f32 v28, v28
  v_exp_f32 v29, v29
  v_exp_f32 v30, v30
  v_exp_f32 v31, v31
  v_cvt_pk_bf16_f32 v92, v24, v25
  v_cvt_pk_bf16_f32 v93, v26, v27
  v_cvt_pk_bf16_f32 v94, v28, v29
  v_cvt_pk_bf16_f32 v95, v30, v31
  v_exp_f32 v32, v32
  v_exp_f32 v33, v33
  v_mfma_f32_32x32x16_bf16 v[48:63], v[108:111], v[92:95], v[48:63]
  v_exp_f32 v34, v34
  v_exp_f32 v35, v35
  v_exp_f32 v36, v36
  v_exp_f32 v37, v37
  v_mfma_f32_32x32x16_bf16 v[16:31], v[100:103], v[80:83], 0
  v_exp_f32 v38, v38
  v_exp_f32 v39, v39
  v_cvt_pk_bf16_f32 v88, v32, v33
  v_cvt_pk_bf16_f32 v89, v34, v35
  v_cvt_pk_bf16_f32 v90, v36, v37
  v_cvt_pk_bf16_f32 v91, v38, v39
  v_exp_f32 v40, v40
  v_exp_f32 v41, v41
  v_mfma_f32_32x32x16_bf16 v[64:79], v[104:107], v[88:91], 0
  v_exp_f32 v42, v42
  v_exp_f32 v43, v43
  v_exp_f32 v44, v44
  v_exp_f32 v45, v45
  v_exp_f32 v46, v46
  v_exp_f32 v47, v47
  v_cvt_pk_bf16_f32 v92, v40, v41
  v_cvt_pk_bf16_f32 v93, v42, v43
  v_cvt_pk_bf16_f32 v94, v44, v45
  v_cvt_pk_bf16_f32 v95, v46, v47
  v_exp_f32 v16, v16
  v_exp_f32 v17, v17
  v_mfma_f32_32x32x16_bf16 v[64:79], v[108:111], v[92:95], v[64:79]
  v_exp_f32 v18, v18
  v_exp_f32 v19, v19
  v_exp_f32 v20, v20
  v_exp_f32 v21, v21
  v_mfma_f32_32x32x16_bf16 v[32:47], v[100:103], v[84:87], 0
  s_waitcnt lgkmcnt(0)
  v_mov_b32 v12, 94224
  s_mov_b32 s93, 0x4000000
gww_13:
  ds_read_b32 v13, v12 offset:4
  ds_read2_b32 v[120:121], v12 offset0:0 offset1:2
  s_sub_u32 s93, s93, 1
  s_waitcnt lgkmcnt(0)
  v_readfirstlane_b32 s22, v13
  s_cmp_eq_u32 s93, 0
  s_cbranch_scc1 gww_13_x
  s_cmp_lg_u32 s22, s94
  s_cbranch_scc1 gww_13
gww_13_x:
  v_mov_b32 v12, 0x53800000
  v_cmp_nle_f32 s[30:31], v121, v12
  v_mov_b32 v13, 0x45610000
  v_mul_f32 v12, v120, v122
  v_cmp_nle_f32 vcc, v12, v13
  s_or_b64 s[30:31], s[30:31], vcc
  s_cmp_lg_u64 s[30:31], 0
  s_cbranch_scc1 att0_slow
  s_add_u32 s28, s48, 0
  s_and_b32 s28, s28, 7
  s_lshl_b32 s28, s28, 13
  s_add_u32 s28, s28, s27
  s_add_u32 m0, s26, 0
  s_cmp_lt_u32 s39, 2
  s_cselect_b64 exec, 0, -1
  buffer_load_dwordx4 v2, s[8:11], s28 offen lds
  buffer_load_dwordx4 v2, s[8:11], s28 offen offset:1024 lds
  s_add_u32 m0, s26, 16384
  s_add_u32 s28, s28, 65536
  buffer_load_dwordx4 v2, s[8:11], s28 offen lds
  buffer_load_dwordx4 v2, s[8:11], s28 offen offset:1024 lds
  s_mov_b64 exec, -1
  s_add_u32 s28, s48, 2
  s_and_b32 s28, s28, 7
  s_lshl_b32 s28, s28, 13
  s_add_u32 s28, s28, s27
  s_add_u32 m0, s26, 32768
  s_nop 0
  buffer_load_dwordx4 v2, s[8:11], s28 offen lds
  buffer_load_dwordx4 v2, s[8:11], s28 offen offset:1024 lds
  s_add_u32 m0, s26, 49152
  s_add_u32 s28, s28, 65536
  buffer_load_dwordx4 v2, s[8:11], s28 offen lds
  buffer_load_dwordx4 v2, s[8:11], s28 offen offset:1024 lds
  ds_read_b128 v[100:103], v124 offset:3072
  s_mov_b64 exec, s[20:21]
  ds_read_b128 v[104:107], v125 offset:2048
  ds_read_b128 v[108:111], v125 offset:2560
  s_mov_b64 exec, -1
  v_exp_f32 v22, v22
  v_exp_f32 v23, v23
  v_cvt_pk_bf16_f32 v88, v16, v17
  v_cvt_pk_bf16_f32 v89, v18, v19
  v_cvt_pk_bf16_f32 v90, v20, v21
  v_cvt_pk_bf16_f32 v91, v22, v23
  v_exp_f32 v24, v24
  v_exp_f32 v25, v25
  v_mfma_f32_32x32x16_bf16 v[48:63], v[112:115], v[88:91], v[48:63]
  v_exp_f32 v26, v26
  v_exp_f32 v27, v27
  v_exp_f32 v28, v28
  v_exp_f32 v29, v29
  v_exp_f32 v30, v30
  v_exp_f32 v31, v31
  v_cvt_pk_bf16_f32 v92, v24, v25
  v_cvt_pk_bf16_f32 v93, v26, v27
  v_cvt_pk_bf16_f32 v94, v28, v29
  v_cvt_pk_bf16_f32 v95, v30, v31
  v_exp_f32 v32, v32
  v_exp_f32 v33, v33
  v_mfma_f32_32x32x16_bf16 v[48:63], v[116:119], v[92:95], v[48:63]
  v_exp_f32 v34, v34
  v_exp_f32 v35, v35
  v_exp_f32 v36, v36
  v_exp_f32 v37, v37
  v_mfma_f32_32x32x16_bf16 v[16:31], v[96:99], v[80:83], 0
  v_exp_f32 v38, v38
  v_exp_f32 v39, v39
  v_cvt_pk_bf16_f32 v88, v32, v33
  v_cvt_pk_bf16_f32 v89, v34, v35
  v_cvt_pk_bf16_f32 v90, v36, v37
  v_cvt_pk_bf16_f32 v91, v38, v39
  v_exp_f32 v40, v40
  v_exp_f32 v41, v41
  v_mfma_f32_32x32x16_bf16 v[64:79], v[112:115], v[88:91], v[64:79]
  v_exp_f32 v42, v42
  v_exp_f32 v43, v43
  v_exp_f32 v44, v44
  v_exp_f32 v45, v45
  v_exp_f32 v46, v46
  v_exp_f32 v47, v47
  v_cvt_pk_bf16_f32 v92, v40, v41
  v_cvt_pk_bf16_f32 v93, v42, v43
  v_cvt_pk_bf16_f32 v94, v44, v45
  v_cvt_pk_bf16_f32 v95, v46, v47
  v_exp_f32 v16, v16
  v_exp_f32 v17, v17
  v_mfma_f32_32x32x16_bf16 v[64:79], v[116:119], v[92:95], v[64:79]
  v_exp_f32 v18, v18
  v_exp_f32 v19, v19
  v_exp_f32 v20, v20
  v_exp_f32 v21, v21
  v_mfma_f32_32x32x16_bf16 v[32:47], v[96:99], v[84:87], 0
  s_waitcnt lgkmcnt(0)
  s_and_b32 s22, s13, 7
  s_cbranch_scc1 qsave_14
  s_add_u32 s22, s40, 0
  buffer_store_dwordx4 v[144:147], v2, s[8:11], s22 offen offset:0 sc1
  buffer_store_dwordx4 v[148:151], v2, s[8:11], s22 offen offset:1024 sc1
qsave_14:
  s_mov_b64 exec, s[20:21]
  ds_read_b128 v[112:115], v125 offset:3072
  ds_read_b128 v[116:119], v125 offset:3584
  s_mov_b64 exec, -1
  v_exp_f32 v22, v22
  v_exp_f32 v23, v23
  v_cvt_pk_bf16_f32 v88, v16, v17
  v_cvt_pk_bf16_f32 v89, v18, v19
  v_cvt_pk_bf16_f32 v90, v20, v21
  v_cvt_pk_bf16_f32 v91, v22, v23
  v_exp_f32 v24, v24
  v_exp_f32 v25, v25
  v_mfma_f32_32x32x16_bf16 v[48:63], v[104:107], v[88:91], v[48:63]
  v_exp_f32 v26, v26
  v_exp_f32 v27, v27
  v_exp_f32 v28, v28
  v_exp_f32 v29, v29
  v_exp_f32 v30, v30
  v_exp_f32 v31, v31
  v_cvt_pk_bf16_f32 v92, v24, v25
  v_cvt_pk_bf16_f32 v93, v26, v27
  v_cvt_pk_bf16_f32 v94, v28, v29
  v_cvt_pk_bf16_f32 v95, v30, v31
  v_exp_f32 v32, v32
  v_exp_f32 v33, v33
  v_mfma_f32_32x32x16_bf16 v[48:63], v[108:111], v[92:95], v[48:63]
  v_exp_f32 v34, v34
  v_exp_f32 v35, v35
  v_exp_f32 v36, v36
  v_exp_f32 v37, v37
  v_mfma_f32_32x32x16_bf16 v[16:31], v[100:103], v[80:83], 0
  v_exp_f32 v38, v38
  v_exp_f32 v39, v39
  v_cvt_pk_bf16_f32 v88, v32, v33
  v_cvt_pk_bf16_f32 v89, v34, v35
  v_cvt_pk_bf16_f32 v90, v36, v37
  v_cvt_pk_bf16_f32 v91, v38, v39
  v_exp_f32 v40, v40
  v_exp_f32 v41, v41
  v_mfma_f32_32x32x16_bf16 v[64:79], v[104:107], v[88:91], v[64:79]
  v_exp_f32 v42, v42
  v_exp_f32 v43, v43
  v_exp_f32 v44, v44
  v_exp_f32 v45, v45
  v_exp_f32 v46, v46
  v_exp_f32 v47, v47
  v_cvt_pk_bf16_f32 v92, v40, v41
  v_cvt_pk_bf16_f32 v93, v42, v43
  v_cvt_pk_bf16_f32 v94, v44, v45
  v_cvt_pk_bf16_f32 v95, v46, v47
  v_exp_f32 v16, v16
  v_exp_f32 v17, v17
  v_mfma_f32_32x32x16_bf16 v[64:79], v[108:111], v[92:95], v[64:79]
  v_exp_f32 v18, v18
  v_exp_f32 v19, v19
  v_exp_f32 v20, v20
  v_exp_f32 v21, v21
  v_mfma_f32_32x32x16_bf16 v[32:47], v[100:103], v[84:87], 0
  s_waitcnt lgkmcnt(0)
  s_waitcnt vmcnt(4)
  s_barrier
  s_and_b32 s22, s13, 7
  s_cbranch_scc1 qsave_15
  s_add_u32 s22, s40, 2048
  buffer_store_dwordx4 v[152:155], v2, s[8:11], s22 offen offset:0 sc1
  buffer_store_dwordx4 v[156:159], v2, s[8:11], s22 offen offset:1024 sc1
qsave_15:
  ds_read_b128 v[96:99], v124 offset:4096
  ds_read_b128 v[100:103], v124 offset:5120
  s_mov_b64 exec, s[20:21]
  ds_read_b128 v[104:107], v125 offset:4096
  ds_read_b128 v[108:111], v125 offset:4608
  s_mov_b64 exec, -1
  v_exp_f32 v22, v22
  v_exp_f32 v23, v23
  v_cvt_pk_bf16_f32 v88, v16, v17
  v_cvt_pk_bf16_f32 v89, v18, v19
  v_cvt_pk_bf16_f32 v90, v20, v21
  v_cvt_pk_bf16_f32 v91, v22, v23
  v_exp_f32 v24, v24
  v_exp_f32 v25, v25
  v_mfma_f32_32x32x16_bf16 v[48:63], v[112:115], v[88:91], v[48:63]
  v_exp_f32 v26, v26
  v_exp_f32 v27, v27
  v_exp_f32 v28, v28
  v_exp_f32 v29, v29
  v_exp_f32 v30, v30
  v_exp_f32 v31, v31
  v_cvt_pk_bf16_f32 v92, v24, v25
  v_cvt_pk_bf16_f32 v93, v26, v27
  v_cvt_pk_bf16_f32 v94, v28, v29
  v_cvt_pk_bf16_f32 v95, v30, v31
  v_exp_f32 v32, v32
  v_exp_f32 v33, v33
  v_mfma_f32_32x32x16_bf16 v[48:63], v[116:119], v[92:95], v[48:63]
  v_exp_f32 v34, v34
  v_exp_f32 v35, v35
  v_exp_f32 v36, v36
  v_exp_f32 v37, v37
  s_waitcnt lgkmcnt(3)
  v_mfma_f32_32x32x16_bf16 v[16:31], v[96:99], v[80:83], 0
  v_exp_f32 v38, v38
  v_exp_f32 v39, v39
  v_cvt_pk_bf16_f32 v88, v32, v33
  v_cvt_pk_bf16_f32 v89, v34, v35
  v_cvt_pk_bf16_f32 v90, v36, v37
  v_cvt_pk_bf16_f32 v91, v38, v39
  v_exp_f32 v40, v40
  v_exp_f32 v41, v41
  v_mfma_f32_32x32x16_bf16 v[64:79], v[112:115], v[88:91], v[64:79]
  v_exp_f32 v42, v42
  v_exp_f32 v43, v43
  v_exp_f32 v44, v44
  v_exp_f32 v45, v45
  v_exp_f32 v46, v46
  v_exp_f32 v47, v47
  v_cvt_pk_bf16_f32 v92, v40, v41
  v_cvt_pk_bf16_f32 v93, v42, v43
  v_cvt_pk_bf16_f32 v94, v44, v45
  v_cvt_pk_bf16_f32 v95, v46, v47
  v_exp_f32 v16, v16
  v_exp_f32 v17, v17
  v_mfma_f32_32x32x16_bf16 v[64:79], v[116:119], v[92:95], v[64:79]
  v_exp_f32 v18, v18
  v_exp_f32 v19, v19
  v_exp_f32 v20, v20
  v_exp_f32 v21, v21
  v_mfma_f32_32x32x16_bf16 v[32:47], v[96:99], v[84:87], 0
  s_waitcnt lgkmcnt(0)
  s_and_b32 s22, s13, 7
  s_cbranch_scc1 qsave_16
  s_add_u32 s22, s40, 4096
  buffer_store_dwordx4 v[160:163], v2, s[8:11], s22 offen offset:0 sc1
  buffer_store_dwordx4 v[164:167], v2, s[8:11], s22 offen offset:1024 sc1
qsave_16:
  s_cmp_lg_u32 s14, 5
  s_cbranch_scc1 wf_17
  v_mov_b32 v237, 0
  v_mov_b32 v232, s95
  v_mov_b32 v233, s94
  s_lshl_b32 s23, s2, 7
  s_add_u32 s23, s23, 6848512
  s_mov_b64 exec, 1
  buffer_store_dwordx2 v[232:233], v237, s[8:11], s23 offen sc1
  s_mov_b64 exec, -1
wf_17:
  s_and_b32 s16, s13, 7
  s_lshr_b32 s15, s13, 3
  s_lshl_b32 s15, s15, 1
  s_lshl_b32 s19, s12, 3
  s_add_u32 s15, s15, s19
  s_and_b32 s18, s14, 1
  s_lshr_b32 s17, s14, 1
  s_lshr_b32 s49, s14, 2
  s_and_b32 s48, s17, 1
  s_add_u32 s20, s15, s49
  s_lshl_b32 s21, s16, 1
  s_and_b32 s19, s14, 1
  s_add_u32 s21, s21, s19
  s_lshl_b32 s21, s21, 1
  s_add_u32 s21, s21, s48
  s_lshl_b32 s19, s20, 5
  s_add_u32 s19, s19, s21
  s_lshl_b32 s19, s19, 10
  s_mov_b32 s20, 0xffff0000
  s_mov_b32 s21, 0xffff0000
  s_lshl_b32 s22, s36, 5
  s_lshl_b32 s23, s37, 1
  s_add_u32 s22, s22, s23
  s_add_u32 s22, s22, s38
  s_lshl_b32 s22, s22, 10
  s_add_u32 s22, s22, 16777216
  s_lshr_b32 s25, s13, 4
  s_lshl_b32 s24, s25, 2
  s_xor_b32 s24, s24, s14
  s_lshl_b32 s23, s12, 3
  s_add_u32 s24, s24, s23
  s_mul_i32 s23, s24, 112
  s_and_b32 s24, s13, 15
  s_mul_i32 s24, s24, 7
  s_add_u32 s23, s23, s24
  s_mul_i32 s24, s25, 3
  s_add_u32 s23, s23, s24
  s_and_b32 s24, s25, s38
  s_add_u32 s23, s23, s24
  s_lshl_b32 s23, s23, 10
  s_add_u32 s23, s23, 20967424
  s_add_u32 s24, s19, 9436160
  s_add_u32 s25, s19, 11532288
  v_lshrrev_b32 v12, 3, v1
  v_mov_b32 v13, s22
  v_mov_b32 v14, s24
  v_cmp_eq_u32 vcc, 1, v12
  s_sub_u32 s22, s22, 3072
  s_nop 0
  v_cndmask_b32 v13, v13, v14, vcc
  v_mov_b32 v14, s25
  v_cmp_eq_u32 vcc, 2, v12
  s_nop 1
  v_cndmask_b32 v13, v13, v14, vcc
  v_mov_b32 v14, s22
  v_cmp_eq_u32 vcc, 3, v12
  s_nop 1
  v_cndmask_b32 v13, v13, v14, vcc
  v_mov_b32 v14, s23
  v_cmp_lt_u32 vcc, 3, v12
  s_nop 1
  v_cndmask_b32 v13, v13, v14, vcc
  v_lshl_add_u32 v13, v1, 7, v13
  v_mov_b32 v123, v13
  v_mov_b32 v11, v13
  s_lshr_b32 s48, s39, 1
  s_add_u32 s48, s48, s12
  s_mov_b32 exec_lo, 0xff
  s_mov_b32 exec_hi, 0x0
  buffer_load_dword v14, v123, s[8:11], 0 offen sc1
  s_mov_b64 exec, -1
  ds_read_b128 v[96:99], v124 offset:6144
  s_mov_b64 exec, s[20:21]
  ds_read_b128 v[112:115], v125 offset:5120
  ds_read_b128 v[116:119], v125 offset:5632
  s_mov_b64 exec, -1
  v_exp_f32 v22, v22
  v_exp_f32 v23, v23
  v_cvt_pk_bf16_f32 v88, v16, v17
  v_cvt_pk_bf16_f32 v89, v18, v19
  v_cvt_pk_bf16_f32 v90, v20, v21
  v_cvt_pk_bf16_f32 v91, v22, v23
  v_exp_f32 v24, v24
  v_exp_f32 v25, v25
  v_mfma_f32_32x32x16_bf16 v[48:63], v[104:107], v[88:91], v[48:63]
  v_exp_f32 v26, v26
  v_exp_f32 v27, v27
  v_exp_f32 v28, v28
  v_exp_f32 v29, v29
  v_exp_f32 v30, v30
  v_exp_f32 v31, v31
  v_cvt_pk_bf16_f32 v92, v24, v25
  v_cvt_pk_bf16_f32 v93, v26, v27
  v_cvt_pk_bf16_f32 v94, v28, v29
  v_cvt_pk_bf16_f32 v95, v30, v31
  v_exp_f32 v32, v32
  v_exp_f32 v33, v33
  v_mfma_f32_32x32x16_bf16 v[48:63], v[108:111], v[92:95], v[48:63]
  v_exp_f32 v34, v34
  v_exp_f32 v35, v35
  v_exp_f32 v36, v36
  v_exp_f32 v37, v37
  v_mfma_f32_32x32x16_bf16 v[16:31], v[100:103], v[80:83], 0
  v_exp_f32 v38, v38
  v_exp_f32 v39, v39
  v_cvt_pk_bf16_f32 v88, v32, v33
  v_cvt_pk_bf16_f32 v89, v34, v35
  v_cvt_pk_bf16_f32 v90, v36, v37
  v_cvt_pk_bf16_f32 v91, v38, v39
  v_exp_f32 v40, v40
  v_exp_f32 v41, v41
  v_mfma_f32_32x32x16_bf16 v[64:79], v[104:107], v[88:91], v[64:79]
  v_exp_f32 v42, v42
  v_exp_f32 v43, v43
  v_exp_f32 v44, v44
  v_exp_f32 v45, v45
  v_exp_f32 v46, v46
  v_exp_f32 v47, v47
  v_cvt_pk_bf16_f32 v92, v40, v41
  v_cvt_pk_bf16_f32 v93, v42, v43
  v_cvt_pk_bf16_f32 v94, v44, v45
  v_cvt_pk_bf16_f32 v95, v46, v47
  v_exp_f32 v16, v16
  v_exp_f32 v17, v17
  v_mfma_f32_32x32x16_bf16 v[64:79], v[108:111], v[92:95], v[64:79]
  v_exp_f32 v18, v18
  v_exp_f32 v19, v19
  v_exp_f32 v20, v20
  v_exp_f32 v21, v21
  v_mfma_f32_32x32x16_bf16 v[32:47], v[100:103], v[84:87], 0
  s_waitcnt lgkmcnt(0)
  s_and_b32 s22, s13, 7
  s_cbranch_scc1 qsave_18
  s_add_u32 s22, s40, 6144
  buffer_store_dwordx4 v[168:171], v2, s[8:11], s22 offen offset:0 sc1
  buffer_store_dwordx4 v[172:175], v2, s[8:11], s22 offen offset:1024 sc1
qsave_18:
  s_cmp_eq_u32 s38, 0
  s_cbranch_scc1 prio_19
  s_setprio 0
prio_19:
  s_mov_b32 exec_lo, 0xff00
  s_mov_b32 exec_hi, 0x0
  buffer_load_dword v14, v123, s[8:11], 0 offen sc1
  s_mov_b64 exec, -1
  ds_read_b128 v[100:103], v124 offset:7168
  s_mov_b64 exec, s[20:21]
  ds_read_b128 v[104:107], v125 offset:6144
  ds_read_b128 v[108:111], v125 offset:6656
  s_mov_b64 exec, -1
  v_exp_f32 v22, v22
  v_exp_f32 v23, v23
  v_cvt_pk_bf16_f32 v88, v16, v17
  v_cvt_pk_bf16_f32 v89, v18, v19
  v_cvt_pk_bf16_f32 v90, v20, v21
  v_cvt_pk_bf16_f32 v91, v22, v23
  v_exp_f32 v24, v24
  v_exp_f32 v25, v25
  v_mfma_f32_32x32x16_bf16 v[48:63], v[112:115], v[88:91], v[48:63]
  v_exp_f32 v26, v26
  v_exp_f32 v27, v27
  v_exp_f32 v28, v28
  v_exp_f32 v29, v29
  v_exp_f32 v30, v30
  v_exp_f32 v31, v31
  v_cvt_pk_bf16_f32 v92, v24, v25
  v_cvt_pk_bf16_f32 v93, v26, v27
  v_cvt_pk_bf16_f32 v94, v28, v29
  v_cvt_pk_bf16_f32 v95, v30, v31
  v_exp_f32 v32, v32
  v_exp_f32 v33, v33
  v_mfma_f32_32x32x16_bf16 v[48:63], v[116:119], v[92:95], v[48:63]
  v_exp_f32 v34, v34
  v_exp_f32 v35, v35
  v_exp_f32 v36, v36
  v_exp_f32 v37, v37
  v_mfma_f32_32x32x16_bf16 v[16:31], v[96:99], v[80:83], 0
  v_exp_f32 v38, v38
  v_exp_f32 v39, v39
  v_cvt_pk_bf16_f32 v88, v32, v33
  v_cvt_pk_bf16_f32 v89, v34, v35
  v_cvt_pk_bf16_f32 v90, v36, v37
  v_cvt_pk_bf16_f32 v91, v38, v39
  v_exp_f32 v40, v40
  v_exp_f32 v41, v41
  v_mfma_f32_32x32x16_bf16 v[64:79], v[112:115], v[88:91], v[64:79]
  v_exp_f32 v42, v42
  v_exp_f32 v43, v43
  v_exp_f32 v44, v44
  v_exp_f32 v45, v45
  v_exp_f32 v46, v46
  v_exp_f32 v47, v47
  v_cvt_pk_bf16_f32 v92, v40, v41
  v_cvt_pk_bf16_f32 v93, v42, v43
  v_cvt_pk_bf16_f32 v94, v44, v45
  v_cvt_pk_bf16_f32 v95, v46, v47
  v_exp_f32 v16, v16
  v_exp_f32 v17, v17
  v_mfma_f32_32x32x16_bf16 v[64:79], v[116:119], v[92:95], v[64:79]
  v_exp_f32 v18, v18
  v_exp_f32 v19, v19
  v_exp_f32 v20, v20
  v_exp_f32 v21, v21
  v_mfma_f32_32x32x16_bf16 v[32:47], v[96:99], v[84:87], 0
  s_waitcnt lgkmcnt(0)
  s_and_b32 s22, s13, 7
  s_cbranch_scc1 qsave_20
  s_add_u32 s22, s40, 8192
  buffer_store_dwordx4 v[176:179], v2, s[8:11], s22 offen offset:0 sc1
  buffer_store_dwordx4 v[180:183], v2, s[8:11], s22 offen offset:1024 sc1
qsave_20:
  s_cmp_eq_u32 s38, 0
  s_cbranch_scc1 prio_21
  s_setprio 1
prio_21:
  s_waitcnt vmcnt(2)
  s_barrier
  s_add_u32 s28, s48, 4
  s_and_b32 s28, s28, 7
  s_lshl_b32 s28, s28, 13
  s_add_u32 s28, s28, s27
  s_add_u32 m0, s26, 65536
  s_nop 0
  buffer_load_dwordx4 v2, s[8:11], s28 offen lds
  buffer_load_dwordx4 v2, s[8:11], s28 offen offset:1024 lds
  s_add_u32 m0, s26, 81920
  s_add_u32 s28, s28, 65536
  buffer_load_dwordx4 v2, s[8:11], s28 offen lds
  buffer_load_dwordx4 v2, s[8:11], s28 offen offset:1024 lds
  s_mov_b32 exec_lo, 0xff0000
  s_mov_b32 exec_hi, 0x0
  buffer_load_dword v14, v123, s[8:11], 0 offen sc1
  s_mov_b64 exec, -1
  ds_read_b128 v[96:99], v124 offset:32768
  s_mov_b64 exec, s[20:21]
  ds_read_b128 v[112:115], v125 offset:7168
  ds_read_b128 v[116:119], v125 offset:7680
  s_mov_b64 exec, -1
  v_exp_f32 v22, v22
  v_exp_f32 v23, v23
  v_cvt_pk_bf16_f32 v88, v16, v17
  v_cvt_pk_bf16_f32 v89, v18, v19
  v_cvt_pk_bf16_f32 v90, v20, v21
  v_cvt_pk_bf16_f32 v91, v22, v23
  v_exp_f32 v24, v24
  v_exp_f32 v25, v25
  v_mfma_f32_32x32x16_bf16 v[48:63], v[104:107], v[88:91], v[48:63]
  v_exp_f32 v26, v26
  v_exp_f32 v27, v27
  v_exp_f32 v28, v28
  v_exp_f32 v29, v29
  v_exp_f32 v30, v30
  v_exp_f32 v31, v31
  v_cvt_pk_bf16_f32 v92, v24, v25
  v_cvt_pk_bf16_f32 v93, v26, v27
  v_cvt_pk_bf16_f32 v94, v28, v29
  v_cvt_pk_bf16_f32 v95, v30, v31
  v_exp_f32 v32, v32
  v_exp_f32 v33, v33
  v_mfma_f32_32x32x16_bf16 v[48:63], v[108:111], v[92:95], v[48:63]
  v_exp_f32 v34, v34
  v_exp_f32 v35, v35
  v_exp_f32 v36, v36
  v_exp_f32 v37, v37
  v_mfma_f32_32x32x16_bf16 v[16:31], v[100:103], v[80:83], 0
  v_exp_f32 v38, v38
  v_exp_f32 v39, v39
  v_cvt_pk_bf16_f32 v88, v32, v33
  v_cvt_pk_bf16_f32 v89, v34, v35
  v_cvt_pk_bf16_f32 v90, v36, v37
  v_cvt_pk_bf16_f32 v91, v38, v39
  v_exp_f32 v40, v40
  v_exp_f32 v41, v41
  v_mfma_f32_32x32x16_bf16 v[64:79], v[104:107], v[88:91], v[64:79]
  v_exp_f32 v42, v42
  v_exp_f32 v43, v43
  v_exp_f32 v44, v44
  v_exp_f32 v45, v45
  v_exp_f32 v46, v46
  v_exp_f32 v47, v47
  v_cvt_pk_bf16_f32 v92, v40, v41
  v_cvt_pk_bf16_f32 v93, v42, v43
  v_cvt_pk_bf16_f32 v94, v44, v45
  v_cvt_pk_bf16_f32 v95, v46, v47
  v_exp_f32 v16, v16
  v_exp_f32 v17, v17
  v_mfma_f32_32x32x16_bf16 v[64:79], v[108:111], v[92:95], v[64:79]
  v_exp_f32 v18, v18
  v_exp_f32 v19, v19
  v_exp_f32 v20, v20
  v_exp_f32 v21, v21
  v_mfma_f32_32x32x16_bf16 v[32:47], v[100:103], v[84:87], 0
  s_waitcnt lgkmcnt(0)
  s_and_b32 s22, s13, 7
  s_cbranch_scc1 qsave_22
  s_add_u32 s22, s40, 10240
  buffer_store_dwordx4 v[184:187], v2, s[8:11], s22 offen offset:0 sc1
  buffer_store_dwordx4 v[188:191], v2, s[8:11], s22 offen offset:1024 sc1
qsave_22:
  ds_read_b128 v[100:103], v124 offset:33792
  s_mov_b64 exec, s[20:21]
  ds_read_b128 v[104:107], v125 offset:32768
  ds_read_b128 v[108:111], v125 offset:33280
  s_mov_b64 exec, -1
  v_exp_f32 v22, v22
  v_exp_f32 v23, v23
  v_cvt_pk_bf16_f32 v88, v16, v17
  v_cvt_pk_bf16_f32 v89, v18, v19
  v_cvt_pk_bf16_f32 v90, v20, v21
  v_cvt_pk_bf16_f32 v91, v22, v23
  v_exp_f32 v24, v24
  v_exp_f32 v25, v25
  v_mfma_f32_32x32x16_bf16 v[48:63], v[112:115], v[88:91], v[48:63]
  v_exp_f32 v26, v26
  v_exp_f32 v27, v27
  v_exp_f32 v28, v28
  v_exp_f32 v29, v29
  v_exp_f32 v30, v30
  v_exp_f32 v31, v31
  v_cvt_pk_bf16_f32 v92, v24, v25
  v_cvt_pk_bf16_f32 v93, v26, v27
  v_cvt_pk_bf16_f32 v94, v28, v29
  v_cvt_pk_bf16_f32 v95, v30, v31
  v_exp_f32 v32, v32
  v_exp_f32 v33, v33
  v_mfma_f32_32x32x16_bf16 v[48:63], v[116:119], v[92:95], v[48:63]
  v_exp_f32 v34, v34
  v_exp_f32 v35, v35
  v_exp_f32 v36, v36
  v_exp_f32 v37, v37
  v_mfma_f32_32x32x16_bf16 v[16:31], v[96:99], v[80:83], 0
  v_exp_f32 v38, v38
  v_exp_f32 v39, v39
  v_cvt_pk_bf16_f32 v88, v32, v33
  v_cvt_pk_bf16_f32 v89, v34, v35
  v_cvt_pk_bf16_f32 v90, v36, v37
  v_cvt_pk_bf16_f32 v91, v38, v39
  v_exp_f32 v40, v40
  v_exp_f32 v41, v41
  v_mfma_f32_32x32x16_bf16 v[64:79], v[112:115], v[88:91], v[64:79]
  v_exp_f32 v42, v42
  v_exp_f32 v43, v43
  v_exp_f32 v44, v44
  v_exp_f32 v45, v45
  v_exp_f32 v46, v46
  v_exp_f32 v47, v47
  v_cvt_pk_bf16_f32 v92, v40, v41
  v_cvt_pk_bf16_f32 v93, v42, v43
  v_cvt_pk_bf16_f32 v94, v44, v45
  v_cvt_pk_bf16_f32 v95, v46, v47
  v_exp_f32 v16, v16
  v_exp_f32 v17, v17
  v_mfma_f32_32x32x16_bf16 v[64:79], v[116:119], v[92:95], v[64:79]
  v_exp_f32 v18, v18
  v_exp_f32 v19, v19
  v_exp_f32 v20, v20
  v_exp_f32 v21, v21
  v_mfma_f32_32x32x16_bf16 v[32:47], v[96:99], v[84:87], 0
  s_waitcnt lgkmcnt(0)
  s_and_b32 s22, s13, 7
  s_cbranch_scc1 qsave_23
  s_add_u32 s22, s40, 12288
  buffer_store_dwordx4 v[192:195], v2, s[8:11], s22 offen offset:0 sc1
  buffer_store_dwordx4 v[196:199], v2, s[8:11], s22 offen offset:1024 sc1
qsave_23:
  ds_read_b128 v[96:99], v124 offset:34816
  s_mov_b64 exec, s[20:21]
  ds_read_b128 v[112:115], v125 offset:33792
  ds_read_b128 v[116:119], v125 offset:34304
  s_mov_b64 exec, -1
  v_exp_f32 v22, v22
  v_exp_f32 v23, v23
  v_cvt_pk_bf16_f32 v88, v16, v17
  v_cvt_pk_bf16_f32 v89, v18, v19
  v_cvt_pk_bf16_f32 v90, v20, v21
  v_cvt_pk_bf16_f32 v91, v22, v23
  v_exp_f32 v24, v24
  v_exp_f32 v25, v25
  v_mfma_f32_32x32x16_bf16 v[48:63], v[104:107], v[88:91], v[48:63]
  v_exp_f32 v26, v26
  v_exp_f32 v27, v27
  v_exp_f32 v28, v28
  v_exp_f32 v29, v29
  v_exp_f32 v30, v30
  v_exp_f32 v31, v31
  v_cvt_pk_bf16_f32 v92, v24, v25
  v_cvt_pk_bf16_f32 v93, v26, v27
  v_cvt_pk_bf16_f32 v94, v28, v29
  v_cvt_pk_bf16_f32 v95, v30, v31
  v_exp_f32 v32, v32
  v_exp_f32 v33, v33
  v_mfma_f32_32x32x16_bf16 v[48:63], v[108:111], v[92:95], v[48:63]
  v_exp_f32 v34, v34
  v_exp_f32 v35, v35
  v_exp_f32 v36, v36
  v_exp_f32 v37, v37
  v_mfma_f32_32x32x16_bf16 v[16:31], v[100:103], v[80:83], 0
  v_exp_f32 v38, v38
  v_exp_f32 v39, v39
  v_cvt_pk_bf16_f32 v88, v32, v33
  v_cvt_pk_bf16_f32 v89, v34, v35
  v_cvt_pk_bf16_f32 v90, v36, v37
  v_cvt_pk_bf16_f32 v91, v38, v39
  v_exp_f32 v40, v40
  v_exp_f32 v41, v41
  v_mfma_f32_32x32x16_bf16 v[64:79], v[104:107], v[88:91], v[64:79]
  v_exp_f32 v42, v42
  v_exp_f32 v43, v43
  v_exp_f32 v44, v44
  v_exp_f32 v45, v45
  v_exp_f32 v46, v46
  v_exp_f32 v47, v47
  v_cvt_pk_bf16_f32 v92, v40, v41
  v_cvt_pk_bf16_f32 v93, v42, v43
  v_cvt_pk_bf16_f32 v94, v44, v45
  v_cvt_pk_bf16_f32 v95, v46, v47
  v_exp_f32 v16, v16
  v_exp_f32 v17, v17
  v_mfma_f32_32x32x16_bf16 v[64:79], v[108:111], v[92:95], v[64:79]
  v_exp_f32 v18, v18
  v_exp_f32 v19, v19
  v_exp_f32 v20, v20
  v_exp_f32 v21, v21
  v_mfma_f32_32x32x16_bf16 v[32:47], v[100:103], v[84:87], 0
  s_waitcnt lgkmcnt(0)
  s_and_b32 s22, s13, 7
  s_cbranch_scc1 qsave_24
  s_add_u32 s22, s40, 14336
  buffer_store_dwordx4 v[200:203], v2, s[8:11], s22 offen offset:0 sc1
  buffer_store_dwordx4 v[204:207], v2, s[8:11], s22 offen offset:1024 sc1
qsave_24:
  ds_read_b128 v[100:103], v124 offset:35840
  s_mov_b64 exec, s[20:21]
  ds_read_b128 v[104:107], v125 offset:34816
  ds_read_b128 v[108:111], v125 offset:35328
  s_mov_b64 exec, -1
  v_exp_f32 v22, v22
  v_exp_f32 v23, v23
  v_cvt_pk_bf16_f32 v88, v16, v17
  v_cvt_pk_bf16_f32 v89, v18, v19
  v_cvt_pk_bf16_f32 v90, v20, v21
  v_cvt_pk_bf16_f32 v91, v22, v23
  v_exp_f32 v24, v24
  v_exp_f32 v25, v25
  v_mfma_f32_32x32x16_bf16 v[48:63], v[112:115], v[88:91], v[48:63]
  v_exp_f32 v26, v26
  v_exp_f32 v27, v27
  v_exp_f32 v28, v28
  v_exp_f32 v29, v29
  v_exp_f32 v30, v30
  v_exp_f32 v31, v31
  v_cvt_pk_bf16_f32 v92, v24, v25
  v_cvt_pk_bf16_f32 v93, v26, v27
  v_cvt_pk_bf16_f32 v94, v28, v29
  v_cvt_pk_bf16_f32 v95, v30, v31
  v_exp_f32 v32, v32
  v_exp_f32 v33, v33
  v_mfma_f32_32x32x16_bf16 v[48:63], v[116:119], v[92:95], v[48:63]
  v_exp_f32 v34, v34
  v_exp_f32 v35, v35
  v_exp_f32 v36, v36
  v_exp_f32 v37, v37
  v_mfma_f32_32x32x16_bf16 v[16:31], v[96:99], v[80:83], 0
  v_exp_f32 v38, v38
  v_exp_f32 v39, v39
  v_cvt_pk_bf16_f32 v88, v32, v33
  v_cvt_pk_bf16_f32 v89, v34, v35
  v_cvt_pk_bf16_f32 v90, v36, v37
  v_cvt_pk_bf16_f32 v91, v38, v39
  v_exp_f32 v40, v40
  v_exp_f32 v41, v41
  v_mfma_f32_32x32x16_bf16 v[64:79], v[112:115], v[88:91], v[64:79]
  v_exp_f32 v42, v42
  v_exp_f32 v43, v43
  v_exp_f32 v44, v44
  v_exp_f32 v45, v45
  v_exp_f32 v46, v46
  v_exp_f32 v47, v47
  v_cvt_pk_bf16_f32 v92, v40, v41
  v_cvt_pk_bf16_f32 v93, v42, v43
  v_cvt_pk_bf16_f32 v94, v44, v45
  v_cvt_pk_bf16_f32 v95, v46, v47
  v_exp_f32 v16, v16
  v_exp_f32 v17, v17
  v_mfma_f32_32x32x16_bf16 v[64:79], v[116:119], v[92:95], v[64:79]
  v_exp_f32 v18, v18
  v_exp_f32 v19, v19
  v_exp_f32 v20, v20
  v_exp_f32 v21, v21
  v_mfma_f32_32x32x16_bf16 v[32:47], v[96:99], v[84:87], 0
  s_waitcnt lgkmcnt(0)
  s_and_b32 s22, s13, 7
  s_cbranch_scc1 qsave_25
  s_add_u32 s22, s40, 16384
  buffer_store_dwordx4 v[208:211], v2, s[8:11], s22 offen offset:0 sc1
qsave_25:
  ds_read_b128 v[96:99], v124 offset:36864
  s_mov_b64 exec, s[20:21]
  ds_read_b128 v[112:115], v125 offset:35840
  ds_read_b128 v[116:119], v125 offset:36352
  s_mov_b64 exec, -1
  v_exp_f32 v22, v22
  v_exp_f32 v23, v23
  v_cvt_pk_bf16_f32 v88, v16, v17
  v_cvt_pk_bf16_f32 v89, v18, v19
  v_cvt_pk_bf16_f32 v90, v20, v21
  v_cvt_pk_bf16_f32 v91, v22, v23
  v_exp_f32 v24, v24
  v_exp_f32 v25, v25
  v_mfma_f32_32x32x16_bf16 v[48:63], v[104:107], v[88:91], v[48:63]
  v_exp_f32 v26, v26
  v_exp_f32 v27, v27
  v_exp_f32 v28, v28
  v_exp_f32 v29, v29
  v_exp_f32 v30, v30
  v_exp_f32 v31, v31
  v_cvt_pk_bf16_f32 v92, v24, v25
  v_cvt_pk_bf16_f32 v93, v26, v27
  v_cvt_pk_bf16_f32 v94, v28, v29
  v_cvt_pk_bf16_f32 v95, v30, v31
  v_exp_f32 v32, v32
  v_exp_f32 v33, v33
  v_mfma_f32_32x32x16_bf16 v[48:63], v[108:111], v[92:95], v[48:63]
  v_exp_f32 v34, v34
  v_exp_f32 v35, v35
  v_exp_f32 v36, v36
  v_exp_f32 v37, v37
  v_mfma_f32_32x32x16_bf16 v[16:31], v[100:103], v[80:83], 0
  v_exp_f32 v38, v38
  v_exp_f32 v39, v39
  v_cvt_pk_bf16_f32 v88, v32, v33
  v_cvt_pk_bf16_f32 v89, v34, v35
  v_cvt_pk_bf16_f32 v90, v36, v37
  v_cvt_pk_bf16_f32 v91, v38, v39
  v_exp_f32 v40, v40
  v_exp_f32 v41, v41
  v_mfma_f32_32x32x16_bf16 v[64:79], v[104:107], v[88:91], v[64:79]
  v_exp_f32 v42, v42
  v_exp_f32 v43, v43
  v_exp_f32 v44, v44
  v_exp_f32 v45, v45
  v_exp_f32 v46, v46
  v_exp_f32 v47, v47
  v_cvt_pk_bf16_f32 v92, v40, v41
  v_cvt_pk_bf16_f32 v93, v42, v43
  v_cvt_pk_bf16_f32 v94, v44, v45
  v_cvt_pk_bf16_f32 v95, v46, v47
  v_exp_f32 v16, v16
  v_exp_f32 v17, v17
  v_mfma_f32_32x32x16_bf16 v[64:79], v[108:111], v[92:95], v[64:79]
  v_exp_f32 v18, v18
  v_exp_f32 v19, v19
  v_exp_f32 v20, v20
  v_exp_f32 v21, v21
  v_mfma_f32_32x32x16_bf16 v[32:47], v[100:103], v[84:87], 0
  s_waitcnt lgkmcnt(0)
  s_cmp_lg_u32 s14, 4
  s_cbranch_scc1 wchk_26
  s_cmp_eq_u32 s13, 8
  s_cbranch_scc0 wchk_26
  s_getreg_b32 s23, hwreg(HW_REG_XCC_ID, 0, 3)
  s_lshl_b32 s23, s23, 7
  s_add_u32 s23, s23, 6883328
  v_mov_b32 v239, 0
  v_lshlrev_b32 v237, 7, v1
  s_mov_b32 s93, 0x80000
wchk_26_p:
  s_mov_b32 s22, 6848512
  buffer_load_dwordx2 v[216:217], v237, s[8:11], s22 offen sc1
  s_mov_b32 s22, 6856704
  buffer_load_dwordx2 v[218:219], v237, s[8:11], s22 offen sc1
  s_mov_b32 s22, 6864896
  buffer_load_dwordx2 v[220:221], v237, s[8:11], s22 offen sc1
  s_mov_b32 s22, 6873088
  buffer_load_dwordx2 v[222:223], v237, s[8:11], s22 offen sc1
  s_sub_u32 s93, s93, 1
  s_waitcnt vmcnt(0)
  v_xor_b32 v217, s94, v217
  v_xor_b32 v216, s95, v216
  v_xor_b32 v219, s94, v219
  v_xor_b32 v218, s95, v218
  v_xor_b32 v221, s94, v221
  v_xor_b32 v220, s95, v220
  v_xor_b32 v223, s94, v223
  v_xor_b32 v222, s95, v222
  v_or3_b32 v217, v217, v219, v221
  v_or_b32 v217, v217, v223
  v_cmp_ne_u32 vcc, 0, v217
  s_cmp_eq_u32 s93, 0
  s_cbranch_scc1 wchk_26_px
  s_cbranch_vccz wchk_26_px
  s_sleep 8
  s_branch wchk_26_p
wchk_26_px:
  v_or3_b32 v216, v216, v218, v220
  v_or_b32 v216, v216, v222
  v_cmp_ne_u32 vcc, 0, v216
  v_mov_b32 v233, s94
  v_mov_b32 v235, s94
  s_cmp_lg_u64 vcc, 0
  s_cselect_b32 s22, 2, 1
  v_mov_b32 v232, s22
  s_mov_b64 exec, 1
  buffer_store_dwordx4 v[232:235], v239, s[8:11], s23 offen
  s_mov_b64 exec, -1
wchk_26_w:
  v_mov_b32 v237, 134144
  ds_write_b32 v237, v232
wchk_26:
  ds_read_b128 v[100:103], v124 offset:37888
  s_mov_b64 exec, s[20:21]
  ds_read_b128 v[104:107], v125 offset:36864
  ds_read_b128 v[108:111], v125 offset:37376
  s_mov_b64 exec, -1
  v_exp_f32 v22, v22
  v_exp_f32 v23, v23
  v_cvt_pk_bf16_f32 v88, v16, v17
  v_cvt_pk_bf16_f32 v89, v18, v19
  v_cvt_pk_bf16_f32 v90, v20, v21
  v_cvt_pk_bf16_f32 v91, v22, v23
  v_exp_f32 v24, v24
  v_exp_f32 v25, v25
  v_mfma_f32_32x32x16_bf16 v[48:63], v[112:115], v[88:91], v[48:63]
  v_exp_f32 v26, v26
  v_exp_f32 v27, v27
  v_exp_f32 v28, v28
  v_exp_f32 v29, v29
  v_exp_f32 v30, v30
  v_exp_f32 v31, v31
  v_cvt_pk_bf16_f32 v92, v24, v25
  v_cvt_pk_bf16_f32 v93, v26, v27
  v_cvt_pk_bf16_f32 v94, v28, v29
  v_cvt_pk_bf16_f32 v95, v30, v31
  v_exp_f32 v32, v32
  v_exp_f32 v33, v33
  v_mfma_f32_32x32x16_bf16 v[48:63], v[116:119], v[92:95], v[48:63]
  v_exp_f32 v34, v34
  v_exp_f32 v35, v35
  v_exp_f32 v36, v36
  v_exp_f32 v37, v37
  v_mfma_f32_32x32x16_bf16 v[16:31], v[96:99], v[80:83], 0
  v_exp_f32 v38, v38
  v_exp_f32 v39, v39
  v_cvt_pk_bf16_f32 v88, v32, v33
  v_cvt_pk_bf16_f32 v89, v34, v35
  v_cvt_pk_bf16_f32 v90, v36, v37
  v_cvt_pk_bf16_f32 v91, v38, v39
  v_exp_f32 v40, v40
  v_exp_f32 v41, v41
  v_mfma_f32_32x32x16_bf16 v[64:79], v[112:115], v[88:91], v[64:79]
  v_exp_f32 v42, v42
  v_exp_f32 v43, v43
  v_exp_f32 v44, v44
  v_exp_f32 v45, v45
  v_exp_f32 v46, v46
  v_exp_f32 v47, v47
  v_cvt_pk_bf16_f32 v92, v40, v41
  v_cvt_pk_bf16_f32 v93, v42, v43
  v_cvt_pk_bf16_f32 v94, v44, v45
  v_cvt_pk_bf16_f32 v95, v46, v47
  v_exp_f32 v16, v16
  v_exp_f32 v17, v17
  v_mfma_f32_32x32x16_bf16 v[64:79], v[116:119], v[92:95], v[64:79]
  v_exp_f32 v18, v18
  v_exp_f32 v19, v19
  v_exp_f32 v20, v20
  v_exp_f32 v21, v21
  v_mfma_f32_32x32x16_bf16 v[32:47], v[96:99], v[84:87], 0
  s_waitcnt lgkmcnt(0)
  s_cmp_eq_u32 s38, 0
  s_cbranch_scc1 prio_27
  s_setprio 0
prio_27:
  ds_read_b128 v[96:99], v124 offset:38912
  s_mov_b64 exec, s[20:21]
  ds_read_b128 v[112:115], v125 offset:37888
  ds_read_b128 v[116:119], v125 offset:38400
  s_mov_b64 exec, -1
  v_exp_f32 v22, v22
  v_exp_f32 v23, v23
  v_cvt_pk_bf16_f32 v88, v16, v17
  v_cvt_pk_bf16_f32 v89, v18, v19
  v_cvt_pk_bf16_f32 v90, v20, v21
  v_cvt_pk_bf16_f32 v91, v22, v23
  v_exp_f32 v24, v24
  v_exp_f32 v25, v25
  v_mfma_f32_32x32x16_bf16 v[48:63], v[104:107], v[88:91], v[48:63]
  v_exp_f32 v26, v26
  v_exp_f32 v27, v27
  v_exp_f32 v28, v28
  v_exp_f32 v29, v29
  v_exp_f32 v30, v30
  v_exp_f32 v31, v31
  v_cvt_pk_bf16_f32 v92, v24, v25
  v_cvt_pk_bf16_f32 v93, v26, v27
  v_cvt_pk_bf16_f32 v94, v28, v29
  v_cvt_pk_bf16_f32 v95, v30, v31
  v_exp_f32 v32, v32
  v_exp_f32 v33, v33
  v_mfma_f32_32x32x16_bf16 v[48:63], v[108:111], v[92:95], v[48:63]
  v_exp_f32 v34, v34
  v_exp_f32 v35, v35
  v_exp_f32 v36, v36
  v_exp_f32 v37, v37
  v_mfma_f32_32x32x16_bf16 v[16:31], v[100:103], v[80:83], 0
  v_exp_f32 v38, v38
  v_exp_f32 v39, v39
  v_cvt_pk_bf16_f32 v88, v32, v33
  v_cvt_pk_bf16_f32 v89, v34, v35
  v_cvt_pk_bf16_f32 v90, v36, v37
  v_cvt_pk_bf16_f32 v91, v38, v39
  v_exp_f32 v40, v40
  v_exp_f32 v41, v41
  v_mfma_f32_32x32x16_bf16 v[64:79], v[104:107], v[88:91], v[64:79]
  v_exp_f32 v42, v42
  v_exp_f32 v43, v43
  v_exp_f32 v44, v44
  v_exp_f32 v45, v45
  v_exp_f32 v46, v46
  v_exp_f32 v47, v47
  v_cvt_pk_bf16_f32 v92, v40, v41
  v_cvt_pk_bf16_f32 v93, v42, v43
  v_cvt_pk_bf16_f32 v94, v44, v45
  v_cvt_pk_bf16_f32 v95, v46, v47
  v_exp_f32 v16, v16
  v_exp_f32 v17, v17
  v_mfma_f32_32x32x16_bf16 v[64:79], v[108:111], v[92:95], v[64:79]
  v_exp_f32 v18, v18
  v_exp_f32 v19, v19
  v_exp_f32 v20, v20
  v_exp_f32 v21, v21
  v_mfma_f32_32x32x16_bf16 v[32:47], v[100:103], v[84:87], 0
  s_waitcnt lgkmcnt(0)
  s_cmp_lg_u32 s14, 4
  s_cbranch_scc1 wchk_28
  s_cmp_eq_u32 s13, 8
  s_cbranch_scc1 wchk_28
  s_getreg_b32 s23, hwreg(HW_REG_XCC_ID, 0, 3)
  s_lshl_b32 s23, s23, 7
  s_add_u32 s23, s23, 6883328
  v_mov_b32 v239, 0
  s_mov_b32 s93, 48
wchk_28_l:
  buffer_load_dwordx4 v[232:235], v239, s[8:11], s23 offen sc1
  s_sub_u32 s93, s93, 1
  s_waitcnt vmcnt(0)
  v_cmp_ne_u32 s[24:25], s94, v233
  v_cmp_ne_u32 vcc, s94, v235
  s_or_b64 vcc, vcc, s[24:25]
  s_cmp_eq_u32 s93, 0
  s_cbranch_scc1 wchk_28_l_x
  s_cbranch_vccz wchk_28_l_x
  s_sleep 1
  s_branch wchk_28_l
wchk_28_l_x:
  s_cbranch_vccz wchk_28_w
  v_lshlrev_b32 v237, 7, v1
  s_mov_b32 s93, 0x80000
wchk_28_p:
  s_mov_b32 s22, 6848512
  buffer_load_dwordx2 v[216:217], v237, s[8:11], s22 offen sc1
  s_mov_b32 s22, 6856704
  buffer_load_dwordx2 v[218:219], v237, s[8:11], s22 offen sc1
  s_mov_b32 s22, 6864896
  buffer_load_dwordx2 v[220:221], v237, s[8:11], s22 offen sc1
  s_mov_b32 s22, 6873088
  buffer_load_dwordx2 v[222:223], v237, s[8:11], s22 offen sc1
  s_sub_u32 s93, s93, 1
  s_waitcnt vmcnt(0)
  v_xor_b32 v217, s94, v217
  v_xor_b32 v216, s95, v216
  v_xor_b32 v219, s94, v219
  v_xor_b32 v218, s95, v218
  v_xor_b32 v221, s94, v221
  v_xor_b32 v220, s95, v220
  v_xor_b32 v223, s94, v223
  v_xor_b32 v222, s95, v222
  v_or3_b32 v217, v217, v219, v221
  v_or_b32 v217, v217, v223
  v_cmp_ne_u32 vcc, 0, v217
  s_cmp_eq_u32 s93, 0
  s_cbranch_scc1 wchk_28_px
  s_cbranch_vccz wchk_28_px
  s_sleep 8
  s_branch wchk_28_p
wchk_28_px:
  v_or3_b32 v216, v216, v218, v220
  v_or_b32 v216, v216, v222
  v_cmp_ne_u32 vcc, 0, v216
  v_mov_b32 v233, s94
  v_mov_b32 v235, s94
  s_cmp_lg_u64 vcc, 0
  s_cselect_b32 s22, 2, 1
  v_mov_b32 v232, s22
wchk_28_w:
  v_mov_b32 v237, 134144
  ds_write_b32 v237, v232
wchk_28:
  ds_read_b128 v[100:103], v124 offset:39936
  s_mov_b64 exec, s[20:21]
  ds_read_b128 v[104:107], v125 offset:38912
  ds_read_b128 v[108:111], v125 offset:39424
  s_mov_b64 exec, -1
  v_exp_f32 v22, v22
  v_exp_f32 v23, v23
  v_cvt_pk_bf16_f32 v88, v16, v17
  v_cvt_pk_bf16_f32 v89, v18, v19
  v_cvt_pk_bf16_f32 v90, v20, v21
  v_cvt_pk_bf16_f32 v91, v22, v23
  v_exp_f32 v24, v24
  v_exp_f32 v25, v25
  v_mfma_f32_32x32x16_bf16 v[48:63], v[112:115], v[88:91], v[48:63]
  v_exp_f32 v26, v26
  v_exp_f32 v27, v27
  v_exp_f32 v28, v28
  v_exp_f32 v29, v29
  v_exp_f32 v30, v30
  v_exp_f32 v31, v31
  v_cvt_pk_bf16_f32 v92, v24, v25
  v_cvt_pk_bf16_f32 v93, v26, v27
  v_cvt_pk_bf16_f32 v94, v28, v29
  v_cvt_pk_bf16_f32 v95, v30, v31
  v_exp_f32 v32, v32
  v_exp_f32 v33, v33
  v_mfma_f32_32x32x16_bf16 v[48:63], v[116:119], v[92:95], v[48:63]
  v_exp_f32 v34, v34
  v_exp_f32 v35, v35
  v_exp_f32 v36, v36
  v_exp_f32 v37, v37
  v_mfma_f32_32x32x16_bf16 v[16:31], v[96:99], v[80:83], 0
  v_exp_f32 v38, v38
  v_exp_f32 v39, v39
  v_cvt_pk_bf16_f32 v88, v32, v33
  v_cvt_pk_bf16_f32 v89, v34, v35
  v_cvt_pk_bf16_f32 v90, v36, v37
  v_cvt_pk_bf16_f32 v91, v38, v39
  v_exp_f32 v40, v40
  v_exp_f32 v41, v41
  v_mfma_f32_32x32x16_bf16 v[64:79], v[112:115], v[88:91], v[64:79]
  v_exp_f32 v42, v42
  v_exp_f32 v43, v43
  v_exp_f32 v44, v44
  v_exp_f32 v45, v45
  v_exp_f32 v46, v46
  v_exp_f32 v47, v47
  v_cvt_pk_bf16_f32 v92, v40, v41
  v_cvt_pk_bf16_f32 v93, v42, v43
  v_cvt_pk_bf16_f32 v94, v44, v45
  v_cvt_pk_bf16_f32 v95, v46, v47
  v_exp_f32 v16, v16
  v_exp_f32 v17, v17
  v_mfma_f32_32x32x16_bf16 v[64:79], v[116:119], v[92:95], v[64:79]
  v_exp_f32 v18, v18
  v_exp_f32 v19, v19
  v_exp_f32 v20, v20
  v_exp_f32 v21, v21
  v_mfma_f32_32x32x16_bf16 v[32:47], v[96:99], v[84:87], 0
  s_waitcnt lgkmcnt(0)
  v_mov_b32 v237, 134144
  s_mov_b32 s93, 0x4000000
wrdy_29:
  ds_read_b32 v236, v237
  s_sub_u32 s93, s93, 1
  s_waitcnt lgkmcnt(0)
  v_readfirstlane_b32 s92, v236
  s_cmp_eq_u32 s93, 0
  s_cbranch_scc1 wrdy_29_x
  s_cmp_eq_u32 s92, 0
  s_cbranch_scc1 wrdy_29
wrdy_29_x:
  s_sub_u32 s92, s92, 1
  s_cmp_eq_u32 s38, 0
  s_cbranch_scc1 prio_30
  s_setprio 1
prio_30:
  s_waitcnt vmcnt(1)
  s_barrier
  s_add_u32 s28, s48, 6
  s_and_b32 s28, s28, 7
  s_lshl_b32 s28, s28, 13
  s_add_u32 s28, s28, s27
  s_add_u32 m0, s26, 98304
  s_nop 0
  buffer_load_dwordx4 v2, s[8:11], s28 offen lds
  buffer_load_dwordx4 v2, s[8:11], s28 offen offset:1024 lds
  s_add_u32 m0, s26, 114688
  s_add_u32 s28, s28, 65536
  buffer_load_dwordx4 v2, s[8:11], s28 offen lds
  buffer_load_dwordx4 v2, s[8:11], s28 offen offset:1024 lds
  s_lshl_b32 s28, s14, 12
  s_add_u32 m0, s28, 0
  s_add_u32 s28, s33, 0
  buffer_load_dwordx4 v2, s[8:11], s28 offen offset:0 lds
  buffer_load_dwordx4 v2, s[8:11], s28 offen offset:1024 lds
  buffer_load_dwordx4 v2, s[8:11], s28 offen offset:2048 lds
  buffer_load_dwordx4 v2, s[8:11], s28 offen offset:3072 lds
  buffer_load_dwordx4 v[144:147], v2, s[8:11], s32 offen offset:0
  ds_read_b128 v[96:99], v126 offset:0
  s_mov_b64 exec, s[20:21]
  ds_read_b128 v[112:115], v125 offset:39936
  ds_read_b128 v[116:119], v125 offset:40448
  s_mov_b64 exec, -1
  v_exp_f32 v22, v22
  v_exp_f32 v23, v23
  v_cvt_pk_bf16_f32 v88, v16, v17
  v_cvt_pk_bf16_f32 v89, v18, v19
  v_cvt_pk_bf16_f32 v90, v20, v21
  v_cvt_pk_bf16_f32 v91, v22, v23
  v_exp_f32 v24, v24
  v_exp_f32 v25, v25
  v_mfma_f32_32x32x16_bf16 v[48:63], v[104:107], v[88:91], v[48:63]
  v_exp_f32 v26, v26
  v_exp_f32 v27, v27
  v_exp_f32 v28, v28
  v_exp_f32 v29, v29
  v_exp_f32 v30, v30
  v_exp_f32 v31, v31
  v_cvt_pk_bf16_f32 v92, v24, v25
  v_cvt_pk_bf16_f32 v93, v26, v27
  v_cvt_pk_bf16_f32 v94, v28, v29
  v_cvt_pk_bf16_f32 v95, v30, v31
  v_exp_f32 v32, v32
  v_exp_f32 v33, v33
  v_mfma_f32_32x32x16_bf16 v[48:63], v[108:111], v[92:95], v[48:63]
  v_exp_f32 v34, v34
  v_exp_f32 v35, v35
  v_exp_f32 v36, v36
  v_exp_f32 v37, v37
  v_mfma_f32_32x32x16_bf16 v[16:31], v[100:103], v[80:83], 0
  v_exp_f32 v38, v38
  v_exp_f32 v39, v39
  v_cvt_pk_bf16_f32 v88, v32, v33
  v_cvt_pk_bf16_f32 v89, v34, v35
  v_cvt_pk_bf16_f32 v90, v36, v37
  v_cvt_pk_bf16_f32 v91, v38, v39
  v_exp_f32 v40, v40
  v_exp_f32 v41, v41
  v_mfma_f32_32x32x16_bf16 v[64:79], v[104:107], v[88:91], v[64:79]
  v_exp_f32 v42, v42
  v_exp_f32 v43, v43
  v_exp_f32 v44, v44
  v_exp_f32 v45, v45
  v_exp_f32 v46, v46
  v_exp_f32 v47, v47
  v_cvt_pk_bf16_f32 v92, v40, v41
  v_cvt_pk_bf16_f32 v93, v42, v43
  v_cvt_pk_bf16_f32 v94, v44, v45
  v_cvt_pk_bf16_f32 v95, v46, v47
  v_exp_f32 v16, v16
  v_exp_f32 v17, v17
  v_mfma_f32_32x32x16_bf16 v[64:79], v[108:111], v[92:95], v[64:79]
  v_exp_f32 v18, v18
  v_exp_f32 v19, v19
  v_exp_f32 v20, v20
  v_exp_f32 v21, v21
  v_mfma_f32_32x32x16_bf16 v[32:47], v[100:103], v[84:87], 0
  s_waitcnt lgkmcnt(0)
  buffer_load_dwordx4 v[148:151], v2, s[8:11], s32 offen offset:1024
  buffer_load_dwordx4 v[152:155], v2, s[8:11], s32 offen offset:2048
  ds_read_b128 v[100:103], v126 offset:1024
  s_mov_b64 exec, s[20:21]
  ds_read_b128 v[104:107], v127 offset:0
  ds_read_b128 v[108:111], v127 offset:512
  s_mov_b64 exec, -1
  v_exp_f32 v22, v22
  v_exp_f32 v23, v23
  v_cvt_pk_bf16_f32 v88, v16, v17
  v_cvt_pk_bf16_f32 v89, v18, v19
  v_cvt_pk_bf16_f32 v90, v20, v21
  v_cvt_pk_bf16_f32 v91, v22, v23
  v_exp_f32 v24, v24
  v_exp_f32 v25, v25
  v_mfma_f32_32x32x16_bf16 v[48:63], v[112:115], v[88:91], v[48:63]
  v_exp_f32 v26, v26
  v_exp_f32 v27, v27
  v_exp_f32 v28, v28
  v_exp_f32 v29, v29
  v_exp_f32 v30, v30
  v_exp_f32 v31, v31
  v_cvt_pk_bf16_f32 v92, v24, v25
  v_cvt_pk_bf16_f32 v93, v26, v27
  v_cvt_pk_bf16_f32 v94, v28, v29
  v_cvt_pk_bf16_f32 v95, v30, v31
  v_exp_f32 v32, v32
  v_exp_f32 v33, v33
  v_mfma_f32_32x32x16_bf16 v[48:63], v[116:119], v[92:95], v[48:63]
  v_exp_f32 v34, v34
  v_exp_f32 v35, v35
  v_exp_f32 v36, v36
  v_exp_f32 v37, v37
  v_mfma_f32_32x32x16_bf16 v[16:31], v[96:99], v[80:83], 0
  v_exp_f32 v38, v38
  v_exp_f32 v39, v39
  v_cvt_pk_bf16_f32 v88, v32, v33
  v_cvt_pk_bf16_f32 v89, v34, v35
  v_cvt_pk_bf16_f32 v90, v36, v37
  v_cvt_pk_bf16_f32 v91, v38, v39
  v_exp_f32 v40, v40
  v_exp_f32 v41, v41
  v_mfma_f32_32x32x16_bf16 v[64:79], v[112:115], v[88:91], v[64:79]
  v_exp_f32 v42, v42
  v_exp_f32 v43, v43
  v_exp_f32 v44, v44
  v_exp_f32 v45, v45
  v_exp_f32 v46, v46
  v_exp_f32 v47, v47
  v_cvt_pk_bf16_f32 v92, v40, v41
  v_cvt_pk_bf16_f32 v93, v42, v43
  v_cvt_pk_bf16_f32 v94, v44, v45
  v_cvt_pk_bf16_f32 v95, v46, v47
  v_exp_f32 v16, v16
  v_exp_f32 v17, v17
  v_mfma_f32_32x32x16_bf16 v[64:79], v[116:119], v[92:95], v[64:79]
  v_exp_f32 v18, v18
  v_exp_f32 v19, v19
  v_exp_f32 v20, v20
  v_exp_f32 v21, v21
  v_mfma_f32_32x32x16_bf16 v[32:47], v[96:99], v[84:87], 0
  s_waitcnt lgkmcnt(0)
  buffer_load_dwordx4 v[156:159], v2, s[8:11], s32 offen offset:3072
  s_add_u32 s32, s32, 4096
  buffer_load_dwordx4 v[160:163], v2, s[8:11], s32 offen offset:0
  ds_read_b128 v[96:99], v126 offset:2048
  s_mov_b64 exec, s[20:21]
  ds_read_b128 v[112:115], v127 offset:1024
  ds_read_b128 v[116:119], v127 offset:1536
  s_mov_b64 exec, -1
  v_exp_f32 v22, v22
  v_exp_f32 v23, v23
  v_cvt_pk_bf16_f32 v88, v16, v17
  v_cvt_pk_bf16_f32 v89, v18, v19
  v_cvt_pk_bf16_f32 v90, v20, v21
  v_cvt_pk_bf16_f32 v91, v22, v23
  v_exp_f32 v24, v24
  v_exp_f32 v25, v25
  v_mfma_f32_32x32x16_bf16 v[48:63], v[104:107], v[88:91], v[48:63]
  v_exp_f32 v26, v26
  v_exp_f32 v27, v27
  v_exp_f32 v28, v28
  v_exp_f32 v29, v29
  v_exp_f32 v30, v30
  v_exp_f32 v31, v31
  v_cvt_pk_bf16_f32 v92, v24, v25
  v_cvt_pk_bf16_f32 v93, v26, v27
  v_cvt_pk_bf16_f32 v94, v28, v29
  v_cvt_pk_bf16_f32 v95, v30, v31
  v_exp_f32 v32, v32
  v_exp_f32 v33, v33
  v_mfma_f32_32x32x16_bf16 v[48:63], v[108:111], v[92:95], v[48:63]
  v_exp_f32 v34, v34
  v_exp_f32 v35, v35
  v_exp_f32 v36, v36
  v_exp_f32 v37, v37
  v_mfma_f32_32x32x16_bf16 v[16:31], v[100:103], v[80:83], 0
  v_exp_f32 v38, v38
  v_exp_f32 v39, v39
  v_cvt_pk_bf16_f32 v88, v32, v33
  v_cvt_pk_bf16_f32 v89, v34, v35
  v_cvt_pk_bf16_f32 v90, v36, v37
  v_cvt_pk_bf16_f32 v91, v38, v39
  v_exp_f32 v40, v40
  v_exp_f32 v41, v41
  v_mfma_f32_32x32x16_bf16 v[64:79], v[104:107], v[88:91], v[64:79]
  v_exp_f32 v42, v42
  v_exp_f32 v43, v43
  v_exp_f32 v44, v44
  v_exp_f32 v45, v45
  v_exp_f32 v46, v46
  v_exp_f32 v47, v47
  v_cvt_pk_bf16_f32 v92, v40, v41
  v_cvt_pk_bf16_f32 v93, v42, v43
  v_cvt_pk_bf16_f32 v94, v44, v45
  v_cvt_pk_bf16_f32 v95, v46, v47
  v_exp_f32 v16, v16
  v_exp_f32 v17, v17
  v_mfma_f32_32x32x16_bf16 v[64:79], v[108:111], v[92:95], v[64:79]
  v_exp_f32 v18, v18
  v_exp_f32 v19, v19
  v_exp_f32 v20, v20
  v_exp_f32 v21, v21
  v_mfma_f32_32x32x16_bf16 v[32:47], v[100:103], v[84:87], 0
  s_waitcnt lgkmcnt(0)
  buffer_load_dwordx4 v[164:167], v2, s[8:11], s32 offen offset:1024
  buffer_load_dwordx4 v[168:171], v2, s[8:11], s32 offen offset:2048
  ds_read_b128 v[100:103], v126 offset:3072
  s_mov_b64 exec, s[20:21]
  ds_read_b128 v[104:107], v127 offset:2048
  ds_read_b128 v[108:111], v127 offset:2560
  s_mov_b64 exec, -1
  v_exp_f32 v22, v22
  v_exp_f32 v23, v23
  v_cvt_pk_bf16_f32 v88, v16, v17
  v_cvt_pk_bf16_f32 v89, v18, v19
  v_cvt_pk_bf16_f32 v90, v20, v21
  v_cvt_pk_bf16_f32 v91, v22, v23
  v_exp_f32 v24, v24
  v_exp_f32 v25, v25
  v_mfma_f32_32x32x16_bf16 v[48:63], v[112:115], v[88:91], v[48:63]
  v_exp_f32 v26, v26
  v_exp_f32 v27, v27
  v_exp_f32 v28, v28
  v_exp_f32 v29, v29
  v_exp_f32 v30, v30
  v_exp_f32 v31, v31
  v_cvt_pk_bf16_f32 v92, v24, v25
  v_cvt_pk_bf16_f32 v93, v26, v27
  v_cvt_pk_bf16_f32 v94, v28, v29
  v_cvt_pk_bf16_f32 v95, v30, v31
  v_exp_f32 v32, v32
  v_exp_f32 v33, v33
  v_mfma_f32_32x32x16_bf16 v[48:63], v[116:119], v[92:95], v[48:63]
  v_exp_f32 v34, v34
  v_exp_f32 v35, v35
  v_exp_f32 v36, v36
  v_exp_f32 v37, v37
  v_mfma_f32_32x32x16_bf16 v[16:31], v[96:99], v[80:83], 0
  v_exp_f32 v38, v38
  v_exp_f32 v39, v39
  v_cvt_pk_bf16_f32 v88, v32, v33
  v_cvt_pk_bf16_f32 v89, v34, v35
  v_cvt_pk_bf16_f32 v90, v36, v37
  v_cvt_pk_bf16_f32 v91, v38, v39
  v_exp_f32 v40, v40
  v_exp_f32 v41, v41
  v_mfma_f32_32x32x16_bf16 v[64:79], v[112:115], v[88:91], v[64:79]
  v_exp_f32 v42, v42
  v_exp_f32 v43, v43
  v_exp_f32 v44, v44
  v_exp_f32 v45, v45
  v_exp_f32 v46, v46
  v_exp_f32 v47, v47
  v_cvt_pk_bf16_f32 v92, v40, v41
  v_cvt_pk_bf16_f32 v93, v42, v43
  v_cvt_pk_bf16_f32 v94, v44, v45
  v_cvt_pk_bf16_f32 v95, v46, v47
  v_exp_f32 v16, v16
  v_exp_f32 v17, v17
  v_mfma_f32_32x32x16_bf16 v[64:79], v[116:119], v[92:95], v[64:79]
  v_exp_f32 v18, v18
  v_exp_f32 v19, v19
  v_exp_f32 v20, v20
  v_exp_f32 v21, v21
  v_mfma_f32_32x32x16_bf16 v[32:47], v[96:99], v[84:87], 0
  s_waitcnt lgkmcnt(0)
  buffer_load_dwordx4 v[172:175], v2, s[8:11], s32 offen offset:3072
  s_add_u32 s32, s32, 4096
  ds_read_b128 v[96:99], v126 offset:4096
  s_mov_b64 exec, s[20:21]
  ds_read_b128 v[112:115], v127 offset:3072
  ds_read_b128 v[116:119], v127 offset:3584
  s_mov_b64 exec, -1
  v_exp_f32 v22, v22
  v_exp_f32 v23, v23
  v_cvt_pk_bf16_f32 v88, v16, v17
  v_cvt_pk_bf16_f32 v89, v18, v19
  v_cvt_pk_bf16_f32 v90, v20, v21
  v_cvt_pk_bf16_f32 v91, v22, v23
  v_exp_f32 v24, v24
  v_exp_f32 v25, v25
  v_mfma_f32_32x32x16_bf16 v[48:63], v[104:107], v[88:91], v[48:63]
  v_exp_f32 v26, v26
  v_exp_f32 v27, v27
  v_exp_f32 v28, v28
  v_exp_f32 v29, v29
  v_exp_f32 v30, v30
  v_exp_f32 v31, v31
  v_cvt_pk_bf16_f32 v92, v24, v25
  v_cvt_pk_bf16_f32 v93, v26, v27
  v_cvt_pk_bf16_f32 v94, v28, v29
  v_cvt_pk_bf16_f32 v95, v30, v31
  v_exp_f32 v32, v32
  v_exp_f32 v33, v33
  v_mfma_f32_32x32x16_bf16 v[48:63], v[108:111], v[92:95], v[48:63]
  v_exp_f32 v34, v34
  v_exp_f32 v35, v35
  v_exp_f32 v36, v36
  v_exp_f32 v37, v37
  v_mfma_f32_32x32x16_bf16 v[16:31], v[100:103], v[80:83], 0
  v_exp_f32 v38, v38
  v_exp_f32 v39, v39
  v_cvt_pk_bf16_f32 v88, v32, v33
  v_cvt_pk_bf16_f32 v89, v34, v35
  v_cvt_pk_bf16_f32 v90, v36, v37
  v_cvt_pk_bf16_f32 v91, v38, v39
  v_exp_f32 v40, v40
  v_exp_f32 v41, v41
  v_mfma_f32_32x32x16_bf16 v[64:79], v[104:107], v[88:91], v[64:79]
  v_exp_f32 v42, v42
  v_exp_f32 v43, v43
  v_exp_f32 v44, v44
  v_exp_f32 v45, v45
  v_exp_f32 v46, v46
  v_exp_f32 v47, v47
  v_cvt_pk_bf16_f32 v92, v40, v41
  v_cvt_pk_bf16_f32 v93, v42, v43
  v_cvt_pk_bf16_f32 v94, v44, v45
  v_cvt_pk_bf16_f32 v95, v46, v47
  v_exp_f32 v16, v16
  v_exp_f32 v17, v17
  v_mfma_f32_32x32x16_bf16 v[64:79], v[108:111], v[92:95], v[64:79]
  v_exp_f32 v18, v18
  v_exp_f32 v19, v19
  v_exp_f32 v20, v20
  v_exp_f32 v21, v21
  v_mfma_f32_32x32x16_bf16 v[32:47], v[100:103], v[84:87], 0
  s_waitcnt lgkmcnt(0)
  buffer_load_dwordx4 v[176:179], v2, s[8:11], s32 offen offset:0
  buffer_load_dwordx4 v[180:183], v2, s[8:11], s32 offen offset:1024
  ds_read_b128 v[100:103], v126 offset:5120
  s_mov_b64 exec, s[20:21]
  ds_read_b128 v[104:107], v127 offset:4096
  ds_read_b128 v[108:111], v127 offset:4608
  s_mov_b64 exec, -1
  v_exp_f32 v22, v22
  v_exp_f32 v23, v23
  v_cvt_pk_bf16_f32 v88, v16, v17
  v_cvt_pk_bf16_f32 v89, v18, v19
  v_cvt_pk_bf16_f32 v90, v20, v21
  v_cvt_pk_bf16_f32 v91, v22, v23
  v_exp_f32 v24, v24
  v_exp_f32 v25, v25
  v_mfma_f32_32x32x16_bf16 v[48:63], v[112:115], v[88:91], v[48:63]
  v_exp_f32 v26, v26
  v_exp_f32 v27, v27
  v_exp_f32 v28, v28
  v_exp_f32 v29, v29
  v_exp_f32 v30, v30
  v_exp_f32 v31, v31
  v_cvt_pk_bf16_f32 v92, v24, v25
  v_cvt_pk_bf16_f32 v93, v26, v27
  v_cvt_pk_bf16_f32 v94, v28, v29
  v_cvt_pk_bf16_f32 v95, v30, v31
  v_exp_f32 v32, v32
  v_exp_f32 v33, v33
  v_mfma_f32_32x32x16_bf16 v[48:63], v[116:119], v[92:95], v[48:63]
  v_exp_f32 v34, v34
  v_exp_f32 v35, v35
  v_exp_f32 v36, v36
  v_exp_f32 v37, v37
  v_mfma_f32_32x32x16_bf16 v[16:31], v[96:99], v[80:83], 0
  v_exp_f32 v38, v38
  v_exp_f32 v39, v39
  v_cvt_pk_bf16_f32 v88, v32, v33
  v_cvt_pk_bf16_f32 v89, v34, v35
  v_cvt_pk_bf16_f32 v90, v36, v37
  v_cvt_pk_bf16_f32 v91, v38, v39
  v_exp_f32 v40, v40
  v_exp_f32 v41, v41
  v_mfma_f32_32x32x16_bf16 v[64:79], v[112:115], v[88:91], v[64:79]
  v_exp_f32 v42, v42
  v_exp_f32 v43, v43
  v_exp_f32 v44, v44
  v_exp_f32 v45, v45
  v_exp_f32 v46, v46
  v_exp_f32 v47, v47
  v_cvt_pk_bf16_f32 v92, v40, v41
  v_cvt_pk_bf16_f32 v93, v42, v43
  v_cvt_pk_bf16_f32 v94, v44, v45
  v_cvt_pk_bf16_f32 v95, v46, v47
  v_exp_f32 v16, v16
  v_exp_f32 v17, v17
  v_mfma_f32_32x32x16_bf16 v[64:79], v[116:119], v[92:95], v[64:79]
  v_exp_f32 v18, v18
  v_exp_f32 v19, v19
  v_exp_f32 v20, v20
  v_exp_f32 v21, v21
  v_mfma_f32_32x32x16_bf16 v[32:47], v[96:99], v[84:87], 0
  s_waitcnt lgkmcnt(0)
  s_cmp_eq_u32 s38, 0
  s_cbranch_scc1 prio_31
  s_setprio 0
prio_31:
  buffer_load_dwordx4 v[184:187], v2, s[8:11], s32 offen offset:2048
  buffer_load_dwordx4 v[188:191], v2, s[8:11], s32 offen offset:3072
  s_add_u32 s32, s32, 4096
  ds_read_b128 v[96:99], v126 offset:6144
  s_mov_b64 exec, s[20:21]
  ds_read_b128 v[112:115], v127 offset:5120
  ds_read_b128 v[116:119], v127 offset:5632
  s_mov_b64 exec, -1
  v_exp_f32 v22, v22
  v_exp_f32 v23, v23
  v_cvt_pk_bf16_f32 v88, v16, v17
  v_cvt_pk_bf16_f32 v89, v18, v19
  v_cvt_pk_bf16_f32 v90, v20, v21
  v_cvt_pk_bf16_f32 v91, v22, v23
  v_exp_f32 v24, v24
  v_exp_f32 v25, v25
  v_mfma_f32_32x32x16_bf16 v[48:63], v[104:107], v[88:91], v[48:63]
  v_exp_f32 v26, v26
  v_exp_f32 v27, v27
  v_exp_f32 v28, v28
  v_exp_f32 v29, v29
  v_exp_f32 v30, v30
  v_exp_f32 v31, v31
  v_cvt_pk_bf16_f32 v92, v24, v25
  v_cvt_pk_bf16_f32 v93, v26, v27
  v_cvt_pk_bf16_f32 v94, v28, v29
  v_cvt_pk_bf16_f32 v95, v30, v31
  v_exp_f32 v32, v32
  v_exp_f32 v33, v33
  v_mfma_f32_32x32x16_bf16 v[48:63], v[108:111], v[92:95], v[48:63]
  v_exp_f32 v34, v34
  v_exp_f32 v35, v35
  v_exp_f32 v36, v36
  v_exp_f32 v37, v37
  v_mfma_f32_32x32x16_bf16 v[16:31], v[100:103], v[80:83], 0
  v_exp_f32 v38, v38
  v_exp_f32 v39, v39
  v_cvt_pk_bf16_f32 v88, v32, v33
  v_cvt_pk_bf16_f32 v89, v34, v35
  v_cvt_pk_bf16_f32 v90, v36, v37
  v_cvt_pk_bf16_f32 v91, v38, v39
  v_exp_f32 v40, v40
  v_exp_f32 v41, v41
  v_mfma_f32_32x32x16_bf16 v[64:79], v[104:107], v[88:91], v[64:79]
  v_exp_f32 v42, v42
  v_exp_f32 v43, v43
  v_exp_f32 v44, v44
  v_exp_f32 v45, v45
  v_exp_f32 v46, v46
  v_exp_f32 v47, v47
  v_cvt_pk_bf16_f32 v92, v40, v41
  v_cvt_pk_bf16_f32 v93, v42, v43
  v_cvt_pk_bf16_f32 v94, v44, v45
  v_cvt_pk_bf16_f32 v95, v46, v47
  v_exp_f32 v16, v16
  v_exp_f32 v17, v17
  v_mfma_f32_32x32x16_bf16 v[64:79], v[108:111], v[92:95], v[64:79]
  v_exp_f32 v18, v18
  v_exp_f32 v19, v19
  v_exp_f32 v20, v20
  v_exp_f32 v21, v21
  v_mfma_f32_32x32x16_bf16 v[32:47], v[100:103], v[84:87], 0
  s_waitcnt lgkmcnt(0)
  buffer_load_dwordx4 v[192:195], v2, s[8:11], s32 offen offset:0
  buffer_load_dwordx4 v[196:199], v2, s[8:11], s32 offen offset:1024
  ds_read_b128 v[100:103], v126 offset:7168
  s_mov_b64 exec, s[20:21]
  ds_read_b128 v[104:107], v127 offset:6144
  ds_read_b128 v[108:111], v127 offset:6656
  s_mov_b64 exec, -1
  v_exp_f32 v22, v22
  v_exp_f32 v23, v23
  v_cvt_pk_bf16_f32 v88, v16, v17
  v_cvt_pk_bf16_f32 v89, v18, v19
  v_cvt_pk_bf16_f32 v90, v20, v21
  v_cvt_pk_bf16_f32 v91, v22, v23
  v_exp_f32 v24, v24
  v_exp_f32 v25, v25
  v_mfma_f32_32x32x16_bf16 v[48:63], v[112:115], v[88:91], v[48:63]
  v_exp_f32 v26, v26
  v_exp_f32 v27, v27
  v_exp_f32 v28, v28
  v_exp_f32 v29, v29
  v_exp_f32 v30, v30
  v_exp_f32 v31, v31
  v_cvt_pk_bf16_f32 v92, v24, v25
  v_cvt_pk_bf16_f32 v93, v26, v27
  v_cvt_pk_bf16_f32 v94, v28, v29
  v_cvt_pk_bf16_f32 v95, v30, v31
  v_exp_f32 v32, v32
  v_exp_f32 v33, v33
  v_mfma_f32_32x32x16_bf16 v[48:63], v[116:119], v[92:95], v[48:63]
  v_exp_f32 v34, v34
  v_exp_f32 v35, v35
  v_exp_f32 v36, v36
  v_exp_f32 v37, v37
  v_mfma_f32_32x32x16_bf16 v[16:31], v[96:99], v[80:83], 0
  v_exp_f32 v38, v38
  v_exp_f32 v39, v39
  v_cvt_pk_bf16_f32 v88, v32, v33
  v_cvt_pk_bf16_f32 v89, v34, v35
  v_cvt_pk_bf16_f32 v90, v36, v37
  v_cvt_pk_bf16_f32 v91, v38, v39
  v_exp_f32 v40, v40
  v_exp_f32 v41, v41
  v_mfma_f32_32x32x16_bf16 v[64:79], v[112:115], v[88:91], v[64:79]
  v_exp_f32 v42, v42
  v_exp_f32 v43, v43
  v_exp_f32 v44, v44
  v_exp_f32 v45, v45
  v_exp_f32 v46, v46
  v_exp_f32 v47, v47
  v_cvt_pk_bf16_f32 v92, v40, v41
  v_cvt_pk_bf16_f32 v93, v42, v43
  v_cvt_pk_bf16_f32 v94, v44, v45
  v_cvt_pk_bf16_f32 v95, v46, v47
  v_exp_f32 v16, v16
  v_exp_f32 v17, v17
  v_mfma_f32_32x32x16_bf16 v[64:79], v[116:119], v[92:95], v[64:79]
  v_exp_f32 v18, v18
  v_exp_f32 v19, v19
  v_exp_f32 v20, v20
  v_exp_f32 v21, v21
  v_mfma_f32_32x32x16_bf16 v[32:47], v[96:99], v[84:87], 0
  s_waitcnt lgkmcnt(0)
  s_cmp_eq_u32 s38, 0
  s_cbranch_scc1 prio_32
  s_setprio 1
prio_32:
  s_waitcnt vmcnt(18)
  s_barrier
  s_lshl_b32 s28, s14, 12
  s_add_u32 m0, s28, 32768
  s_add_u32 s28, s33, 57344
  buffer_load_dwordx4 v2, s[8:11], s28 offen offset:0 lds
  buffer_load_dwordx4 v2, s[8:11], s28 offen offset:1024 lds
  buffer_load_dwordx4 v2, s[8:11], s28 offen offset:2048 lds
  buffer_load_dwordx4 v2, s[8:11], s28 offen offset:3072 lds
  buffer_load_dwordx4 v[200:203], v2, s[8:11], s32 offen offset:2048
  ds_read_b128 v[96:99], v126 offset:32768
  s_mov_b64 exec, s[20:21]
  ds_read_b128 v[112:115], v127 offset:7168
  ds_read_b128 v[116:119], v127 offset:7680
  s_mov_b64 exec, -1
  v_exp_f32 v22, v22
  v_exp_f32 v23, v23
  v_cvt_pk_bf16_f32 v88, v16, v17
  v_cvt_pk_bf16_f32 v89, v18, v19
  v_cvt_pk_bf16_f32 v90, v20, v21
  v_cvt_pk_bf16_f32 v91, v22, v23
  v_exp_f32 v24, v24
  v_exp_f32 v25, v25
  v_mfma_f32_32x32x16_bf16 v[48:63], v[104:107], v[88:91], v[48:63]
  v_exp_f32 v26, v26
  v_exp_f32 v27, v27
  v_exp_f32 v28, v28
  v_exp_f32 v29, v29
  v_exp_f32 v30, v30
  v_exp_f32 v31, v31
  v_cvt_pk_bf16_f32 v92, v24, v25
  v_cvt_pk_bf16_f32 v93, v26, v27
  v_cvt_pk_bf16_f32 v94, v28, v29
  v_cvt_pk_bf16_f32 v95, v30, v31
  v_exp_f32 v32, v32
  v_exp_f32 v33, v33
  v_mfma_f32_32x32x16_bf16 v[48:63], v[108:111], v[92:95], v[48:63]
  v_exp_f32 v34, v34
  v_exp_f32 v35, v35
  v_exp_f32 v36, v36
  v_exp_f32 v37, v37
  v_mfma_f32_32x32x16_bf16 v[16:31], v[100:103], v[80:83], 0
  v_exp_f32 v38, v38
  v_exp_f32 v39, v39
  v_cvt_pk_bf16_f32 v88, v32, v33
  v_cvt_pk_bf16_f32 v89, v34, v35
  v_cvt_pk_bf16_f32 v90, v36, v37
  v_cvt_pk_bf16_f32 v91, v38, v39
  v_exp_f32 v40, v40
  v_exp_f32 v41, v41
  v_mfma_f32_32x32x16_bf16 v[64:79], v[104:107], v[88:91], v[64:79]
  v_exp_f32 v42, v42
  v_exp_f32 v43, v43
  v_exp_f32 v44, v44
  v_exp_f32 v45, v45
  v_exp_f32 v46, v46
  v_exp_f32 v47, v47
  v_cvt_pk_bf16_f32 v92, v40, v41
  v_cvt_pk_bf16_f32 v93, v42, v43
  v_cvt_pk_bf16_f32 v94, v44, v45
  v_cvt_pk_bf16_f32 v95, v46, v47
  v_exp_f32 v16, v16
  v_exp_f32 v17, v17
  v_mfma_f32_32x32x16_bf16 v[64:79], v[108:111], v[92:95], v[64:79]
  v_exp_f32 v18, v18
  v_exp_f32 v19, v19
  v_exp_f32 v20, v20
  v_exp_f32 v21, v21
  v_mfma_f32_32x32x16_bf16 v[32:47], v[100:103], v[84:87], 0
  s_waitcnt lgkmcnt(0)
  buffer_load_dwordx4 v[204:207], v2, s[8:11], s32 offen offset:3072
  s_add_u32 s32, s32, 4096
  buffer_load_dwordx4 v[208:211], v2, s[8:11], s32 offen offset:0
  ds_read_b128 v[100:103], v126 offset:33792
  s_mov_b64 exec, s[20:21]
  ds_read_b128 v[104:107], v127 offset:32768
  ds_read_b128 v[108:111], v127 offset:33280
  s_mov_b64 exec, -1
  v_exp_f32 v22, v22
  v_exp_f32 v23, v23
  v_cvt_pk_bf16_f32 v88, v16, v17
  v_cvt_pk_bf16_f32 v89, v18, v19
  v_cvt_pk_bf16_f32 v90, v20, v21
  v_cvt_pk_bf16_f32 v91, v22, v23
  v_exp_f32 v24, v24
  v_exp_f32 v25, v25
  v_mfma_f32_32x32x16_bf16 v[48:63], v[112:115], v[88:91], v[48:63]
  v_exp_f32 v26, v26
  v_exp_f32 v27, v27
  v_exp_f32 v28, v28
  v_exp_f32 v29, v29
  v_exp_f32 v30, v30
  v_exp_f32 v31, v31
  v_cvt_pk_bf16_f32 v92, v24, v25
  v_cvt_pk_bf16_f32 v93, v26, v27
  v_cvt_pk_bf16_f32 v94, v28, v29
  v_cvt_pk_bf16_f32 v95, v30, v31
  v_exp_f32 v32, v32
  v_exp_f32 v33, v33
  v_mfma_f32_32x32x16_bf16 v[48:63], v[116:119], v[92:95], v[48:63]
  v_exp_f32 v34, v34
  v_exp_f32 v35, v35
  v_exp_f32 v36, v36
  v_exp_f32 v37, v37
  v_mfma_f32_32x32x16_bf16 v[16:31], v[96:99], v[80:83], 0
  v_exp_f32 v38, v38
  v_exp_f32 v39, v39
  v_cvt_pk_bf16_f32 v88, v32, v33
  v_cvt_pk_bf16_f32 v89, v34, v35
  v_cvt_pk_bf16_f32 v90, v36, v37
  v_cvt_pk_bf16_f32 v91, v38, v39
  v_exp_f32 v40, v40
  v_exp_f32 v41, v41
  v_mfma_f32_32x32x16_bf16 v[64:79], v[112:115], v[88:91], v[64:79]
  v_exp_f32 v42, v42
  v_exp_f32 v43, v43
  v_exp_f32 v44, v44
  v_exp_f32 v45, v45
  v_exp_f32 v46, v46
  v_exp_f32 v47, v47
  v_cvt_pk_bf16_f32 v92, v40, v41
  v_cvt_pk_bf16_f32 v93, v42, v43
  v_cvt_pk_bf16_f32 v94, v44, v45
  v_cvt_pk_bf16_f32 v95, v46, v47
  v_exp_f32 v16, v16
  v_exp_f32 v17, v17
  v_mfma_f32_32x32x16_bf16 v[64:79], v[116:119], v[92:95], v[64:79]
  v_exp_f32 v18, v18
  v_exp_f32 v19, v19
  v_exp_f32 v20, v20
  v_exp_f32 v21, v21
  v_mfma_f32_32x32x16_bf16 v[32:47], v[96:99], v[84:87], 0
  s_waitcnt lgkmcnt(0)
  buffer_load_dwordx4 v[212:215], v2, s[8:11], s32 offen offset:1024
  buffer_load_dwordx4 v[216:219], v2, s[8:11], s32 offen offset:2048
  ds_read_b128 v[96:99], v126 offset:34816
  s_mov_b64 exec, s[20:21]
  ds_read_b128 v[112:115], v127 offset:33792
  ds_read_b128 v[116:119], v127 offset:34304
  s_mov_b64 exec, -1
  v_exp_f32 v22, v22
  v_exp_f32 v23, v23
  v_cvt_pk_bf16_f32 v88, v16, v17
  v_cvt_pk_bf16_f32 v89, v18, v19
  v_cvt_pk_bf16_f32 v90, v20, v21
  v_cvt_pk_bf16_f32 v91, v22, v23
  v_exp_f32 v24, v24
  v_exp_f32 v25, v25
  v_mfma_f32_32x32x16_bf16 v[48:63], v[104:107], v[88:91], v[48:63]
  v_exp_f32 v26, v26
  v_exp_f32 v27, v27
  v_exp_f32 v28, v28
  v_exp_f32 v29, v29
  v_exp_f32 v30, v30
  v_exp_f32 v31, v31
  v_cvt_pk_bf16_f32 v92, v24, v25
  v_cvt_pk_bf16_f32 v93, v26, v27
  v_cvt_pk_bf16_f32 v94, v28, v29
  v_cvt_pk_bf16_f32 v95, v30, v31
  v_exp_f32 v32, v32
  v_exp_f32 v33, v33
  v_mfma_f32_32x32x16_bf16 v[48:63], v[108:111], v[92:95], v[48:63]
  v_exp_f32 v34, v34
  v_exp_f32 v35, v35
  v_exp_f32 v36, v36
  v_exp_f32 v37, v37
  v_mfma_f32_32x32x16_bf16 v[16:31], v[100:103], v[80:83], 0
  v_exp_f32 v38, v38
  v_exp_f32 v39, v39
  v_cvt_pk_bf16_f32 v88, v32, v33
  v_cvt_pk_bf16_f32 v89, v34, v35
  v_cvt_pk_bf16_f32 v90, v36, v37
  v_cvt_pk_bf16_f32 v91, v38, v39
  v_exp_f32 v40, v40
  v_exp_f32 v41, v41
  v_mfma_f32_32x32x16_bf16 v[64:79], v[104:107], v[88:91], v[64:79]
  v_exp_f32 v42, v42
  v_exp_f32 v43, v43
  v_exp_f32 v44, v44
  v_exp_f32 v45, v45
  v_exp_f32 v46, v46
  v_exp_f32 v47, v47
  v_cvt_pk_bf16_f32 v92, v40, v41
  v_cvt_pk_bf16_f32 v93, v42, v43
  v_cvt_pk_bf16_f32 v94, v44, v45
  v_cvt_pk_bf16_f32 v95, v46, v47
  v_exp_f32 v16, v16
  v_exp_f32 v17, v17
  v_mfma_f32_32x32x16_bf16 v[64:79], v[108:111], v[92:95], v[64:79]
  v_exp_f32 v18, v18
  v_exp_f32 v19, v19
  v_exp_f32 v20, v20
  v_exp_f32 v21, v21
  v_mfma_f32_32x32x16_bf16 v[32:47], v[100:103], v[84:87], 0
  s_waitcnt lgkmcnt(0)
  buffer_load_dwordx4 v[220:223], v2, s[8:11], s32 offen offset:3072
  s_add_u32 s32, s32, 4096
  buffer_load_dwordx4 v[224:227], v2, s[8:11], s32 offen offset:0
  ds_read_b128 v[100:103], v126 offset:35840
  s_mov_b64 exec, s[20:21]
  ds_read_b128 v[104:107], v127 offset:34816
  ds_read_b128 v[108:111], v127 offset:35328
  s_mov_b64 exec, -1
  v_exp_f32 v22, v22
  v_exp_f32 v23, v23
  v_cvt_pk_bf16_f32 v88, v16, v17
  v_cvt_pk_bf16_f32 v89, v18, v19
  v_cvt_pk_bf16_f32 v90, v20, v21
  v_cvt_pk_bf16_f32 v91, v22, v23
  v_exp_f32 v24, v24
  v_exp_f32 v25, v25
  v_mfma_f32_32x32x16_bf16 v[48:63], v[112:115], v[88:91], v[48:63]
  v_exp_f32 v26, v26
  v_exp_f32 v27, v27
  v_exp_f32 v28, v28
  v_exp_f32 v29, v29
  v_exp_f32 v30, v30
  v_exp_f32 v31, v31
  v_cvt_pk_bf16_f32 v92, v24, v25
  v_cvt_pk_bf16_f32 v93, v26, v27
  v_cvt_pk_bf16_f32 v94, v28, v29
  v_cvt_pk_bf16_f32 v95, v30, v31
  v_exp_f32 v32, v32
  v_exp_f32 v33, v33
  v_mfma_f32_32x32x16_bf16 v[48:63], v[116:119], v[92:95], v[48:63]
  v_exp_f32 v34, v34
  v_exp_f32 v35, v35
  v_exp_f32 v36, v36
  v_exp_f32 v37, v37
  v_mfma_f32_32x32x16_bf16 v[16:31], v[96:99], v[80:83], 0
  v_exp_f32 v38, v38
  v_exp_f32 v39, v39
  v_cvt_pk_bf16_f32 v88, v32, v33
  v_cvt_pk_bf16_f32 v89, v34, v35
  v_cvt_pk_bf16_f32 v90, v36, v37
  v_cvt_pk_bf16_f32 v91, v38, v39
  v_exp_f32 v40, v40
  v_exp_f32 v41, v41
  v_mfma_f32_32x32x16_bf16 v[64:79], v[112:115], v[88:91], v[64:79]
  v_exp_f32 v42, v42
  v_exp_f32 v43, v43
  v_exp_f32 v44, v44
  v_exp_f32 v45, v45
  v_exp_f32 v46, v46
  v_exp_f32 v47, v47
  v_cvt_pk_bf16_f32 v92, v40, v41
  v_cvt_pk_bf16_f32 v93, v42, v43
  v_cvt_pk_bf16_f32 v94, v44, v45
  v_cvt_pk_bf16_f32 v95, v46, v47
  v_exp_f32 v16, v16
  v_exp_f32 v17, v17
  v_mfma_f32_32x32x16_bf16 v[64:79], v[116:119], v[92:95], v[64:79]
  v_exp_f32 v18, v18
  v_exp_f32 v19, v19
  v_exp_f32 v20, v20
  v_exp_f32 v21, v21
  v_mfma_f32_32x32x16_bf16 v[32:47], v[96:99], v[84:87], 0
  s_waitcnt lgkmcnt(0)
  buffer_load_dwordx4 v[228:231], v2, s[8:11], s32 offen offset:1024
  buffer_load_dwordx4 v[128:131], v2, s[8:11], s46 offen offset:0
  buffer_load_dwordx4 v[132:135], v2, s[8:11], s46 offen offset:1024
  ds_read_b128 v[96:99], v126 offset:36864
  s_mov_b64 exec, s[20:21]
  ds_read_b128 v[112:115], v127 offset:35840
  ds_read_b128 v[116:119], v127 offset:36352
  s_mov_b64 exec, -1
  v_exp_f32 v22, v22
  v_exp_f32 v23, v23
  v_cvt_pk_bf16_f32 v88, v16, v17
  v_cvt_pk_bf16_f32 v89, v18, v19
  v_cvt_pk_bf16_f32 v90, v20, v21
  v_cvt_pk_bf16_f32 v91, v22, v23
  v_exp_f32 v24, v24
  v_exp_f32 v25, v25
  v_mfma_f32_32x32x16_bf16 v[48:63], v[104:107], v[88:91], v[48:63]
  v_exp_f32 v26, v26
  v_exp_f32 v27, v27
  v_exp_f32 v28, v28
  v_exp_f32 v29, v29
  v_exp_f32 v30, v30
  v_exp_f32 v31, v31
  v_cvt_pk_bf16_f32 v92, v24, v25
  v_cvt_pk_bf16_f32 v93, v26, v27
  v_cvt_pk_bf16_f32 v94, v28, v29
  v_cvt_pk_bf16_f32 v95, v30, v31
  v_exp_f32 v32, v32
  v_exp_f32 v33, v33
  v_mfma_f32_32x32x16_bf16 v[48:63], v[108:111], v[92:95], v[48:63]
  v_exp_f32 v34, v34
  v_exp_f32 v35, v35
  v_exp_f32 v36, v36
  v_exp_f32 v37, v37
  v_mfma_f32_32x32x16_bf16 v[16:31], v[100:103], v[80:83], 0
  v_exp_f32 v38, v38
  v_exp_f32 v39, v39
  v_cvt_pk_bf16_f32 v88, v32, v33
  v_cvt_pk_bf16_f32 v89, v34, v35
  v_cvt_pk_bf16_f32 v90, v36, v37
  v_cvt_pk_bf16_f32 v91, v38, v39
  v_exp_f32 v40, v40
  v_exp_f32 v41, v41
  v_mfma_f32_32x32x16_bf16 v[64:79], v[104:107], v[88:91], v[64:79]
  v_exp_f32 v42, v42
  v_exp_f32 v43, v43
  v_exp_f32 v44, v44
  v_exp_f32 v45, v45
  v_exp_f32 v46, v46
  v_exp_f32 v47, v47
  v_cvt_pk_bf16_f32 v92, v40, v41
  v_cvt_pk_bf16_f32 v93, v42, v43
  v_cvt_pk_bf16_f32 v94, v44, v45
  v_cvt_pk_bf16_f32 v95, v46, v47
  v_exp_f32 v16, v16
  v_exp_f32 v17, v17
  v_mfma_f32_32x32x16_bf16 v[64:79], v[108:111], v[92:95], v[64:79]
  v_exp_f32 v18, v18
  v_exp_f32 v19, v19
  v_exp_f32 v20, v20
  v_exp_f32 v21, v21
  v_mfma_f32_32x32x16_bf16 v[32:47], v[100:103], v[84:87], 0
  s_waitcnt lgkmcnt(0)
  buffer_load_dwordx4 v[232:235], v2, s[8:11], s32 offen offset:2048
  buffer_load_dwordx4 v[236:239], v2, s[8:11], s32 offen offset:3072
  s_add_u32 s32, s32, 4096
  buffer_load_dwordx4 v[136:139], v2, s[8:11], s46 offen offset:2048
  buffer_load_dwordx4 v[140:143], v2, s[8:11], s46 offen offset:3072
  ds_read_b128 v[100:103], v126 offset:37888
  s_mov_b64 exec, s[20:21]
  ds_read_b128 v[104:107], v127 offset:36864
  ds_read_b128 v[108:111], v127 offset:37376
  s_mov_b64 exec, -1
  v_exp_f32 v22, v22
  v_exp_f32 v23, v23
  v_cvt_pk_bf16_f32 v88, v16, v17
  v_cvt_pk_bf16_f32 v89, v18, v19
  v_cvt_pk_bf16_f32 v90, v20, v21
  v_cvt_pk_bf16_f32 v91, v22, v23
  v_exp_f32 v24, v24
  v_exp_f32 v25, v25
  v_mfma_f32_32x32x16_bf16 v[48:63], v[112:115], v[88:91], v[48:63]
  v_exp_f32 v26, v26
  v_exp_f32 v27, v27
  v_exp_f32 v28, v28
  v_exp_f32 v29, v29
  v_exp_f32 v30, v30
  v_exp_f32 v31, v31
  v_cvt_pk_bf16_f32 v92, v24, v25
  v_cvt_pk_bf16_f32 v93, v26, v27
  v_cvt_pk_bf16_f32 v94, v28, v29
  v_cvt_pk_bf16_f32 v95, v30, v31
  v_exp_f32 v32, v32
  v_exp_f32 v33, v33
  v_mfma_f32_32x32x16_bf16 v[48:63], v[116:119], v[92:95], v[48:63]
  v_exp_f32 v34, v34
  v_exp_f32 v35, v35
  v_exp_f32 v36, v36
  v_exp_f32 v37, v37
  v_mfma_f32_32x32x16_bf16 v[16:31], v[96:99], v[80:83], 0
  v_exp_f32 v38, v38
  v_exp_f32 v39, v39
  v_cvt_pk_bf16_f32 v88, v32, v33
  v_cvt_pk_bf16_f32 v89, v34, v35
  v_cvt_pk_bf16_f32 v90, v36, v37
  v_cvt_pk_bf16_f32 v91, v38, v39
  v_exp_f32 v40, v40
  v_exp_f32 v41, v41
  v_mfma_f32_32x32x16_bf16 v[64:79], v[112:115], v[88:91], v[64:79]
  v_exp_f32 v42, v42
  v_exp_f32 v43, v43
  v_exp_f32 v44, v44
  v_exp_f32 v45, v45
  v_exp_f32 v46, v46
  v_exp_f32 v47, v47
  v_cvt_pk_bf16_f32 v92, v40, v41
  v_cvt_pk_bf16_f32 v93, v42, v43
  v_cvt_pk_bf16_f32 v94, v44, v45
  v_cvt_pk_bf16_f32 v95, v46, v47
  v_exp_f32 v16, v16
  v_exp_f32 v17, v17
  v_mfma_f32_32x32x16_bf16 v[64:79], v[116:119], v[92:95], v[64:79]
  v_exp_f32 v18, v18
  v_exp_f32 v19, v19
  v_exp_f32 v20, v20
  v_exp_f32 v21, v21
  v_mfma_f32_32x32x16_bf16 v[32:47], v[96:99], v[84:87], 0
  s_waitcnt lgkmcnt(0)
  buffer_load_dwordx4 v[240:243], v2, s[8:11], s32 offen offset:0
  buffer_load_dwordx4 v[244:247], v2, s[8:11], s32 offen offset:1024
  s_and_b32 s16, s13, 7
  s_lshr_b32 s15, s13, 3
  s_lshl_b32 s15, s15, 1
  s_lshl_b32 s19, s12, 3
  s_add_u32 s15, s15, s19
  s_and_b32 s18, s14, 1
  s_lshr_b32 s17, s14, 1
  s_lshr_b32 s49, s14, 2
  s_and_b32 s48, s17, 1
  s_add_u32 s20, s15, s49
  s_lshl_b32 s21, s16, 1
  s_and_b32 s19, s14, 1
  s_add_u32 s21, s21, s19
  s_lshl_b32 s21, s21, 1
  s_add_u32 s21, s21, s48
  s_lshl_b32 s19, s20, 5
  s_add_u32 s19, s19, s21
  s_lshl_b32 s19, s19, 10
  v_lshlrev_b32 v12, 10, v3
  v_lshl_add_u32 v12, v4, 4, v12
  s_lshl_b32 s22, s20, 15
  s_lshl_b32 s23, s21, 5
  s_add_u32 s22, s22, s23
  buffer_load_dwordx4 v[120:123], v12, s[80:83], s22 offen
  s_mov_b32 s20, 0xffff0000
  s_mov_b32 s21, 0xffff0000
  ds_read_b128 v[96:99], v126 offset:38912
  s_mov_b64 exec, s[20:21]
  ds_read_b128 v[112:115], v127 offset:37888
  ds_read_b128 v[116:119], v127 offset:38400
  s_mov_b64 exec, -1
  v_exp_f32 v22, v22
  v_exp_f32 v23, v23
  v_cvt_pk_bf16_f32 v88, v16, v17
  v_cvt_pk_bf16_f32 v89, v18, v19
  v_cvt_pk_bf16_f32 v90, v20, v21
  v_cvt_pk_bf16_f32 v91, v22, v23
  v_exp_f32 v24, v24
  v_exp_f32 v25, v25
  v_mfma_f32_32x32x16_bf16 v[48:63], v[104:107], v[88:91], v[48:63]
  v_exp_f32 v26, v26
  v_exp_f32 v27, v27
  v_exp_f32 v28, v28
  v_exp_f32 v29, v29
  v_exp_f32 v30, v30
  v_exp_f32 v31, v31
  v_cvt_pk_bf16_f32 v92, v24, v25
  v_cvt_pk_bf16_f32 v93, v26, v27
  v_cvt_pk_bf16_f32 v94, v28, v29
  v_cvt_pk_bf16_f32 v95, v30, v31
  v_exp_f32 v32, v32
  v_exp_f32 v33, v33
  v_mfma_f32_32x32x16_bf16 v[48:63], v[108:111], v[92:95], v[48:63]
  v_exp_f32 v34, v34
  v_exp_f32 v35, v35
  v_exp_f32 v36, v36
  v_exp_f32 v37, v37
  v_mfma_f32_32x32x16_bf16 v[16:31], v[100:103], v[80:83], 0
  v_exp_f32 v38, v38
  v_exp_f32 v39, v39
  v_cvt_pk_bf16_f32 v88, v32, v33
  v_cvt_pk_bf16_f32 v89, v34, v35
  v_cvt_pk_bf16_f32 v90, v36, v37
  v_cvt_pk_bf16_f32 v91, v38, v39
  v_exp_f32 v40, v40
  v_exp_f32 v41, v41
  v_mfma_f32_32x32x16_bf16 v[64:79], v[104:107], v[88:91], v[64:79]
  v_exp_f32 v42, v42
  v_exp_f32 v43, v43
  v_exp_f32 v44, v44
  v_exp_f32 v45, v45
  v_exp_f32 v46, v46
  v_exp_f32 v47, v47
  v_cvt_pk_bf16_f32 v92, v40, v41
  v_cvt_pk_bf16_f32 v93, v42, v43
  v_cvt_pk_bf16_f32 v94, v44, v45
  v_cvt_pk_bf16_f32 v95, v46, v47
  v_exp_f32 v16, v16
  v_exp_f32 v17, v17
  v_mfma_f32_32x32x16_bf16 v[64:79], v[108:111], v[92:95], v[64:79]
  v_exp_f32 v18, v18
  v_exp_f32 v19, v19
  v_exp_f32 v20, v20
  v_exp_f32 v21, v21
  v_mfma_f32_32x32x16_bf16 v[32:47], v[100:103], v[84:87], 0
  s_waitcnt lgkmcnt(0)
  buffer_load_dwordx4 v[248:251], v2, s[8:11], s32 offen offset:2048
  buffer_load_dwordx4 v[252:255], v2, s[8:11], s32 offen offset:3072
  s_add_u32 s32, s32, 4096
  ds_read_b128 v[100:103], v126 offset:39936
  s_mov_b64 exec, s[20:21]
  ds_read_b128 v[104:107], v127 offset:38912
  ds_read_b128 v[108:111], v127 offset:39424
  s_mov_b64 exec, -1
  v_exp_f32 v22, v22
  v_exp_f32 v23, v23
  v_cvt_pk_bf16_f32 v88, v16, v17
  v_cvt_pk_bf16_f32 v89, v18, v19
  v_cvt_pk_bf16_f32 v90, v20, v21
  v_cvt_pk_bf16_f32 v91, v22, v23
  v_exp_f32 v24, v24
  v_exp_f32 v25, v25
  v_mfma_f32_32x32x16_bf16 v[48:63], v[112:115], v[88:91], v[48:63]
  v_exp_f32 v26, v26
  v_exp_f32 v27, v27
  v_exp_f32 v28, v28
  v_exp_f32 v29, v29
  v_exp_f32 v30, v30
  v_exp_f32 v31, v31
  v_cvt_pk_bf16_f32 v92, v24, v25
  v_cvt_pk_bf16_f32 v93, v26, v27
  v_cvt_pk_bf16_f32 v94, v28, v29
  v_cvt_pk_bf16_f32 v95, v30, v31
  v_exp_f32 v32, v32
  v_exp_f32 v33, v33
  v_mfma_f32_32x32x16_bf16 v[48:63], v[116:119], v[92:95], v[48:63]
  v_exp_f32 v34, v34
  v_exp_f32 v35, v35
  v_exp_f32 v36, v36
  v_exp_f32 v37, v37
  v_mfma_f32_32x32x16_bf16 v[16:31], v[96:99], v[80:83], 0
  v_exp_f32 v38, v38
  v_exp_f32 v39, v39
  v_cvt_pk_bf16_f32 v88, v32, v33
  v_cvt_pk_bf16_f32 v89, v34, v35
  v_cvt_pk_bf16_f32 v90, v36, v37
  v_cvt_pk_bf16_f32 v91, v38, v39
  v_exp_f32 v40, v40
  v_exp_f32 v41, v41
  v_mfma_f32_32x32x16_bf16 v[64:79], v[112:115], v[88:91], v[64:79]
  v_exp_f32 v42, v42
  v_exp_f32 v43, v43
  v_exp_f32 v44, v44
  v_exp_f32 v45, v45
  v_exp_f32 v46, v46
  v_exp_f32 v47, v47
  v_cvt_pk_bf16_f32 v92, v40, v41
  v_cvt_pk_bf16_f32 v93, v42, v43
  v_cvt_pk_bf16_f32 v94, v44, v45
  v_cvt_pk_bf16_f32 v95, v46, v47
  v_exp_f32 v16, v16
  v_exp_f32 v17, v17
  v_mfma_f32_32x32x16_bf16 v[64:79], v[116:119], v[92:95], v[64:79]
  v_exp_f32 v18, v18
  v_exp_f32 v19, v19
  v_exp_f32 v20, v20
  v_exp_f32 v21, v21
  v_mfma_f32_32x32x16_bf16 v[32:47], v[96:99], v[84:87], 0
  s_waitcnt lgkmcnt(0)
  s_cmp_eq_u32 s38, 0
  s_cbranch_scc1 prio_33
  s_setprio 0
prio_33:
  buffer_load_dwordx4 v[96:99], v2, s[8:11], s47 offen offset:0
  s_mov_b64 exec, s[20:21]
  ds_read_b128 v[112:115], v127 offset:39936
  ds_read_b128 v[116:119], v127 offset:40448
  s_mov_b64 exec, -1
  v_exp_f32 v22, v22
  v_exp_f32 v23, v23
  v_cvt_pk_bf16_f32 v88, v16, v17
  v_cvt_pk_bf16_f32 v89, v18, v19
  v_cvt_pk_bf16_f32 v90, v20, v21
  v_cvt_pk_bf16_f32 v91, v22, v23
  v_exp_f32 v24, v24
  v_exp_f32 v25, v25
  v_mfma_f32_32x32x16_bf16 v[48:63], v[104:107], v[88:91], v[48:63]
  v_exp_f32 v26, v26
  v_exp_f32 v27, v27
  v_exp_f32 v28, v28
  v_exp_f32 v29, v29
  v_exp_f32 v30, v30
  v_exp_f32 v31, v31
  v_cvt_pk_bf16_f32 v92, v24, v25
  v_cvt_pk_bf16_f32 v93, v26, v27
  v_cvt_pk_bf16_f32 v94, v28, v29
  v_cvt_pk_bf16_f32 v95, v30, v31
  v_exp_f32 v32, v32
  v_exp_f32 v33, v33
  v_mfma_f32_32x32x16_bf16 v[48:63], v[108:111], v[92:95], v[48:63]
  v_exp_f32 v34, v34
  v_exp_f32 v35, v35
  v_exp_f32 v36, v36
  v_exp_f32 v37, v37
  v_mfma_f32_32x32x16_bf16 v[16:31], v[100:103], v[80:83], 0
  v_exp_f32 v38, v38
  v_exp_f32 v39, v39
  v_cvt_pk_bf16_f32 v88, v32, v33
  v_cvt_pk_bf16_f32 v89, v34, v35
  v_cvt_pk_bf16_f32 v90, v36, v37
  v_cvt_pk_bf16_f32 v91, v38, v39
  v_exp_f32 v40, v40
  v_exp_f32 v41, v41
  v_mfma_f32_32x32x16_bf16 v[64:79], v[104:107], v[88:91], v[64:79]
  v_exp_f32 v42, v42
  v_exp_f32 v43, v43
  v_exp_f32 v44, v44
  v_exp_f32 v45, v45
  v_exp_f32 v46, v46
  v_exp_f32 v47, v47
  v_cvt_pk_bf16_f32 v92, v40, v41
  v_cvt_pk_bf16_f32 v93, v42, v43
  v_cvt_pk_bf16_f32 v94, v44, v45
  v_cvt_pk_bf16_f32 v95, v46, v47
  v_exp_f32 v16, v16
  v_exp_f32 v17, v17
  v_mfma_f32_32x32x16_bf16 v[64:79], v[108:111], v[92:95], v[64:79]
  v_exp_f32 v18, v18
  v_exp_f32 v19, v19
  v_exp_f32 v20, v20
  v_exp_f32 v21, v21
  v_mfma_f32_32x32x16_bf16 v[32:47], v[100:103], v[84:87], 0
  s_waitcnt lgkmcnt(0)
  buffer_load_dwordx4 v[104:107], v2, s[8:11], s47 offen offset:1024
  buffer_load_dwordx4 v[108:111], v2, s[8:11], s47 offen offset:2048
  buffer_load_dwordx4 v[100:103], v2, s[8:11], s47 offen offset:3072
  v_exp_f32 v22, v22
  v_exp_f32 v23, v23
  v_cvt_pk_bf16_f32 v88, v16, v17
  v_cvt_pk_bf16_f32 v89, v18, v19
  v_cvt_pk_bf16_f32 v90, v20, v21
  v_cvt_pk_bf16_f32 v91, v22, v23
  v_exp_f32 v24, v24
  v_exp_f32 v25, v25
  v_mfma_f32_32x32x16_bf16 v[48:63], v[112:115], v[88:91], v[48:63]
  v_exp_f32 v26, v26
  v_exp_f32 v27, v27
  v_exp_f32 v28, v28
  v_exp_f32 v29, v29
  v_exp_f32 v30, v30
  v_exp_f32 v31, v31
  v_cvt_pk_bf16_f32 v92, v24, v25
  v_cvt_pk_bf16_f32 v93, v26, v27
  v_cvt_pk_bf16_f32 v94, v28, v29
  v_cvt_pk_bf16_f32 v95, v30, v31
  v_exp_f32 v32, v32
  v_exp_f32 v33, v33
  v_mfma_f32_32x32x16_bf16 v[48:63], v[116:119], v[92:95], v[48:63]
  v_exp_f32 v34, v34
  v_exp_f32 v35, v35
  v_exp_f32 v36, v36
  v_exp_f32 v37, v37
  v_exp_f32 v38, v38
  v_exp_f32 v39, v39
  v_cvt_pk_bf16_f32 v88, v32, v33
  v_cvt_pk_bf16_f32 v89, v34, v35
  v_cvt_pk_bf16_f32 v90, v36, v37
  v_cvt_pk_bf16_f32 v91, v38, v39
  v_exp_f32 v40, v40
  v_exp_f32 v41, v41
  v_mfma_f32_32x32x16_bf16 v[64:79], v[112:115], v[88:91], v[64:79]
  v_exp_f32 v42, v42
  v_exp_f32 v43, v43
  v_exp_f32 v44, v44
  v_exp_f32 v45, v45
  v_exp_f32 v46, v46
  v_exp_f32 v47, v47
  v_cvt_pk_bf16_f32 v92, v40, v41
  v_cvt_pk_bf16_f32 v93, v42, v43
  v_cvt_pk_bf16_f32 v94, v44, v45
  v_cvt_pk_bf16_f32 v95, v46, v47
  s_nop 1
att0_epi:
  v_mfma_f32_32x32x16_bf16 v[64:79], v[116:119], v[92:95], v[64:79]
  s_nop 9
  s_cmp_lg_u32 s38, 0
  s_cbranch_scc1 epib_34
  ds_write_b128 v8, v[72:75]
  ds_write_b128 v8, v[76:79] offset:1024
  ds_write_b32 v8, v64 offset:2048
  s_branch epij_35
epib_34:
  ds_write_b128 v8, v[56:59]
  ds_write_b128 v8, v[60:63] offset:1024
  ds_write_b32 v8, v48 offset:2048
  s_waitcnt lgkmcnt(0)
  v_mov_b32 v48, v64
  v_mov_b32 v56, v72
  v_mov_b32 v57, v73
  v_mov_b32 v58, v74
  v_mov_b32 v59, v75
  v_mov_b32 v60, v76
  v_mov_b32 v61, v77
  v_mov_b32 v62, v78
  v_mov_b32 v63, v79
epij_35:
  s_waitcnt lgkmcnt(0)
  s_barrier
  ds_read_b32 v16, v9 offset:2048
  ds_read_b128 v[24:27], v9
  ds_read_b128 v[28:31], v9 offset:1024
  s_lshl_b32 s22, s36, 5
  s_lshl_b32 s23, s37, 1
  s_add_u32 s22, s22, s23
  s_add_u32 s22, s22, s38
  s_lshl_b32 s22, s22, 10
  s_add_u32 s22, s22, 16777216
  s_waitcnt lgkmcnt(2)
  v_add_f32 v48, v48, v16
  v_rcp_f32 v48, v48
  s_waitcnt lgkmcnt(0)
  v_add_f32 v56, v56, v24
  v_add_f32 v57, v57, v25
  v_add_f32 v58, v58, v26
  v_add_f32 v59, v59, v27
  v_add_f32 v60, v60, v28
  v_add_f32 v61, v61, v29
  v_add_f32 v62, v62, v30
  v_add_f32 v63, v63, v31
  v_mul_f32 v56, v56, v48
  v_mul_f32 v57, v57, v48
  v_mul_f32 v58, v58, v48
  v_mul_f32 v59, v59, v48
  v_mul_f32 v60, v60, v48
  v_mul_f32 v61, v61, v48
  v_mul_f32 v62, v62, v48
  v_mul_f32 v63, v63, v48
  v_cvt_pk_bf16_f32 v88, v56, v57
  v_cvt_pk_bf16_f32 v89, v58, v59
  v_cvt_pk_bf16_f32 v90, v60, v61
  v_cvt_pk_bf16_f32 v91, v62, v63
  buffer_store_dwordx4 v[88:91], v2, s[8:11], s22 offen
  s_mov_b32 s52, 0
  s_mov_b32 s53, 0
  s_mov_b32 s54, 0
  s_mov_b32 s55, 0
  s_mov_b32 s57, 0
rest:
  s_and_b32 s16, s13, 7
  s_lshr_b32 s15, s13, 3
  s_lshl_b32 s15, s15, 1
  s_lshl_b32 s19, s12, 3
  s_add_u32 s15, s15, s19
  s_and_b32 s18, s14, 1
  s_lshr_b32 s17, s14, 1
  s_lshr_b32 s49, s14, 2
  s_and_b32 s48, s17, 1
  s_add_u32 s20, s15, s49
  s_lshl_b32 s21, s16, 1
  s_and_b32 s19, s14, 1
  s_add_u32 s21, s21, s19
  s_lshl_b32 s21, s21, 1
  s_add_u32 s21, s21, s48
  s_lshl_b32 s19, s20, 5
  s_add_u32 s19, s19, s21
  s_lshl_b32 s19, s19, 10
  s_waitcnt vmcnt(0) lgkmcnt(0)
  s_barrier
  s_cmp_lg_u32 s14, 0
  s_cbranch_scc1 xb0_n0
  s_add_u32 s22, s98, 0
  v_mov_b32 v6, s94
  v_mov_b32 v7, s99
  s_mov_b64 exec, 1
  s_cmp_lg_u32 s92, 0
  s_cbranch_scc1 xb0_f_safe
  buffer_store_dword v6, v7, s[8:11], s22 offen
  s_branch xb0_f_st
xb0_f_safe:
  buffer_wbl2 sc1
  s_waitcnt vmcnt(0)
  buffer_store_dword v6, v7, s[8:11], s22 offen sc1
xb0_f_st:
  s_mov_b64 exec, -1
  v_lshlrev_b32 v5, 2, v3
  s_mov_b32 s93, 0x80000
  buffer_load_dword v12, v5, s[8:11], s22 offen sc1
  s_sleep 3
xb0_poll:
  buffer_load_dword v13, v5, s[8:11], s22 offen sc1
  s_waitcnt vmcnt(1)
  v_cmp_ne_u32 vcc, s94, v12
  s_cbranch_vccz xb0_poll_x
  buffer_load_dword v12, v5, s[8:11], s22 offen sc1
  s_waitcnt vmcnt(1)
  v_cmp_ne_u32 vcc, s94, v13
  s_cbranch_vccz xb0_poll_x
  s_sub_u32 s93, s93, 1
  s_cmp_lg_u32 s93, 0
  s_cbranch_scc1 xb0_poll
xb0_poll_x:
  s_cmp_eq_u32 s92, 0
  s_cbranch_scc1 xb0_rel
  buffer_inv sc1
  s_waitcnt vmcnt(0)
xb0_n0:
xb0_rel:
  s_barrier
  s_add_u32 s22, s15, s18
  s_mul_i32 s22, s22, 32
  s_mul_i32 s23, s17, 8
  s_add_u32 s22, s22, s23
  s_lshl_b32 s26, s22, 10
  s_add_u32 s26, s26, 16777216
  s_add_u32 s26, s26, s54
  s_lshl_b32 s28, s14, 11
  s_add_u32 m0, s28, 98304
  s_add_u32 s29, s26, 0
  buffer_load_dwordx4 v2, s[8:11], s29 offen offset:0 lds
  buffer_load_dwordx4 v2, s[8:11], s29 offen offset:1024 lds
  s_barrier
  s_add_u32 m0, s28, 114688
  s_add_u32 s29, s26, 2048
  buffer_load_dwordx4 v2, s[8:11], s29 offen offset:0 lds
  buffer_load_dwordx4 v2, s[8:11], s29 offen offset:1024 lds
  s_barrier
  s_add_u32 m0, s28, 131072
  s_add_u32 s29, s26, 4096
  buffer_load_dwordx4 v2, s[8:11], s29 offen offset:0 lds
  buffer_load_dwordx4 v2, s[8:11], s29 offen offset:1024 lds
  s_barrier
  s_add_u32 m0, s28, 147456
  s_add_u32 s29, s26, 6144
  buffer_load_dwordx4 v2, s[8:11], s29 offen offset:0 lds
  buffer_load_dwordx4 v2, s[8:11], s29 offen offset:1024 lds
  s_lshl_b32 s22, s17, 12
  s_add_u32 s22, s22, 98304
  v_add_u32 v5, s22, v2
  v_add_u32 v6, 0x10000, v5
  s_mul_i32 s22, s18, 24576
  s_add_u32 s22, s22, 114688
  v_add_u32 v8, s22, v2
  s_mul_i32 s23, s17, 6144
  s_add_u32 s22, s22, s23
  v_add_u32 v9, s22, v2
  s_waitcnt vmcnt(6)
  s_barrier
  ds_read_b128 v[56:59], v5 offset:0
  ds_read_b128 v[60:63], v5 offset:2048
  s_lshl_b32 s28, s14, 12
  s_add_u32 m0, s28, 65536
  s_add_u32 s28, s33, 114688
  buffer_load_dwordx4 v2, s[8:11], s28 offen offset:0 lds
  buffer_load_dwordx4 v2, s[8:11], s28 offen offset:1024 lds
  buffer_load_dwordx4 v2, s[8:11], s28 offen offset:2048 lds
  buffer_load_dwordx4 v2, s[8:11], s28 offen offset:3072 lds
  ds_read_b128 v[64:67], v5 offset:1024
  ds_read_b128 v[68:71], v5 offset:3072
  s_waitcnt lgkmcnt(2)
  v_mfma_f32_32x32x16_bf16 v[16:31], v[128:131], v[56:59], 0
  v_mfma_f32_32x32x16_bf16 v[32:47], v[128:131], v[60:63], 0
  s_waitcnt vmcnt(8) lgkmcnt(0)
  s_barrier
  ds_read_b128 v[56:59], v5 offset:16384
  ds_read_b128 v[60:63], v5 offset:18432
  v_mfma_f32_32x32x16_bf16 v[16:31], v[132:135], v[64:67], v[16:31]
  v_mfma_f32_32x32x16_bf16 v[32:47], v[132:135], v[68:71], v[32:47]
  ds_read_b128 v[64:67], v5 offset:17408
  ds_read_b128 v[68:71], v5 offset:19456
  s_waitcnt lgkmcnt(2)
  v_mfma_f32_32x32x16_bf16 v[16:31], v[136:139], v[56:59], v[16:31]
  v_mfma_f32_32x32x16_bf16 v[32:47], v[136:139], v[60:63], v[32:47]
  s_waitcnt vmcnt(6) lgkmcnt(0)
  s_barrier
  ds_read_b128 v[56:59], v5 offset:32768
  ds_read_b128 v[60:63], v5 offset:34816
  v_mfma_f32_32x32x16_bf16 v[16:31], v[140:143], v[64:67], v[16:31]
  v_mfma_f32_32x32x16_bf16 v[32:47], v[140:143], v[68:71], v[32:47]
  ds_read_b128 v[64:67], v5 offset:33792
  ds_read_b128 v[68:71], v5 offset:35840
  s_waitcnt lgkmcnt(2)
  v_mfma_f32_32x32x16_bf16 v[16:31], v[96:99], v[56:59], v[16:31]
  v_mfma_f32_32x32x16_bf16 v[32:47], v[96:99], v[60:63], v[32:47]
  s_waitcnt vmcnt(4) lgkmcnt(0)
  s_barrier
  ds_read_b128 v[56:59], v5 offset:49152
  ds_read_b128 v[60:63], v5 offset:51200
  v_mfma_f32_32x32x16_bf16 v[16:31], v[104:107], v[64:67], v[16:31]
  v_mfma_f32_32x32x16_bf16 v[32:47], v[104:107], v[68:71], v[32:47]
  ds_read_b128 v[64:67], v5 offset:50176
  ds_read_b128 v[68:71], v5 offset:52224
  s_waitcnt lgkmcnt(2)
  v_mfma_f32_32x32x16_bf16 v[16:31], v[108:111], v[56:59], v[16:31]
  v_mfma_f32_32x32x16_bf16 v[32:47], v[108:111], v[60:63], v[32:47]
  s_waitcnt lgkmcnt(0)
  s_barrier
  v_mfma_f32_32x32x16_bf16 v[16:31], v[100:103], v[64:67], v[16:31]
  v_mfma_f32_32x32x16_bf16 v[32:47], v[100:103], v[68:71], v[32:47]
  s_nop 4
  s_cmp_eq_u32 s17, 1
  s_cbranch_scc1 f2v_38
  s_cmp_eq_u32 s17, 2
  s_cbranch_scc1 f2v_39
  s_cmp_eq_u32 s17, 3
  s_cbranch_scc1 f2v_40
f2v_37:
  s_nop 0
  ds_write_b128 v8, v[24:27] offset:10240
  ds_write_b128 v8, v[28:31] offset:11264
  ds_write_b128 v8, v[32:35] offset:14336
  ds_write_b128 v8, v[36:39] offset:15360
  ds_write_b128 v8, v[40:43] offset:18432
  ds_write_b128 v8, v[44:47] offset:19456
  s_waitcnt lgkmcnt(0)
  s_branch f2j_36
f2v_38:
  s_nop 3
  ds_write_b128 v8, v[16:19] offset:0
  ds_write_b128 v8, v[20:23] offset:1024
  ds_write_b128 v8, v[32:35] offset:16384
  ds_write_b128 v8, v[36:39] offset:17408
  ds_write_b128 v8, v[40:43] offset:20480
  ds_write_b128 v8, v[44:47] offset:21504
  s_waitcnt lgkmcnt(0)
  v_mov_b32 v16, v24
  v_mov_b32 v17, v25
  v_mov_b32 v18, v26
  v_mov_b32 v19, v27
  v_mov_b32 v20, v28
  v_mov_b32 v21, v29
  v_mov_b32 v22, v30
  v_mov_b32 v23, v31
  s_branch f2j_36
f2v_39:
  s_nop 1
  ds_write_b128 v8, v[16:19] offset:2048
  ds_write_b128 v8, v[20:23] offset:3072
  ds_write_b128 v8, v[24:27] offset:6144
  ds_write_b128 v8, v[28:31] offset:7168
  ds_write_b128 v8, v[40:43] offset:22528
  ds_write_b128 v8, v[44:47] offset:23552
  s_waitcnt lgkmcnt(0)
  v_mov_b32 v16, v32
  v_mov_b32 v17, v33
  v_mov_b32 v18, v34
  v_mov_b32 v19, v35
  v_mov_b32 v20, v36
  v_mov_b32 v21, v37
  v_mov_b32 v22, v38
  v_mov_b32 v23, v39
  s_branch f2j_36
f2v_40:
  ds_write_b128 v8, v[16:19] offset:4096
  ds_write_b128 v8, v[20:23] offset:5120
  ds_write_b128 v8, v[24:27] offset:8192
  ds_write_b128 v8, v[28:31] offset:9216
  ds_write_b128 v8, v[32:35] offset:12288
  ds_write_b128 v8, v[36:39] offset:13312
  s_waitcnt lgkmcnt(0)
  v_mov_b32 v16, v40
  v_mov_b32 v17, v41
  v_mov_b32 v18, v42
  v_mov_b32 v19, v43
  v_mov_b32 v20, v44
  v_mov_b32 v21, v45
  v_mov_b32 v22, v46
  v_mov_b32 v23, v47
f2j_36:
  s_barrier
  ds_read_b128 v[24:27], v9 offset:0
  ds_read_b128 v[28:31], v9 offset:1024
  ds_read_b128 v[32:35], v9 offset:2048
  ds_read_b128 v[36:39], v9 offset:3072
  ds_read_b128 v[40:43], v9 offset:4096
  ds_read_b128 v[44:47], v9 offset:5120
  s_waitcnt lgkmcnt(4)
  s_cmp_lg_u32 s57, 0
  s_cbranch_scc1 notraw_41
  v_permlane32_swap_b32 v120, v122
  v_permlane32_swap_b32 v121, v123
notraw_41:
  v_add_f32 v16, v16, v24
  v_add_f32 v17, v17, v25
  v_add_f32 v18, v18, v26
  v_add_f32 v19, v19, v27
  v_add_f32 v20, v20, v28
  v_add_f32 v21, v21, v29
  v_add_f32 v22, v22, v30
  v_add_f32 v23, v23, v31
  s_waitcnt lgkmcnt(0)
  v_add_f32 v32, v32, v40
  v_add_f32 v33, v33, v41
  v_add_f32 v34, v34, v42
  v_add_f32 v35, v35, v43
  v_add_f32 v36, v36, v44
  v_add_f32 v37, v37, v45
  v_add_f32 v38, v38, v46
  v_add_f32 v39, v39, v47
  v_add_f32 v16, v16, v32
  v_add_f32 v17, v17, v33
  v_add_f32 v18, v18, v34
  v_add_f32 v19, v19, v35
  v_add_f32 v20, v20, v36
  v_add_f32 v21, v21, v37
  v_add_f32 v22, v22, v38
  v_add_f32 v23, v23, v39
  v_lshlrev_b32 v56, 16, v120
  v_and_b32 v57, 0xffff0000, v120
  v_lshlrev_b32 v58, 16, v121
  v_and_b32 v59, 0xffff0000, v121
  v_lshlrev_b32 v60, 16, v122
  v_and_b32 v61, 0xffff0000, v122
  v_lshlrev_b32 v62, 16, v123
  v_and_b32 v63, 0xffff0000, v123
  v_add_f32 v16, v16, v56
  v_add_f32 v17, v17, v57
  v_add_f32 v18, v18, v58
  v_add_f32 v19, v19, v59
  v_add_f32 v20, v20, v60
  v_add_f32 v21, v21, v61
  v_add_f32 v22, v22, v62
  v_add_f32 v23, v23, v63
  v_cvt_pk_bf16_f32 v56, v16, v17
  v_cvt_pk_bf16_f32 v57, v18, v19
  v_cvt_pk_bf16_f32 v58, v20, v21
  v_cvt_pk_bf16_f32 v59, v22, v23
  s_add_u32 s22, s19, 9437184
  s_add_u32 s22, s22, s52
  buffer_store_dwordx4 v[56:59], v2, s[8:11], s22 offen
  v_add_f32 v60, v16, v17
  v_mul_f32 v61, v16, v16
  v_fmac_f32 v61, v17, v17
  v_add_f32 v60, v60, v18
  v_fmac_f32 v61, v18, v18
  v_add_f32 v60, v60, v19
  v_fmac_f32 v61, v19, v19
  v_add_f32 v60, v60, v20
  v_fmac_f32 v61, v20, v20
  v_add_f32 v60, v60, v21
  v_fmac_f32 v61, v21, v21
  v_add_f32 v60, v60, v22
  v_fmac_f32 v61, v22, v22
  v_add_f32 v60, v60, v23
  v_fmac_f32 v61, v23, v23
  v_lshlrev_b32 v8, 6, v3
  v_lshl_add_u32 v8, v4, 3, v8
  s_lshl_b32 s22, s49, 11
  s_and_b32 s23, s21, 3
  s_lshl_b32 s23, s23, 4
  s_add_u32 s22, s22, s23
  s_add_u32 s22, s22, 98304
  v_add_u32 v8, s22, v8
  ds_write_b64 v8, v[60:61]
  s_waitcnt vmcnt(0) lgkmcnt(0)
  s_barrier
  s_cmp_lg_u32 s14, 0
  s_cbranch_scc1 xb1_n0
  s_add_u32 s22, s98, 128
  v_mov_b32 v6, s94
  v_mov_b32 v7, s99
  s_mov_b64 exec, 1
  s_cmp_lg_u32 s92, 0
  s_cbranch_scc1 xb1_f_safe
  buffer_store_dword v6, v7, s[8:11], s22 offen
  s_branch xb1_f_st
xb1_f_safe:
  buffer_wbl2 sc1
  s_waitcnt vmcnt(0)
  buffer_store_dword v6, v7, s[8:11], s22 offen sc1
xb1_f_st:
  s_mov_b64 exec, -1
  v_lshlrev_b32 v5, 2, v3
  s_mov_b32 s93, 0x80000
  buffer_load_dword v12, v5, s[8:11], s22 offen sc1
  s_sleep 3
xb1_poll:
  buffer_load_dword v13, v5, s[8:11], s22 offen sc1
  s_waitcnt vmcnt(1)
  v_cmp_ne_u32 vcc, s94, v12
  s_cbranch_vccz xb1_poll_x
  buffer_load_dword v12, v5, s[8:11], s22 offen sc1
  s_waitcnt vmcnt(1)
  v_cmp_ne_u32 vcc, s94, v13
  s_cbranch_vccz xb1_poll_x
  s_sub_u32 s93, s93, 1
  s_cmp_lg_u32 s93, 0
  s_cbranch_scc1 xb1_poll
xb1_poll_x:
  s_cmp_eq_u32 s92, 0
  s_cbranch_scc1 xb1_rel
  buffer_inv sc1
  s_waitcnt vmcnt(0)
  s_branch xb1_rel
xb1_n0:
  s_cmp_lg_u32 s14, 1
  s_cbranch_scc1 xb1_rel
  v_lshlrev_b32 v8, 6, v1
  v_add_u32 v8, 98304, v8
  ds_read_b128 v[32:35], v8 offset:0
  ds_read_b128 v[36:39], v8 offset:16
  ds_read_b128 v[40:43], v8 offset:32
  ds_read_b128 v[44:47], v8 offset:48
  v_lshlrev_b32 v8, 3, v3
  v_lshl_add_u32 v8, v4, 11, v8
  s_lshl_b32 s22, s15, 11
  s_lshl_b32 s23, s16, 8
  s_add_u32 s22, s22, s23
  s_add_u32 s22, s22, 15859712
  s_add_u32 s22, s22, s53
  s_waitcnt lgkmcnt(0)
  v_add_f32 v32, v32, v40
  v_add_f32 v33, v33, v41
  v_add_f32 v34, v34, v42
  v_add_f32 v35, v35, v43
  v_add_f32 v36, v36, v44
  v_add_f32 v37, v37, v45
  v_add_f32 v38, v38, v46
  v_add_f32 v39, v39, v47
  v_add_f32 v32, v32, v36
  v_add_f32 v33, v33, v37
  v_add_f32 v34, v34, v38
  v_add_f32 v35, v35, v39
  v_add_f32 v32, v32, v34
  v_add_f32 v33, v33, v35
  buffer_store_dwordx2 v[32:33], v8, s[8:11], s22 offen sc1
  s_waitcnt vmcnt(0)
  s_add_u32 s22, s98, 1152
  v_mov_b32 v6, s94
  v_mov_b32 v7, s99
  s_mov_b64 exec, 1
  s_cmp_lg_u32 s92, 0
  s_cbranch_scc1 xb1_s_safe
  buffer_store_dword v6, v7, s[8:11], s22 offen
  s_branch xb1_s_st
xb1_s_safe:
  buffer_wbl2 sc1
  s_waitcnt vmcnt(0)
  buffer_store_dword v6, v7, s[8:11], s22 offen sc1
xb1_s_st:
  s_mov_b64 exec, -1
xb1_rel:
  s_barrier
  s_lshr_b32 s25, s13, 4
  s_lshl_b32 s24, s25, 2
  s_xor_b32 s24, s24, s14
  s_lshl_b32 s20, s12, 3
  s_add_u32 s24, s24, s20
  s_lshl_b32 s20, s24, 15
  s_add_u32 s20, s20, 9437184
  s_add_u32 s20, s20, s52
  buffer_load_dwordx4 v[112:115], v2, s[8:11], s20 offen offset:0
  buffer_load_dwordx4 v[116:119], v2, s[8:11], s20 offen offset:1024
  s_barrier
  buffer_load_dwordx4 v[120:123], v2, s[8:11], s20 offen offset:2048
  buffer_load_dwordx4 v[124:127], v2, s[8:11], s20 offen offset:3072
  s_add_u32 s20, s20, 4096
  buffer_load_dwordx4 v[128:131], v2, s[8:11], s20 offen offset:0
  buffer_load_dwordx4 v[132:135], v2, s[8:11], s20 offen offset:1024
  s_add_u32 s34, s98, 1152
  v_lshlrev_b32 v137, 2, v3
  buffer_load_dword v136, v137, s[8:11], s34 offen sc1
  v_lshlrev_b32 v10, 3, v3
  v_lshl_add_u32 v10, v4, 10, v10
  s_lshl_b32 s19, s24, 11
  s_add_u32 s19, s19, 15859712
  s_add_u32 s19, s19, s53
  s_and_b32 s27, s25, s38
  s_mul_i32 s30, s24, 112
  s_and_b32 s31, s13, 15
  s_mul_i32 s31, s31, 7
  s_add_u32 s30, s30, s31
  s_mul_i32 s31, s25, 3
  s_add_u32 s30, s30, s31
  s_add_u32 s30, s30, s27
  s_lshl_b32 s30, s30, 10
  s_add_u32 s30, s30, 20971520
  s_add_u32 s30, s30, s55
  s_lshl_b32 s27, s27, 10
  v_add_u32 v5, s27, v2
  v_add_u32 v6, 0x10000, v5
  v_add_u32 v7, 0x20000, v5
  s_cmp_lg_u32 s38, 0
  s_cbranch_scc1 f10_up
  ds_read_b128 v[80:83], v5 offset:0
  ds_read_b128 v[84:87], v5 offset:1024
  ds_read_b128 v[88:91], v5 offset:2048
  ds_read_b128 v[92:95], v5 offset:3072
  ds_read_b128 v[96:99], v5 offset:4096
  ds_read_b128 v[100:103], v5 offset:5120
  ds_read_b128 v[104:107], v5 offset:6144
  ds_read_b128 v[108:111], v5 offset:7168
  s_waitcnt vmcnt(6) lgkmcnt(4)
  v_mfma_f32_32x32x16_bf16 v[16:31], v[80:83], v[112:115], 0
  v_mfma_f32_32x32x16_bf16 v[32:47], v[84:87], v[112:115], 0
  v_mfma_f32_32x32x16_bf16 v[48:63], v[88:91], v[112:115], 0
  v_mfma_f32_32x32x16_bf16 v[64:79], v[92:95], v[112:115], 0
  buffer_load_dwordx4 v[112:115], v2, s[8:11], s20 offen offset:2048
  ds_read_b128 v[80:83], v5 offset:8192
  ds_read_b128 v[84:87], v5 offset:9216
  ds_read_b128 v[88:91], v5 offset:10240
  ds_read_b128 v[92:95], v5 offset:11264
  s_waitcnt vmcnt(6) lgkmcnt(4)
  v_mfma_f32_32x32x16_bf16 v[16:31], v[96:99], v[116:119], v[16:31]
  v_mfma_f32_32x32x16_bf16 v[32:47], v[100:103], v[116:119], v[32:47]
  v_mfma_f32_32x32x16_bf16 v[48:63], v[104:107], v[116:119], v[48:63]
  v_mfma_f32_32x32x16_bf16 v[64:79], v[108:111], v[116:119], v[64:79]
  buffer_load_dwordx4 v[116:119], v2, s[8:11], s20 offen offset:3072
  ds_read_b128 v[96:99], v5 offset:12288
  ds_read_b128 v[100:103], v5 offset:13312
  ds_read_b128 v[104:107], v5 offset:14336
  ds_read_b128 v[108:111], v5 offset:15360
  s_waitcnt vmcnt(6) lgkmcnt(4)
  v_mfma_f32_32x32x16_bf16 v[16:31], v[80:83], v[120:123], v[16:31]
  v_mfma_f32_32x32x16_bf16 v[32:47], v[84:87], v[120:123], v[32:47]
  v_mfma_f32_32x32x16_bf16 v[48:63], v[88:91], v[120:123], v[48:63]
  v_mfma_f32_32x32x16_bf16 v[64:79], v[92:95], v[120:123], v[64:79]
  s_add_u32 s20, s20, 4096
  buffer_load_dwordx4 v[120:123], v2, s[8:11], s20 offen offset:0
  ds_read_b128 v[80:83], v5 offset:16384
  ds_read_b128 v[84:87], v5 offset:17408
  ds_read_b128 v[88:91], v5 offset:18432
  ds_read_b128 v[92:95], v5 offset:19456
  s_waitcnt vmcnt(6) lgkmcnt(4)
  v_mfma_f32_32x32x16_bf16 v[16:31], v[96:99], v[124:127], v[16:31]
  v_mfma_f32_32x32x16_bf16 v[32:47], v[100:103], v[124:127], v[32:47]
  v_mfma_f32_32x32x16_bf16 v[48:63], v[104:107], v[124:127], v[48:63]
  v_mfma_f32_32x32x16_bf16 v[64:79], v[108:111], v[124:127], v[64:79]
  buffer_load_dwordx4 v[124:127], v2, s[8:11], s20 offen offset:1024
  ds_read_b128 v[96:99], v5 offset:20480
  ds_read_b128 v[100:103], v5 offset:21504
  ds_read_b128 v[104:107], v5 offset:22528
  ds_read_b128 v[108:111], v5 offset:23552
  s_waitcnt vmcnt(6) lgkmcnt(4)
  v_mfma_f32_32x32x16_bf16 v[16:31], v[80:83], v[128:131], v[16:31]
  v_mfma_f32_32x32x16_bf16 v[32:47], v[84:87], v[128:131], v[32:47]
  v_mfma_f32_32x32x16_bf16 v[48:63], v[88:91], v[128:131], v[48:63]
  v_mfma_f32_32x32x16_bf16 v[64:79], v[92:95], v[128:131], v[64:79]
  buffer_load_dwordx4 v[128:131], v2, s[8:11], s20 offen offset:2048
  s_lshl_b32 s28, s14, 12
  s_add_u32 m0, s28, 98304
  s_add_u32 s28, s33, 172032
  buffer_load_dwordx4 v2, s[8:11], s28 offen offset:0 lds
  buffer_load_dwordx4 v2, s[8:11], s28 offen offset:1024 lds
  buffer_load_dwordx4 v2, s[8:11], s28 offen offset:2048 lds
  buffer_load_dwordx4 v2, s[8:11], s28 offen offset:3072 lds
  s_lshl_b32 s28, s39, 10
  s_add_u32 m0, s28, 131072
  s_mul_i32 s29, s14, 7168
  s_sub_u32 s29, s33, s29
  s_add_u32 s29, s29, s28
  s_add_u32 s29, s29, 229376
  buffer_load_dwordx4 v2, s[8:11], s29 offen lds
  ds_read_b128 v[80:83], v5 offset:24576
  ds_read_b128 v[84:87], v5 offset:25600
  ds_read_b128 v[88:91], v5 offset:26624
  ds_read_b128 v[92:95], v5 offset:27648
  s_waitcnt vmcnt(11) lgkmcnt(4)
  v_mfma_f32_32x32x16_bf16 v[16:31], v[96:99], v[132:135], v[16:31]
  v_mfma_f32_32x32x16_bf16 v[32:47], v[100:103], v[132:135], v[32:47]
  v_mfma_f32_32x32x16_bf16 v[48:63], v[104:107], v[132:135], v[48:63]
  v_mfma_f32_32x32x16_bf16 v[64:79], v[108:111], v[132:135], v[64:79]
  buffer_load_dwordx4 v[132:135], v2, s[8:11], s20 offen offset:3072
  ds_read_b128 v[96:99], v5 offset:28672
  ds_read_b128 v[100:103], v5 offset:29696
  ds_read_b128 v[104:107], v5 offset:30720
  ds_read_b128 v[108:111], v5 offset:31744
  s_waitcnt vmcnt(10) lgkmcnt(4)
  v_mfma_f32_32x32x16_bf16 v[16:31], v[80:83], v[112:115], v[16:31]
  v_mfma_f32_32x32x16_bf16 v[32:47], v[84:87], v[112:115], v[32:47]
  v_mfma_f32_32x32x16_bf16 v[48:63], v[88:91], v[112:115], v[48:63]
  v_mfma_f32_32x32x16_bf16 v[64:79], v[92:95], v[112:115], v[64:79]
  s_add_u32 s20, s20, 4096
  buffer_load_dwordx4 v[112:115], v2, s[8:11], s20 offen offset:0
  ds_read_b128 v[80:83], v5 offset:32768
  ds_read_b128 v[84:87], v5 offset:33792
  ds_read_b128 v[88:91], v5 offset:34816
  ds_read_b128 v[92:95], v5 offset:35840
  s_waitcnt vmcnt(10) lgkmcnt(4)
  v_mfma_f32_32x32x16_bf16 v[16:31], v[96:99], v[116:119], v[16:31]
  v_mfma_f32_32x32x16_bf16 v[32:47], v[100:103], v[116:119], v[32:47]
  v_mfma_f32_32x32x16_bf16 v[48:63], v[104:107], v[116:119], v[48:63]
  v_mfma_f32_32x32x16_bf16 v[64:79], v[108:111], v[116:119], v[64:79]
  buffer_load_dwordx4 v[116:119], v2, s[8:11], s20 offen offset:1024
  ds_read_b128 v[96:99], v5 offset:36864
  ds_read_b128 v[100:103], v5 offset:37888
  ds_read_b128 v[104:107], v5 offset:38912
  ds_read_b128 v[108:111], v5 offset:39936
  s_waitcnt vmcnt(10) lgkmcnt(4)
  v_mfma_f32_32x32x16_bf16 v[16:31], v[80:83], v[120:123], v[16:31]
  v_mfma_f32_32x32x16_bf16 v[32:47], v[84:87], v[120:123], v[32:47]
  v_mfma_f32_32x32x16_bf16 v[48:63], v[88:91], v[120:123], v[48:63]
  v_mfma_f32_32x32x16_bf16 v[64:79], v[92:95], v[120:123], v[64:79]
  buffer_load_dwordx4 v[120:123], v2, s[8:11], s20 offen offset:2048
  v_cmp_ne_u32 vcc, s94, v136
  s_cbranch_vccz spoll_42_ok
  s_mov_b32 s93, 524288
spoll_42:
  buffer_load_dword v136, v137, s[8:11], s34 offen offset:0 sc1
  s_sub_u32 s93, s93, 1
  s_waitcnt vmcnt(0)
  v_cmp_ne_u32 vcc, s94, v136
  s_cmp_eq_u32 s93, 0
  s_cbranch_scc1 spoll_42_x
  s_cbranch_vccz spoll_42_x
  s_branch spoll_42
spoll_42_x:
spoll_42_ok:
  buffer_load_dwordx2 v[136:137], v10, s[8:11], s19 offen offset:0
  buffer_load_dwordx2 v[138:139], v10, s[8:11], s19 offen offset:256
  buffer_load_dwordx2 v[140:141], v10, s[8:11], s19 offen offset:512
  buffer_load_dwordx2 v[142:143], v10, s[8:11], s19 offen offset:768
  ds_read_b128 v[80:83], v5 offset:40960
  ds_read_b128 v[84:87], v5 offset:41984
  ds_read_b128 v[88:91], v5 offset:43008
  ds_read_b128 v[92:95], v5 offset:44032
  s_waitcnt vmcnt(14) lgkmcnt(4)
  v_mfma_f32_32x32x16_bf16 v[16:31], v[96:99], v[124:127], v[16:31]
  v_mfma_f32_32x32x16_bf16 v[32:47], v[100:103], v[124:127], v[32:47]
  v_mfma_f32_32x32x16_bf16 v[48:63], v[104:107], v[124:127], v[48:63]
  v_mfma_f32_32x32x16_bf16 v[64:79], v[108:111], v[124:127], v[64:79]
  buffer_load_dwordx4 v[124:127], v2, s[8:11], s20 offen offset:3072
  ds_read_b128 v[96:99], v5 offset:45056
  ds_read_b128 v[100:103], v5 offset:46080
  ds_read_b128 v[104:107], v5 offset:47104
  ds_read_b128 v[108:111], v5 offset:48128
  s_waitcnt vmcnt(14) lgkmcnt(4)
  v_mfma_f32_32x32x16_bf16 v[16:31], v[80:83], v[128:131], v[16:31]
  v_mfma_f32_32x32x16_bf16 v[32:47], v[84:87], v[128:131], v[32:47]
  v_mfma_f32_32x32x16_bf16 v[48:63], v[88:91], v[128:131], v[48:63]
  v_mfma_f32_32x32x16_bf16 v[64:79], v[92:95], v[128:131], v[64:79]
  s_add_u32 s20, s20, 4096
  buffer_load_dwordx4 v[128:131], v2, s[8:11], s20 offen offset:0
  ds_read_b128 v[80:83], v5 offset:49152
  ds_read_b128 v[84:87], v5 offset:50176
  ds_read_b128 v[88:91], v5 offset:51200
  ds_read_b128 v[92:95], v5 offset:52224
  s_waitcnt vmcnt(9) lgkmcnt(4)
  v_mfma_f32_32x32x16_bf16 v[16:31], v[96:99], v[132:135], v[16:31]
  v_mfma_f32_32x32x16_bf16 v[32:47], v[100:103], v[132:135], v[32:47]
  v_mfma_f32_32x32x16_bf16 v[48:63], v[104:107], v[132:135], v[48:63]
  v_mfma_f32_32x32x16_bf16 v[64:79], v[108:111], v[132:135], v[64:79]
  buffer_load_dwordx4 v[132:135], v2, s[8:11], s20 offen offset:1024
  ds_read_b128 v[96:99], v5 offset:53248
  ds_read_b128 v[100:103], v5 offset:54272
  ds_read_b128 v[104:107], v5 offset:55296
  ds_read_b128 v[108:111], v5 offset:56320
  s_waitcnt vmcnt(9) lgkmcnt(4)
  v_mfma_f32_32x32x16_bf16 v[16:31], v[80:83], v[112:115], v[16:31]
  v_mfma_f32_32x32x16_bf16 v[32:47], v[84:87], v[112:115], v[32:47]
  v_mfma_f32_32x32x16_bf16 v[48:63], v[88:91], v[112:115], v[48:63]
  v_mfma_f32_32x32x16_bf16 v[64:79], v[92:95], v[112:115], v[64:79]
  buffer_load_dwordx4 v[112:115], v2, s[8:11], s20 offen offset:2048
  ds_read_b128 v[80:83], v5 offset:57344
  ds_read_b128 v[84:87], v5 offset:58368
  ds_read_b128 v[88:91], v5 offset:59392
  ds_read_b128 v[92:95], v5 offset:60416
  s_waitcnt vmcnt(9) lgkmcnt(4)
  v_mfma_f32_32x32x16_bf16 v[16:31], v[96:99], v[116:119], v[16:31]
  v_mfma_f32_32x32x16_bf16 v[32:47], v[100:103], v[116:119], v[32:47]
  v_mfma_f32_32x32x16_bf16 v[48:63], v[104:107], v[116:119], v[48:63]
  v_mfma_f32_32x32x16_bf16 v[64:79], v[108:111], v[116:119], v[64:79]
  buffer_load_dwordx4 v[116:119], v2, s[8:11], s20 offen offset:3072
  ds_read_b128 v[96:99], v5 offset:61440
  ds_read_b128 v[100:103], v5 offset:62464
  ds_read_b128 v[104:107], v5 offset:63488
  ds_read_b128 v[108:111], v5 offset:64512
  s_waitcnt vmcnt(9) lgkmcnt(4)
  v_mfma_f32_32x32x16_bf16 v[16:31], v[80:83], v[120:123], v[16:31]
  v_mfma_f32_32x32x16_bf16 v[32:47], v[84:87], v[120:123], v[32:47]
  v_mfma_f32_32x32x16_bf16 v[48:63], v[88:91], v[120:123], v[48:63]
  v_mfma_f32_32x32x16_bf16 v[64:79], v[92:95], v[120:123], v[64:79]
  s_add_u32 s20, s20, 4096
  buffer_load_dwordx4 v[120:123], v2, s[8:11], s20 offen offset:0
  ds_read_b128 v[80:83], v6 offset:0
  ds_read_b128 v[84:87], v6 offset:1024
  ds_read_b128 v[88:91], v6 offset:2048
  ds_read_b128 v[92:95], v6 offset:3072
  s_waitcnt vmcnt(5) lgkmcnt(4)
  v_mfma_f32_32x32x16_bf16 v[16:31], v[96:99], v[124:127], v[16:31]
  v_mfma_f32_32x32x16_bf16 v[32:47], v[100:103], v[124:127], v[32:47]
  v_mfma_f32_32x32x16_bf16 v[48:63], v[104:107], v[124:127], v[48:63]
  v_mfma_f32_32x32x16_bf16 v[64:79], v[108:111], v[124:127], v[64:79]
  buffer_load_dwordx4 v[124:127], v2, s[8:11], s20 offen offset:1024
  ds_read_b128 v[96:99], v6 offset:4096
  ds_read_b128 v[100:103], v6 offset:5120
  ds_read_b128 v[104:107], v6 offset:6144
  ds_read_b128 v[108:111], v6 offset:7168
  s_waitcnt vmcnt(5) lgkmcnt(4)
  v_mfma_f32_32x32x16_bf16 v[16:31], v[80:83], v[128:131], v[16:31]
  v_mfma_f32_32x32x16_bf16 v[32:47], v[84:87], v[128:131], v[32:47]
  v_mfma_f32_32x32x16_bf16 v[48:63], v[88:91], v[128:131], v[48:63]
  v_mfma_f32_32x32x16_bf16 v[64:79], v[92:95], v[128:131], v[64:79]
  buffer_load_dwordx4 v[128:131], v2, s[8:11], s20 offen offset:2048
  ds_read_b128 v[80:83], v6 offset:8192
  ds_read_b128 v[84:87], v6 offset:9216
  ds_read_b128 v[88:91], v6 offset:10240
  ds_read_b128 v[92:95], v6 offset:11264
  s_waitcnt vmcnt(5) lgkmcnt(4)
  v_mfma_f32_32x32x16_bf16 v[16:31], v[96:99], v[132:135], v[16:31]
  v_mfma_f32_32x32x16_bf16 v[32:47], v[100:103], v[132:135], v[32:47]
  v_mfma_f32_32x32x16_bf16 v[48:63], v[104:107], v[132:135], v[48:63]
  v_mfma_f32_32x32x16_bf16 v[64:79], v[108:111], v[132:135], v[64:79]
  buffer_load_dwordx4 v[132:135], v2, s[8:11], s20 offen offset:3072
  ds_read_b128 v[96:99], v6 offset:12288
  ds_read_b128 v[100:103], v6 offset:13312
  ds_read_b128 v[104:107], v6 offset:14336
  ds_read_b128 v[108:111], v6 offset:15360
  s_waitcnt vmcnt(5) lgkmcnt(4)
  v_mfma_f32_32x32x16_bf16 v[16:31], v[80:83], v[112:115], v[16:31]
  v_mfma_f32_32x32x16_bf16 v[32:47], v[84:87], v[112:115], v[32:47]
  v_mfma_f32_32x32x16_bf16 v[48:63], v[88:91], v[112:115], v[48:63]
  v_mfma_f32_32x32x16_bf16 v[64:79], v[92:95], v[112:115], v[64:79]
  s_add_u32 s20, s20, 4096
  buffer_load_dwordx4 v[112:115], v2, s[8:11], s20 offen offset:0
  ds_read_b128 v[80:83], v6 offset:16384
  ds_read_b128 v[84:87], v6 offset:17408
  ds_read_b128 v[88:91], v6 offset:18432
  ds_read_b128 v[92:95], v6 offset:19456
  s_waitcnt vmcnt(5) lgkmcnt(4)
  v_mfma_f32_32x32x16_bf16 v[16:31], v[96:99], v[116:119], v[16:31]
  v_mfma_f32_32x32x16_bf16 v[32:47], v[100:103], v[116:119], v[32:47]
  v_mfma_f32_32x32x16_bf16 v[48:63], v[104:107], v[116:119], v[48:63]
  v_mfma_f32_32x32x16_bf16 v[64:79], v[108:111], v[116:119], v[64:79]
  buffer_load_dwordx4 v[116:119], v2, s[8:11], s20 offen offset:1024
  ds_read_b128 v[96:99], v6 offset:20480
  ds_read_b128 v[100:103], v6 offset:21504
  ds_read_b128 v[104:107], v6 offset:22528
  ds_read_b128 v[108:111], v6 offset:23552
  s_waitcnt vmcnt(5) lgkmcnt(4)
  v_add_f32 v136, v136, v138
  v_add_f32 v137, v137, v139
  v_add_f32 v140, v140, v142
  v_add_f32 v141, v141, v143
  v_add_f32 v136, v136, v140
  v_add_f32 v137, v137, v141
  v_mov_b32 v8, v136
  v_mov_b32 v9, v137
  s_nop 1
  v_permlane32_swap_b32 v136, v8
  v_permlane32_swap_b32 v137, v9
  s_nop 1
  v_add_f32 v136, v136, v8
  v_add_f32 v137, v137, v9
  v_mul_f32 v136, 0x3b000000, v136
  v_mul_f32 v137, 0x3b000000, v137
  v_fma_f32 v137, -v136, v136, v137
  v_max_f32 v137, 0, v137
  v_add_f32 v137, 0x3727c5ac, v137
  v_rsq_f32 v12, v137
  v_and_b32 v8, 0xffff0000, v136
  v_sub_f32 v9, v136, v8
  v_cvt_pk_bf16_f32 v140, -v8, -v8
  v_cvt_pk_bf16_f32 v141, -v9, 0
  v_mov_b32 v142, v140
  v_mov_b32 v143, v141
  v_mul_f32 v12, 0xbfb8aa3b, v12
  v_mul_f32 v137, v137, v12
  v_mov_b32 v13, v12
  v_mov_b32 v136, v137
  v_mfma_f32_32x32x16_bf16 v[16:31], v[80:83], v[120:123], v[16:31]
  v_mfma_f32_32x32x16_bf16 v[32:47], v[84:87], v[120:123], v[32:47]
  v_mfma_f32_32x32x16_bf16 v[48:63], v[88:91], v[120:123], v[48:63]
  v_mfma_f32_32x32x16_bf16 v[64:79], v[92:95], v[120:123], v[64:79]
  buffer_load_dwordx4 v[120:123], v2, s[8:11], s20 offen offset:2048
  ds_read_b128 v[80:83], v6 offset:24576
  ds_read_b128 v[84:87], v6 offset:25600
  ds_read_b128 v[88:91], v6 offset:26624
  ds_read_b128 v[92:95], v6 offset:27648
  s_waitcnt vmcnt(5) lgkmcnt(4)
  v_mfma_f32_32x32x16_bf16 v[16:31], v[96:99], v[124:127], v[16:31]
  v_mfma_f32_32x32x16_bf16 v[32:47], v[100:103], v[124:127], v[32:47]
  v_mfma_f32_32x32x16_bf16 v[48:63], v[104:107], v[124:127], v[48:63]
  v_mfma_f32_32x32x16_bf16 v[64:79], v[108:111], v[124:127], v[64:79]
  buffer_load_dwordx4 v[124:127], v2, s[8:11], s20 offen offset:3072
  ds_read_b128 v[96:99], v6 offset:28672
  ds_read_b128 v[100:103], v6 offset:29696
  ds_read_b128 v[104:107], v6 offset:30720
  ds_read_b128 v[108:111], v6 offset:31744
  s_waitcnt vmcnt(5) lgkmcnt(4)
  v_mfma_f32_32x32x16_bf16 v[16:31], v[80:83], v[128:131], v[16:31]
  v_mfma_f32_32x32x16_bf16 v[32:47], v[84:87], v[128:131], v[32:47]
  v_mfma_f32_32x32x16_bf16 v[48:63], v[88:91], v[128:131], v[48:63]
  v_mfma_f32_32x32x16_bf16 v[64:79], v[92:95], v[128:131], v[64:79]
  s_add_u32 s20, s20, 4096
  buffer_load_dwordx4 v[128:131], v2, s[8:11], s20 offen offset:0
  s_waitcnt vmcnt(5)
  s_barrier
  ds_read_b128 v[80:83], v6 offset:32768
  ds_read_b128 v[84:87], v6 offset:33792
  ds_read_b128 v[88:91], v6 offset:34816
  ds_read_b128 v[92:95], v6 offset:35840
  s_waitcnt lgkmcnt(4)
  v_mfma_f32_32x32x16_bf16 v[16:31], v[96:99], v[132:135], v[16:31]
  v_mfma_f32_32x32x16_bf16 v[32:47], v[100:103], v[132:135], v[32:47]
  v_mfma_f32_32x32x16_bf16 v[48:63], v[104:107], v[132:135], v[48:63]
  v_mfma_f32_32x32x16_bf16 v[64:79], v[108:111], v[132:135], v[64:79]
  buffer_load_dwordx4 v[132:135], v2, s[8:11], s20 offen offset:1024
  ds_read_b128 v[96:99], v6 offset:36864
  ds_read_b128 v[100:103], v6 offset:37888
  ds_read_b128 v[104:107], v6 offset:38912
  ds_read_b128 v[108:111], v6 offset:39936
  s_waitcnt vmcnt(5) lgkmcnt(4)
  v_mfma_f32_32x32x16_bf16 v[16:31], v[80:83], v[112:115], v[16:31]
  v_mfma_f32_32x32x16_bf16 v[32:47], v[84:87], v[112:115], v[32:47]
  v_mfma_f32_32x32x16_bf16 v[48:63], v[88:91], v[112:115], v[48:63]
  v_mfma_f32_32x32x16_bf16 v[64:79], v[92:95], v[112:115], v[64:79]
  buffer_load_dwordx4 v[112:115], v2, s[8:11], s20 offen offset:2048
  ds_read_b128 v[80:83], v6 offset:40960
  ds_read_b128 v[84:87], v6 offset:41984
  ds_read_b128 v[88:91], v6 offset:43008
  ds_read_b128 v[92:95], v6 offset:44032
  s_waitcnt vmcnt(5) lgkmcnt(4)
  v_mfma_f32_32x32x16_bf16 v[16:31], v[96:99], v[116:119], v[16:31]
  v_mfma_f32_32x32x16_bf16 v[32:47], v[100:103], v[116:119], v[32:47]
  v_mfma_f32_32x32x16_bf16 v[48:63], v[104:107], v[116:119], v[48:63]
  v_mfma_f32_32x32x16_bf16 v[64:79], v[108:111], v[116:119], v[64:79]
  buffer_load_dwordx4 v[116:119], v2, s[8:11], s20 offen offset:3072
  ds_read_b128 v[96:99], v6 offset:45056
  ds_read_b128 v[100:103], v6 offset:46080
  ds_read_b128 v[104:107], v6 offset:47104
  ds_read_b128 v[108:111], v6 offset:48128
  s_waitcnt vmcnt(5) lgkmcnt(4)
  v_mfma_f32_32x32x16_bf16 v[16:31], v[80:83], v[120:123], v[16:31]
  v_mfma_f32_32x32x16_bf16 v[32:47], v[84:87], v[120:123], v[32:47]
  v_mfma_f32_32x32x16_bf16 v[48:63], v[88:91], v[120:123], v[48:63]
  v_mfma_f32_32x32x16_bf16 v[64:79], v[92:95], v[120:123], v[64:79]
  ds_read_b128 v[80:83], v6 offset:49152
  ds_read_b128 v[84:87], v6 offset:53248
  ds_read_b128 v[88:91], v6 offset:57344
  ds_read_b128 v[92:95], v6 offset:61440
  ds_read_b128 v[120:123], v7 offset:0
  s_waitcnt vmcnt(4) lgkmcnt(5)
  v_mfma_f32_32x32x16_bf16 v[16:31], v[96:99], v[124:127], v[16:31]
  v_mfma_f32_32x32x16_bf16 v[32:47], v[100:103], v[124:127], v[32:47]
  v_mfma_f32_32x32x16_bf16 v[48:63], v[104:107], v[124:127], v[48:63]
  v_mfma_f32_32x32x16_bf16 v[64:79], v[108:111], v[124:127], v[64:79]
  s_waitcnt vmcnt(0)
  ds_read_b128 v[96:99], v6 offset:50176
  ds_read_b128 v[100:103], v6 offset:54272
  ds_read_b128 v[104:107], v6 offset:58368
  ds_read_b128 v[108:111], v6 offset:62464
  ds_read_b128 v[124:127], v7 offset:1024
  s_waitcnt lgkmcnt(5)
  v_mfma_f32_32x32x16_bf16 v[16:31], v[80:83], v[128:131], v[16:31]
  v_mfma_f32_32x32x16_bf16 v[16:31], v[84:87], v[132:135], v[16:31]
  v_mfma_f32_32x32x16_bf16 v[16:31], v[88:91], v[112:115], v[16:31]
  v_mfma_f32_32x32x16_bf16 v[16:31], v[92:95], v[116:119], v[16:31]
  v_mfma_f32_32x32x16_bf16 v[16:31], v[120:123], v[140:143], v[16:31]
  ds_read_b128 v[80:83], v6 offset:51200
  ds_read_b128 v[84:87], v6 offset:55296
  ds_read_b128 v[88:91], v6 offset:59392
  ds_read_b128 v[92:95], v6 offset:63488
  ds_read_b128 v[120:123], v7 offset:2048
  s_waitcnt lgkmcnt(5)
  v_mfma_f32_32x32x16_bf16 v[32:47], v[96:99], v[128:131], v[32:47]
  s_nop 9
  v_mul_f32 v16, v16, v12
  v_mul_f32 v17, v17, v13
  v_mul_f32 v18, v18, v12
  v_mul_f32 v19, v19, v13
  v_mul_f32 v20, v20, v12
  v_mul_f32 v21, v21, v13
  v_mul_f32 v22, v22, v12
  v_mul_f32 v23, v23, v13
  v_exp_f32 v8, v16
  v_exp_f32 v9, v17
  v_exp_f32 v10, v18
  v_exp_f32 v11, v19
  v_mfma_f32_32x32x16_bf16 v[32:47], v[100:103], v[132:135], v[32:47]
  s_nop 0
  v_fma_f32 v8, v8, v136, v136
  v_fma_f32 v9, v9, v137, v137
  v_fma_f32 v10, v10, v136, v136
  v_fma_f32 v11, v11, v137, v137
  v_rcp_f32 v8, v8
  v_rcp_f32 v9, v9
  v_rcp_f32 v10, v10
  v_rcp_f32 v11, v11
  s_nop 0
  v_mul_f32 v16, v16, v8
  v_mul_f32 v17, v17, v9
  v_mfma_f32_32x32x16_bf16 v[32:47], v[104:107], v[112:115], v[32:47]
  v_mul_f32 v18, v18, v10
  v_mul_f32 v19, v19, v11
  v_mul_f32 v16, v16, v24
  v_mul_f32 v17, v17, v25
  v_mul_f32 v18, v18, v26
  v_mul_f32 v19, v19, v27
  v_exp_f32 v8, v20
  v_exp_f32 v9, v21
  v_exp_f32 v10, v22
  v_exp_f32 v11, v23
  s_nop 0
  v_mfma_f32_32x32x16_bf16 v[32:47], v[108:111], v[116:119], v[32:47]
  v_fma_f32 v8, v8, v136, v136
  v_fma_f32 v9, v9, v137, v137
  v_fma_f32 v10, v10, v136, v136
  v_fma_f32 v11, v11, v137, v137
  v_rcp_f32 v8, v8
  v_rcp_f32 v9, v9
  v_rcp_f32 v10, v10
  v_rcp_f32 v11, v11
  s_nop 0
  v_mul_f32 v20, v20, v8
  v_mul_f32 v21, v21, v9
  v_mfma_f32_32x32x16_bf16 v[32:47], v[124:127], v[140:143], v[32:47]
  v_mul_f32 v22, v22, v10
  v_mul_f32 v23, v23, v11
  v_mul_f32 v20, v20, v28
  v_mul_f32 v21, v21, v29
  v_mul_f32 v22, v22, v30
  v_mul_f32 v23, v23, v31
  v_cvt_pk_bf16_f32 v24, v16, v17
  v_cvt_pk_bf16_f32 v25, v18, v19
  v_cvt_pk_bf16_f32 v26, v20, v21
  v_cvt_pk_bf16_f32 v27, v22, v23
  buffer_store_dwordx4 v[24:27], v2, s[8:11], s30 offen offset:0 sc1
  ds_read_b128 v[96:99], v6 offset:52224
  ds_read_b128 v[100:103], v6 offset:56320
  ds_read_b128 v[104:107], v6 offset:60416
  ds_read_b128 v[108:111], v6 offset:64512
  ds_read_b128 v[124:127], v7 offset:3072
  s_waitcnt lgkmcnt(5)
  v_mfma_f32_32x32x16_bf16 v[48:63], v[80:83], v[128:131], v[48:63]
  s_nop 9
  v_mul_f32 v32, v32, v12
  v_mul_f32 v33, v33, v13
  v_mul_f32 v34, v34, v12
  v_mul_f32 v35, v35, v13
  v_mul_f32 v36, v36, v12
  v_mul_f32 v37, v37, v13
  v_mul_f32 v38, v38, v12
  v_mul_f32 v39, v39, v13
  v_exp_f32 v8, v32
  v_exp_f32 v9, v33
  v_exp_f32 v10, v34
  v_exp_f32 v11, v35
  v_mfma_f32_32x32x16_bf16 v[48:63], v[84:87], v[132:135], v[48:63]
  s_nop 0
  v_fma_f32 v8, v8, v136, v136
  v_fma_f32 v9, v9, v137, v137
  v_fma_f32 v10, v10, v136, v136
  v_fma_f32 v11, v11, v137, v137
  v_rcp_f32 v8, v8
  v_rcp_f32 v9, v9
  v_rcp_f32 v10, v10
  v_rcp_f32 v11, v11
  s_nop 0
  v_mul_f32 v32, v32, v8
  v_mul_f32 v33, v33, v9
  v_mfma_f32_32x32x16_bf16 v[48:63], v[88:91], v[112:115], v[48:63]
  v_mul_f32 v34, v34, v10
  v_mul_f32 v35, v35, v11
  v_mul_f32 v32, v32, v40
  v_mul_f32 v33, v33, v41
  v_mul_f32 v34, v34, v42
  v_mul_f32 v35, v35, v43
  v_exp_f32 v8, v36
  v_exp_f32 v9, v37
  v_exp_f32 v10, v38
  v_exp_f32 v11, v39
  s_nop 0
  v_mfma_f32_32x32x16_bf16 v[48:63], v[92:95], v[116:119], v[48:63]
  v_fma_f32 v8, v8, v136, v136
  v_fma_f32 v9, v9, v137, v137
  v_fma_f32 v10, v10, v136, v136
  v_fma_f32 v11, v11, v137, v137
  v_rcp_f32 v8, v8
  v_rcp_f32 v9, v9
  v_rcp_f32 v10, v10
  v_rcp_f32 v11, v11
  s_nop 0
  v_mul_f32 v36, v36, v8
  v_mul_f32 v37, v37, v9
  v_mfma_f32_32x32x16_bf16 v[48:63], v[120:123], v[140:143], v[48:63]
  v_mul_f32 v38, v38, v10
  v_mul_f32 v39, v39, v11
  v_mul_f32 v36, v36, v44
  v_mul_f32 v37, v37, v45
  v_mul_f32 v38, v38, v46
  v_mul_f32 v39, v39, v47
  v_cvt_pk_bf16_f32 v40, v32, v33
  v_cvt_pk_bf16_f32 v41, v34, v35
  v_cvt_pk_bf16_f32 v42, v36, v37
  v_cvt_pk_bf16_f32 v43, v38, v39
  buffer_store_dwordx4 v[40:43], v2, s[8:11], s30 offen offset:1024 sc1
  s_waitcnt lgkmcnt(0)
  v_mfma_f32_32x32x16_bf16 v[64:79], v[96:99], v[128:131], v[64:79]
  s_nop 9
  v_mul_f32 v48, v48, v12
  v_mul_f32 v49, v49, v13
  v_mul_f32 v50, v50, v12
  v_mul_f32 v51, v51, v13
  v_mul_f32 v52, v52, v12
  v_mul_f32 v53, v53, v13
  v_mul_f32 v54, v54, v12
  v_mul_f32 v55, v55, v13
  v_exp_f32 v8, v48
  v_exp_f32 v9, v49
  v_exp_f32 v10, v50
  v_exp_f32 v11, v51
  v_mfma_f32_32x32x16_bf16 v[64:79], v[100:103], v[132:135], v[64:79]
  s_nop 0
  v_fma_f32 v8, v8, v136, v136
  v_fma_f32 v9, v9, v137, v137
  v_fma_f32 v10, v10, v136, v136
  v_fma_f32 v11, v11, v137, v137
  v_rcp_f32 v8, v8
  v_rcp_f32 v9, v9
  v_rcp_f32 v10, v10
  v_rcp_f32 v11, v11
  s_nop 0
  v_mul_f32 v48, v48, v8
  v_mul_f32 v49, v49, v9
  v_mfma_f32_32x32x16_bf16 v[64:79], v[104:107], v[112:115], v[64:79]
  v_mul_f32 v50, v50, v10
  v_mul_f32 v51, v51, v11
  v_mul_f32 v48, v48, v56
  v_mul_f32 v49, v49, v57
  v_mul_f32 v50, v50, v58
  v_mul_f32 v51, v51, v59
  v_exp_f32 v8, v52
  v_exp_f32 v9, v53
  v_exp_f32 v10, v54
  v_exp_f32 v11, v55
  s_nop 0
  v_mfma_f32_32x32x16_bf16 v[64:79], v[108:111], v[116:119], v[64:79]
  v_fma_f32 v8, v8, v136, v136
  v_fma_f32 v9, v9, v137, v137
  v_fma_f32 v10, v10, v136, v136
  v_fma_f32 v11, v11, v137, v137
  v_rcp_f32 v8, v8
  v_rcp_f32 v9, v9
  v_rcp_f32 v10, v10
  v_rcp_f32 v11, v11
  s_nop 0
  v_mul_f32 v52, v52, v8
  v_mul_f32 v53, v53, v9
  v_mfma_f32_32x32x16_bf16 v[64:79], v[124:127], v[140:143], v[64:79]
  v_mul_f32 v54, v54, v10
  v_mul_f32 v55, v55, v11
  v_mul_f32 v52, v52, v60
  v_mul_f32 v53, v53, v61
  v_mul_f32 v54, v54, v62
  v_mul_f32 v55, v55, v63
  v_cvt_pk_bf16_f32 v56, v48, v49
  v_cvt_pk_bf16_f32 v57, v50, v51
  v_cvt_pk_bf16_f32 v58, v52, v53
  v_cvt_pk_bf16_f32 v59, v54, v55
  buffer_store_dwordx4 v[56:59], v2, s[8:11], s30 offen offset:2048 sc1
  s_nop 11
  v_pk_mul_f32 v[64:65], v[64:65], v[12:13]
  v_pk_mul_f32 v[66:67], v[66:67], v[12:13]
  v_pk_mul_f32 v[68:69], v[68:69], v[12:13]
  v_pk_mul_f32 v[70:71], v[70:71], v[12:13]
  v_exp_f32 v8, v64
  v_exp_f32 v9, v65
  v_exp_f32 v10, v66
  v_exp_f32 v11, v67
  s_nop 0
  v_pk_fma_f32 v[8:9], v[8:9], v[136:137], v[136:137]
  v_pk_fma_f32 v[10:11], v[10:11], v[136:137], v[136:137]
  v_rcp_f32 v8, v8
  v_rcp_f32 v9, v9
  v_rcp_f32 v10, v10
  v_rcp_f32 v11, v11
  s_nop 0
  v_pk_mul_f32 v[64:65], v[64:65], v[8:9]
  v_pk_mul_f32 v[66:67], v[66:67], v[10:11]
  v_pk_mul_f32 v[64:65], v[64:65], v[72:73]
  v_pk_mul_f32 v[66:67], v[66:67], v[74:75]
  v_exp_f32 v8, v68
  v_exp_f32 v9, v69
  v_exp_f32 v10, v70
  v_exp_f32 v11, v71
  s_nop 0
  v_pk_fma_f32 v[8:9], v[8:9], v[136:137], v[136:137]
  v_pk_fma_f32 v[10:11], v[10:11], v[136:137], v[136:137]
  v_rcp_f32 v8, v8
  v_rcp_f32 v9, v9
  v_rcp_f32 v10, v10
  v_rcp_f32 v11, v11
  s_nop 0
  v_pk_mul_f32 v[68:69], v[68:69], v[8:9]
  v_pk_mul_f32 v[70:71], v[70:71], v[10:11]
  v_pk_mul_f32 v[68:69], v[68:69], v[76:77]
  v_pk_mul_f32 v[70:71], v[70:71], v[78:79]
  v_cvt_pk_bf16_f32 v72, v64, v65
  v_cvt_pk_bf16_f32 v73, v66, v67
  v_cvt_pk_bf16_f32 v74, v68, v69
  v_cvt_pk_bf16_f32 v75, v70, v71
  buffer_store_dwordx4 v[72:75], v2, s[8:11], s30 offen offset:3072 sc1
  s_branch f10_join
f10_up:
  ds_read_b128 v[80:83], v5 offset:0
  ds_read_b128 v[84:87], v5 offset:1024
  ds_read_b128 v[88:91], v5 offset:2048
  ds_read_b128 v[96:99], v5 offset:4096
  ds_read_b128 v[100:103], v5 offset:5120
  ds_read_b128 v[104:107], v5 offset:6144
  s_waitcnt vmcnt(6) lgkmcnt(3)
  v_mfma_f32_32x32x16_bf16 v[16:31], v[80:83], v[112:115], 0
  v_mfma_f32_32x32x16_bf16 v[32:47], v[84:87], v[112:115], 0
  v_mfma_f32_32x32x16_bf16 v[48:63], v[88:91], v[112:115], 0
  buffer_load_dwordx4 v[112:115], v2, s[8:11], s20 offen offset:2048
  ds_read_b128 v[80:83], v5 offset:8192
  ds_read_b128 v[84:87], v5 offset:9216
  ds_read_b128 v[88:91], v5 offset:10240
  s_waitcnt vmcnt(6) lgkmcnt(3)
  v_mfma_f32_32x32x16_bf16 v[16:31], v[96:99], v[116:119], v[16:31]
  v_mfma_f32_32x32x16_bf16 v[32:47], v[100:103], v[116:119], v[32:47]
  v_mfma_f32_32x32x16_bf16 v[48:63], v[104:107], v[116:119], v[48:63]
  buffer_load_dwordx4 v[116:119], v2, s[8:11], s20 offen offset:3072
  ds_read_b128 v[96:99], v5 offset:12288
  ds_read_b128 v[100:103], v5 offset:13312
  ds_read_b128 v[104:107], v5 offset:14336
  s_waitcnt vmcnt(6) lgkmcnt(3)
  v_mfma_f32_32x32x16_bf16 v[16:31], v[80:83], v[120:123], v[16:31]
  v_mfma_f32_32x32x16_bf16 v[32:47], v[84:87], v[120:123], v[32:47]
  v_mfma_f32_32x32x16_bf16 v[48:63], v[88:91], v[120:123], v[48:63]
  s_add_u32 s20, s20, 4096
  buffer_load_dwordx4 v[120:123], v2, s[8:11], s20 offen offset:0
  ds_read_b128 v[80:83], v5 offset:16384
  ds_read_b128 v[84:87], v5 offset:17408
  ds_read_b128 v[88:91], v5 offset:18432
  s_waitcnt vmcnt(6) lgkmcnt(3)
  v_mfma_f32_32x32x16_bf16 v[16:31], v[96:99], v[124:127], v[16:31]
  v_mfma_f32_32x32x16_bf16 v[32:47], v[100:103], v[124:127], v[32:47]
  v_mfma_f32_32x32x16_bf16 v[48:63], v[104:107], v[124:127], v[48:63]
  buffer_load_dwordx4 v[124:127], v2, s[8:11], s20 offen offset:1024
  ds_read_b128 v[96:99], v5 offset:20480
  ds_read_b128 v[100:103], v5 offset:21504
  ds_read_b128 v[104:107], v5 offset:22528
  s_waitcnt vmcnt(6) lgkmcnt(3)
  v_mfma_f32_32x32x16_bf16 v[16:31], v[80:83], v[128:131], v[16:31]
  v_mfma_f32_32x32x16_bf16 v[32:47], v[84:87], v[128:131], v[32:47]
  v_mfma_f32_32x32x16_bf16 v[48:63], v[88:91], v[128:131], v[48:63]
  buffer_load_dwordx4 v[128:131], v2, s[8:11], s20 offen offset:2048
  s_lshl_b32 s28, s14, 12
  s_add_u32 m0, s28, 98304
  s_add_u32 s28, s33, 172032
  buffer_load_dwordx4 v2, s[8:11], s28 offen offset:0 lds
  buffer_load_dwordx4 v2, s[8:11], s28 offen offset:1024 lds
  buffer_load_dwordx4 v2, s[8:11], s28 offen offset:2048 lds
  buffer_load_dwordx4 v2, s[8:11], s28 offen offset:3072 lds
  s_lshl_b32 s28, s39, 10
  s_add_u32 m0, s28, 131072
  s_mul_i32 s29, s14, 7168
  s_sub_u32 s29, s33, s29
  s_add_u32 s29, s29, s28
  s_add_u32 s29, s29, 229376
  buffer_load_dwordx4 v2, s[8:11], s29 offen lds
  ds_read_b128 v[80:83], v5 offset:24576
  ds_read_b128 v[84:87], v5 offset:25600
  ds_read_b128 v[88:91], v5 offset:26624
  s_waitcnt vmcnt(11) lgkmcnt(3)
  v_mfma_f32_32x32x16_bf16 v[16:31], v[96:99], v[132:135], v[16:31]
  v_mfma_f32_32x32x16_bf16 v[32:47], v[100:103], v[132:135], v[32:47]
  v_mfma_f32_32x32x16_bf16 v[48:63], v[104:107], v[132:135], v[48:63]
  buffer_load_dwordx4 v[132:135], v2, s[8:11], s20 offen offset:3072
  ds_read_b128 v[96:99], v5 offset:28672
  ds_read_b128 v[100:103], v5 offset:29696
  ds_read_b128 v[104:107], v5 offset:30720
  s_waitcnt vmcnt(10) lgkmcnt(3)
  v_mfma_f32_32x32x16_bf16 v[16:31], v[80:83], v[112:115], v[16:31]
  v_mfma_f32_32x32x16_bf16 v[32:47], v[84:87], v[112:115], v[32:47]
  v_mfma_f32_32x32x16_bf16 v[48:63], v[88:91], v[112:115], v[48:63]
  s_add_u32 s20, s20, 4096
  buffer_load_dwordx4 v[112:115], v2, s[8:11], s20 offen offset:0
  ds_read_b128 v[80:83], v5 offset:32768
  ds_read_b128 v[84:87], v5 offset:33792
  ds_read_b128 v[88:91], v5 offset:34816
  s_waitcnt vmcnt(10) lgkmcnt(3)
  v_mfma_f32_32x32x16_bf16 v[16:31], v[96:99], v[116:119], v[16:31]
  v_mfma_f32_32x32x16_bf16 v[32:47], v[100:103], v[116:119], v[32:47]
  v_mfma_f32_32x32x16_bf16 v[48:63], v[104:107], v[116:119], v[48:63]
  buffer_load_dwordx4 v[116:119], v2, s[8:11], s20 offen offset:1024
  ds_read_b128 v[96:99], v5 offset:36864
  ds_read_b128 v[100:103], v5 offset:37888
  ds_read_b128 v[104:107], v5 offset:38912
  s_waitcnt vmcnt(10) lgkmcnt(3)
  v_mfma_f32_32x32x16_bf16 v[16:31], v[80:83], v[120:123], v[16:31]
  v_mfma_f32_32x32x16_bf16 v[32:47], v[84:87], v[120:123], v[32:47]
  v_mfma_f32_32x32x16_bf16 v[48:63], v[88:91], v[120:123], v[48:63]
  buffer_load_dwordx4 v[120:123], v2, s[8:11], s20 offen offset:2048
  v_cmp_ne_u32 vcc, s94, v136
  s_cbranch_vccz spoll_43_ok
  s_mov_b32 s93, 524288
spoll_43:
  buffer_load_dword v136, v137, s[8:11], s34 offen offset:0 sc1
  s_sub_u32 s93, s93, 1
  s_waitcnt vmcnt(0)
  v_cmp_ne_u32 vcc, s94, v136
  s_cmp_eq_u32 s93, 0
  s_cbranch_scc1 spoll_43_x
  s_cbranch_vccz spoll_43_x
  s_branch spoll_43
spoll_43_x:
spoll_43_ok:
  buffer_load_dwordx2 v[136:137], v10, s[8:11], s19 offen offset:0
  buffer_load_dwordx2 v[138:139], v10, s[8:11], s19 offen offset:256
  buffer_load_dwordx2 v[140:141], v10, s[8:11], s19 offen offset:512
  buffer_load_dwordx2 v[142:143], v10, s[8:11], s19 offen offset:768
  ds_read_b128 v[80:83], v5 offset:40960
  ds_read_b128 v[84:87], v5 offset:41984
  ds_read_b128 v[88:91], v5 offset:43008
  s_waitcnt vmcnt(14) lgkmcnt(3)
  v_mfma_f32_32x32x16_bf16 v[16:31], v[96:99], v[124:127], v[16:31]
  v_mfma_f32_32x32x16_bf16 v[32:47], v[100:103], v[124:127], v[32:47]
  v_mfma_f32_32x32x16_bf16 v[48:63], v[104:107], v[124:127], v[48:63]
  buffer_load_dwordx4 v[124:127], v2, s[8:11], s20 offen offset:3072
  ds_read_b128 v[96:99], v5 offset:45056
  ds_read_b128 v[100:103], v5 offset:46080
  ds_read_b128 v[104:107], v5 offset:47104
  s_waitcnt vmcnt(14) lgkmcnt(3)
  v_mfma_f32_32x32x16_bf16 v[16:31], v[80:83], v[128:131], v[16:31]
  v_mfma_f32_32x32x16_bf16 v[32:47], v[84:87], v[128:131], v[32:47]
  v_mfma_f32_32x32x16_bf16 v[48:63], v[88:91], v[128:131], v[48:63]
  s_add_u32 s20, s20, 4096
  buffer_load_dwordx4 v[128:131], v2, s[8:11], s20 offen offset:0
  ds_read_b128 v[80:83], v5 offset:49152
  ds_read_b128 v[84:87], v5 offset:50176
  ds_read_b128 v[88:91], v5 offset:51200
  s_waitcnt vmcnt(9) lgkmcnt(3)
  v_mfma_f32_32x32x16_bf16 v[16:31], v[96:99], v[132:135], v[16:31]
  v_mfma_f32_32x32x16_bf16 v[32:47], v[100:103], v[132:135], v[32:47]
  v_mfma_f32_32x32x16_bf16 v[48:63], v[104:107], v[132:135], v[48:63]
  buffer_load_dwordx4 v[132:135], v2, s[8:11], s20 offen offset:1024
  ds_read_b128 v[96:99], v5 offset:53248
  ds_read_b128 v[100:103], v5 offset:54272
  ds_read_b128 v[104:107], v5 offset:55296
  s_waitcnt vmcnt(9) lgkmcnt(3)
  v_mfma_f32_32x32x16_bf16 v[16:31], v[80:83], v[112:115], v[16:31]
  v_mfma_f32_32x32x16_bf16 v[32:47], v[84:87], v[112:115], v[32:47]
  v_mfma_f32_32x32x16_bf16 v[48:63], v[88:91], v[112:115], v[48:63]
  buffer_load_dwordx4 v[112:115], v2, s[8:11], s20 offen offset:2048
  ds_read_b128 v[80:83], v5 offset:57344
  ds_read_b128 v[84:87], v5 offset:58368
  ds_read_b128 v[88:91], v5 offset:59392
  s_waitcnt vmcnt(9) lgkmcnt(3)
  v_mfma_f32_32x32x16_bf16 v[16:31], v[96:99], v[116:119], v[16:31]
  v_mfma_f32_32x32x16_bf16 v[32:47], v[100:103], v[116:119], v[32:47]
  v_mfma_f32_32x32x16_bf16 v[48:63], v[104:107], v[116:119], v[48:63]
  buffer_load_dwordx4 v[116:119], v2, s[8:11], s20 offen offset:3072
  ds_read_b128 v[96:99], v5 offset:61440
  ds_read_b128 v[100:103], v5 offset:62464
  ds_read_b128 v[104:107], v5 offset:63488
  s_waitcnt vmcnt(9) lgkmcnt(3)
  v_mfma_f32_32x32x16_bf16 v[16:31], v[80:83], v[120:123], v[16:31]
  v_mfma_f32_32x32x16_bf16 v[32:47], v[84:87], v[120:123], v[32:47]
  v_mfma_f32_32x32x16_bf16 v[48:63], v[88:91], v[120:123], v[48:63]
  s_add_u32 s20, s20, 4096
  buffer_load_dwordx4 v[120:123], v2, s[8:11], s20 offen offset:0
  ds_read_b128 v[80:83], v6 offset:0
  ds_read_b128 v[84:87], v6 offset:1024
  ds_read_b128 v[88:91], v6 offset:2048
  s_waitcnt vmcnt(5) lgkmcnt(3)
  v_mfma_f32_32x32x16_bf16 v[16:31], v[96:99], v[124:127], v[16:31]
  v_mfma_f32_32x32x16_bf16 v[32:47], v[100:103], v[124:127], v[32:47]
  v_mfma_f32_32x32x16_bf16 v[48:63], v[104:107], v[124:127], v[48:63]
  buffer_load_dwordx4 v[124:127], v2, s[8:11], s20 offen offset:1024
  ds_read_b128 v[96:99], v6 offset:4096
  ds_read_b128 v[100:103], v6 offset:5120
  ds_read_b128 v[104:107], v6 offset:6144
  s_waitcnt vmcnt(5) lgkmcnt(3)
  v_mfma_f32_32x32x16_bf16 v[16:31], v[80:83], v[128:131], v[16:31]
  v_mfma_f32_32x32x16_bf16 v[32:47], v[84:87], v[128:131], v[32:47]
  v_mfma_f32_32x32x16_bf16 v[48:63], v[88:91], v[128:131], v[48:63]
  buffer_load_dwordx4 v[128:131], v2, s[8:11], s20 offen offset:2048
  ds_read_b128 v[80:83], v6 offset:8192
  ds_read_b128 v[84:87], v6 offset:9216
  ds_read_b128 v[88:91], v6 offset:10240
  s_waitcnt vmcnt(5) lgkmcnt(3)
  v_mfma_f32_32x32x16_bf16 v[16:31], v[96:99], v[132:135], v[16:31]
  v_mfma_f32_32x32x16_bf16 v[32:47], v[100:103], v[132:135], v[32:47]
  v_mfma_f32_32x32x16_bf16 v[48:63], v[104:107], v[132:135], v[48:63]
  buffer_load_dwordx4 v[132:135], v2, s[8:11], s20 offen offset:3072
  ds_read_b128 v[96:99], v6 offset:12288
  ds_read_b128 v[100:103], v6 offset:13312
  ds_read_b128 v[104:107], v6 offset:14336
  s_waitcnt vmcnt(5) lgkmcnt(3)
  v_mfma_f32_32x32x16_bf16 v[16:31], v[80:83], v[112:115], v[16:31]
  v_mfma_f32_32x32x16_bf16 v[32:47], v[84:87], v[112:115], v[32:47]
  v_mfma_f32_32x32x16_bf16 v[48:63], v[88:91], v[112:115], v[48:63]
  s_add_u32 s20, s20, 4096
  buffer_load_dwordx4 v[112:115], v2, s[8:11], s20 offen offset:0
  ds_read_b128 v[80:83], v6 offset:16384
  ds_read_b128 v[84:87], v6 offset:17408
  ds_read_b128 v[88:91], v6 offset:18432
  s_waitcnt vmcnt(5) lgkmcnt(3)
  v_mfma_f32_32x32x16_bf16 v[16:31], v[96:99], v[116:119], v[16:31]
  v_mfma_f32_32x32x16_bf16 v[32:47], v[100:103], v[116:119], v[32:47]
  v_mfma_f32_32x32x16_bf16 v[48:63], v[104:107], v[116:119], v[48:63]
  buffer_load_dwordx4 v[116:119], v2, s[8:11], s20 offen offset:1024
  ds_read_b128 v[96:99], v6 offset:20480
  ds_read_b128 v[100:103], v6 offset:21504
  ds_read_b128 v[104:107], v6 offset:22528
  s_waitcnt vmcnt(5) lgkmcnt(3)
  v_add_f32 v136, v136, v138
  v_add_f32 v137, v137, v139
  v_add_f32 v140, v140, v142
  v_add_f32 v141, v141, v143
  v_add_f32 v136, v136, v140
  v_add_f32 v137, v137, v141
  v_mov_b32 v8, v136
  v_mov_b32 v9, v137
  s_nop 1
  v_permlane32_swap_b32 v136, v8
  v_permlane32_swap_b32 v137, v9
  s_nop 1
  v_add_f32 v136, v136, v8
  v_add_f32 v137, v137, v9
  v_mul_f32 v136, 0x3b000000, v136
  v_mul_f32 v137, 0x3b000000, v137
  v_fma_f32 v137, -v136, v136, v137
  v_max_f32 v137, 0, v137
  v_add_f32 v137, 0x3727c5ac, v137
  v_rsq_f32 v12, v137
  v_and_b32 v8, 0xffff0000, v136
  v_sub_f32 v9, v136, v8
  v_cvt_pk_bf16_f32 v140, -v8, -v8
  v_cvt_pk_bf16_f32 v141, -v9, 0
  v_mov_b32 v142, v140
  v_mov_b32 v143, v141
  v_mul_f32 v12, 0xbfb8aa3b, v12
  v_mul_f32 v137, v137, v12
  v_mov_b32 v13, v12
  v_mov_b32 v136, v137
  v_mfma_f32_32x32x16_bf16 v[16:31], v[80:83], v[120:123], v[16:31]
  v_mfma_f32_32x32x16_bf16 v[32:47], v[84:87], v[120:123], v[32:47]
  v_mfma_f32_32x32x16_bf16 v[48:63], v[88:91], v[120:123], v[48:63]
  buffer_load_dwordx4 v[120:123], v2, s[8:11], s20 offen offset:2048
  ds_read_b128 v[80:83], v6 offset:24576
  ds_read_b128 v[84:87], v6 offset:25600
  ds_read_b128 v[88:91], v6 offset:26624
  s_waitcnt vmcnt(5) lgkmcnt(3)
  v_mfma_f32_32x32x16_bf16 v[16:31], v[96:99], v[124:127], v[16:31]
  v_mfma_f32_32x32x16_bf16 v[32:47], v[100:103], v[124:127], v[32:47]
  v_mfma_f32_32x32x16_bf16 v[48:63], v[104:107], v[124:127], v[48:63]
  buffer_load_dwordx4 v[124:127], v2, s[8:11], s20 offen offset:3072
  ds_read_b128 v[96:99], v6 offset:28672
  ds_read_b128 v[100:103], v6 offset:29696
  ds_read_b128 v[104:107], v6 offset:30720
  s_waitcnt vmcnt(5) lgkmcnt(3)
  v_mfma_f32_32x32x16_bf16 v[16:31], v[80:83], v[128:131], v[16:31]
  v_mfma_f32_32x32x16_bf16 v[32:47], v[84:87], v[128:131], v[32:47]
  v_mfma_f32_32x32x16_bf16 v[48:63], v[88:91], v[128:131], v[48:63]
  s_add_u32 s20, s20, 4096
  buffer_load_dwordx4 v[128:131], v2, s[8:11], s20 offen offset:0
  s_waitcnt vmcnt(5)
  s_barrier
  ds_read_b128 v[80:83], v6 offset:32768
  ds_read_b128 v[84:87], v6 offset:33792
  ds_read_b128 v[88:91], v6 offset:34816
  s_waitcnt lgkmcnt(3)
  v_mfma_f32_32x32x16_bf16 v[16:31], v[96:99], v[132:135], v[16:31]
  v_mfma_f32_32x32x16_bf16 v[32:47], v[100:103], v[132:135], v[32:47]
  v_mfma_f32_32x32x16_bf16 v[48:63], v[104:107], v[132:135], v[48:63]
  buffer_load_dwordx4 v[132:135], v2, s[8:11], s20 offen offset:1024
  ds_read_b128 v[96:99], v6 offset:36864
  ds_read_b128 v[100:103], v6 offset:37888
  ds_read_b128 v[104:107], v6 offset:38912
  s_waitcnt vmcnt(5) lgkmcnt(3)
  v_mfma_f32_32x32x16_bf16 v[16:31], v[80:83], v[112:115], v[16:31]
  v_mfma_f32_32x32x16_bf16 v[32:47], v[84:87], v[112:115], v[32:47]
  v_mfma_f32_32x32x16_bf16 v[48:63], v[88:91], v[112:115], v[48:63]
  buffer_load_dwordx4 v[112:115], v2, s[8:11], s20 offen offset:2048
  ds_read_b128 v[80:83], v6 offset:40960
  ds_read_b128 v[84:87], v6 offset:41984
  ds_read_b128 v[88:91], v6 offset:43008
  s_waitcnt vmcnt(5) lgkmcnt(3)
  v_mfma_f32_32x32x16_bf16 v[16:31], v[96:99], v[116:119], v[16:31]
  v_mfma_f32_32x32x16_bf16 v[32:47], v[100:103], v[116:119], v[32:47]
  v_mfma_f32_32x32x16_bf16 v[48:63], v[104:107], v[116:119], v[48:63]
  buffer_load_dwordx4 v[116:119], v2, s[8:11], s20 offen offset:3072
  ds_read_b128 v[96:99], v6 offset:45056
  ds_read_b128 v[100:103], v6 offset:46080
  ds_read_b128 v[104:107], v6 offset:47104
  s_waitcnt vmcnt(5) lgkmcnt(3)
  v_mfma_f32_32x32x16_bf16 v[16:31], v[80:83], v[120:123], v[16:31]
  v_mfma_f32_32x32x16_bf16 v[32:47], v[84:87], v[120:123], v[32:47]
  v_mfma_f32_32x32x16_bf16 v[48:63], v[88:91], v[120:123], v[48:63]
  ds_read_b128 v[80:83], v6 offset:49152
  ds_read_b128 v[84:87], v6 offset:53248
  ds_read_b128 v[88:91], v6 offset:57344
  ds_read_b128 v[92:95], v6 offset:61440
  ds_read_b128 v[120:123], v7 offset:0
  s_waitcnt vmcnt(4) lgkmcnt(5)
  v_mfma_f32_32x32x16_bf16 v[16:31], v[96:99], v[124:127], v[16:31]
  v_mfma_f32_32x32x16_bf16 v[32:47], v[100:103], v[124:127], v[32:47]
  v_mfma_f32_32x32x16_bf16 v[48:63], v[104:107], v[124:127], v[48:63]
  s_waitcnt vmcnt(0)
  ds_read_b128 v[96:99], v6 offset:50176
  ds_read_b128 v[100:103], v6 offset:54272
  ds_read_b128 v[104:107], v6 offset:58368
  ds_read_b128 v[108:111], v6 offset:62464
  ds_read_b128 v[124:127], v7 offset:1024
  s_waitcnt lgkmcnt(5)
  v_mfma_f32_32x32x16_bf16 v[16:31], v[80:83], v[128:131], v[16:31]
  v_mfma_f32_32x32x16_bf16 v[16:31], v[84:87], v[132:135], v[16:31]
  v_mfma_f32_32x32x16_bf16 v[16:31], v[88:91], v[112:115], v[16:31]
  v_mfma_f32_32x32x16_bf16 v[16:31], v[92:95], v[116:119], v[16:31]
  v_mfma_f32_32x32x16_bf16 v[16:31], v[120:123], v[140:143], v[16:31]
  ds_read_b128 v[80:83], v6 offset:51200
  ds_read_b128 v[84:87], v6 offset:55296
  ds_read_b128 v[88:91], v6 offset:59392
  ds_read_b128 v[92:95], v6 offset:63488
  ds_read_b128 v[120:123], v7 offset:2048
  s_waitcnt lgkmcnt(5)
  v_mfma_f32_32x32x16_bf16 v[32:47], v[96:99], v[128:131], v[32:47]
  s_nop 9
  v_mul_f32 v16, v16, v12
  v_mul_f32 v17, v17, v13
  v_mul_f32 v18, v18, v12
  v_mul_f32 v19, v19, v13
  v_mul_f32 v20, v20, v12
  v_mul_f32 v21, v21, v13
  v_mul_f32 v22, v22, v12
  v_mul_f32 v23, v23, v13
  v_exp_f32 v8, v16
  v_exp_f32 v9, v17
  v_exp_f32 v10, v18
  v_exp_f32 v11, v19
  v_mfma_f32_32x32x16_bf16 v[32:47], v[100:103], v[132:135], v[32:47]
  s_nop 0
  v_fma_f32 v8, v8, v136, v136
  v_fma_f32 v9, v9, v137, v137
  v_fma_f32 v10, v10, v136, v136
  v_fma_f32 v11, v11, v137, v137
  v_rcp_f32 v8, v8
  v_rcp_f32 v9, v9
  v_rcp_f32 v10, v10
  v_rcp_f32 v11, v11
  s_nop 0
  v_mul_f32 v16, v16, v8
  v_mul_f32 v17, v17, v9
  v_mfma_f32_32x32x16_bf16 v[32:47], v[104:107], v[112:115], v[32:47]
  v_mul_f32 v18, v18, v10
  v_mul_f32 v19, v19, v11
  v_mul_f32 v16, v16, v24
  v_mul_f32 v17, v17, v25
  v_mul_f32 v18, v18, v26
  v_mul_f32 v19, v19, v27
  v_exp_f32 v8, v20
  v_exp_f32 v9, v21
  v_exp_f32 v10, v22
  v_exp_f32 v11, v23
  s_nop 0
  v_mfma_f32_32x32x16_bf16 v[32:47], v[108:111], v[116:119], v[32:47]
  v_fma_f32 v8, v8, v136, v136
  v_fma_f32 v9, v9, v137, v137
  v_fma_f32 v10, v10, v136, v136
  v_fma_f32 v11, v11, v137, v137
  v_rcp_f32 v8, v8
  v_rcp_f32 v9, v9
  v_rcp_f32 v10, v10
  v_rcp_f32 v11, v11
  s_nop 0
  v_mul_f32 v20, v20, v8
  v_mul_f32 v21, v21, v9
  v_mfma_f32_32x32x16_bf16 v[32:47], v[124:127], v[140:143], v[32:47]
  v_mul_f32 v22, v22, v10
  v_mul_f32 v23, v23, v11
  v_mul_f32 v20, v20, v28
  v_mul_f32 v21, v21, v29
  v_mul_f32 v22, v22, v30
  v_mul_f32 v23, v23, v31
  v_cvt_pk_bf16_f32 v24, v16, v17
  v_cvt_pk_bf16_f32 v25, v18, v19
  v_cvt_pk_bf16_f32 v26, v20, v21
  v_cvt_pk_bf16_f32 v27, v22, v23
  buffer_store_dwordx4 v[24:27], v2, s[8:11], s30 offen offset:0 sc1
  s_waitcnt lgkmcnt(0)
  v_mfma_f32_32x32x16_bf16 v[48:63], v[80:83], v[128:131], v[48:63]
  s_nop 9
  v_mul_f32 v32, v32, v12
  v_mul_f32 v33, v33, v13
  v_mul_f32 v34, v34, v12
  v_mul_f32 v35, v35, v13
  v_mul_f32 v36, v36, v12
  v_mul_f32 v37, v37, v13
  v_mul_f32 v38, v38, v12
  v_mul_f32 v39, v39, v13
  v_exp_f32 v8, v32
  v_exp_f32 v9, v33
  v_exp_f32 v10, v34
  v_exp_f32 v11, v35
  v_mfma_f32_32x32x16_bf16 v[48:63], v[84:87], v[132:135], v[48:63]
  s_nop 0
  v_fma_f32 v8, v8, v136, v136
  v_fma_f32 v9, v9, v137, v137
  v_fma_f32 v10, v10, v136, v136
  v_fma_f32 v11, v11, v137, v137
  v_rcp_f32 v8, v8
  v_rcp_f32 v9, v9
  v_rcp_f32 v10, v10
  v_rcp_f32 v11, v11
  s_nop 0
  v_mul_f32 v32, v32, v8
  v_mul_f32 v33, v33, v9
  v_mfma_f32_32x32x16_bf16 v[48:63], v[88:91], v[112:115], v[48:63]
  v_mul_f32 v34, v34, v10
  v_mul_f32 v35, v35, v11
  v_mul_f32 v32, v32, v40
  v_mul_f32 v33, v33, v41
  v_mul_f32 v34, v34, v42
  v_mul_f32 v35, v35, v43
  v_exp_f32 v8, v36
  v_exp_f32 v9, v37
  v_exp_f32 v10, v38
  v_exp_f32 v11, v39
  s_nop 0
  v_mfma_f32_32x32x16_bf16 v[48:63], v[92:95], v[116:119], v[48:63]
  v_fma_f32 v8, v8, v136, v136
  v_fma_f32 v9, v9, v137, v137
  v_fma_f32 v10, v10, v136, v136
  v_fma_f32 v11, v11, v137, v137
  v_rcp_f32 v8, v8
  v_rcp_f32 v9, v9
  v_rcp_f32 v10, v10
  v_rcp_f32 v11, v11
  s_nop 0
  v_mul_f32 v36, v36, v8
  v_mul_f32 v37, v37, v9
  v_mfma_f32_32x32x16_bf16 v[48:63], v[120:123], v[140:143], v[48:63]
  v_mul_f32 v38, v38, v10
  v_mul_f32 v39, v39, v11
  v_mul_f32 v36, v36, v44
  v_mul_f32 v37, v37, v45
  v_mul_f32 v38, v38, v46
  v_mul_f32 v39, v39, v47
  v_cvt_pk_bf16_f32 v40, v32, v33
  v_cvt_pk_bf16_f32 v41, v34, v35
  v_cvt_pk_bf16_f32 v42, v36, v37
  v_cvt_pk_bf16_f32 v43, v38, v39
  buffer_store_dwordx4 v[40:43], v2, s[8:11], s30 offen offset:1024 sc1
  s_nop 11
  v_pk_mul_f32 v[48:49], v[48:49], v[12:13]
  v_pk_mul_f32 v[50:51], v[50:51], v[12:13]
  v_pk_mul_f32 v[52:53], v[52:53], v[12:13]
  v_pk_mul_f32 v[54:55], v[54:55], v[12:13]
  v_exp_f32 v8, v48
  v_exp_f32 v9, v49
  v_exp_f32 v10, v50
  v_exp_f32 v11, v51
  s_nop 0
  v_pk_fma_f32 v[8:9], v[8:9], v[136:137], v[136:137]
  v_pk_fma_f32 v[10:11], v[10:11], v[136:137], v[136:137]
  v_rcp_f32 v8, v8
  v_rcp_f32 v9, v9
  v_rcp_f32 v10, v10
  v_rcp_f32 v11, v11
  s_nop 0
  v_pk_mul_f32 v[48:49], v[48:49], v[8:9]
  v_pk_mul_f32 v[50:51], v[50:51], v[10:11]
  v_pk_mul_f32 v[48:49], v[48:49], v[56:57]
  v_pk_mul_f32 v[50:51], v[50:51], v[58:59]
  v_exp_f32 v8, v52
  v_exp_f32 v9, v53
  v_exp_f32 v10, v54
  v_exp_f32 v11, v55
  s_nop 0
  v_pk_fma_f32 v[8:9], v[8:9], v[136:137], v[136:137]
  v_pk_fma_f32 v[10:11], v[10:11], v[136:137], v[136:137]
  v_rcp_f32 v8, v8
  v_rcp_f32 v9, v9
  v_rcp_f32 v10, v10
  v_rcp_f32 v11, v11
  s_nop 0
  v_pk_mul_f32 v[52:53], v[52:53], v[8:9]
  v_pk_mul_f32 v[54:55], v[54:55], v[10:11]
  v_pk_mul_f32 v[52:53], v[52:53], v[60:61]
  v_pk_mul_f32 v[54:55], v[54:55], v[62:63]
  v_cvt_pk_bf16_f32 v56, v48, v49
  v_cvt_pk_bf16_f32 v57, v50, v51
  v_cvt_pk_bf16_f32 v58, v52, v53
  v_cvt_pk_bf16_f32 v59, v54, v55
  buffer_store_dwordx4 v[56:59], v2, s[8:11], s30 offen offset:2048 sc1
f10_join:
  s_and_b32 s18, s14, 1
  s_lshr_b32 s17, s14, 1
  s_lshr_b32 s49, s14, 2
  s_and_b32 s48, s17, 1
  s_add_u32 s20, s15, s49
  s_lshl_b32 s21, s16, 1
  s_and_b32 s19, s14, 1
  s_add_u32 s21, s21, s19
  s_lshl_b32 s21, s21, 1
  s_add_u32 s21, s21, s48
  s_lshl_b32 s19, s20, 5
  s_add_u32 s19, s19, s21
  s_lshl_b32 s19, s19, 10
  s_waitcnt vmcnt(0) lgkmcnt(0)
  s_barrier
  s_cmp_lg_u32 s14, 0
  s_cbranch_scc1 xb2_n0
  s_add_u32 s22, s98, 256
  v_mov_b32 v6, s94
  v_mov_b32 v7, s99
  s_mov_b64 exec, 1
  s_cmp_lg_u32 s92, 0
  s_cbranch_scc1 xb2_f_safe
  buffer_store_dword v6, v7, s[8:11], s22 offen
  s_branch xb2_f_st
xb2_f_safe:
  buffer_wbl2 sc1
  s_waitcnt vmcnt(0)
  buffer_store_dword v6, v7, s[8:11], s22 offen sc1
xb2_f_st:
  s_mov_b64 exec, -1
  v_lshlrev_b32 v5, 2, v3
  s_mov_b32 s93, 0x80000
  buffer_load_dword v12, v5, s[8:11], s22 offen sc1
  s_sleep 3
xb2_poll:
  buffer_load_dword v13, v5, s[8:11], s22 offen sc1
  s_waitcnt vmcnt(1)
  v_cmp_ne_u32 vcc, s94, v12
  s_cbranch_vccz xb2_poll_x
  buffer_load_dword v12, v5, s[8:11], s22 offen sc1
  s_waitcnt vmcnt(1)
  v_cmp_ne_u32 vcc, s94, v13
  s_cbranch_vccz xb2_poll_x
  s_sub_u32 s93, s93, 1
  s_cmp_lg_u32 s93, 0
  s_cbranch_scc1 xb2_poll
xb2_poll_x:
  s_cmp_eq_u32 s92, 0
  s_cbranch_scc1 xb2_rel
  buffer_inv sc1
  s_waitcnt vmcnt(0)
xb2_n0:
xb2_rel:
  s_barrier
  s_add_u32 s22, s15, s18
  s_mul_i32 s22, s22, 112
  s_mul_i32 s23, s17, 28
  s_add_u32 s22, s22, s23
  s_lshl_b32 s26, s22, 10
  s_add_u32 s26, s26, 20971520
  s_add_u32 s26, s26, s55
  s_lshl_b32 s28, s14, 11
  s_add_u32 m0, s28, 0
  s_add_u32 s29, s26, 0
  buffer_load_dwordx4 v2, s[8:11], s29 offen offset:0 lds
  buffer_load_dwordx4 v2, s[8:11], s29 offen offset:1024 lds
  s_barrier
  s_add_u32 m0, s28, 16384
  s_add_u32 s29, s26, 2048
  buffer_load_dwordx4 v2, s[8:11], s29 offen offset:0 lds
  buffer_load_dwordx4 v2, s[8:11], s29 offen offset:1024 lds
  s_barrier
  s_add_u32 m0, s28, 32768
  s_add_u32 s29, s26, 4096
  buffer_load_dwordx4 v2, s[8:11], s29 offen offset:0 lds
  buffer_load_dwordx4 v2, s[8:11], s29 offen offset:1024 lds
  s_barrier
  s_add_u32 m0, s28, 49152
  s_add_u32 s29, s26, 6144
  buffer_load_dwordx4 v2, s[8:11], s29 offen offset:0 lds
  buffer_load_dwordx4 v2, s[8:11], s29 offen offset:1024 lds
  s_lshl_b32 s22, s17, 12
  s_add_u32 s22, s22, 0
  v_add_u32 v5, s22, v2
  v_add_u32 v6, 0x10000, v5
  s_mul_i32 s22, s18, 24576
  s_add_u32 s22, s22, 98304
  v_add_u32 v8, s22, v2
  s_mul_i32 s23, s17, 6144
  s_add_u32 s22, s22, s23
  v_add_u32 v9, s22, v2
  s_waitcnt vmcnt(6)
  s_barrier
  ds_read_b128 v[56:59], v5 offset:0
  ds_read_b128 v[60:63], v5 offset:2048
  s_add_u32 m0, s28, 65536
  s_add_u32 s29, s26, 8192
  buffer_load_dwordx4 v2, s[8:11], s29 offen offset:0 lds
  buffer_load_dwordx4 v2, s[8:11], s29 offen offset:1024 lds
  ds_read_b128 v[64:67], v5 offset:1024
  ds_read_b128 v[68:71], v5 offset:3072
  s_waitcnt lgkmcnt(2)
  v_mfma_f32_32x32x16_bf16 v[16:31], v[144:147], v[56:59], 0
  v_mfma_f32_32x32x16_bf16 v[32:47], v[144:147], v[60:63], 0
  s_waitcnt vmcnt(6) lgkmcnt(0)
  s_barrier
  ds_read_b128 v[56:59], v5 offset:16384
  ds_read_b128 v[60:63], v5 offset:18432
  s_add_u32 m0, s28, 0
  s_add_u32 s29, s26, 10240
  buffer_load_dwordx4 v2, s[8:11], s29 offen offset:0 lds
  buffer_load_dwordx4 v2, s[8:11], s29 offen offset:1024 lds
  v_mfma_f32_32x32x16_bf16 v[16:31], v[148:151], v[64:67], v[16:31]
  v_mfma_f32_32x32x16_bf16 v[32:47], v[148:151], v[68:71], v[32:47]
  ds_read_b128 v[64:67], v5 offset:17408
  ds_read_b128 v[68:71], v5 offset:19456
  s_waitcnt lgkmcnt(2)
  v_mfma_f32_32x32x16_bf16 v[16:31], v[152:155], v[56:59], v[16:31]
  v_mfma_f32_32x32x16_bf16 v[32:47], v[152:155], v[60:63], v[32:47]
  s_waitcnt vmcnt(6) lgkmcnt(0)
  s_barrier
  ds_read_b128 v[56:59], v5 offset:32768
  ds_read_b128 v[60:63], v5 offset:34816
  s_add_u32 m0, s28, 16384
  s_add_u32 s29, s26, 12288
  buffer_load_dwordx4 v2, s[8:11], s29 offen offset:0 lds
  buffer_load_dwordx4 v2, s[8:11], s29 offen offset:1024 lds
  v_mfma_f32_32x32x16_bf16 v[16:31], v[156:159], v[64:67], v[16:31]
  v_mfma_f32_32x32x16_bf16 v[32:47], v[156:159], v[68:71], v[32:47]
  ds_read_b128 v[64:67], v5 offset:33792
  ds_read_b128 v[68:71], v5 offset:35840
  s_waitcnt lgkmcnt(2)
  v_mfma_f32_32x32x16_bf16 v[16:31], v[160:163], v[56:59], v[16:31]
  v_mfma_f32_32x32x16_bf16 v[32:47], v[160:163], v[60:63], v[32:47]
  s_waitcnt vmcnt(6) lgkmcnt(0)
  s_barrier
  ds_read_b128 v[56:59], v5 offset:49152
  ds_read_b128 v[60:63], v5 offset:51200
  s_add_u32 m0, s28, 32768
  s_add_u32 s29, s26, 14336
  buffer_load_dwordx4 v2, s[8:11], s29 offen offset:0 lds
  buffer_load_dwordx4 v2, s[8:11], s29 offen offset:1024 lds
  v_mfma_f32_32x32x16_bf16 v[16:31], v[164:167], v[64:67], v[16:31]
  v_mfma_f32_32x32x16_bf16 v[32:47], v[164:167], v[68:71], v[32:47]
  ds_read_b128 v[64:67], v5 offset:50176
  ds_read_b128 v[68:71], v5 offset:52224
  s_waitcnt lgkmcnt(2)
  v_mfma_f32_32x32x16_bf16 v[16:31], v[168:171], v[56:59], v[16:31]
  v_mfma_f32_32x32x16_bf16 v[32:47], v[168:171], v[60:63], v[32:47]
  s_waitcnt vmcnt(6) lgkmcnt(0)
  s_barrier
  ds_read_b128 v[56:59], v6 offset:0
  ds_read_b128 v[60:63], v6 offset:2048
  s_add_u32 m0, s28, 49152
  s_add_u32 s29, s26, 16384
  buffer_load_dwordx4 v2, s[8:11], s29 offen offset:0 lds
  buffer_load_dwordx4 v2, s[8:11], s29 offen offset:1024 lds
  v_mfma_f32_32x32x16_bf16 v[16:31], v[172:175], v[64:67], v[16:31]
  v_mfma_f32_32x32x16_bf16 v[32:47], v[172:175], v[68:71], v[32:47]
  ds_read_b128 v[64:67], v6 offset:1024
  ds_read_b128 v[68:71], v6 offset:3072
  s_waitcnt lgkmcnt(2)
  v_mfma_f32_32x32x16_bf16 v[16:31], v[176:179], v[56:59], v[16:31]
  v_mfma_f32_32x32x16_bf16 v[32:47], v[176:179], v[60:63], v[32:47]
  s_waitcnt vmcnt(6) lgkmcnt(0)
  s_barrier
  ds_read_b128 v[56:59], v5 offset:0
  ds_read_b128 v[60:63], v5 offset:2048
  s_add_u32 m0, s28, 65536
  s_add_u32 s29, s26, 18432
  buffer_load_dwordx4 v2, s[8:11], s29 offen offset:0 lds
  buffer_load_dwordx4 v2, s[8:11], s29 offen offset:1024 lds
  v_mfma_f32_32x32x16_bf16 v[16:31], v[180:183], v[64:67], v[16:31]
  v_mfma_f32_32x32x16_bf16 v[32:47], v[180:183], v[68:71], v[32:47]
  ds_read_b128 v[64:67], v5 offset:1024
  ds_read_b128 v[68:71], v5 offset:3072
  s_waitcnt lgkmcnt(2)
  v_mfma_f32_32x32x16_bf16 v[16:31], v[184:187], v[56:59], v[16:31]
  v_mfma_f32_32x32x16_bf16 v[32:47], v[184:187], v[60:63], v[32:47]
  s_waitcnt vmcnt(6) lgkmcnt(0)
  s_barrier
  ds_read_b128 v[56:59], v5 offset:16384
  ds_read_b128 v[60:63], v5 offset:18432
  s_add_u32 m0, s28, 0
  s_add_u32 s29, s26, 20480
  buffer_load_dwordx4 v2, s[8:11], s29 offen offset:0 lds
  buffer_load_dwordx4 v2, s[8:11], s29 offen offset:1024 lds
  v_mfma_f32_32x32x16_bf16 v[16:31], v[188:191], v[64:67], v[16:31]
  v_mfma_f32_32x32x16_bf16 v[32:47], v[188:191], v[68:71], v[32:47]
  ds_read_b128 v[64:67], v5 offset:17408
  ds_read_b128 v[68:71], v5 offset:19456
  s_waitcnt lgkmcnt(2)
  v_mfma_f32_32x32x16_bf16 v[16:31], v[192:195], v[56:59], v[16:31]
  v_mfma_f32_32x32x16_bf16 v[32:47], v[192:195], v[60:63], v[32:47]
  s_waitcnt vmcnt(6) lgkmcnt(0)
  s_barrier
  ds_read_b128 v[56:59], v5 offset:32768
  ds_read_b128 v[60:63], v5 offset:34816
  s_add_u32 m0, s28, 16384
  s_add_u32 s29, s26, 22528
  buffer_load_dwordx4 v2, s[8:11], s29 offen offset:0 lds
  buffer_load_dwordx4 v2, s[8:11], s29 offen offset:1024 lds
  v_mfma_f32_32x32x16_bf16 v[16:31], v[196:199], v[64:67], v[16:31]
  v_mfma_f32_32x32x16_bf16 v[32:47], v[196:199], v[68:71], v[32:47]
  ds_read_b128 v[64:67], v5 offset:33792
  ds_read_b128 v[68:71], v5 offset:35840
  s_waitcnt lgkmcnt(2)
  v_mfma_f32_32x32x16_bf16 v[16:31], v[200:203], v[56:59], v[16:31]
  v_mfma_f32_32x32x16_bf16 v[32:47], v[200:203], v[60:63], v[32:47]
  s_waitcnt vmcnt(6) lgkmcnt(0)
  s_barrier
  ds_read_b128 v[56:59], v5 offset:49152
  ds_read_b128 v[60:63], v5 offset:51200
  s_add_u32 m0, s28, 32768
  s_add_u32 s29, s26, 24576
  buffer_load_dwordx4 v2, s[8:11], s29 offen offset:0 lds
  buffer_load_dwordx4 v2, s[8:11], s29 offen offset:1024 lds
  v_mfma_f32_32x32x16_bf16 v[16:31], v[204:207], v[64:67], v[16:31]
  v_mfma_f32_32x32x16_bf16 v[32:47], v[204:207], v[68:71], v[32:47]
  ds_read_b128 v[64:67], v5 offset:50176
  ds_read_b128 v[68:71], v5 offset:52224
  s_waitcnt lgkmcnt(2)
  v_mfma_f32_32x32x16_bf16 v[16:31], v[208:211], v[56:59], v[16:31]
  v_mfma_f32_32x32x16_bf16 v[32:47], v[208:211], v[60:63], v[32:47]
  s_waitcnt vmcnt(6) lgkmcnt(0)
  s_barrier
  ds_read_b128 v[56:59], v6 offset:0
  ds_read_b128 v[60:63], v6 offset:2048
  s_add_u32 m0, s28, 49152
  s_add_u32 s29, s26, 26624
  buffer_load_dwordx4 v2, s[8:11], s29 offen offset:0 lds
  buffer_load_dwordx4 v2, s[8:11], s29 offen offset:1024 lds
  v_mfma_f32_32x32x16_bf16 v[16:31], v[212:215], v[64:67], v[16:31]
  v_mfma_f32_32x32x16_bf16 v[32:47], v[212:215], v[68:71], v[32:47]
  ds_read_b128 v[64:67], v6 offset:1024
  ds_read_b128 v[68:71], v6 offset:3072
  s_waitcnt lgkmcnt(2)
  v_mfma_f32_32x32x16_bf16 v[16:31], v[216:219], v[56:59], v[16:31]
  v_mfma_f32_32x32x16_bf16 v[32:47], v[216:219], v[60:63], v[32:47]
  s_waitcnt vmcnt(6) lgkmcnt(0)
  s_barrier
  ds_read_b128 v[56:59], v5 offset:0
  ds_read_b128 v[60:63], v5 offset:2048
  s_add_u32 s22, s19, 9437184
  s_add_u32 s22, s22, s52
  buffer_load_dwordx4 v[48:51], v2, s[8:11], s22 offen
  v_mfma_f32_32x32x16_bf16 v[16:31], v[220:223], v[64:67], v[16:31]
  v_mfma_f32_32x32x16_bf16 v[32:47], v[220:223], v[68:71], v[32:47]
  ds_read_b128 v[64:67], v5 offset:1024
  ds_read_b128 v[68:71], v5 offset:3072
  s_waitcnt lgkmcnt(2)
  v_mfma_f32_32x32x16_bf16 v[16:31], v[224:227], v[56:59], v[16:31]
  v_mfma_f32_32x32x16_bf16 v[32:47], v[224:227], v[60:63], v[32:47]
  s_waitcnt vmcnt(5) lgkmcnt(0)
  s_barrier
  ds_read_b128 v[56:59], v5 offset:16384
  ds_read_b128 v[60:63], v5 offset:18432
  v_mfma_f32_32x32x16_bf16 v[16:31], v[228:231], v[64:67], v[16:31]
  v_mfma_f32_32x32x16_bf16 v[32:47], v[228:231], v[68:71], v[32:47]
  ds_read_b128 v[64:67], v5 offset:17408
  ds_read_b128 v[68:71], v5 offset:19456
  s_waitcnt lgkmcnt(2)
  v_mfma_f32_32x32x16_bf16 v[16:31], v[232:235], v[56:59], v[16:31]
  v_mfma_f32_32x32x16_bf16 v[32:47], v[232:235], v[60:63], v[32:47]
  s_waitcnt vmcnt(3) lgkmcnt(0)
  s_barrier
  ds_read_b128 v[56:59], v5 offset:32768
  ds_read_b128 v[60:63], v5 offset:34816
  v_mfma_f32_32x32x16_bf16 v[16:31], v[236:239], v[64:67], v[16:31]
  v_mfma_f32_32x32x16_bf16 v[32:47], v[236:239], v[68:71], v[32:47]
  ds_read_b128 v[64:67], v5 offset:33792
  ds_read_b128 v[68:71], v5 offset:35840
  s_waitcnt lgkmcnt(2)
  v_mfma_f32_32x32x16_bf16 v[16:31], v[240:243], v[56:59], v[16:31]
  v_mfma_f32_32x32x16_bf16 v[32:47], v[240:243], v[60:63], v[32:47]
  s_waitcnt vmcnt(1) lgkmcnt(0)
  s_barrier
  ds_read_b128 v[56:59], v5 offset:49152
  ds_read_b128 v[60:63], v5 offset:51200
  s_lshl_b32 s22, s14, 12
  s_add_u32 s22, s22, s41
  s_or_b32 s23, s35, s57
  s_cmp_eq_u32 s23, 0
  s_cselect_b64 exec, -1, 0
  buffer_load_dwordx4 v[96:99], v2, s[8:11], s22 offen offset:0
  buffer_load_dwordx4 v[100:103], v2, s[8:11], s22 offen offset:1024
  buffer_load_dwordx4 v[104:107], v2, s[8:11], s22 offen offset:2048
  buffer_load_dwordx4 v[108:111], v2, s[8:11], s22 offen offset:3072
  s_add_u32 s22, s41, 32768
  buffer_load_dwordx4 v[112:115], v2, s[8:11], s22 offen
  s_mov_b64 exec, -1
  v_mfma_f32_32x32x16_bf16 v[16:31], v[244:247], v[64:67], v[16:31]
  v_mfma_f32_32x32x16_bf16 v[32:47], v[244:247], v[68:71], v[32:47]
  ds_read_b128 v[64:67], v5 offset:50176
  ds_read_b128 v[68:71], v5 offset:52224
  s_waitcnt lgkmcnt(2)
  v_mfma_f32_32x32x16_bf16 v[16:31], v[248:251], v[56:59], v[16:31]
  v_mfma_f32_32x32x16_bf16 v[32:47], v[248:251], v[60:63], v[32:47]
  s_waitcnt lgkmcnt(0)
  v_mfma_f32_32x32x16_bf16 v[16:31], v[252:255], v[64:67], v[16:31]
  v_mfma_f32_32x32x16_bf16 v[32:47], v[252:255], v[68:71], v[32:47]
  s_nop 4
  s_cmp_eq_u32 s17, 1
  s_cbranch_scc1 f2v_46
  s_cmp_eq_u32 s17, 2
  s_cbranch_scc1 f2v_47
  s_cmp_eq_u32 s17, 3
  s_cbranch_scc1 f2v_48
f2v_45:
  s_nop 0
  ds_write_b128 v8, v[24:27] offset:10240
  ds_write_b128 v8, v[28:31] offset:11264
  ds_write_b128 v8, v[32:35] offset:14336
  ds_write_b128 v8, v[36:39] offset:15360
  ds_write_b128 v8, v[40:43] offset:18432
  ds_write_b128 v8, v[44:47] offset:19456
  s_waitcnt lgkmcnt(0)
  s_branch f2j_44
f2v_46:
  s_nop 3
  ds_write_b128 v8, v[16:19] offset:0
  ds_write_b128 v8, v[20:23] offset:1024
  ds_write_b128 v8, v[32:35] offset:16384
  ds_write_b128 v8, v[36:39] offset:17408
  ds_write_b128 v8, v[40:43] offset:20480
  ds_write_b128 v8, v[44:47] offset:21504
  s_waitcnt lgkmcnt(0)
  v_mov_b32 v16, v24
  v_mov_b32 v17, v25
  v_mov_b32 v18, v26
  v_mov_b32 v19, v27
  v_mov_b32 v20, v28
  v_mov_b32 v21, v29
  v_mov_b32 v22, v30
  v_mov_b32 v23, v31
  s_branch f2j_44
f2v_47:
  s_nop 1
  ds_write_b128 v8, v[16:19] offset:2048
  ds_write_b128 v8, v[20:23] offset:3072
  ds_write_b128 v8, v[24:27] offset:6144
  ds_write_b128 v8, v[28:31] offset:7168
  ds_write_b128 v8, v[40:43] offset:22528
  ds_write_b128 v8, v[44:47] offset:23552
  s_waitcnt lgkmcnt(0)
  v_mov_b32 v16, v32
  v_mov_b32 v17, v33
  v_mov_b32 v18, v34
  v_mov_b32 v19, v35
  v_mov_b32 v20, v36
  v_mov_b32 v21, v37
  v_mov_b32 v22, v38
  v_mov_b32 v23, v39
  s_branch f2j_44
f2v_48:
  ds_write_b128 v8, v[16:19] offset:4096
  ds_write_b128 v8, v[20:23] offset:5120
  ds_write_b128 v8, v[24:27] offset:8192
  ds_write_b128 v8, v[28:31] offset:9216
  ds_write_b128 v8, v[32:35] offset:12288
  ds_write_b128 v8, v[36:39] offset:13312
  s_waitcnt lgkmcnt(0)
  v_mov_b32 v16, v40
  v_mov_b32 v17, v41
  v_mov_b32 v18, v42
  v_mov_b32 v19, v43
  v_mov_b32 v20, v44
  v_mov_b32 v21, v45
  v_mov_b32 v22, v46
  v_mov_b32 v23, v47
f2j_44:
  s_barrier
  ds_read_b128 v[24:27], v9 offset:0
  ds_read_b128 v[28:31], v9 offset:1024
  ds_read_b128 v[32:35], v9 offset:2048
  ds_read_b128 v[36:39], v9 offset:3072
  ds_read_b128 v[40:43], v9 offset:4096
  ds_read_b128 v[44:47], v9 offset:5120
  s_waitcnt vmcnt(5) lgkmcnt(4)
  v_add_f32 v16, v16, v24
  v_add_f32 v17, v17, v25
  v_add_f32 v18, v18, v26
  v_add_f32 v19, v19, v27
  v_add_f32 v20, v20, v28
  v_add_f32 v21, v21, v29
  v_add_f32 v22, v22, v30
  v_add_f32 v23, v23, v31
  s_waitcnt lgkmcnt(0)
  v_add_f32 v32, v32, v40
  v_add_f32 v33, v33, v41
  v_add_f32 v34, v34, v42
  v_add_f32 v35, v35, v43
  v_add_f32 v36, v36, v44
  v_add_f32 v37, v37, v45
  v_add_f32 v38, v38, v46
  v_add_f32 v39, v39, v47
  v_add_f32 v16, v16, v32
  v_add_f32 v17, v17, v33
  v_add_f32 v18, v18, v34
  v_add_f32 v19, v19, v35
  v_add_f32 v20, v20, v36
  v_add_f32 v21, v21, v37
  v_add_f32 v22, v22, v38
  v_add_f32 v23, v23, v39
  v_lshlrev_b32 v56, 16, v48
  v_and_b32 v57, 0xffff0000, v48
  v_lshlrev_b32 v58, 16, v49
  v_and_b32 v59, 0xffff0000, v49
  v_lshlrev_b32 v60, 16, v50
  v_and_b32 v61, 0xffff0000, v50
  v_lshlrev_b32 v62, 16, v51
  v_and_b32 v63, 0xffff0000, v51
  v_add_f32 v16, v16, v56
  v_add_f32 v17, v17, v57
  v_add_f32 v18, v18, v58
  v_add_f32 v19, v19, v59
  v_add_f32 v20, v20, v60
  v_add_f32 v21, v21, v61
  v_add_f32 v22, v22, v62
  v_add_f32 v23, v23, v63
  v_cvt_pk_bf16_f32 v56, v16, v17
  v_cvt_pk_bf16_f32 v57, v18, v19
  v_cvt_pk_bf16_f32 v58, v20, v21
  v_cvt_pk_bf16_f32 v59, v22, v23
  s_cmp_eq_u32 s57, 0
  s_cbranch_scc1 notfinal_49
  v_lshlrev_b32 v8, 10, v3
  v_lshl_add_u32 v8, v4, 4, v8
  v_permlane32_swap_b32 v56, v58
  v_permlane32_swap_b32 v57, v59
  s_lshl_b32 s22, s20, 15
  s_lshl_b32 s23, s21, 5
  s_add_u32 s22, s22, s23
  buffer_store_dwordx4 v[56:59], v8, s[84:87], s22 offen
  s_branch main_end
notfinal_49:
  s_add_u32 s22, s19, 11534336
  buffer_store_dwordx4 v[56:59], v2, s[8:11], s22 offen
  v_add_f32 v60, v16, v17
  v_mul_f32 v61, v16, v16
  v_fmac_f32 v61, v17, v17
  v_add_f32 v60, v60, v18
  v_fmac_f32 v61, v18, v18
  v_add_f32 v60, v60, v19
  v_fmac_f32 v61, v19, v19
  v_add_f32 v60, v60, v20
  v_fmac_f32 v61, v20, v20
  v_add_f32 v60, v60, v21
  v_fmac_f32 v61, v21, v21
  v_add_f32 v60, v60, v22
  v_fmac_f32 v61, v22, v22
  v_add_f32 v60, v60, v23
  v_fmac_f32 v61, v23, v23
  v_lshlrev_b32 v8, 6, v3
  v_lshl_add_u32 v8, v4, 3, v8
  s_lshl_b32 s22, s49, 11
  s_and_b32 s23, s21, 3
  s_lshl_b32 s23, s23, 4
  s_add_u32 s22, s22, s23
  s_add_u32 s22, s22, 147456
  v_add_u32 v8, s22, v8
  ds_write_b64 v8, v[60:61]
  s_waitcnt vmcnt(0) lgkmcnt(0)
  s_barrier
  s_cmp_lg_u32 s14, 0
  s_cbranch_scc1 xb3_n0
  s_add_u32 s22, s98, 384
  v_mov_b32 v6, s94
  v_mov_b32 v7, s99
  s_mov_b64 exec, 1
  s_cmp_lg_u32 s92, 0
  s_cbranch_scc1 xb3_f_safe
  buffer_store_dword v6, v7, s[8:11], s22 offen
  s_branch xb3_f_st
xb3_f_safe:
  buffer_wbl2 sc1
  s_waitcnt vmcnt(0)
  buffer_store_dword v6, v7, s[8:11], s22 offen sc1
xb3_f_st:
  s_mov_b64 exec, -1
  v_lshlrev_b32 v5, 2, v3
  s_mov_b32 s93, 0x80000
  buffer_load_dword v12, v5, s[8:11], s22 offen sc1
  s_sleep 3
xb3_poll:
  buffer_load_dword v13, v5, s[8:11], s22 offen sc1
  s_waitcnt vmcnt(1)
  v_cmp_ne_u32 vcc, s94, v12
  s_cbranch_vccz xb3_poll_x
  buffer_load_dword v12, v5, s[8:11], s22 offen sc1
  s_waitcnt vmcnt(1)
  v_cmp_ne_u32 vcc, s94, v13
  s_cbranch_vccz xb3_poll_x
  s_sub_u32 s93, s93, 1
  s_cmp_lg_u32 s93, 0
  s_cbranch_scc1 xb3_poll
xb3_poll_x:
  s_cmp_eq_u32 s92, 0
  s_cbranch_scc1 xb3_rel
  buffer_inv sc1
  s_waitcnt vmcnt(0)
  s_branch xb3_rel
xb3_n0:
  s_cmp_lg_u32 s14, 1
  s_cbranch_scc1 xb3_rel
  v_lshlrev_b32 v8, 6, v1
  v_add_u32 v8, 147456, v8
  ds_read_b128 v[32:35], v8 offset:0
  ds_read_b128 v[36:39], v8 offset:16
  ds_read_b128 v[40:43], v8 offset:32
  ds_read_b128 v[44:47], v8 offset:48
  v_lshlrev_b32 v8, 3, v3
  v_lshl_add_u32 v8, v4, 11, v8
  s_lshl_b32 s22, s15, 11
  s_lshl_b32 s23, s16, 8
  s_add_u32 s22, s22, s23
  s_add_u32 s22, s22, 15990784
  s_waitcnt lgkmcnt(0)
  v_add_f32 v32, v32, v40
  v_add_f32 v33, v33, v41
  v_add_f32 v34, v34, v42
  v_add_f32 v35, v35, v43
  v_add_f32 v36, v36, v44
  v_add_f32 v37, v37, v45
  v_add_f32 v38, v38, v46
  v_add_f32 v39, v39, v47
  v_add_f32 v32, v32, v36
  v_add_f32 v33, v33, v37
  v_add_f32 v34, v34, v38
  v_add_f32 v35, v35, v39
  v_add_f32 v32, v32, v34
  v_add_f32 v33, v33, v35
  buffer_store_dwordx2 v[32:33], v8, s[8:11], s22 offen sc1
  s_waitcnt vmcnt(0)
  s_add_u32 s22, s98, 1408
  v_mov_b32 v6, s94
  v_mov_b32 v7, s99
  s_mov_b64 exec, 1
  s_cmp_lg_u32 s92, 0
  s_cbranch_scc1 xb3_s_safe
  buffer_store_dword v6, v7, s[8:11], s22 offen
  s_branch xb3_s_st
xb3_s_safe:
  buffer_wbl2 sc1
  s_waitcnt vmcnt(0)
  buffer_store_dword v6, v7, s[8:11], s22 offen sc1
xb3_s_st:
  s_mov_b64 exec, -1
xb3_rel:
  s_barrier
  s_add_u32 s98, s98, 512
  s_lshl_b32 s22, s14, 12
  s_add_u32 m0, s22, 131072
  s_lshl_b32 s23, s36, 15
  s_add_u32 s23, s23, s22
  s_add_u32 s23, s23, 11534336
  buffer_load_dwordx4 v2, s[8:11], s23 offen offset:0 lds
  buffer_load_dwordx4 v2, s[8:11], s23 offen offset:1024 lds
  buffer_load_dwordx4 v2, s[8:11], s23 offen offset:2048 lds
  buffer_load_dwordx4 v2, s[8:11], s23 offen offset:3072 lds
  v_lshlrev_b32 v5, 3, v3
  v_lshl_add_u32 v5, v4, 10, v5
  s_lshl_b32 s19, s36, 11
  s_add_u32 s19, s19, 15990784
  s_add_u32 s34, s98, 896
  v_lshlrev_b32 v41, 2, v3
  buffer_load_dword v40, v41, s[8:11], s34 offen sc1
  s_lshl_b32 s26, s38, 13
  s_lshl_b32 s27, s39, 11
  s_add_u32 s26, s26, s27
  s_and_b32 s27, s39, 1
  s_lshl_b32 s27, s27, 11
  s_lshl_b32 s28, s38, 12
  s_add_u32 s27, s27, s28
  s_add_u32 s27, s27, 16515072
  s_lshr_b32 s48, s39, 1
  s_add_u32 s48, s48, s12
  s_lshl_b32 s28, s38, 14
  s_add_u32 s28, s28, 131072
  v_add_u32 v10, s28, v2
  s_lshl_b32 s28, s38, 13
  v_add_u32 v124, s28, v2
  v_and_b32 v125, 15, v1
  v_lshlrev_b32 v125, 4, v125
  v_lshl_add_u32 v125, v4, 8, v125
  s_add_u32 s28, s28, 16384
  v_add_u32 v125, s28, v125
  v_add_u32 v126, 0x10000, v124
  v_add_u32 v127, 0x10000, v125
  s_lshl_b32 s28, s14, 12
  s_add_u32 s28, s28, 98304
  v_add_u32 v8, s28, v2
  s_xor_b32 s28, s28, 16384
  v_add_u32 v9, s28, v2
  s_waitcnt vmcnt(1) lgkmcnt(0)
  s_barrier
  s_cmp_lg_u32 s35, 0
  s_cbranch_scc1 att1_nokv0
  s_lshl_b32 s28, s14, 12
  s_add_u32 s29, s28, 131072
  v_add_u32 v11, s29, v2
  ds_read_b128 v[16:19], v11 offset:0
  ds_read_b128 v[20:23], v11 offset:1024
  ds_read_b128 v[24:27], v11 offset:2048
  ds_read_b128 v[28:31], v11 offset:3072
  s_add_u32 s28, s28, 1024
  v_add_u32 v11, s28, v2
  s_waitcnt vmcnt(0)
  v_cmp_ne_u32 vcc, s94, v40
  s_cbranch_vccz spoll_50_ok
  s_mov_b32 s93, 524288
spoll_50:
  buffer_load_dword v40, v41, s[8:11], s34 offen offset:0 sc1
  s_sub_u32 s93, s93, 1
  s_waitcnt vmcnt(0)
  v_cmp_ne_u32 vcc, s94, v40
  s_cmp_eq_u32 s93, 0
  s_cbranch_scc1 spoll_50_x
  s_cbranch_vccz spoll_50_x
  s_branch spoll_50
spoll_50_x:
spoll_50_ok:
  buffer_load_dwordx2 v[40:41], v5, s[8:11], s19 offen offset:0
  buffer_load_dwordx2 v[42:43], v5, s[8:11], s19 offen offset:256
  buffer_load_dwordx2 v[44:45], v5, s[8:11], s19 offen offset:512
  buffer_load_dwordx2 v[46:47], v5, s[8:11], s19 offen offset:768
  s_waitcnt lgkmcnt(3)
  v_mfma_f32_32x32x16_bf16 v[48:63], v[96:99], v[16:19], 0
  s_waitcnt lgkmcnt(2)
  v_mfma_f32_32x32x16_bf16 v[48:63], v[100:103], v[20:23], v[48:63]
  s_waitcnt lgkmcnt(1)
  v_mfma_f32_32x32x16_bf16 v[48:63], v[104:107], v[24:27], v[48:63]
  s_waitcnt lgkmcnt(0)
  v_mfma_f32_32x32x16_bf16 v[48:63], v[108:111], v[28:31], v[48:63]
  s_nop 11
  ds_write_b128 v11, v[48:51] offset:0
  ds_write_b128 v11, v[52:55] offset:1024
  ds_write_b128 v11, v[56:59] offset:2048
  ds_write_b128 v11, v[60:63] offset:3072
  s_waitcnt lgkmcnt(0)
  s_barrier
  s_cmp_ge_u32 s14, 2
  s_cbranch_scc1 att1_nokv
  s_waitcnt vmcnt(0)
  v_add_f32 v40, v40, v42
  v_add_f32 v41, v41, v43
  v_add_f32 v44, v44, v46
  v_add_f32 v45, v45, v47
  v_add_f32 v40, v40, v44
  v_add_f32 v41, v41, v45
  v_mov_b32 v12, v40
  v_mov_b32 v13, v41
  s_nop 1
  v_permlane32_swap_b32 v40, v12
  v_permlane32_swap_b32 v41, v13
  s_nop 1
  v_add_f32 v40, v40, v12
  v_add_f32 v41, v41, v13
  v_mul_f32 v40, 0x3b000000, v40
  v_mul_f32 v41, 0x3b000000, v41
  v_fma_f32 v41, -v40, v40, v41
  v_max_f32 v41, 0, v41
  v_add_f32 v41, 0x3727c5ac, v41
  v_rsq_f32 v122, v41
  v_and_b32 v12, 0xffff0000, v40
  v_sub_f32 v13, v40, v12
  v_cvt_pk_bf16_f32 v36, -v12, -v12
  v_cvt_pk_bf16_f32 v37, -v13, 0
  v_mov_b32 v38, v36
  v_mov_b32 v39, v37
  s_nop 1
  v_mfma_f32_32x32x16_bf16 v[48:63], v[112:115], v[36:39], 0
  s_lshl_b32 s20, s14, 11
  s_add_u32 s20, s20, 1024
  v_add_u32 v5, s20, v2
  ds_read_b128 v[72:75], v5 offset:0
  ds_read_b128 v[76:79], v5 offset:1024
  ds_read_b128 v[80:83], v5 offset:4096
  ds_read_b128 v[84:87], v5 offset:5120
  ds_read_b128 v[88:91], v5 offset:8192
  ds_read_b128 v[92:95], v5 offset:9216
  ds_read_b128 v[96:99], v5 offset:12288
  ds_read_b128 v[100:103], v5 offset:13312
  s_waitcnt lgkmcnt(0)
  v_add_f32 v64, v72, v80
  v_add_f32 v65, v73, v81
  v_add_f32 v66, v74, v82
  v_add_f32 v67, v75, v83
  v_add_f32 v68, v76, v84
  v_add_f32 v69, v77, v85
  v_add_f32 v70, v78, v86
  v_add_f32 v71, v79, v87
  v_add_f32 v88, v88, v96
  v_add_f32 v89, v89, v97
  v_add_f32 v90, v90, v98
  v_add_f32 v91, v91, v99
  v_add_f32 v92, v92, v100
  v_add_f32 v93, v93, v101
  v_add_f32 v94, v94, v102
  v_add_f32 v95, v95, v103
  v_add_f32 v64, v64, v88
  v_add_f32 v65, v65, v89
  v_add_f32 v66, v66, v90
  v_add_f32 v67, v67, v91
  v_add_f32 v68, v68, v92
  v_add_f32 v69, v69, v93
  v_add_f32 v70, v70, v94
  v_add_f32 v71, v71, v95
  ds_read_b128 v[72:75], v5 offset:16384
  ds_read_b128 v[76:79], v5 offset:17408
  ds_read_b128 v[80:83], v5 offset:20480
  ds_read_b128 v[84:87], v5 offset:21504
  ds_read_b128 v[88:91], v5 offset:24576
  ds_read_b128 v[92:95], v5 offset:25600
  ds_read_b128 v[96:99], v5 offset:28672
  ds_read_b128 v[100:103], v5 offset:29696
  s_waitcnt lgkmcnt(0)
  v_add_f32 v72, v72, v80
  v_add_f32 v73, v73, v81
  v_add_f32 v74, v74, v82
  v_add_f32 v75, v75, v83
  v_add_f32 v76, v76, v84
  v_add_f32 v77, v77, v85
  v_add_f32 v78, v78, v86
  v_add_f32 v79, v79, v87
  v_add_f32 v88, v88, v96
  v_add_f32 v89, v89, v97
  v_add_f32 v90, v90, v98
  v_add_f32 v91, v91, v99
  v_add_f32 v92, v92, v100
  v_add_f32 v93, v93, v101
  v_add_f32 v94, v94, v102
  v_add_f32 v95, v95, v103
  v_add_f32 v64, v64, v72
  v_add_f32 v65, v65, v73
  v_add_f32 v66, v66, v74
  v_add_f32 v67, v67, v75
  v_add_f32 v68, v68, v76
  v_add_f32 v69, v69, v77
  v_add_f32 v70, v70, v78
  v_add_f32 v71, v71, v79
  v_add_f32 v64, v64, v88
  v_add_f32 v65, v65, v89
  v_add_f32 v66, v66, v90
  v_add_f32 v67, v67, v91
  v_add_f32 v68, v68, v92
  v_add_f32 v69, v69, v93
  v_add_f32 v70, v70, v94
  v_add_f32 v71, v71, v95
  s_lshl_b32 s21, s36, 10
  s_add_u32 s21, s21, 16515072
  s_lshl_b32 s22, s36, 7
  s_add_u32 s22, s22, 6823936
  s_lshl_b32 s23, s99, 2
  s_add_u32 s23, s23, s98
  s_cmp_eq_u32 s14, 1
  s_cbranch_scc1 kvfinV_51
  v_add_f32 v64, v64, v48
  v_add_f32 v65, v65, v49
  v_add_f32 v66, v66, v50
  v_add_f32 v67, v67, v51
  v_add_f32 v68, v68, v52
  v_add_f32 v69, v69, v53
  v_add_f32 v70, v70, v54
  v_add_f32 v71, v71, v55
  v_mul_f32 v64, v64, v122
  v_mul_f32 v65, v65, v122
  v_mul_f32 v66, v66, v122
  v_mul_f32 v67, v67, v122
  v_mul_f32 v68, v68, v122
  v_mul_f32 v69, v69, v122
  v_mul_f32 v70, v70, v122
  v_mul_f32 v71, v71, v122
  v_cvt_pk_bf16_f32 v72, v64, v65
  v_cvt_pk_bf16_f32 v73, v66, v67
  v_cvt_pk_bf16_f32 v74, v68, v69
  v_cvt_pk_bf16_f32 v75, v70, v71
  buffer_store_dwordx4 v[72:75], v2, s[8:11], s21 offen sc1
  v_mul_f32 v76, v64, v64
  v_fmac_f32 v76, v65, v65
  v_fmac_f32 v76, v66, v66
  v_fmac_f32 v76, v67, v67
  v_fmac_f32 v76, v68, v68
  v_fmac_f32 v76, v69, v69
  v_fmac_f32 v76, v70, v70
  v_fmac_f32 v76, v71, v71
  v_mov_b32 v77, v76
  s_nop 1
  v_permlane32_swap_b32 v76, v77
  s_nop 1
  v_add_f32 v76, v76, v77
  s_nop 1
  v_max_f32_dpp v76, v76, v76 row_shr:1 row_mask:0xf bank_mask:0xf
  s_nop 1
  v_max_f32_dpp v76, v76, v76 row_shr:2 row_mask:0xf bank_mask:0xf
  s_nop 1
  v_max_f32_dpp v76, v76, v76 row_shr:4 row_mask:0xf bank_mask:0xf
  s_nop 1
  v_max_f32_dpp v76, v76, v76 row_shr:8 row_mask:0xf bank_mask:0xf
  s_nop 1
  v_max_f32_dpp v76, v76, v76 row_bcast:15 row_mask:0xa bank_mask:0xf
  s_nop 1
  v_max_f32_dpp v76, v76, v76 row_bcast:31 row_mask:0xc bank_mask:0xf
  v_mov_b32 v78, 0
  s_mov_b32 s24, 0
  s_mov_b32 s25, 0x80000000
  s_mov_b64 exec, s[24:25]
  s_mov_b64 s[30:31], exec
  s_mov_b32 s29, s22
  s_mov_b64 exec, -1
  s_add_u32 s22, s40, 0
  buffer_load_dwordx4 v[144:147], v2, s[8:11], s22 offen offset:0
  buffer_load_dwordx4 v[148:151], v2, s[8:11], s22 offen offset:1024
  buffer_load_dwordx4 v[152:155], v2, s[8:11], s22 offen offset:2048
  buffer_load_dwordx4 v[156:159], v2, s[8:11], s22 offen offset:3072
  s_add_u32 s22, s40, 4096
  buffer_load_dwordx4 v[160:163], v2, s[8:11], s22 offen offset:0
  buffer_load_dwordx4 v[164:167], v2, s[8:11], s22 offen offset:1024
  buffer_load_dwordx4 v[168:171], v2, s[8:11], s22 offen offset:2048
  buffer_load_dwordx4 v[172:175], v2, s[8:11], s22 offen offset:3072
  s_mov_b64 exec, s[30:31]
  s_mov_b32 s22, s29
  s_waitcnt vmcnt(8)
  v_mov_b32 v77, s94
  buffer_store_dwordx2 v[76:77], v78, s[8:11], s23 offen offset:1408
  buffer_store_dwordx2 v[76:77], v78, s[8:11], s22 offen offset:0 sc1
  s_mov_b64 exec, -1
  s_branch att1_nokv_r
kvfinV_51:
  v_add_f32 v64, v64, v56
  v_add_f32 v65, v65, v57
  v_add_f32 v66, v66, v58
  v_add_f32 v67, v67, v59
  v_add_f32 v68, v68, v60
  v_add_f32 v69, v69, v61
  v_add_f32 v70, v70, v62
  v_add_f32 v71, v71, v63
  v_mul_f32 v64, v64, v122
  v_mul_f32 v65, v65, v122
  v_mul_f32 v66, v66, v122
  v_mul_f32 v67, v67, v122
  v_mul_f32 v68, v68, v122
  v_mul_f32 v69, v69, v122
  v_mul_f32 v70, v70, v122
  v_mul_f32 v71, v71, v122
  v_cvt_pk_bf16_f32 v72, v64, v65
  v_cvt_pk_bf16_f32 v73, v66, v67
  v_cvt_pk_bf16_f32 v74, v68, v69
  v_cvt_pk_bf16_f32 v75, v70, v71
  v_lshlrev_b32 v5, 5, v3
  v_lshl_add_u32 v5, v4, 3, v5
  ds_write_b64 v5, v[72:73] offset:0
  ds_write_b64 v5, v[74:75] offset:16
  v_lshlrev_b32 v6, 9, v4
  v_bfe_u32 v7, v1, 4, 1
  v_lshl_add_u32 v6, v7, 7, v6
  v_bfe_u32 v7, v1, 2, 2
  v_lshl_add_u32 v6, v7, 5, v6
  v_and_b32 v7, 3, v1
  v_lshl_add_u32 v6, v7, 3, v6
  v_max3_f32 v76, abs(v64), abs(v65), abs(v66)
  v_max3_f32 v76, abs(v67), abs(v68), v76
  v_max3_f32 v76, abs(v69), abs(v70), v76
  v_max_f32 v76, v76, abs(v71)
  s_waitcnt lgkmcnt(0)
  ds_read_b64_tr_b16 v[80:81], v6 offset:0
  ds_read_b64_tr_b16 v[82:83], v6 offset:256
  s_nop 1
  v_max_f32_dpp v76, v76, v76 row_shr:1 row_mask:0xf bank_mask:0xf
  s_nop 1
  v_max_f32_dpp v76, v76, v76 row_shr:2 row_mask:0xf bank_mask:0xf
  s_nop 1
  v_max_f32_dpp v76, v76, v76 row_shr:4 row_mask:0xf bank_mask:0xf
  s_nop 1
  v_max_f32_dpp v76, v76, v76 row_shr:8 row_mask:0xf bank_mask:0xf
  s_nop 1
  v_max_f32_dpp v76, v76, v76 row_bcast:15 row_mask:0xa bank_mask:0xf
  s_nop 1
  v_max_f32_dpp v76, v76, v76 row_bcast:31 row_mask:0xc bank_mask:0xf
  s_add_u32 s21, s21, 65536
  s_waitcnt lgkmcnt(0)
  buffer_store_dwordx4 v[80:83], v2, s[8:11], s21 offen sc1
  v_mov_b32 v78, 0
  s_mov_b32 s24, 0
  s_mov_b32 s25, 0x80000000
  s_mov_b64 exec, s[24:25]
  s_mov_b64 s[30:31], exec
  s_mov_b32 s29, s22
  s_mov_b64 exec, -1
  s_add_u32 s22, s40, 0
  buffer_load_dwordx4 v[144:147], v2, s[8:11], s22 offen offset:0
  buffer_load_dwordx4 v[148:151], v2, s[8:11], s22 offen offset:1024
  buffer_load_dwordx4 v[152:155], v2, s[8:11], s22 offen offset:2048
  buffer_load_dwordx4 v[156:159], v2, s[8:11], s22 offen offset:3072
  s_add_u32 s22, s40, 4096
  buffer_load_dwordx4 v[160:163], v2, s[8:11], s22 offen offset:0
  buffer_load_dwordx4 v[164:167], v2, s[8:11], s22 offen offset:1024
  buffer_load_dwordx4 v[168:171], v2, s[8:11], s22 offen offset:2048
  buffer_load_dwordx4 v[172:175], v2, s[8:11], s22 offen offset:3072
  s_mov_b64 exec, s[30:31]
  s_mov_b32 s22, s29
  s_waitcnt vmcnt(8)
  v_mov_b32 v77, s94
  buffer_store_dwordx2 v[76:77], v78, s[8:11], s23 offen offset:1416
  buffer_store_dwordx2 v[76:77], v78, s[8:11], s22 offen offset:8 sc1
  s_mov_b64 exec, -1
  s_branch att1_nokv_r
att1_nokv_r:
  s_branch att1_nokv_j
att1_nokv0:
  s_waitcnt vmcnt(0)
  v_cmp_ne_u32 vcc, s94, v40
  s_cbranch_vccz spoll_52_ok
  s_mov_b32 s93, 524288
spoll_52:
  buffer_load_dword v40, v41, s[8:11], s34 offen offset:0 sc1
  s_sub_u32 s93, s93, 1
  s_waitcnt vmcnt(0)
  v_cmp_ne_u32 vcc, s94, v40
  s_cmp_eq_u32 s93, 0
  s_cbranch_scc1 spoll_52_x
  s_cbranch_vccz spoll_52_x
  s_branch spoll_52
spoll_52_x:
spoll_52_ok:
  buffer_load_dwordx2 v[40:41], v5, s[8:11], s19 offen offset:0
  buffer_load_dwordx2 v[42:43], v5, s[8:11], s19 offen offset:256
  buffer_load_dwordx2 v[44:45], v5, s[8:11], s19 offen offset:512
  buffer_load_dwordx2 v[46:47], v5, s[8:11], s19 offen offset:768
att1_nokv:
  s_add_u32 s22, s40, 0
  buffer_load_dwordx4 v[144:147], v2, s[8:11], s22 offen offset:0
  buffer_load_dwordx4 v[148:151], v2, s[8:11], s22 offen offset:1024
  buffer_load_dwordx4 v[152:155], v2, s[8:11], s22 offen offset:2048
  buffer_load_dwordx4 v[156:159], v2, s[8:11], s22 offen offset:3072
  s_add_u32 s22, s40, 4096
  buffer_load_dwordx4 v[160:163], v2, s[8:11], s22 offen offset:0
  buffer_load_dwordx4 v[164:167], v2, s[8:11], s22 offen offset:1024
  buffer_load_dwordx4 v[168:171], v2, s[8:11], s22 offen offset:2048
  buffer_load_dwordx4 v[172:175], v2, s[8:11], s22 offen offset:3072
  s_waitcnt vmcnt(8)
  v_add_f32 v40, v40, v42
  v_add_f32 v41, v41, v43
  v_add_f32 v44, v44, v46
  v_add_f32 v45, v45, v47
  v_add_f32 v40, v40, v44
  v_add_f32 v41, v41, v45
  v_mov_b32 v12, v40
  v_mov_b32 v13, v41
  s_nop 1
  v_permlane32_swap_b32 v40, v12
  v_permlane32_swap_b32 v41, v13
  s_nop 1
  v_add_f32 v40, v40, v12
  v_add_f32 v41, v41, v13
  v_mul_f32 v40, 0x3b000000, v40
  v_mul_f32 v41, 0x3b000000, v41
  v_fma_f32 v41, -v40, v40, v41
  v_max_f32 v41, 0, v41
  v_add_f32 v41, 0x3727c5ac, v41
  v_rsq_f32 v122, v41
  v_and_b32 v12, 0xffff0000, v40
  v_sub_f32 v13, v40, v12
  v_cvt_pk_bf16_f32 v36, -v12, -v12
  v_cvt_pk_bf16_f32 v37, -v13, 0
  v_mov_b32 v38, v36
  v_mov_b32 v39, v37
att1_nokv_j:
  ds_read_b128 v[48:51], v10 offset:0
  ds_read_b128 v[52:55], v10 offset:1024
  ds_read_b128 v[56:59], v10 offset:2048
  s_add_u32 s22, s40, 8192
  buffer_load_dwordx4 v[176:179], v2, s[8:11], s22 offen offset:0
  buffer_load_dwordx4 v[180:183], v2, s[8:11], s22 offen offset:1024
  buffer_load_dwordx4 v[184:187], v2, s[8:11], s22 offen offset:2048
  buffer_load_dwordx4 v[188:191], v2, s[8:11], s22 offen offset:3072
  s_add_u32 s22, s40, 12288
  buffer_load_dwordx4 v[192:195], v2, s[8:11], s22 offen offset:0
  buffer_load_dwordx4 v[196:199], v2, s[8:11], s22 offen offset:1024
  buffer_load_dwordx4 v[200:203], v2, s[8:11], s22 offen offset:2048
  buffer_load_dwordx4 v[204:207], v2, s[8:11], s22 offen offset:3072
  s_add_u32 s22, s40, 16384
  buffer_load_dwordx4 v[208:211], v2, s[8:11], s22 offen offset:0
  v_mul_f32 v122, 0x3eb8aa3b, v122
  v_and_b32 v7, 27, v3
  v_cmp_eq_u32 vcc, 0, v7
  v_mov_b32 v7, 0x3f803f80
  s_mov_b32 s20, 0xffff0000
  s_mov_b32 s21, 0xffff0000
  v_cndmask_b32 v7, 0, v7, vcc
  v_mov_b32 v104, v7
  v_mov_b32 v105, v7
  v_mov_b32 v106, v7
  v_mov_b32 v107, v7
  v_mov_b32 v108, v7
  v_mov_b32 v109, v7
  v_mov_b32 v110, v7
  v_mov_b32 v111, v7
  v_mov_b32 v112, v7
  v_mov_b32 v113, v7
  v_mov_b32 v114, v7
  v_mov_b32 v115, v7
  v_mov_b32 v116, v7
  v_mov_b32 v117, v7
  v_mov_b32 v118, v7
  v_mov_b32 v119, v7
  ds_read_b128 v[60:63], v10 offset:3072
  s_waitcnt vmcnt(16) lgkmcnt(3)
  v_mfma_f32_32x32x16_bf16 v[16:31], v[144:147], v[48:51], 0
  ds_read_b128 v[48:51], v10 offset:4096
  s_waitcnt vmcnt(15) lgkmcnt(3)
  v_mfma_f32_32x32x16_bf16 v[16:31], v[148:151], v[52:55], v[16:31]
  ds_read_b128 v[52:55], v10 offset:5120
  s_waitcnt vmcnt(14) lgkmcnt(3)
  v_mfma_f32_32x32x16_bf16 v[16:31], v[152:155], v[56:59], v[16:31]
  ds_read_b128 v[56:59], v10 offset:6144
  s_waitcnt vmcnt(13) lgkmcnt(3)
  v_mfma_f32_32x32x16_bf16 v[16:31], v[156:159], v[60:63], v[16:31]
  ds_read_b128 v[60:63], v10 offset:7168
  s_waitcnt vmcnt(12) lgkmcnt(3)
  v_mfma_f32_32x32x16_bf16 v[16:31], v[160:163], v[48:51], v[16:31]
  ds_read_b128 v[48:51], v10 offset:8192
  s_waitcnt vmcnt(11) lgkmcnt(3)
  v_mfma_f32_32x32x16_bf16 v[16:31], v[164:167], v[52:55], v[16:31]
  ds_read_b128 v[52:55], v10 offset:9216
  s_waitcnt vmcnt(10) lgkmcnt(3)
  v_mfma_f32_32x32x16_bf16 v[16:31], v[168:171], v[56:59], v[16:31]
  ds_read_b128 v[56:59], v10 offset:10240
  s_waitcnt vmcnt(9) lgkmcnt(3)
  v_mfma_f32_32x32x16_bf16 v[16:31], v[172:175], v[60:63], v[16:31]
  ds_read_b128 v[60:63], v10 offset:11264
  s_waitcnt vmcnt(8) lgkmcnt(3)
  v_mfma_f32_32x32x16_bf16 v[16:31], v[176:179], v[48:51], v[16:31]
  ds_read_b128 v[48:51], v10 offset:12288
  s_waitcnt vmcnt(7) lgkmcnt(3)
  v_mfma_f32_32x32x16_bf16 v[16:31], v[180:183], v[52:55], v[16:31]
  ds_read_b128 v[52:55], v10 offset:13312
  s_waitcnt vmcnt(6) lgkmcnt(3)
  v_mfma_f32_32x32x16_bf16 v[16:31], v[184:187], v[56:59], v[16:31]
  ds_read_b128 v[56:59], v10 offset:14336
  s_waitcnt vmcnt(5) lgkmcnt(3)
  v_mfma_f32_32x32x16_bf16 v[16:31], v[188:191], v[60:63], v[16:31]
  ds_read_b128 v[60:63], v10 offset:15360
  s_waitcnt vmcnt(4) lgkmcnt(3)
  v_mfma_f32_32x32x16_bf16 v[16:31], v[192:195], v[48:51], v[16:31]
  s_waitcnt vmcnt(3) lgkmcnt(2)
  v_mfma_f32_32x32x16_bf16 v[16:31], v[196:199], v[52:55], v[16:31]
  s_waitcnt vmcnt(2) lgkmcnt(1)
  v_mfma_f32_32x32x16_bf16 v[16:31], v[200:203], v[56:59], v[16:31]
  s_waitcnt vmcnt(1) lgkmcnt(0)
  v_mfma_f32_32x32x16_bf16 v[16:31], v[204:207], v[60:63], v[16:31]
  s_waitcnt vmcnt(0)
  v_mfma_f32_32x32x16_bf16 v[16:31], v[208:211], v[36:39], v[16:31]
  s_nop 11
  ds_write_b128 v8, v[16:19] offset:0
  ds_write_b128 v8, v[20:23] offset:1024
  ds_write_b128 v8, v[24:27] offset:2048
  ds_write_b128 v8, v[28:31] offset:3072
  s_cmp_lg_u32 s14, 0
  s_cbranch_scc1 att1_gw
  v_mov_b32 v13, 94208
  v_mov_b32 v12, 0
  ds_write_b32 v13, v12 offset:20
  s_cmp_lg_u32 s92, 0
  s_cbranch_scc1 att1_gw_far
  v_and_b32 v12, 7, v1
  v_lshlrev_b32 v12, 4, v12
  s_add_u32 s28, s98, 1408
  s_mov_b32 s93, 64
att1_gw_loc:
  buffer_load_dwordx4 v[32:35], v12, s[8:11], s28 offen sc1
  s_sub_u32 s93, s93, 1
  s_waitcnt vmcnt(0)
  v_cmp_ne_u32 s[24:25], s94, v33
  v_cmp_ne_u32 vcc, s94, v35
  s_or_b64 vcc, vcc, s[24:25]
  s_cmp_eq_u32 s93, 0
  s_cbranch_scc1 att1_gw_loc_x
  s_cbranch_vccz att1_gw_loc_x
  s_branch att1_gw_loc
att1_gw_loc_x:
  s_cbranch_vccnz att1_gw_far
  v_max_u32_dpp v32, v32, v32 row_shr:1 row_mask:0xf bank_mask:0xf
  v_max_u32_dpp v34, v34, v34 row_shr:1 row_mask:0xf bank_mask:0xf
  s_nop 0
  v_max_u32_dpp v32, v32, v32 row_shr:2 row_mask:0xf bank_mask:0xf
  v_max_u32_dpp v34, v34, v34 row_shr:2 row_mask:0xf bank_mask:0xf
  s_nop 0
  v_max_u32_dpp v32, v32, v32 row_shr:4 row_mask:0xf bank_mask:0xf
  v_max_u32_dpp v34, v34, v34 row_shr:4 row_mask:0xf bank_mask:0xf
  s_nop 0
  v_max_u32_dpp v32, v32, v32 row_shr:8 row_mask:0xf bank_mask:0xf
  v_max_u32_dpp v34, v34, v34 row_shr:8 row_mask:0xf bank_mask:0xf
  s_nop 0
  v_max_u32_dpp v32, v32, v32 row_bcast:15 row_mask:0xa bank_mask:0xf
  v_max_u32_dpp v34, v34, v34 row_bcast:15 row_mask:0xa bank_mask:0xf
  s_nop 0
  v_max_u32_dpp v32, v32, v32 row_bcast:31 row_mask:0xc bank_mask:0xf
  v_max_u32_dpp v34, v34, v34 row_bcast:31 row_mask:0xc bank_mask:0xf
  s_nop 0
  v_readlane_b32 s22, v32, 63
  v_readlane_b32 s23, v34, 63
  s_nop 1
  v_mov_b32 v32, s22
  v_mov_b32 v34, s23
  s_branch att1_gw_w
att1_gw_far:
  v_mov_b32 v10, 0
  s_getreg_b32 s28, hwreg(HW_REG_XCC_ID, 0, 3)
  s_lshl_b32 s28, s28, 7
  s_add_u32 s28, s28, 6882304
  v_lshlrev_b32 v11, 7, v1
  s_mov_b32 s29, 6823936
  s_mov_b32 s93, 524288
att1_gw_d_p:
  buffer_load_dwordx4 v[32:35], v11, s[8:11], s29 offen sc1
  s_sub_u32 s93, s93, 1
  s_waitcnt vmcnt(0)
  v_cmp_ne_u32 s[24:25], s94, v33
  v_cmp_ne_u32 vcc, s94, v35
  s_or_b64 vcc, vcc, s[24:25]
  s_cmp_eq_u32 s93, 0
  s_cbranch_scc1 att1_gw_d_p_x
  s_cbranch_vccz att1_gw_d_p_x
  s_sleep 1
  s_branch att1_gw_d_p
att1_gw_d_p_x:
  v_max_u32_dpp v32, v32, v32 row_shr:1 row_mask:0xf bank_mask:0xf
  v_max_u32_dpp v34, v34, v34 row_shr:1 row_mask:0xf bank_mask:0xf
  s_nop 0
  v_max_u32_dpp v32, v32, v32 row_shr:2 row_mask:0xf bank_mask:0xf
  v_max_u32_dpp v34, v34, v34 row_shr:2 row_mask:0xf bank_mask:0xf
  s_nop 0
  v_max_u32_dpp v32, v32, v32 row_shr:4 row_mask:0xf bank_mask:0xf
  v_max_u32_dpp v34, v34, v34 row_shr:4 row_mask:0xf bank_mask:0xf
  s_nop 0
  v_max_u32_dpp v32, v32, v32 row_shr:8 row_mask:0xf bank_mask:0xf
  v_max_u32_dpp v34, v34, v34 row_shr:8 row_mask:0xf bank_mask:0xf
  s_nop 0
  v_max_u32_dpp v32, v32, v32 row_bcast:15 row_mask:0xa bank_mask:0xf
  v_max_u32_dpp v34, v34, v34 row_bcast:15 row_mask:0xa bank_mask:0xf
  s_nop 0
  v_max_u32_dpp v32, v32, v32 row_bcast:31 row_mask:0xc bank_mask:0xf
  v_max_u32_dpp v34, v34, v34 row_bcast:31 row_mask:0xc bank_mask:0xf
  s_nop 0
  v_readlane_b32 s22, v32, 63
  v_readlane_b32 s23, v34, 63
  s_nop 1
  v_mov_b32 v32, s22
  v_mov_b32 v34, s23
  s_cmp_eq_u32 s13, 8
  s_cselect_b64 exec, 1, 0
  buffer_store_dwordx4 v[32:35], v10, s[8:11], s28 offen
  s_mov_b64 exec, -1
att1_gw_d_w:
  v_mov_b32 v10, 94224
  ds_write_b128 v10, v[32:35]
att1_gw_w:
  ds_write_b128 v13, v[32:35]
att1_gw:
  s_waitcnt lgkmcnt(0)
  s_barrier
  s_add_u32 s28, s48, 0
  s_and_b32 s28, s28, 7
  s_lshl_b32 s28, s28, 13
  s_add_u32 s28, s28, s27
  s_add_u32 m0, s26, 0
  s_cmp_lt_u32 s39, 2
  s_cselect_b64 exec, -1, 0
  buffer_load_dwordx4 v2, s[8:11], s28 offen lds
  buffer_load_dwordx4 v2, s[8:11], s28 offen offset:1024 lds
  s_add_u32 m0, s26, 16384
  s_add_u32 s28, s28, 65536
  buffer_load_dwordx4 v2, s[8:11], s28 offen lds
  buffer_load_dwordx4 v2, s[8:11], s28 offen offset:1024 lds
  s_mov_b64 exec, -1
  v_lshlrev_b32 v244, 7, v1
  s_mov_b32 s29, 6823936
  s_cmp_eq_u32 s14, 4
  s_cselect_b64 exec, -1, 0
  buffer_load_dwordx4 v[240:243], v244, s[8:11], s29 offen sc1
  s_mov_b64 exec, -1
  v_mov_b32 v13, 94208
  ds_read2_b32 v[120:121], v13 offset0:0 offset1:2
  ds_read_b128 v[32:35], v9 offset:0
  ds_read_b128 v[36:39], v9 offset:1024
  ds_read_b128 v[40:43], v9 offset:2048
  ds_read_b128 v[44:47], v9 offset:3072
  s_lshl_b32 s28, s14, 12
  s_add_u32 s29, s28, 131072
  v_add_u32 v8, s29, v2
  s_xor_b32 s29, s29, 16384
  v_add_u32 v9, s29, v2
  s_and_b32 s32, s13, 7
  s_lshl_b32 s32, s32, 3
  s_add_u32 s32, s32, s14
  s_mul_i32 s32, s32, 28672
  s_add_u32 s32, s32, 4915200
  s_and_b32 s46, s13, 7
  s_lshl_b32 s46, s46, 1
  s_and_b32 s47, s14, 1
  s_add_u32 s46, s46, s47
  s_lshl_b32 s46, s46, 2
  s_lshr_b32 s47, s14, 1
  s_add_u32 s46, s46, s47
  s_lshl_b32 s46, s46, 13
  s_add_u32 s46, s46, 589824
  s_add_u32 s47, s46, 4096
  s_waitcnt lgkmcnt(0)
  v_add_f32 v16, v16, v32
  v_add_f32 v17, v17, v33
  v_add_f32 v18, v18, v34
  v_add_f32 v19, v19, v35
  v_add_f32 v20, v20, v36
  v_add_f32 v21, v21, v37
  v_add_f32 v22, v22, v38
  v_add_f32 v23, v23, v39
  v_add_f32 v24, v24, v40
  v_add_f32 v25, v25, v41
  v_add_f32 v26, v26, v42
  v_add_f32 v27, v27, v43
  v_add_f32 v28, v28, v44
  v_add_f32 v29, v29, v45
  v_add_f32 v30, v30, v46
  v_add_f32 v31, v31, v47
  v_mul_f32 v16, v16, v122
  v_mul_f32 v17, v17, v122
  v_mul_f32 v18, v18, v122
  v_mul_f32 v19, v19, v122
  v_mul_f32 v20, v20, v122
  v_mul_f32 v21, v21, v122
  v_mul_f32 v22, v22, v122
  v_mul_f32 v23, v23, v122
  v_mul_f32 v24, v24, v122
  v_mul_f32 v25, v25, v122
  v_mul_f32 v26, v26, v122
  v_mul_f32 v27, v27, v122
  v_mul_f32 v28, v28, v122
  v_mul_f32 v29, v29, v122
  v_mul_f32 v30, v30, v122
  v_mul_f32 v31, v31, v122
  v_cvt_pk_bf16_f32 v80, v16, v17
  v_cvt_pk_bf16_f32 v81, v18, v19
  v_cvt_pk_bf16_f32 v82, v20, v21
  v_cvt_pk_bf16_f32 v83, v22, v23
  v_cvt_pk_bf16_f32 v84, v24, v25
  v_cvt_pk_bf16_f32 v85, v26, v27
  v_cvt_pk_bf16_f32 v86, v28, v29
  v_cvt_pk_bf16_f32 v87, v30, v31
  v_mul_f32 v10, v16, v16
  v_mul_f32 v11, v24, v24
  v_fmac_f32 v10, v17, v17
  v_fmac_f32 v11, v25, v25
  v_fmac_f32 v10, v18, v18
  v_fmac_f32 v11, v26, v26
  v_fmac_f32 v10, v19, v19
  v_fmac_f32 v11, v27, v27
  v_fmac_f32 v10, v20, v20
  v_fmac_f32 v11, v28, v28
  v_fmac_f32 v10, v21, v21
  v_fmac_f32 v11, v29, v29
  v_fmac_f32 v10, v22, v22
  v_fmac_f32 v11, v30, v30
  v_fmac_f32 v10, v23, v23
  v_fmac_f32 v11, v31, v31
  v_mov_b32 v12, v10
  v_mov_b32 v13, v11
  s_nop 1
  v_permlane32_swap_b32 v10, v12
  v_permlane32_swap_b32 v11, v13
  s_nop 1
  v_add_f32 v10, v10, v12
  v_add_f32 v11, v11, v13
  v_max_f32 v10, v10, v11
  v_mov_b32 v122, v10
  v_mov_b32 v12, 0x53800000
  v_cmp_nle_f32 s[30:31], v121, v12
  v_mov_b32 v13, 0x45610000
  v_mul_f32 v12, v120, v122
  v_cmp_nle_f32 vcc, v12, v13
  s_or_b64 s[30:31], s[30:31], vcc
  s_waitcnt vmcnt(1)
  s_barrier
  ds_read_b128 v[96:99], v124
  ds_read_b128 v[100:103], v124 offset:1024
  s_mov_b64 exec, s[20:21]
  ds_read_b128 v[104:107], v125
  ds_read_b128 v[108:111], v125 offset:512
  s_mov_b64 exec, -1
  s_waitcnt lgkmcnt(3)
  v_mfma_f32_32x32x16_bf16 v[16:31], v[96:99], v[80:83], 0
  s_cmp_lg_u64 s[30:31], 0
  s_cbranch_scc1 att1_slow
  s_nop 9
  v_exp_f32 v16, v16
  v_exp_f32 v17, v17
  v_exp_f32 v18, v18
  v_exp_f32 v19, v19
  v_exp_f32 v20, v20
  v_exp_f32 v21, v21
  v_mfma_f32_32x32x16_bf16 v[32:47], v[96:99], v[84:87], 0
  s_waitcnt lgkmcnt(0)
  s_cmp_lg_u32 s14, 4
  s_cbranch_scc1 gwp_53
  v_mov_b32 v12, 94224
  ds_read_b32 v13, v12 offset:4
  s_waitcnt lgkmcnt(0)
  v_readfirstlane_b32 s22, v13
  s_cmp_eq_u32 s22, s94
  s_cbranch_scc1 gwp_53
  v_mov_b32 v12, 0
  s_getreg_b32 s28, hwreg(HW_REG_XCC_ID, 0, 3)
  s_lshl_b32 s28, s28, 7
  s_add_u32 s28, s28, 6882304
  s_waitcnt vmcnt(0)
  v_cmp_ne_u32 s[24:25], s94, v241
  v_cmp_ne_u32 vcc, s94, v243
  s_or_b64 vcc, vcc, s[24:25]
  s_cbranch_vccz gwp_53_q_p_x
  s_cmp_eq_u32 s13, 8
  s_cbranch_scc1 gwp_53_q_g
  s_mov_b32 s93, 48
gwp_53_q_l:
  buffer_load_dwordx4 v[240:243], v12, s[8:11], s28 offen sc1
  s_sub_u32 s93, s93, 1
  s_waitcnt vmcnt(0)
  v_cmp_ne_u32 s[24:25], s94, v241
  v_cmp_ne_u32 vcc, s94, v243
  s_or_b64 vcc, vcc, s[24:25]
  s_cmp_eq_u32 s93, 0
  s_cbranch_scc1 gwp_53_q_l_x
  s_cbranch_vccz gwp_53_q_l_x
  s_branch gwp_53_q_l
gwp_53_q_l_x:
  s_cbranch_vccz gwp_53_q_w
gwp_53_q_g:
  v_lshlrev_b32 v13, 7, v1
  s_mov_b32 s29, 6823936
  s_mov_b32 s93, 524288
gwp_53_q_p:
  buffer_load_dwordx4 v[240:243], v13, s[8:11], s29 offen sc1
  s_sub_u32 s93, s93, 1
  s_waitcnt vmcnt(0)
  v_cmp_ne_u32 s[24:25], s94, v241
  v_cmp_ne_u32 vcc, s94, v243
  s_or_b64 vcc, vcc, s[24:25]
  s_cmp_eq_u32 s93, 0
  s_cbranch_scc1 gwp_53_q_p_x
  s_cbranch_vccz gwp_53_q_p_x
  s_sleep 1
  s_branch gwp_53_q_p
gwp_53_q_p_x:
  v_max_u32_dpp v240, v240, v240 row_shr:1 row_mask:0xf bank_mask:0xf
  v_max_u32_dpp v242, v242, v242 row_shr:1 row_mask:0xf bank_mask:0xf
  s_nop 0
  v_max_u32_dpp v240, v240, v240 row_shr:2 row_mask:0xf bank_mask:0xf
  v_max_u32_dpp v242, v242, v242 row_shr:2 row_mask:0xf bank_mask:0xf
  s_nop 0
  v_max_u32_dpp v240, v240, v240 row_shr:4 row_mask:0xf bank_mask:0xf
  v_max_u32_dpp v242, v242, v242 row_shr:4 row_mask:0xf bank_mask:0xf
  s_nop 0
  v_max_u32_dpp v240, v240, v240 row_shr:8 row_mask:0xf bank_mask:0xf
  v_max_u32_dpp v242, v242, v242 row_shr:8 row_mask:0xf bank_mask:0xf
  s_nop 0
  v_max_u32_dpp v240, v240, v240 row_bcast:15 row_mask:0xa bank_mask:0xf
  v_max_u32_dpp v242, v242, v242 row_bcast:15 row_mask:0xa bank_mask:0xf
  s_nop 0
  v_max_u32_dpp v240, v240, v240 row_bcast:31 row_mask:0xc bank_mask:0xf
  v_max_u32_dpp v242, v242, v242 row_bcast:31 row_mask:0xc bank_mask:0xf
  s_nop 0
  v_readlane_b32 s22, v240, 63
  v_readlane_b32 s23, v242, 63
  s_nop 1
  v_mov_b32 v240, s22
  v_mov_b32 v242, s23
  s_cmp_eq_u32 s13, 8
  s_cselect_b64 exec, 1, 0
  buffer_store_dwordx4 v[240:243], v12, s[8:11], s28 offen
  s_mov_b64 exec, -1
gwp_53_q_w:
  v_mov_b32 v12, 94224
  ds_write_b128 v12, v[240:243]
gwp_53:
  s_cmp_eq_u32 s38, 0
  s_cbranch_scc1 prio_54
  s_setprio 1
prio_54:
  ds_read_b128 v[96:99], v124 offset:2048
  s_mov_b64 exec, s[20:21]
  ds_read_b128 v[112:115], v125 offset:1024
  ds_read_b128 v[116:119], v125 offset:1536
  s_mov_b64 exec, -1
  v_exp_f32 v22, v22
  v_exp_f32 v23, v23
  v_cvt_pk_bf16_f32 v88, v16, v17
  v_cvt_pk_bf16_f32 v89, v18, v19
  v_cvt_pk_bf16_f32 v90, v20, v21
  v_cvt_pk_bf16_f32 v91, v22, v23
  v_exp_f32 v24, v24
  v_exp_f32 v25, v25
  v_mfma_f32_32x32x16_bf16 v[48:63], v[104:107], v[88:91], 0
  v_exp_f32 v26, v26
  v_exp_f32 v27, v27
  v_exp_f32 v28, v28
  v_exp_f32 v29, v29
  v_exp_f32 v30, v30
  v_exp_f32 v31, v31
  v_cvt_pk_bf16_f32 v92, v24, v25
  v_cvt_pk_bf16_f32 v93, v26, v27
  v_cvt_pk_bf16_f32 v94, v28, v29
  v_cvt_pk_bf16_f32 v95, v30, v31
  v_exp_f32 v32, v32
  v_exp_f32 v33, v33
  v_mfma_f32_32x32x16_bf16 v[48:63], v[108:111], v[92:95], v[48:63]
  v_exp_f32 v34, v34
  v_exp_f32 v35, v35
  v_exp_f32 v36, v36
  v_exp_f32 v37, v37
  v_mfma_f32_32x32x16_bf16 v[16:31], v[100:103], v[80:83], 0
  v_exp_f32 v38, v38
  v_exp_f32 v39, v39
  v_cvt_pk_bf16_f32 v88, v32, v33
  v_cvt_pk_bf16_f32 v89, v34, v35
  v_cvt_pk_bf16_f32 v90, v36, v37
  v_cvt_pk_bf16_f32 v91, v38, v39
  v_exp_f32 v40, v40
  v_exp_f32 v41, v41
  v_mfma_f32_32x32x16_bf16 v[64:79], v[104:107], v[88:91], 0
  v_exp_f32 v42, v42
  v_exp_f32 v43, v43
  v_exp_f32 v44, v44
  v_exp_f32 v45, v45
  v_exp_f32 v46, v46
  v_exp_f32 v47, v47
  v_cvt_pk_bf16_f32 v92, v40, v41
  v_cvt_pk_bf16_f32 v93, v42, v43
  v_cvt_pk_bf16_f32 v94, v44, v45
  v_cvt_pk_bf16_f32 v95, v46, v47
  v_exp_f32 v16, v16
  v_exp_f32 v17, v17
  v_mfma_f32_32x32x16_bf16 v[64:79], v[108:111], v[92:95], v[64:79]
  v_exp_f32 v18, v18
  v_exp_f32 v19, v19
  v_exp_f32 v20, v20
  v_exp_f32 v21, v21
  v_mfma_f32_32x32x16_bf16 v[32:47], v[100:103], v[84:87], 0
  s_waitcnt lgkmcnt(0)
  v_mov_b32 v12, 94224
  s_mov_b32 s93, 0x4000000
gww_55:
  ds_read_b32 v13, v12 offset:4
  ds_read2_b32 v[120:121], v12 offset0:0 offset1:2
  s_sub_u32 s93, s93, 1
  s_waitcnt lgkmcnt(0)
  v_readfirstlane_b32 s22, v13
  s_cmp_eq_u32 s93, 0
  s_cbranch_scc1 gww_55_x
  s_cmp_lg_u32 s22, s94
  s_cbranch_scc1 gww_55
gww_55_x:
  v_mov_b32 v12, 0x53800000
  v_cmp_nle_f32 s[30:31], v121, v12
  v_mov_b32 v13, 0x45610000
  v_mul_f32 v12, v120, v122
  v_cmp_nle_f32 vcc, v12, v13
  s_or_b64 s[30:31], s[30:31], vcc
  s_cmp_lg_u64 s[30:31], 0
  s_cbranch_scc1 att1_slow
  s_add_u32 s28, s48, 0
  s_and_b32 s28, s28, 7
  s_lshl_b32 s28, s28, 13
  s_add_u32 s28, s28, s27
  s_add_u32 m0, s26, 0
  s_cmp_lt_u32 s39, 2
  s_cselect_b64 exec, 0, -1
  buffer_load_dwordx4 v2, s[8:11], s28 offen lds
  buffer_load_dwordx4 v2, s[8:11], s28 offen offset:1024 lds
  s_add_u32 m0, s26, 16384
  s_add_u32 s28, s28, 65536
  buffer_load_dwordx4 v2, s[8:11], s28 offen lds
  buffer_load_dwordx4 v2, s[8:11], s28 offen offset:1024 lds
  s_mov_b64 exec, -1
  s_add_u32 s28, s48, 2
  s_and_b32 s28, s28, 7
  s_lshl_b32 s28, s28, 13
  s_add_u32 s28, s28, s27
  s_add_u32 m0, s26, 32768
  s_nop 0
  buffer_load_dwordx4 v2, s[8:11], s28 offen lds
  buffer_load_dwordx4 v2, s[8:11], s28 offen offset:1024 lds
  s_add_u32 m0, s26, 49152
  s_add_u32 s28, s28, 65536
  buffer_load_dwordx4 v2, s[8:11], s28 offen lds
  buffer_load_dwordx4 v2, s[8:11], s28 offen offset:1024 lds
  ds_read_b128 v[100:103], v124 offset:3072
  s_mov_b64 exec, s[20:21]
  ds_read_b128 v[104:107], v125 offset:2048
  ds_read_b128 v[108:111], v125 offset:2560
  s_mov_b64 exec, -1
  v_exp_f32 v22, v22
  v_exp_f32 v23, v23
  v_cvt_pk_bf16_f32 v88, v16, v17
  v_cvt_pk_bf16_f32 v89, v18, v19
  v_cvt_pk_bf16_f32 v90, v20, v21
  v_cvt_pk_bf16_f32 v91, v22, v23
  v_exp_f32 v24, v24
  v_exp_f32 v25, v25
  v_mfma_f32_32x32x16_bf16 v[48:63], v[112:115], v[88:91], v[48:63]
  v_exp_f32 v26, v26
  v_exp_f32 v27, v27
  v_exp_f32 v28, v28
  v_exp_f32 v29, v29
  v_exp_f32 v30, v30
  v_exp_f32 v31, v31
  v_cvt_pk_bf16_f32 v92, v24, v25
  v_cvt_pk_bf16_f32 v93, v26, v27
  v_cvt_pk_bf16_f32 v94, v28, v29
  v_cvt_pk_bf16_f32 v95, v30, v31
  v_exp_f32 v32, v32
  v_exp_f32 v33, v33
  v_mfma_f32_32x32x16_bf16 v[48:63], v[116:119], v[92:95], v[48:63]
  v_exp_f32 v34, v34
  v_exp_f32 v35, v35
  v_exp_f32 v36, v36
  v_exp_f32 v37, v37
  v_mfma_f32_32x32x16_bf16 v[16:31], v[96:99], v[80:83], 0
  v_exp_f32 v38, v38
  v_exp_f32 v39, v39
  v_cvt_pk_bf16_f32 v88, v32, v33
  v_cvt_pk_bf16_f32 v89, v34, v35
  v_cvt_pk_bf16_f32 v90, v36, v37
  v_cvt_pk_bf16_f32 v91, v38, v39
  v_exp_f32 v40, v40
  v_exp_f32 v41, v41
  v_mfma_f32_32x32x16_bf16 v[64:79], v[112:115], v[88:91], v[64:79]
  v_exp_f32 v42, v42
  v_exp_f32 v43, v43
  v_exp_f32 v44, v44
  v_exp_f32 v45, v45
  v_exp_f32 v46, v46
  v_exp_f32 v47, v47
  v_cvt_pk_bf16_f32 v92, v40, v41
  v_cvt_pk_bf16_f32 v93, v42, v43
  v_cvt_pk_bf16_f32 v94, v44, v45
  v_cvt_pk_bf16_f32 v95, v46, v47
  v_exp_f32 v16, v16
  v_exp_f32 v17, v17
  v_mfma_f32_32x32x16_bf16 v[64:79], v[116:119], v[92:95], v[64:79]
  v_exp_f32 v18, v18
  v_exp_f32 v19, v19
  v_exp_f32 v20, v20
  v_exp_f32 v21, v21
  v_mfma_f32_32x32x16_bf16 v[32:47], v[96:99], v[84:87], 0
  s_waitcnt lgkmcnt(0)
  buffer_load_dwordx4 v[144:147], v2, s[8:11], s32 offen offset:0
  s_mov_b64 exec, s[20:21]
  ds_read_b128 v[112:115], v125 offset:3072
  ds_read_b128 v[116:119], v125 offset:3584
  s_mov_b64 exec, -1
  v_exp_f32 v22, v22
  v_exp_f32 v23, v23
  v_cvt_pk_bf16_f32 v88, v16, v17
  v_cvt_pk_bf16_f32 v89, v18, v19
  v_cvt_pk_bf16_f32 v90, v20, v21
  v_cvt_pk_bf16_f32 v91, v22, v23
  v_exp_f32 v24, v24
  v_exp_f32 v25, v25
  v_mfma_f32_32x32x16_bf16 v[48:63], v[104:107], v[88:91], v[48:63]
  v_exp_f32 v26, v26
  v_exp_f32 v27, v27
  v_exp_f32 v28, v28
  v_exp_f32 v29, v29
  v_exp_f32 v30, v30
  v_exp_f32 v31, v31
  v_cvt_pk_bf16_f32 v92, v24, v25
  v_cvt_pk_bf16_f32 v93, v26, v27
  v_cvt_pk_bf16_f32 v94, v28, v29
  v_cvt_pk_bf16_f32 v95, v30, v31
  v_exp_f32 v32, v32
  v_exp_f32 v33, v33
  v_mfma_f32_32x32x16_bf16 v[48:63], v[108:111], v[92:95], v[48:63]
  v_exp_f32 v34, v34
  v_exp_f32 v35, v35
  v_exp_f32 v36, v36
  v_exp_f32 v37, v37
  v_mfma_f32_32x32x16_bf16 v[16:31], v[100:103], v[80:83], 0
  v_exp_f32 v38, v38
  v_exp_f32 v39, v39
  v_cvt_pk_bf16_f32 v88, v32, v33
  v_cvt_pk_bf16_f32 v89, v34, v35
  v_cvt_pk_bf16_f32 v90, v36, v37
  v_cvt_pk_bf16_f32 v91, v38, v39
  v_exp_f32 v40, v40
  v_exp_f32 v41, v41
  v_mfma_f32_32x32x16_bf16 v[64:79], v[104:107], v[88:91], v[64:79]
  v_exp_f32 v42, v42
  v_exp_f32 v43, v43
  v_exp_f32 v44, v44
  v_exp_f32 v45, v45
  v_exp_f32 v46, v46
  v_exp_f32 v47, v47
  v_cvt_pk_bf16_f32 v92, v40, v41
  v_cvt_pk_bf16_f32 v93, v42, v43
  v_cvt_pk_bf16_f32 v94, v44, v45
  v_cvt_pk_bf16_f32 v95, v46, v47
  v_exp_f32 v16, v16
  v_exp_f32 v17, v17
  v_mfma_f32_32x32x16_bf16 v[64:79], v[108:111], v[92:95], v[64:79]
  v_exp_f32 v18, v18
  v_exp_f32 v19, v19
  v_exp_f32 v20, v20
  v_exp_f32 v21, v21
  v_mfma_f32_32x32x16_bf16 v[32:47], v[100:103], v[84:87], 0
  s_waitcnt lgkmcnt(0)
  s_waitcnt vmcnt(5)
  s_barrier
  buffer_load_dwordx4 v[148:151], v2, s[8:11], s32 offen offset:1024
  ds_read_b128 v[96:99], v124 offset:4096
  ds_read_b128 v[100:103], v124 offset:5120
  s_mov_b64 exec, s[20:21]
  ds_read_b128 v[104:107], v125 offset:4096
  ds_read_b128 v[108:111], v125 offset:4608
  s_mov_b64 exec, -1
  v_exp_f32 v22, v22
  v_exp_f32 v23, v23
  v_cvt_pk_bf16_f32 v88, v16, v17
  v_cvt_pk_bf16_f32 v89, v18, v19
  v_cvt_pk_bf16_f32 v90, v20, v21
  v_cvt_pk_bf16_f32 v91, v22, v23
  v_exp_f32 v24, v24
  v_exp_f32 v25, v25
  v_mfma_f32_32x32x16_bf16 v[48:63], v[112:115], v[88:91], v[48:63]
  v_exp_f32 v26, v26
  v_exp_f32 v27, v27
  v_exp_f32 v28, v28
  v_exp_f32 v29, v29
  v_exp_f32 v30, v30
  v_exp_f32 v31, v31
  v_cvt_pk_bf16_f32 v92, v24, v25
  v_cvt_pk_bf16_f32 v93, v26, v27
  v_cvt_pk_bf16_f32 v94, v28, v29
  v_cvt_pk_bf16_f32 v95, v30, v31
  v_exp_f32 v32, v32
  v_exp_f32 v33, v33
  v_mfma_f32_32x32x16_bf16 v[48:63], v[116:119], v[92:95], v[48:63]
  v_exp_f32 v34, v34
  v_exp_f32 v35, v35
  v_exp_f32 v36, v36
  v_exp_f32 v37, v37
  s_waitcnt lgkmcnt(3)
  v_mfma_f32_32x32x16_bf16 v[16:31], v[96:99], v[80:83], 0
  v_exp_f32 v38, v38
  v_exp_f32 v39, v39
  v_cvt_pk_bf16_f32 v88, v32, v33
  v_cvt_pk_bf16_f32 v89, v34, v35
  v_cvt_pk_bf16_f32 v90, v36, v37
  v_cvt_pk_bf16_f32 v91, v38, v39
  v_exp_f32 v40, v40
  v_exp_f32 v41, v41
  v_mfma_f32_32x32x16_bf16 v[64:79], v[112:115], v[88:91], v[64:79]
  v_exp_f32 v42, v42
  v_exp_f32 v43, v43
  v_exp_f32 v44, v44
  v_exp_f32 v45, v45
  v_exp_f32 v46, v46
  v_exp_f32 v47, v47
  v_cvt_pk_bf16_f32 v92, v40, v41
  v_cvt_pk_bf16_f32 v93, v42, v43
  v_cvt_pk_bf16_f32 v94, v44, v45
  v_cvt_pk_bf16_f32 v95, v46, v47
  v_exp_f32 v16, v16
  v_exp_f32 v17, v17
  v_mfma_f32_32x32x16_bf16 v[64:79], v[116:119], v[92:95], v[64:79]
  v_exp_f32 v18, v18
  v_exp_f32 v19, v19
  v_exp_f32 v20, v20
  v_exp_f32 v21, v21
  v_mfma_f32_32x32x16_bf16 v[32:47], v[96:99], v[84:87], 0
  s_waitcnt lgkmcnt(0)
  buffer_load_dwordx4 v[152:155], v2, s[8:11], s32 offen offset:2048
  s_and_b32 s16, s13, 7
  s_lshr_b32 s15, s13, 3
  s_lshl_b32 s15, s15, 1
  s_lshl_b32 s19, s12, 3
  s_add_u32 s15, s15, s19
  s_and_b32 s18, s14, 1
  s_lshr_b32 s17, s14, 1
  s_lshr_b32 s49, s14, 2
  s_and_b32 s48, s17, 1
  s_add_u32 s20, s15, s49
  s_lshl_b32 s21, s16, 1
  s_and_b32 s19, s14, 1
  s_add_u32 s21, s21, s19
  s_lshl_b32 s21, s21, 1
  s_add_u32 s21, s21, s48
  s_lshl_b32 s19, s20, 5
  s_add_u32 s19, s19, s21
  s_lshl_b32 s19, s19, 10
  s_mov_b32 s20, 0xffff0000
  s_mov_b32 s21, 0xffff0000
  s_lshl_b32 s22, s36, 5
  s_lshl_b32 s23, s37, 1
  s_add_u32 s22, s22, s23
  s_add_u32 s22, s22, s38
  s_lshl_b32 s22, s22, 10
  s_add_u32 s22, s22, 18874368
  s_lshr_b32 s25, s13, 4
  s_lshl_b32 s24, s25, 2
  s_xor_b32 s24, s24, s14
  s_lshl_b32 s23, s12, 3
  s_add_u32 s24, s24, s23
  s_mul_i32 s23, s24, 112
  s_and_b32 s24, s13, 15
  s_mul_i32 s24, s24, 7
  s_add_u32 s23, s23, s24
  s_mul_i32 s24, s25, 3
  s_add_u32 s23, s23, s24
  s_and_b32 s24, s25, s38
  s_add_u32 s23, s23, s24
  s_lshl_b32 s23, s23, 10
  s_add_u32 s23, s23, 29356032
  s_add_u32 s24, s19, 13630464
  s_sub_u32 s25, s22, 2048
  v_lshrrev_b32 v12, 3, v1
  v_mov_b32 v13, s22
  v_mov_b32 v14, s24
  v_cmp_eq_u32 vcc, 1, v12
  s_sub_u32 s22, s22, 3072
  s_nop 0
  v_cndmask_b32 v13, v13, v14, vcc
  v_mov_b32 v14, s25
  v_cmp_eq_u32 vcc, 2, v12
  s_nop 1
  v_cndmask_b32 v13, v13, v14, vcc
  v_mov_b32 v14, s22
  v_cmp_eq_u32 vcc, 3, v12
  s_nop 1
  v_cndmask_b32 v13, v13, v14, vcc
  v_mov_b32 v14, s23
  v_cmp_lt_u32 vcc, 3, v12
  s_nop 1
  v_cndmask_b32 v13, v13, v14, vcc
  v_lshl_add_u32 v13, v1, 7, v13
  v_mov_b32 v123, v13
  v_mov_b32 v11, v13
  s_lshr_b32 s48, s39, 1
  s_add_u32 s48, s48, s12
  s_mov_b32 exec_lo, 0xff
  s_mov_b32 exec_hi, 0x0
  buffer_load_dword v14, v123, s[8:11], 0 offen sc1
  s_mov_b64 exec, -1
  ds_read_b128 v[96:99], v124 offset:6144
  s_mov_b64 exec, s[20:21]
  ds_read_b128 v[112:115], v125 offset:5120
  ds_read_b128 v[116:119], v125 offset:5632
  s_mov_b64 exec, -1
  v_exp_f32 v22, v22
  v_exp_f32 v23, v23
  v_cvt_pk_bf16_f32 v88, v16, v17
  v_cvt_pk_bf16_f32 v89, v18, v19
  v_cvt_pk_bf16_f32 v90, v20, v21
  v_cvt_pk_bf16_f32 v91, v22, v23
  v_exp_f32 v24, v24
  v_exp_f32 v25, v25
  v_mfma_f32_32x32x16_bf16 v[48:63], v[104:107], v[88:91], v[48:63]
  v_exp_f32 v26, v26
  v_exp_f32 v27, v27
  v_exp_f32 v28, v28
  v_exp_f32 v29, v29
  v_exp_f32 v30, v30
  v_exp_f32 v31, v31
  v_cvt_pk_bf16_f32 v92, v24, v25
  v_cvt_pk_bf16_f32 v93, v26, v27
  v_cvt_pk_bf16_f32 v94, v28, v29
  v_cvt_pk_bf16_f32 v95, v30, v31
  v_exp_f32 v32, v32
  v_exp_f32 v33, v33
  v_mfma_f32_32x32x16_bf16 v[48:63], v[108:111], v[92:95], v[48:63]
  v_exp_f32 v34, v34
  v_exp_f32 v35, v35
  v_exp_f32 v36, v36
  v_exp_f32 v37, v37
  v_mfma_f32_32x32x16_bf16 v[16:31], v[100:103], v[80:83], 0
  v_exp_f32 v38, v38
  v_exp_f32 v39, v39
  v_cvt_pk_bf16_f32 v88, v32, v33
  v_cvt_pk_bf16_f32 v89, v34, v35
  v_cvt_pk_bf16_f32 v90, v36, v37
  v_cvt_pk_bf16_f32 v91, v38, v39
  v_exp_f32 v40, v40
  v_exp_f32 v41, v41
  v_mfma_f32_32x32x16_bf16 v[64:79], v[104:107], v[88:91], v[64:79]
  v_exp_f32 v42, v42
  v_exp_f32 v43, v43
  v_exp_f32 v44, v44
  v_exp_f32 v45, v45
  v_exp_f32 v46, v46
  v_exp_f32 v47, v47
  v_cvt_pk_bf16_f32 v92, v40, v41
  v_cvt_pk_bf16_f32 v93, v42, v43
  v_cvt_pk_bf16_f32 v94, v44, v45
  v_cvt_pk_bf16_f32 v95, v46, v47
  v_exp_f32 v16, v16
  v_exp_f32 v17, v17
  v_mfma_f32_32x32x16_bf16 v[64:79], v[108:111], v[92:95], v[64:79]
  v_exp_f32 v18, v18
  v_exp_f32 v19, v19
  v_exp_f32 v20, v20
  v_exp_f32 v21, v21
  v_mfma_f32_32x32x16_bf16 v[32:47], v[100:103], v[84:87], 0
  s_waitcnt lgkmcnt(0)
  s_cmp_eq_u32 s38, 0
  s_cbranch_scc1 prio_56
  s_setprio 0
prio_56:
  buffer_load_dwordx4 v[156:159], v2, s[8:11], s32 offen offset:3072
  s_add_u32 s32, s32, 4096
  s_mov_b32 exec_lo, 0xff00
  s_mov_b32 exec_hi, 0x0
  buffer_load_dword v14, v123, s[8:11], 0 offen sc1
  s_mov_b64 exec, -1
  ds_read_b128 v[100:103], v124 offset:7168
  s_mov_b64 exec, s[20:21]
  ds_read_b128 v[104:107], v125 offset:6144
  ds_read_b128 v[108:111], v125 offset:6656
  s_mov_b64 exec, -1
  v_exp_f32 v22, v22
  v_exp_f32 v23, v23
  v_cvt_pk_bf16_f32 v88, v16, v17
  v_cvt_pk_bf16_f32 v89, v18, v19
  v_cvt_pk_bf16_f32 v90, v20, v21
  v_cvt_pk_bf16_f32 v91, v22, v23
  v_exp_f32 v24, v24
  v_exp_f32 v25, v25
  v_mfma_f32_32x32x16_bf16 v[48:63], v[112:115], v[88:91], v[48:63]
  v_exp_f32 v26, v26
  v_exp_f32 v27, v27
  v_exp_f32 v28, v28
  v_exp_f32 v29, v29
  v_exp_f32 v30, v30
  v_exp_f32 v31, v31
  v_cvt_pk_bf16_f32 v92, v24, v25
  v_cvt_pk_bf16_f32 v93, v26, v27
  v_cvt_pk_bf16_f32 v94, v28, v29
  v_cvt_pk_bf16_f32 v95, v30, v31
  v_exp_f32 v32, v32
  v_exp_f32 v33, v33
  v_mfma_f32_32x32x16_bf16 v[48:63], v[116:119], v[92:95], v[48:63]
  v_exp_f32 v34, v34
  v_exp_f32 v35, v35
  v_exp_f32 v36, v36
  v_exp_f32 v37, v37
  v_mfma_f32_32x32x16_bf16 v[16:31], v[96:99], v[80:83], 0
  v_exp_f32 v38, v38
  v_exp_f32 v39, v39
  v_cvt_pk_bf16_f32 v88, v32, v33
  v_cvt_pk_bf16_f32 v89, v34, v35
  v_cvt_pk_bf16_f32 v90, v36, v37
  v_cvt_pk_bf16_f32 v91, v38, v39
  v_exp_f32 v40, v40
  v_exp_f32 v41, v41
  v_mfma_f32_32x32x16_bf16 v[64:79], v[112:115], v[88:91], v[64:79]
  v_exp_f32 v42, v42
  v_exp_f32 v43, v43
  v_exp_f32 v44, v44
  v_exp_f32 v45, v45
  v_exp_f32 v46, v46
  v_exp_f32 v47, v47
  v_cvt_pk_bf16_f32 v92, v40, v41
  v_cvt_pk_bf16_f32 v93, v42, v43
  v_cvt_pk_bf16_f32 v94, v44, v45
  v_cvt_pk_bf16_f32 v95, v46, v47
  v_exp_f32 v16, v16
  v_exp_f32 v17, v17
  v_mfma_f32_32x32x16_bf16 v[64:79], v[116:119], v[92:95], v[64:79]
  v_exp_f32 v18, v18
  v_exp_f32 v19, v19
  v_exp_f32 v20, v20
  v_exp_f32 v21, v21
  v_mfma_f32_32x32x16_bf16 v[32:47], v[96:99], v[84:87], 0
  s_waitcnt lgkmcnt(0)
  s_cmp_eq_u32 s38, 0
  s_cbranch_scc1 prio_57
  s_setprio 1
prio_57:
  s_waitcnt vmcnt(6)
  s_barrier
  s_add_u32 s28, s48, 4
  s_and_b32 s28, s28, 7
  s_lshl_b32 s28, s28, 13
  s_add_u32 s28, s28, s27
  s_add_u32 m0, s26, 65536
  s_nop 0
  buffer_load_dwordx4 v2, s[8:11], s28 offen lds
  buffer_load_dwordx4 v2, s[8:11], s28 offen offset:1024 lds
  s_add_u32 m0, s26, 81920
  s_add_u32 s28, s28, 65536
  buffer_load_dwordx4 v2, s[8:11], s28 offen lds
  buffer_load_dwordx4 v2, s[8:11], s28 offen offset:1024 lds
  buffer_load_dwordx4 v[160:163], v2, s[8:11], s32 offen offset:0
  ds_read_b128 v[96:99], v124 offset:32768
  s_mov_b64 exec, s[20:21]
  ds_read_b128 v[112:115], v125 offset:7168
  ds_read_b128 v[116:119], v125 offset:7680
  s_mov_b64 exec, -1
  v_exp_f32 v22, v22
  v_exp_f32 v23, v23
  v_cvt_pk_bf16_f32 v88, v16, v17
  v_cvt_pk_bf16_f32 v89, v18, v19
  v_cvt_pk_bf16_f32 v90, v20, v21
  v_cvt_pk_bf16_f32 v91, v22, v23
  v_exp_f32 v24, v24
  v_exp_f32 v25, v25
  v_mfma_f32_32x32x16_bf16 v[48:63], v[104:107], v[88:91], v[48:63]
  v_exp_f32 v26, v26
  v_exp_f32 v27, v27
  v_exp_f32 v28, v28
  v_exp_f32 v29, v29
  v_exp_f32 v30, v30
  v_exp_f32 v31, v31
  v_cvt_pk_bf16_f32 v92, v24, v25
  v_cvt_pk_bf16_f32 v93, v26, v27
  v_cvt_pk_bf16_f32 v94, v28, v29
  v_cvt_pk_bf16_f32 v95, v30, v31
  v_exp_f32 v32, v32
  v_exp_f32 v33, v33
  v_mfma_f32_32x32x16_bf16 v[48:63], v[108:111], v[92:95], v[48:63]
  v_exp_f32 v34, v34
  v_exp_f32 v35, v35
  v_exp_f32 v36, v36
  v_exp_f32 v37, v37
  v_mfma_f32_32x32x16_bf16 v[16:31], v[100:103], v[80:83], 0
  v_exp_f32 v38, v38
  v_exp_f32 v39, v39
  v_cvt_pk_bf16_f32 v88, v32, v33
  v_cvt_pk_bf16_f32 v89, v34, v35
  v_cvt_pk_bf16_f32 v90, v36, v37
  v_cvt_pk_bf16_f32 v91, v38, v39
  v_exp_f32 v40, v40
  v_exp_f32 v41, v41
  v_mfma_f32_32x32x16_bf16 v[64:79], v[104:107], v[88:91], v[64:79]
  v_exp_f32 v42, v42
  v_exp_f32 v43, v43
  v_exp_f32 v44, v44
  v_exp_f32 v45, v45
  v_exp_f32 v46, v46
  v_exp_f32 v47, v47
  v_cvt_pk_bf16_f32 v92, v40, v41
  v_cvt_pk_bf16_f32 v93, v42, v43
  v_cvt_pk_bf16_f32 v94, v44, v45
  v_cvt_pk_bf16_f32 v95, v46, v47
  v_exp_f32 v16, v16
  v_exp_f32 v17, v17
  v_mfma_f32_32x32x16_bf16 v[64:79], v[108:111], v[92:95], v[64:79]
  v_exp_f32 v18, v18
  v_exp_f32 v19, v19
  v_exp_f32 v20, v20
  v_exp_f32 v21, v21
  v_mfma_f32_32x32x16_bf16 v[32:47], v[100:103], v[84:87], 0
  s_waitcnt lgkmcnt(0)
  buffer_load_dwordx4 v[164:167], v2, s[8:11], s32 offen offset:1024
  ds_read_b128 v[100:103], v124 offset:33792
  s_mov_b64 exec, s[20:21]
  ds_read_b128 v[104:107], v125 offset:32768
  ds_read_b128 v[108:111], v125 offset:33280
  s_mov_b64 exec, -1
  v_exp_f32 v22, v22
  v_exp_f32 v23, v23
  v_cvt_pk_bf16_f32 v88, v16, v17
  v_cvt_pk_bf16_f32 v89, v18, v19
  v_cvt_pk_bf16_f32 v90, v20, v21
  v_cvt_pk_bf16_f32 v91, v22, v23
  v_exp_f32 v24, v24
  v_exp_f32 v25, v25
  v_mfma_f32_32x32x16_bf16 v[48:63], v[112:115], v[88:91], v[48:63]
  v_exp_f32 v26, v26
  v_exp_f32 v27, v27
  v_exp_f32 v28, v28
  v_exp_f32 v29, v29
  v_exp_f32 v30, v30
  v_exp_f32 v31, v31
  v_cvt_pk_bf16_f32 v92, v24, v25
  v_cvt_pk_bf16_f32 v93, v26, v27
  v_cvt_pk_bf16_f32 v94, v28, v29
  v_cvt_pk_bf16_f32 v95, v30, v31
  v_exp_f32 v32, v32
  v_exp_f32 v33, v33
  v_mfma_f32_32x32x16_bf16 v[48:63], v[116:119], v[92:95], v[48:63]
  v_exp_f32 v34, v34
  v_exp_f32 v35, v35
  v_exp_f32 v36, v36
  v_exp_f32 v37, v37
  v_mfma_f32_32x32x16_bf16 v[16:31], v[96:99], v[80:83], 0
  v_exp_f32 v38, v38
  v_exp_f32 v39, v39
  v_cvt_pk_bf16_f32 v88, v32, v33
  v_cvt_pk_bf16_f32 v89, v34, v35
  v_cvt_pk_bf16_f32 v90, v36, v37
  v_cvt_pk_bf16_f32 v91, v38, v39
  v_exp_f32 v40, v40
  v_exp_f32 v41, v41
  v_mfma_f32_32x32x16_bf16 v[64:79], v[112:115], v[88:91], v[64:79]
  v_exp_f32 v42, v42
  v_exp_f32 v43, v43
  v_exp_f32 v44, v44
  v_exp_f32 v45, v45
  v_exp_f32 v46, v46
  v_exp_f32 v47, v47
  v_cvt_pk_bf16_f32 v92, v40, v41
  v_cvt_pk_bf16_f32 v93, v42, v43
  v_cvt_pk_bf16_f32 v94, v44, v45
  v_cvt_pk_bf16_f32 v95, v46, v47
  v_exp_f32 v16, v16
  v_exp_f32 v17, v17
  v_mfma_f32_32x32x16_bf16 v[64:79], v[116:119], v[92:95], v[64:79]
  v_exp_f32 v18, v18
  v_exp_f32 v19, v19
  v_exp_f32 v20, v20
  v_exp_f32 v21, v21
  v_mfma_f32_32x32x16_bf16 v[32:47], v[96:99], v[84:87], 0
  s_waitcnt lgkmcnt(0)
  buffer_load_dwordx4 v[168:171], v2, s[8:11], s32 offen offset:2048
  ds_read_b128 v[96:99], v124 offset:34816
  s_mov_b64 exec, s[20:21]
  ds_read_b128 v[112:115], v125 offset:33792
  ds_read_b128 v[116:119], v125 offset:34304
  s_mov_b64 exec, -1
  v_exp_f32 v22, v22
  v_exp_f32 v23, v23
  v_cvt_pk_bf16_f32 v88, v16, v17
  v_cvt_pk_bf16_f32 v89, v18, v19
  v_cvt_pk_bf16_f32 v90, v20, v21
  v_cvt_pk_bf16_f32 v91, v22, v23
  v_exp_f32 v24, v24
  v_exp_f32 v25, v25
  v_mfma_f32_32x32x16_bf16 v[48:63], v[104:107], v[88:91], v[48:63]
  v_exp_f32 v26, v26
  v_exp_f32 v27, v27
  v_exp_f32 v28, v28
  v_exp_f32 v29, v29
  v_exp_f32 v30, v30
  v_exp_f32 v31, v31
  v_cvt_pk_bf16_f32 v92, v24, v25
  v_cvt_pk_bf16_f32 v93, v26, v27
  v_cvt_pk_bf16_f32 v94, v28, v29
  v_cvt_pk_bf16_f32 v95, v30, v31
  v_exp_f32 v32, v32
  v_exp_f32 v33, v33
  v_mfma_f32_32x32x16_bf16 v[48:63], v[108:111], v[92:95], v[48:63]
  v_exp_f32 v34, v34
  v_exp_f32 v35, v35
  v_exp_f32 v36, v36
  v_exp_f32 v37, v37
  v_mfma_f32_32x32x16_bf16 v[16:31], v[100:103], v[80:83], 0
  v_exp_f32 v38, v38
  v_exp_f32 v39, v39
  v_cvt_pk_bf16_f32 v88, v32, v33
  v_cvt_pk_bf16_f32 v89, v34, v35
  v_cvt_pk_bf16_f32 v90, v36, v37
  v_cvt_pk_bf16_f32 v91, v38, v39
  v_exp_f32 v40, v40
  v_exp_f32 v41, v41
  v_mfma_f32_32x32x16_bf16 v[64:79], v[104:107], v[88:91], v[64:79]
  v_exp_f32 v42, v42
  v_exp_f32 v43, v43
  v_exp_f32 v44, v44
  v_exp_f32 v45, v45
  v_exp_f32 v46, v46
  v_exp_f32 v47, v47
  v_cvt_pk_bf16_f32 v92, v40, v41
  v_cvt_pk_bf16_f32 v93, v42, v43
  v_cvt_pk_bf16_f32 v94, v44, v45
  v_cvt_pk_bf16_f32 v95, v46, v47
  v_exp_f32 v16, v16
  v_exp_f32 v17, v17
  v_mfma_f32_32x32x16_bf16 v[64:79], v[108:111], v[92:95], v[64:79]
  v_exp_f32 v18, v18
  v_exp_f32 v19, v19
  v_exp_f32 v20, v20
  v_exp_f32 v21, v21
  v_mfma_f32_32x32x16_bf16 v[32:47], v[100:103], v[84:87], 0
  s_waitcnt lgkmcnt(0)
  buffer_load_dwordx4 v[172:175], v2, s[8:11], s32 offen offset:3072
  s_add_u32 s32, s32, 4096
  ds_read_b128 v[100:103], v124 offset:35840
  s_mov_b64 exec, s[20:21]
  ds_read_b128 v[104:107], v125 offset:34816
  ds_read_b128 v[108:111], v125 offset:35328
  s_mov_b64 exec, -1
  v_exp_f32 v22, v22
  v_exp_f32 v23, v23
  v_cvt_pk_bf16_f32 v88, v16, v17
  v_cvt_pk_bf16_f32 v89, v18, v19
  v_cvt_pk_bf16_f32 v90, v20, v21
  v_cvt_pk_bf16_f32 v91, v22, v23
  v_exp_f32 v24, v24
  v_exp_f32 v25, v25
  v_mfma_f32_32x32x16_bf16 v[48:63], v[112:115], v[88:91], v[48:63]
  v_exp_f32 v26, v26
  v_exp_f32 v27, v27
  v_exp_f32 v28, v28
  v_exp_f32 v29, v29
  v_exp_f32 v30, v30
  v_exp_f32 v31, v31
  v_cvt_pk_bf16_f32 v92, v24, v25
  v_cvt_pk_bf16_f32 v93, v26, v27
  v_cvt_pk_bf16_f32 v94, v28, v29
  v_cvt_pk_bf16_f32 v95, v30, v31
  v_exp_f32 v32, v32
  v_exp_f32 v33, v33
  v_mfma_f32_32x32x16_bf16 v[48:63], v[116:119], v[92:95], v[48:63]
  v_exp_f32 v34, v34
  v_exp_f32 v35, v35
  v_exp_f32 v36, v36
  v_exp_f32 v37, v37
  v_mfma_f32_32x32x16_bf16 v[16:31], v[96:99], v[80:83], 0
  v_exp_f32 v38, v38
  v_exp_f32 v39, v39
  v_cvt_pk_bf16_f32 v88, v32, v33
  v_cvt_pk_bf16_f32 v89, v34, v35
  v_cvt_pk_bf16_f32 v90, v36, v37
  v_cvt_pk_bf16_f32 v91, v38, v39
  v_exp_f32 v40, v40
  v_exp_f32 v41, v41
  v_mfma_f32_32x32x16_bf16 v[64:79], v[112:115], v[88:91], v[64:79]
  v_exp_f32 v42, v42
  v_exp_f32 v43, v43
  v_exp_f32 v44, v44
  v_exp_f32 v45, v45
  v_exp_f32 v46, v46
  v_exp_f32 v47, v47
  v_cvt_pk_bf16_f32 v92, v40, v41
  v_cvt_pk_bf16_f32 v93, v42, v43
  v_cvt_pk_bf16_f32 v94, v44, v45
  v_cvt_pk_bf16_f32 v95, v46, v47
  v_exp_f32 v16, v16
  v_exp_f32 v17, v17
  v_mfma_f32_32x32x16_bf16 v[64:79], v[116:119], v[92:95], v[64:79]
  v_exp_f32 v18, v18
  v_exp_f32 v19, v19
  v_exp_f32 v20, v20
  v_exp_f32 v21, v21
  v_mfma_f32_32x32x16_bf16 v[32:47], v[96:99], v[84:87], 0
  s_waitcnt lgkmcnt(0)
  buffer_load_dwordx4 v[176:179], v2, s[8:11], s32 offen offset:0
  ds_read_b128 v[96:99], v124 offset:36864
  s_mov_b64 exec, s[20:21]
  ds_read_b128 v[112:115], v125 offset:35840
  ds_read_b128 v[116:119], v125 offset:36352
  s_mov_b64 exec, -1
  v_exp_f32 v22, v22
  v_exp_f32 v23, v23
  v_cvt_pk_bf16_f32 v88, v16, v17
  v_cvt_pk_bf16_f32 v89, v18, v19
  v_cvt_pk_bf16_f32 v90, v20, v21
  v_cvt_pk_bf16_f32 v91, v22, v23
  v_exp_f32 v24, v24
  v_exp_f32 v25, v25
  v_mfma_f32_32x32x16_bf16 v[48:63], v[104:107], v[88:91], v[48:63]
  v_exp_f32 v26, v26
  v_exp_f32 v27, v27
  v_exp_f32 v28, v28
  v_exp_f32 v29, v29
  v_exp_f32 v30, v30
  v_exp_f32 v31, v31
  v_cvt_pk_bf16_f32 v92, v24, v25
  v_cvt_pk_bf16_f32 v93, v26, v27
  v_cvt_pk_bf16_f32 v94, v28, v29
  v_cvt_pk_bf16_f32 v95, v30, v31
  v_exp_f32 v32, v32
  v_exp_f32 v33, v33
  v_mfma_f32_32x32x16_bf16 v[48:63], v[108:111], v[92:95], v[48:63]
  v_exp_f32 v34, v34
  v_exp_f32 v35, v35
  v_exp_f32 v36, v36
  v_exp_f32 v37, v37
  v_mfma_f32_32x32x16_bf16 v[16:31], v[100:103], v[80:83], 0
  v_exp_f32 v38, v38
  v_exp_f32 v39, v39
  v_cvt_pk_bf16_f32 v88, v32, v33
  v_cvt_pk_bf16_f32 v89, v34, v35
  v_cvt_pk_bf16_f32 v90, v36, v37
  v_cvt_pk_bf16_f32 v91, v38, v39
  v_exp_f32 v40, v40
  v_exp_f32 v41, v41
  v_mfma_f32_32x32x16_bf16 v[64:79], v[104:107], v[88:91], v[64:79]
  v_exp_f32 v42, v42
  v_exp_f32 v43, v43
  v_exp_f32 v44, v44
  v_exp_f32 v45, v45
  v_exp_f32 v46, v46
  v_exp_f32 v47, v47
  v_cvt_pk_bf16_f32 v92, v40, v41
  v_cvt_pk_bf16_f32 v93, v42, v43
  v_cvt_pk_bf16_f32 v94, v44, v45
  v_cvt_pk_bf16_f32 v95, v46, v47
  v_exp_f32 v16, v16
  v_exp_f32 v17, v17
  v_mfma_f32_32x32x16_bf16 v[64:79], v[108:111], v[92:95], v[64:79]
  v_exp_f32 v18, v18
  v_exp_f32 v19, v19
  v_exp_f32 v20, v20
  v_exp_f32 v21, v21
  v_mfma_f32_32x32x16_bf16 v[32:47], v[100:103], v[84:87], 0
  s_waitcnt lgkmcnt(0)
  buffer_load_dwordx4 v[180:183], v2, s[8:11], s32 offen offset:1024
  ds_read_b128 v[100:103], v124 offset:37888
  s_mov_b64 exec, s[20:21]
  ds_read_b128 v[104:107], v125 offset:36864
  ds_read_b128 v[108:111], v125 offset:37376
  s_mov_b64 exec, -1
  v_exp_f32 v22, v22
  v_exp_f32 v23, v23
  v_cvt_pk_bf16_f32 v88, v16, v17
  v_cvt_pk_bf16_f32 v89, v18, v19
  v_cvt_pk_bf16_f32 v90, v20, v21
  v_cvt_pk_bf16_f32 v91, v22, v23
  v_exp_f32 v24, v24
  v_exp_f32 v25, v25
  v_mfma_f32_32x32x16_bf16 v[48:63], v[112:115], v[88:91], v[48:63]
  v_exp_f32 v26, v26
  v_exp_f32 v27, v27
  v_exp_f32 v28, v28
  v_exp_f32 v29, v29
  v_exp_f32 v30, v30
  v_exp_f32 v31, v31
  v_cvt_pk_bf16_f32 v92, v24, v25
  v_cvt_pk_bf16_f32 v93, v26, v27
  v_cvt_pk_bf16_f32 v94, v28, v29
  v_cvt_pk_bf16_f32 v95, v30, v31
  v_exp_f32 v32, v32
  v_exp_f32 v33, v33
  v_mfma_f32_32x32x16_bf16 v[48:63], v[116:119], v[92:95], v[48:63]
  v_exp_f32 v34, v34
  v_exp_f32 v35, v35
  v_exp_f32 v36, v36
  v_exp_f32 v37, v37
  v_mfma_f32_32x32x16_bf16 v[16:31], v[96:99], v[80:83], 0
  v_exp_f32 v38, v38
  v_exp_f32 v39, v39
  v_cvt_pk_bf16_f32 v88, v32, v33
  v_cvt_pk_bf16_f32 v89, v34, v35
  v_cvt_pk_bf16_f32 v90, v36, v37
  v_cvt_pk_bf16_f32 v91, v38, v39
  v_exp_f32 v40, v40
  v_exp_f32 v41, v41
  v_mfma_f32_32x32x16_bf16 v[64:79], v[112:115], v[88:91], v[64:79]
  v_exp_f32 v42, v42
  v_exp_f32 v43, v43
  v_exp_f32 v44, v44
  v_exp_f32 v45, v45
  v_exp_f32 v46, v46
  v_exp_f32 v47, v47
  v_cvt_pk_bf16_f32 v92, v40, v41
  v_cvt_pk_bf16_f32 v93, v42, v43
  v_cvt_pk_bf16_f32 v94, v44, v45
  v_cvt_pk_bf16_f32 v95, v46, v47
  v_exp_f32 v16, v16
  v_exp_f32 v17, v17
  v_mfma_f32_32x32x16_bf16 v[64:79], v[116:119], v[92:95], v[64:79]
  v_exp_f32 v18, v18
  v_exp_f32 v19, v19
  v_exp_f32 v20, v20
  v_exp_f32 v21, v21
  v_mfma_f32_32x32x16_bf16 v[32:47], v[96:99], v[84:87], 0
  s_waitcnt lgkmcnt(0)
  s_cmp_eq_u32 s38, 0
  s_cbranch_scc1 prio_58
  s_setprio 0
prio_58:
  buffer_load_dwordx4 v[184:187], v2, s[8:11], s32 offen offset:2048
  ds_read_b128 v[96:99], v124 offset:38912
  s_mov_b64 exec, s[20:21]
  ds_read_b128 v[112:115], v125 offset:37888
  ds_read_b128 v[116:119], v125 offset:38400
  s_mov_b64 exec, -1
  v_exp_f32 v22, v22
  v_exp_f32 v23, v23
  v_cvt_pk_bf16_f32 v88, v16, v17
  v_cvt_pk_bf16_f32 v89, v18, v19
  v_cvt_pk_bf16_f32 v90, v20, v21
  v_cvt_pk_bf16_f32 v91, v22, v23
  v_exp_f32 v24, v24
  v_exp_f32 v25, v25
  v_mfma_f32_32x32x16_bf16 v[48:63], v[104:107], v[88:91], v[48:63]
  v_exp_f32 v26, v26
  v_exp_f32 v27, v27
  v_exp_f32 v28, v28
  v_exp_f32 v29, v29
  v_exp_f32 v30, v30
  v_exp_f32 v31, v31
  v_cvt_pk_bf16_f32 v92, v24, v25
  v_cvt_pk_bf16_f32 v93, v26, v27
  v_cvt_pk_bf16_f32 v94, v28, v29
  v_cvt_pk_bf16_f32 v95, v30, v31
  v_exp_f32 v32, v32
  v_exp_f32 v33, v33
  v_mfma_f32_32x32x16_bf16 v[48:63], v[108:111], v[92:95], v[48:63]
  v_exp_f32 v34, v34
  v_exp_f32 v35, v35
  v_exp_f32 v36, v36
  v_exp_f32 v37, v37
  v_mfma_f32_32x32x16_bf16 v[16:31], v[100:103], v[80:83], 0
  v_exp_f32 v38, v38
  v_exp_f32 v39, v39
  v_cvt_pk_bf16_f32 v88, v32, v33
  v_cvt_pk_bf16_f32 v89, v34, v35
  v_cvt_pk_bf16_f32 v90, v36, v37
  v_cvt_pk_bf16_f32 v91, v38, v39
  v_exp_f32 v40, v40
  v_exp_f32 v41, v41
  v_mfma_f32_32x32x16_bf16 v[64:79], v[104:107], v[88:91], v[64:79]
  v_exp_f32 v42, v42
  v_exp_f32 v43, v43
  v_exp_f32 v44, v44
  v_exp_f32 v45, v45
  v_exp_f32 v46, v46
  v_exp_f32 v47, v47
  v_cvt_pk_bf16_f32 v92, v40, v41
  v_cvt_pk_bf16_f32 v93, v42, v43
  v_cvt_pk_bf16_f32 v94, v44, v45
  v_cvt_pk_bf16_f32 v95, v46, v47
  v_exp_f32 v16, v16
  v_exp_f32 v17, v17
  v_mfma_f32_32x32x16_bf16 v[64:79], v[108:111], v[92:95], v[64:79]
  v_exp_f32 v18, v18
  v_exp_f32 v19, v19
  v_exp_f32 v20, v20
  v_exp_f32 v21, v21
  v_mfma_f32_32x32x16_bf16 v[32:47], v[100:103], v[84:87], 0
  s_waitcnt lgkmcnt(0)
  buffer_load_dwordx4 v[188:191], v2, s[8:11], s32 offen offset:3072
  s_add_u32 s32, s32, 4096
  ds_read_b128 v[100:103], v124 offset:39936
  s_mov_b64 exec, s[20:21]
  ds_read_b128 v[104:107], v125 offset:38912
  ds_read_b128 v[108:111], v125 offset:39424
  s_mov_b64 exec, -1
  v_exp_f32 v22, v22
  v_exp_f32 v23, v23
  v_cvt_pk_bf16_f32 v88, v16, v17
  v_cvt_pk_bf16_f32 v89, v18, v19
  v_cvt_pk_bf16_f32 v90, v20, v21
  v_cvt_pk_bf16_f32 v91, v22, v23
  v_exp_f32 v24, v24
  v_exp_f32 v25, v25
  v_mfma_f32_32x32x16_bf16 v[48:63], v[112:115], v[88:91], v[48:63]
  v_exp_f32 v26, v26
  v_exp_f32 v27, v27
  v_exp_f32 v28, v28
  v_exp_f32 v29, v29
  v_exp_f32 v30, v30
  v_exp_f32 v31, v31
  v_cvt_pk_bf16_f32 v92, v24, v25
  v_cvt_pk_bf16_f32 v93, v26, v27
  v_cvt_pk_bf16_f32 v94, v28, v29
  v_cvt_pk_bf16_f32 v95, v30, v31
  v_exp_f32 v32, v32
  v_exp_f32 v33, v33
  v_mfma_f32_32x32x16_bf16 v[48:63], v[116:119], v[92:95], v[48:63]
  v_exp_f32 v34, v34
  v_exp_f32 v35, v35
  v_exp_f32 v36, v36
  v_exp_f32 v37, v37
  v_mfma_f32_32x32x16_bf16 v[16:31], v[96:99], v[80:83], 0
  v_exp_f32 v38, v38
  v_exp_f32 v39, v39
  v_cvt_pk_bf16_f32 v88, v32, v33
  v_cvt_pk_bf16_f32 v89, v34, v35
  v_cvt_pk_bf16_f32 v90, v36, v37
  v_cvt_pk_bf16_f32 v91, v38, v39
  v_exp_f32 v40, v40
  v_exp_f32 v41, v41
  v_mfma_f32_32x32x16_bf16 v[64:79], v[112:115], v[88:91], v[64:79]
  v_exp_f32 v42, v42
  v_exp_f32 v43, v43
  v_exp_f32 v44, v44
  v_exp_f32 v45, v45
  v_exp_f32 v46, v46
  v_exp_f32 v47, v47
  v_cvt_pk_bf16_f32 v92, v40, v41
  v_cvt_pk_bf16_f32 v93, v42, v43
  v_cvt_pk_bf16_f32 v94, v44, v45
  v_cvt_pk_bf16_f32 v95, v46, v47
  v_exp_f32 v16, v16
  v_exp_f32 v17, v17
  v_mfma_f32_32x32x16_bf16 v[64:79], v[116:119], v[92:95], v[64:79]
  v_exp_f32 v18, v18
  v_exp_f32 v19, v19
  v_exp_f32 v20, v20
  v_exp_f32 v21, v21
  v_mfma_f32_32x32x16_bf16 v[32:47], v[96:99], v[84:87], 0
  s_waitcnt lgkmcnt(0)
  s_cmp_eq_u32 s38, 0
  s_cbranch_scc1 prio_59
  s_setprio 1
prio_59:
  s_waitcnt vmcnt(8)
  s_barrier
  s_add_u32 s28, s48, 6
  s_and_b32 s28, s28, 7
  s_lshl_b32 s28, s28, 13
  s_add_u32 s28, s28, s27
  s_add_u32 m0, s26, 98304
  s_nop 0
  buffer_load_dwordx4 v2, s[8:11], s28 offen lds
  buffer_load_dwordx4 v2, s[8:11], s28 offen offset:1024 lds
  s_add_u32 m0, s26, 114688
  s_add_u32 s28, s28, 65536
  buffer_load_dwordx4 v2, s[8:11], s28 offen lds
  buffer_load_dwordx4 v2, s[8:11], s28 offen offset:1024 lds
  s_lshl_b32 s28, s14, 12
  s_add_u32 m0, s28, 0
  s_add_u32 s28, s33, 0
  buffer_load_dwordx4 v2, s[8:11], s28 offen offset:0 lds
  buffer_load_dwordx4 v2, s[8:11], s28 offen offset:1024 lds
  buffer_load_dwordx4 v2, s[8:11], s28 offen offset:2048 lds
  buffer_load_dwordx4 v2, s[8:11], s28 offen offset:3072 lds
  buffer_load_dwordx4 v[192:195], v2, s[8:11], s32 offen offset:0
  ds_read_b128 v[96:99], v126 offset:0
  s_mov_b64 exec, s[20:21]
  ds_read_b128 v[112:115], v125 offset:39936
  ds_read_b128 v[116:119], v125 offset:40448
  s_mov_b64 exec, -1
  v_exp_f32 v22, v22
  v_exp_f32 v23, v23
  v_cvt_pk_bf16_f32 v88, v16, v17
  v_cvt_pk_bf16_f32 v89, v18, v19
  v_cvt_pk_bf16_f32 v90, v20, v21
  v_cvt_pk_bf16_f32 v91, v22, v23
  v_exp_f32 v24, v24
  v_exp_f32 v25, v25
  v_mfma_f32_32x32x16_bf16 v[48:63], v[104:107], v[88:91], v[48:63]
  v_exp_f32 v26, v26
  v_exp_f32 v27, v27
  v_exp_f32 v28, v28
  v_exp_f32 v29, v29
  v_exp_f32 v30, v30
  v_exp_f32 v31, v31
  v_cvt_pk_bf16_f32 v92, v24, v25
  v_cvt_pk_bf16_f32 v93, v26, v27
  v_cvt_pk_bf16_f32 v94, v28, v29
  v_cvt_pk_bf16_f32 v95, v30, v31
  v_exp_f32 v32, v32
  v_exp_f32 v33, v33
  v_mfma_f32_32x32x16_bf16 v[48:63], v[108:111], v[92:95], v[48:63]
  v_exp_f32 v34, v34
  v_exp_f32 v35, v35
  v_exp_f32 v36, v36
  v_exp_f32 v37, v37
  v_mfma_f32_32x32x16_bf16 v[16:31], v[100:103], v[80:83], 0
  v_exp_f32 v38, v38
  v_exp_f32 v39, v39
  v_cvt_pk_bf16_f32 v88, v32, v33
  v_cvt_pk_bf16_f32 v89, v34, v35
  v_cvt_pk_bf16_f32 v90, v36, v37
  v_cvt_pk_bf16_f32 v91, v38, v39
  v_exp_f32 v40, v40
  v_exp_f32 v41, v41
  v_mfma_f32_32x32x16_bf16 v[64:79], v[104:107], v[88:91], v[64:79]
  v_exp_f32 v42, v42
  v_exp_f32 v43, v43
  v_exp_f32 v44, v44
  v_exp_f32 v45, v45
  v_exp_f32 v46, v46
  v_exp_f32 v47, v47
  v_cvt_pk_bf16_f32 v92, v40, v41
  v_cvt_pk_bf16_f32 v93, v42, v43
  v_cvt_pk_bf16_f32 v94, v44, v45
  v_cvt_pk_bf16_f32 v95, v46, v47
  v_exp_f32 v16, v16
  v_exp_f32 v17, v17
  v_mfma_f32_32x32x16_bf16 v[64:79], v[108:111], v[92:95], v[64:79]
  v_exp_f32 v18, v18
  v_exp_f32 v19, v19
  v_exp_f32 v20, v20
  v_exp_f32 v21, v21
  v_mfma_f32_32x32x16_bf16 v[32:47], v[100:103], v[84:87], 0
  s_waitcnt lgkmcnt(0)
  buffer_load_dwordx4 v[196:199], v2, s[8:11], s32 offen offset:1024
  ds_read_b128 v[100:103], v126 offset:1024
  s_mov_b64 exec, s[20:21]
  ds_read_b128 v[104:107], v127 offset:0
  ds_read_b128 v[108:111], v127 offset:512
  s_mov_b64 exec, -1
  v_exp_f32 v22, v22
  v_exp_f32 v23, v23
  v_cvt_pk_bf16_f32 v88, v16, v17
  v_cvt_pk_bf16_f32 v89, v18, v19
  v_cvt_pk_bf16_f32 v90, v20, v21
  v_cvt_pk_bf16_f32 v91, v22, v23
  v_exp_f32 v24, v24
  v_exp_f32 v25, v25
  v_mfma_f32_32x32x16_bf16 v[48:63], v[112:115], v[88:91], v[48:63]
  v_exp_f32 v26, v26
  v_exp_f32 v27, v27
  v_exp_f32 v28, v28
  v_exp_f32 v29, v29
  v_exp_f32 v30, v30
  v_exp_f32 v31, v31
  v_cvt_pk_bf16_f32 v92, v24, v25
  v_cvt_pk_bf16_f32 v93, v26, v27
  v_cvt_pk_bf16_f32 v94, v28, v29
  v_cvt_pk_bf16_f32 v95, v30, v31
  v_exp_f32 v32, v32
  v_exp_f32 v33, v33
  v_mfma_f32_32x32x16_bf16 v[48:63], v[116:119], v[92:95], v[48:63]
  v_exp_f32 v34, v34
  v_exp_f32 v35, v35
  v_exp_f32 v36, v36
  v_exp_f32 v37, v37
  v_mfma_f32_32x32x16_bf16 v[16:31], v[96:99], v[80:83], 0
  v_exp_f32 v38, v38
  v_exp_f32 v39, v39
  v_cvt_pk_bf16_f32 v88, v32, v33
  v_cvt_pk_bf16_f32 v89, v34, v35
  v_cvt_pk_bf16_f32 v90, v36, v37
  v_cvt_pk_bf16_f32 v91, v38, v39
  v_exp_f32 v40, v40
  v_exp_f32 v41, v41
  v_mfma_f32_32x32x16_bf16 v[64:79], v[112:115], v[88:91], v[64:79]
  v_exp_f32 v42, v42
  v_exp_f32 v43, v43
  v_exp_f32 v44, v44
  v_exp_f32 v45, v45
  v_exp_f32 v46, v46
  v_exp_f32 v47, v47
  v_cvt_pk_bf16_f32 v92, v40, v41
  v_cvt_pk_bf16_f32 v93, v42, v43
  v_cvt_pk_bf16_f32 v94, v44, v45
  v_cvt_pk_bf16_f32 v95, v46, v47
  v_exp_f32 v16, v16
  v_exp_f32 v17, v17
  v_mfma_f32_32x32x16_bf16 v[64:79], v[116:119], v[92:95], v[64:79]
  v_exp_f32 v18, v18
  v_exp_f32 v19, v19
  v_exp_f32 v20, v20
  v_exp_f32 v21, v21
  v_mfma_f32_32x32x16_bf16 v[32:47], v[96:99], v[84:87], 0
  s_waitcnt lgkmcnt(0)
  buffer_load_dwordx4 v[200:203], v2, s[8:11], s32 offen offset:2048
  ds_read_b128 v[96:99], v126 offset:2048
  s_mov_b64 exec, s[20:21]
  ds_read_b128 v[112:115], v127 offset:1024
  ds_read_b128 v[116:119], v127 offset:1536
  s_mov_b64 exec, -1
  v_exp_f32 v22, v22
  v_exp_f32 v23, v23
  v_cvt_pk_bf16_f32 v88, v16, v17
  v_cvt_pk_bf16_f32 v89, v18, v19
  v_cvt_pk_bf16_f32 v90, v20, v21
  v_cvt_pk_bf16_f32 v91, v22, v23
  v_exp_f32 v24, v24
  v_exp_f32 v25, v25
  v_mfma_f32_32x32x16_bf16 v[48:63], v[104:107], v[88:91], v[48:63]
  v_exp_f32 v26, v26
  v_exp_f32 v27, v27
  v_exp_f32 v28, v28
  v_exp_f32 v29, v29
  v_exp_f32 v30, v30
  v_exp_f32 v31, v31
  v_cvt_pk_bf16_f32 v92, v24, v25
  v_cvt_pk_bf16_f32 v93, v26, v27
  v_cvt_pk_bf16_f32 v94, v28, v29
  v_cvt_pk_bf16_f32 v95, v30, v31
  v_exp_f32 v32, v32
  v_exp_f32 v33, v33
  v_mfma_f32_32x32x16_bf16 v[48:63], v[108:111], v[92:95], v[48:63]
  v_exp_f32 v34, v34
  v_exp_f32 v35, v35
  v_exp_f32 v36, v36
  v_exp_f32 v37, v37
  v_mfma_f32_32x32x16_bf16 v[16:31], v[100:103], v[80:83], 0
  v_exp_f32 v38, v38
  v_exp_f32 v39, v39
  v_cvt_pk_bf16_f32 v88, v32, v33
  v_cvt_pk_bf16_f32 v89, v34, v35
  v_cvt_pk_bf16_f32 v90, v36, v37
  v_cvt_pk_bf16_f32 v91, v38, v39
  v_exp_f32 v40, v40
  v_exp_f32 v41, v41
  v_mfma_f32_32x32x16_bf16 v[64:79], v[104:107], v[88:91], v[64:79]
  v_exp_f32 v42, v42
  v_exp_f32 v43, v43
  v_exp_f32 v44, v44
  v_exp_f32 v45, v45
  v_exp_f32 v46, v46
  v_exp_f32 v47, v47
  v_cvt_pk_bf16_f32 v92, v40, v41
  v_cvt_pk_bf16_f32 v93, v42, v43
  v_cvt_pk_bf16_f32 v94, v44, v45
  v_cvt_pk_bf16_f32 v95, v46, v47
  v_exp_f32 v16, v16
  v_exp_f32 v17, v17
  v_mfma_f32_32x32x16_bf16 v[64:79], v[108:111], v[92:95], v[64:79]
  v_exp_f32 v18, v18
  v_exp_f32 v19, v19
  v_exp_f32 v20, v20
  v_exp_f32 v21, v21
  v_mfma_f32_32x32x16_bf16 v[32:47], v[100:103], v[84:87], 0
  s_waitcnt lgkmcnt(0)
  buffer_load_dwordx4 v[204:207], v2, s[8:11], s32 offen offset:3072
  s_add_u32 s32, s32, 4096
  ds_read_b128 v[100:103], v126 offset:3072
  s_mov_b64 exec, s[20:21]
  ds_read_b128 v[104:107], v127 offset:2048
  ds_read_b128 v[108:111], v127 offset:2560
  s_mov_b64 exec, -1
  v_exp_f32 v22, v22
  v_exp_f32 v23, v23
  v_cvt_pk_bf16_f32 v88, v16, v17
  v_cvt_pk_bf16_f32 v89, v18, v19
  v_cvt_pk_bf16_f32 v90, v20, v21
  v_cvt_pk_bf16_f32 v91, v22, v23
  v_exp_f32 v24, v24
  v_exp_f32 v25, v25
  v_mfma_f32_32x32x16_bf16 v[48:63], v[112:115], v[88:91], v[48:63]
  v_exp_f32 v26, v26
  v_exp_f32 v27, v27
  v_exp_f32 v28, v28
  v_exp_f32 v29, v29
  v_exp_f32 v30, v30
  v_exp_f32 v31, v31
  v_cvt_pk_bf16_f32 v92, v24, v25
  v_cvt_pk_bf16_f32 v93, v26, v27
  v_cvt_pk_bf16_f32 v94, v28, v29
  v_cvt_pk_bf16_f32 v95, v30, v31
  v_exp_f32 v32, v32
  v_exp_f32 v33, v33
  v_mfma_f32_32x32x16_bf16 v[48:63], v[116:119], v[92:95], v[48:63]
  v_exp_f32 v34, v34
  v_exp_f32 v35, v35
  v_exp_f32 v36, v36
  v_exp_f32 v37, v37
  v_mfma_f32_32x32x16_bf16 v[16:31], v[96:99], v[80:83], 0
  v_exp_f32 v38, v38
  v_exp_f32 v39, v39
  v_cvt_pk_bf16_f32 v88, v32, v33
  v_cvt_pk_bf16_f32 v89, v34, v35
  v_cvt_pk_bf16_f32 v90, v36, v37
  v_cvt_pk_bf16_f32 v91, v38, v39
  v_exp_f32 v40, v40
  v_exp_f32 v41, v41
  v_mfma_f32_32x32x16_bf16 v[64:79], v[112:115], v[88:91], v[64:79]
  v_exp_f32 v42, v42
  v_exp_f32 v43, v43
  v_exp_f32 v44, v44
  v_exp_f32 v45, v45
  v_exp_f32 v46, v46
  v_exp_f32 v47, v47
  v_cvt_pk_bf16_f32 v92, v40, v41
  v_cvt_pk_bf16_f32 v93, v42, v43
  v_cvt_pk_bf16_f32 v94, v44, v45
  v_cvt_pk_bf16_f32 v95, v46, v47
  v_exp_f32 v16, v16
  v_exp_f32 v17, v17
  v_mfma_f32_32x32x16_bf16 v[64:79], v[116:119], v[92:95], v[64:79]
  v_exp_f32 v18, v18
  v_exp_f32 v19, v19
  v_exp_f32 v20, v20
  v_exp_f32 v21, v21
  v_mfma_f32_32x32x16_bf16 v[32:47], v[96:99], v[84:87], 0
  s_waitcnt lgkmcnt(0)
  buffer_load_dwordx4 v[208:211], v2, s[8:11], s32 offen offset:0
  ds_read_b128 v[96:99], v126 offset:4096
  s_mov_b64 exec, s[20:21]
  ds_read_b128 v[112:115], v127 offset:3072
  ds_read_b128 v[116:119], v127 offset:3584
  s_mov_b64 exec, -1
  v_exp_f32 v22, v22
  v_exp_f32 v23, v23
  v_cvt_pk_bf16_f32 v88, v16, v17
  v_cvt_pk_bf16_f32 v89, v18, v19
  v_cvt_pk_bf16_f32 v90, v20, v21
  v_cvt_pk_bf16_f32 v91, v22, v23
  v_exp_f32 v24, v24
  v_exp_f32 v25, v25
  v_mfma_f32_32x32x16_bf16 v[48:63], v[104:107], v[88:91], v[48:63]
  v_exp_f32 v26, v26
  v_exp_f32 v27, v27
  v_exp_f32 v28, v28
  v_exp_f32 v29, v29
  v_exp_f32 v30, v30
  v_exp_f32 v31, v31
  v_cvt_pk_bf16_f32 v92, v24, v25
  v_cvt_pk_bf16_f32 v93, v26, v27
  v_cvt_pk_bf16_f32 v94, v28, v29
  v_cvt_pk_bf16_f32 v95, v30, v31
  v_exp_f32 v32, v32
  v_exp_f32 v33, v33
  v_mfma_f32_32x32x16_bf16 v[48:63], v[108:111], v[92:95], v[48:63]
  v_exp_f32 v34, v34
  v_exp_f32 v35, v35
  v_exp_f32 v36, v36
  v_exp_f32 v37, v37
  v_mfma_f32_32x32x16_bf16 v[16:31], v[100:103], v[80:83], 0
  v_exp_f32 v38, v38
  v_exp_f32 v39, v39
  v_cvt_pk_bf16_f32 v88, v32, v33
  v_cvt_pk_bf16_f32 v89, v34, v35
  v_cvt_pk_bf16_f32 v90, v36, v37
  v_cvt_pk_bf16_f32 v91, v38, v39
  v_exp_f32 v40, v40
  v_exp_f32 v41, v41
  v_mfma_f32_32x32x16_bf16 v[64:79], v[104:107], v[88:91], v[64:79]
  v_exp_f32 v42, v42
  v_exp_f32 v43, v43
  v_exp_f32 v44, v44
  v_exp_f32 v45, v45
  v_exp_f32 v46, v46
  v_exp_f32 v47, v47
  v_cvt_pk_bf16_f32 v92, v40, v41
  v_cvt_pk_bf16_f32 v93, v42, v43
  v_cvt_pk_bf16_f32 v94, v44, v45
  v_cvt_pk_bf16_f32 v95, v46, v47
  v_exp_f32 v16, v16
  v_exp_f32 v17, v17
  v_mfma_f32_32x32x16_bf16 v[64:79], v[108:111], v[92:95], v[64:79]
  v_exp_f32 v18, v18
  v_exp_f32 v19, v19
  v_exp_f32 v20, v20
  v_exp_f32 v21, v21
  v_mfma_f32_32x32x16_bf16 v[32:47], v[100:103], v[84:87], 0
  s_waitcnt lgkmcnt(0)
  buffer_load_dwordx4 v[212:215], v2, s[8:11], s32 offen offset:1024
  ds_read_b128 v[100:103], v126 offset:5120
  s_mov_b64 exec, s[20:21]
  ds_read_b128 v[104:107], v127 offset:4096
  ds_read_b128 v[108:111], v127 offset:4608
  s_mov_b64 exec, -1
  v_exp_f32 v22, v22
  v_exp_f32 v23, v23
  v_cvt_pk_bf16_f32 v88, v16, v17
  v_cvt_pk_bf16_f32 v89, v18, v19
  v_cvt_pk_bf16_f32 v90, v20, v21
  v_cvt_pk_bf16_f32 v91, v22, v23
  v_exp_f32 v24, v24
  v_exp_f32 v25, v25
  v_mfma_f32_32x32x16_bf16 v[48:63], v[112:115], v[88:91], v[48:63]
  v_exp_f32 v26, v26
  v_exp_f32 v27, v27
  v_exp_f32 v28, v28
  v_exp_f32 v29, v29
  v_exp_f32 v30, v30
  v_exp_f32 v31, v31
  v_cvt_pk_bf16_f32 v92, v24, v25
  v_cvt_pk_bf16_f32 v93, v26, v27
  v_cvt_pk_bf16_f32 v94, v28, v29
  v_cvt_pk_bf16_f32 v95, v30, v31
  v_exp_f32 v32, v32
  v_exp_f32 v33, v33
  v_mfma_f32_32x32x16_bf16 v[48:63], v[116:119], v[92:95], v[48:63]
  v_exp_f32 v34, v34
  v_exp_f32 v35, v35
  v_exp_f32 v36, v36
  v_exp_f32 v37, v37
  v_mfma_f32_32x32x16_bf16 v[16:31], v[96:99], v[80:83], 0
  v_exp_f32 v38, v38
  v_exp_f32 v39, v39
  v_cvt_pk_bf16_f32 v88, v32, v33
  v_cvt_pk_bf16_f32 v89, v34, v35
  v_cvt_pk_bf16_f32 v90, v36, v37
  v_cvt_pk_bf16_f32 v91, v38, v39
  v_exp_f32 v40, v40
  v_exp_f32 v41, v41
  v_mfma_f32_32x32x16_bf16 v[64:79], v[112:115], v[88:91], v[64:79]
  v_exp_f32 v42, v42
  v_exp_f32 v43, v43
  v_exp_f32 v44, v44
  v_exp_f32 v45, v45
  v_exp_f32 v46, v46
  v_exp_f32 v47, v47
  v_cvt_pk_bf16_f32 v92, v40, v41
  v_cvt_pk_bf16_f32 v93, v42, v43
  v_cvt_pk_bf16_f32 v94, v44, v45
  v_cvt_pk_bf16_f32 v95, v46, v47
  v_exp_f32 v16, v16
  v_exp_f32 v17, v17
  v_mfma_f32_32x32x16_bf16 v[64:79], v[116:119], v[92:95], v[64:79]
  v_exp_f32 v18, v18
  v_exp_f32 v19, v19
  v_exp_f32 v20, v20
  v_exp_f32 v21, v21
  v_mfma_f32_32x32x16_bf16 v[32:47], v[96:99], v[84:87], 0
  s_waitcnt lgkmcnt(0)
  s_cmp_eq_u32 s38, 0
  s_cbranch_scc1 prio_60
  s_setprio 0
prio_60:
  buffer_load_dwordx4 v[216:219], v2, s[8:11], s32 offen offset:2048
  ds_read_b128 v[96:99], v126 offset:6144
  s_mov_b64 exec, s[20:21]
  ds_read_b128 v[112:115], v127 offset:5120
  ds_read_b128 v[116:119], v127 offset:5632
  s_mov_b64 exec, -1
  v_exp_f32 v22, v22
  v_exp_f32 v23, v23
  v_cvt_pk_bf16_f32 v88, v16, v17
  v_cvt_pk_bf16_f32 v89, v18, v19
  v_cvt_pk_bf16_f32 v90, v20, v21
  v_cvt_pk_bf16_f32 v91, v22, v23
  v_exp_f32 v24, v24
  v_exp_f32 v25, v25
  v_mfma_f32_32x32x16_bf16 v[48:63], v[104:107], v[88:91], v[48:63]
  v_exp_f32 v26, v26
  v_exp_f32 v27, v27
  v_exp_f32 v28, v28
  v_exp_f32 v29, v29
  v_exp_f32 v30, v30
  v_exp_f32 v31, v31
  v_cvt_pk_bf16_f32 v92, v24, v25
  v_cvt_pk_bf16_f32 v93, v26, v27
  v_cvt_pk_bf16_f32 v94, v28, v29
  v_cvt_pk_bf16_f32 v95, v30, v31
  v_exp_f32 v32, v32
  v_exp_f32 v33, v33
  v_mfma_f32_32x32x16_bf16 v[48:63], v[108:111], v[92:95], v[48:63]
  v_exp_f32 v34, v34
  v_exp_f32 v35, v35
  v_exp_f32 v36, v36
  v_exp_f32 v37, v37
  v_mfma_f32_32x32x16_bf16 v[16:31], v[100:103], v[80:83], 0
  v_exp_f32 v38, v38
  v_exp_f32 v39, v39
  v_cvt_pk_bf16_f32 v88, v32, v33
  v_cvt_pk_bf16_f32 v89, v34, v35
  v_cvt_pk_bf16_f32 v90, v36, v37
  v_cvt_pk_bf16_f32 v91, v38, v39
  v_exp_f32 v40, v40
  v_exp_f32 v41, v41
  v_mfma_f32_32x32x16_bf16 v[64:79], v[104:107], v[88:91], v[64:79]
  v_exp_f32 v42, v42
  v_exp_f32 v43, v43
  v_exp_f32 v44, v44
  v_exp_f32 v45, v45
  v_exp_f32 v46, v46
  v_exp_f32 v47, v47
  v_cvt_pk_bf16_f32 v92, v40, v41
  v_cvt_pk_bf16_f32 v93, v42, v43
  v_cvt_pk_bf16_f32 v94, v44, v45
  v_cvt_pk_bf16_f32 v95, v46, v47
  v_exp_f32 v16, v16
  v_exp_f32 v17, v17
  v_mfma_f32_32x32x16_bf16 v[64:79], v[108:111], v[92:95], v[64:79]
  v_exp_f32 v18, v18
  v_exp_f32 v19, v19
  v_exp_f32 v20, v20
  v_exp_f32 v21, v21
  v_mfma_f32_32x32x16_bf16 v[32:47], v[100:103], v[84:87], 0
  s_waitcnt lgkmcnt(0)
  buffer_load_dwordx4 v[220:223], v2, s[8:11], s32 offen offset:3072
  s_add_u32 s32, s32, 4096
  ds_read_b128 v[100:103], v126 offset:7168
  s_mov_b64 exec, s[20:21]
  ds_read_b128 v[104:107], v127 offset:6144
  ds_read_b128 v[108:111], v127 offset:6656
  s_mov_b64 exec, -1
  v_exp_f32 v22, v22
  v_exp_f32 v23, v23
  v_cvt_pk_bf16_f32 v88, v16, v17
  v_cvt_pk_bf16_f32 v89, v18, v19
  v_cvt_pk_bf16_f32 v90, v20, v21
  v_cvt_pk_bf16_f32 v91, v22, v23
  v_exp_f32 v24, v24
  v_exp_f32 v25, v25
  v_mfma_f32_32x32x16_bf16 v[48:63], v[112:115], v[88:91], v[48:63]
  v_exp_f32 v26, v26
  v_exp_f32 v27, v27
  v_exp_f32 v28, v28
  v_exp_f32 v29, v29
  v_exp_f32 v30, v30
  v_exp_f32 v31, v31
  v_cvt_pk_bf16_f32 v92, v24, v25
  v_cvt_pk_bf16_f32 v93, v26, v27
  v_cvt_pk_bf16_f32 v94, v28, v29
  v_cvt_pk_bf16_f32 v95, v30, v31
  v_exp_f32 v32, v32
  v_exp_f32 v33, v33
  v_mfma_f32_32x32x16_bf16 v[48:63], v[116:119], v[92:95], v[48:63]
  v_exp_f32 v34, v34
  v_exp_f32 v35, v35
  v_exp_f32 v36, v36
  v_exp_f32 v37, v37
  v_mfma_f32_32x32x16_bf16 v[16:31], v[96:99], v[80:83], 0
  v_exp_f32 v38, v38
  v_exp_f32 v39, v39
  v_cvt_pk_bf16_f32 v88, v32, v33
  v_cvt_pk_bf16_f32 v89, v34, v35
  v_cvt_pk_bf16_f32 v90, v36, v37
  v_cvt_pk_bf16_f32 v91, v38, v39
  v_exp_f32 v40, v40
  v_exp_f32 v41, v41
  v_mfma_f32_32x32x16_bf16 v[64:79], v[112:115], v[88:91], v[64:79]
  v_exp_f32 v42, v42
  v_exp_f32 v43, v43
  v_exp_f32 v44, v44
  v_exp_f32 v45, v45
  v_exp_f32 v46, v46
  v_exp_f32 v47, v47
  v_cvt_pk_bf16_f32 v92, v40, v41
  v_cvt_pk_bf16_f32 v93, v42, v43
  v_cvt_pk_bf16_f32 v94, v44, v45
  v_cvt_pk_bf16_f32 v95, v46, v47
  v_exp_f32 v16, v16
  v_exp_f32 v17, v17
  v_mfma_f32_32x32x16_bf16 v[64:79], v[116:119], v[92:95], v[64:79]
  v_exp_f32 v18, v18
  v_exp_f32 v19, v19
  v_exp_f32 v20, v20
  v_exp_f32 v21, v21
  v_mfma_f32_32x32x16_bf16 v[32:47], v[96:99], v[84:87], 0
  s_waitcnt lgkmcnt(0)
  s_cmp_eq_u32 s38, 0
  s_cbranch_scc1 prio_61
  s_setprio 1
prio_61:
  s_waitcnt vmcnt(12)
  s_barrier
  s_lshl_b32 s28, s14, 12
  s_add_u32 m0, s28, 32768
  s_add_u32 s28, s33, 57344
  buffer_load_dwordx4 v2, s[8:11], s28 offen offset:0 lds
  buffer_load_dwordx4 v2, s[8:11], s28 offen offset:1024 lds
  buffer_load_dwordx4 v2, s[8:11], s28 offen offset:2048 lds
  buffer_load_dwordx4 v2, s[8:11], s28 offen offset:3072 lds
  buffer_load_dwordx4 v[224:227], v2, s[8:11], s32 offen offset:0
  ds_read_b128 v[96:99], v126 offset:32768
  s_mov_b64 exec, s[20:21]
  ds_read_b128 v[112:115], v127 offset:7168
  ds_read_b128 v[116:119], v127 offset:7680
  s_mov_b64 exec, -1
  v_exp_f32 v22, v22
  v_exp_f32 v23, v23
  v_cvt_pk_bf16_f32 v88, v16, v17
  v_cvt_pk_bf16_f32 v89, v18, v19
  v_cvt_pk_bf16_f32 v90, v20, v21
  v_cvt_pk_bf16_f32 v91, v22, v23
  v_exp_f32 v24, v24
  v_exp_f32 v25, v25
  v_mfma_f32_32x32x16_bf16 v[48:63], v[104:107], v[88:91], v[48:63]
  v_exp_f32 v26, v26
  v_exp_f32 v27, v27
  v_exp_f32 v28, v28
  v_exp_f32 v29, v29
  v_exp_f32 v30, v30
  v_exp_f32 v31, v31
  v_cvt_pk_bf16_f32 v92, v24, v25
  v_cvt_pk_bf16_f32 v93, v26, v27
  v_cvt_pk_bf16_f32 v94, v28, v29
  v_cvt_pk_bf16_f32 v95, v30, v31
  v_exp_f32 v32, v32
  v_exp_f32 v33, v33
  v_mfma_f32_32x32x16_bf16 v[48:63], v[108:111], v[92:95], v[48:63]
  v_exp_f32 v34, v34
  v_exp_f32 v35, v35
  v_exp_f32 v36, v36
  v_exp_f32 v37, v37
  v_mfma_f32_32x32x16_bf16 v[16:31], v[100:103], v[80:83], 0
  v_exp_f32 v38, v38
  v_exp_f32 v39, v39
  v_cvt_pk_bf16_f32 v88, v32, v33
  v_cvt_pk_bf16_f32 v89, v34, v35
  v_cvt_pk_bf16_f32 v90, v36, v37
  v_cvt_pk_bf16_f32 v91, v38, v39
  v_exp_f32 v40, v40
  v_exp_f32 v41, v41
  v_mfma_f32_32x32x16_bf16 v[64:79], v[104:107], v[88:91], v[64:79]
  v_exp_f32 v42, v42
  v_exp_f32 v43, v43
  v_exp_f32 v44, v44
  v_exp_f32 v45, v45
  v_exp_f32 v46, v46
  v_exp_f32 v47, v47
  v_cvt_pk_bf16_f32 v92, v40, v41
  v_cvt_pk_bf16_f32 v93, v42, v43
  v_cvt_pk_bf16_f32 v94, v44, v45
  v_cvt_pk_bf16_f32 v95, v46, v47
  v_exp_f32 v16, v16
  v_exp_f32 v17, v17
  v_mfma_f32_32x32x16_bf16 v[64:79], v[108:111], v[92:95], v[64:79]
  v_exp_f32 v18, v18
  v_exp_f32 v19, v19
  v_exp_f32 v20, v20
  v_exp_f32 v21, v21
  v_mfma_f32_32x32x16_bf16 v[32:47], v[100:103], v[84:87], 0
  s_waitcnt lgkmcnt(0)
  buffer_load_dwordx4 v[228:231], v2, s[8:11], s32 offen offset:1024
  ds_read_b128 v[100:103], v126 offset:33792
  s_mov_b64 exec, s[20:21]
  ds_read_b128 v[104:107], v127 offset:32768
  ds_read_b128 v[108:111], v127 offset:33280
  s_mov_b64 exec, -1
  v_exp_f32 v22, v22
  v_exp_f32 v23, v23
  v_cvt_pk_bf16_f32 v88, v16, v17
  v_cvt_pk_bf16_f32 v89, v18, v19
  v_cvt_pk_bf16_f32 v90, v20, v21
  v_cvt_pk_bf16_f32 v91, v22, v23
  v_exp_f32 v24, v24
  v_exp_f32 v25, v25
  v_mfma_f32_32x32x16_bf16 v[48:63], v[112:115], v[88:91], v[48:63]
  v_exp_f32 v26, v26
  v_exp_f32 v27, v27
  v_exp_f32 v28, v28
  v_exp_f32 v29, v29
  v_exp_f32 v30, v30
  v_exp_f32 v31, v31
  v_cvt_pk_bf16_f32 v92, v24, v25
  v_cvt_pk_bf16_f32 v93, v26, v27
  v_cvt_pk_bf16_f32 v94, v28, v29
  v_cvt_pk_bf16_f32 v95, v30, v31
  v_exp_f32 v32, v32
  v_exp_f32 v33, v33
  v_mfma_f32_32x32x16_bf16 v[48:63], v[116:119], v[92:95], v[48:63]
  v_exp_f32 v34, v34
  v_exp_f32 v35, v35
  v_exp_f32 v36, v36
  v_exp_f32 v37, v37
  v_mfma_f32_32x32x16_bf16 v[16:31], v[96:99], v[80:83], 0
  v_exp_f32 v38, v38
  v_exp_f32 v39, v39
  v_cvt_pk_bf16_f32 v88, v32, v33
  v_cvt_pk_bf16_f32 v89, v34, v35
  v_cvt_pk_bf16_f32 v90, v36, v37
  v_cvt_pk_bf16_f32 v91, v38, v39
  v_exp_f32 v40, v40
  v_exp_f32 v41, v41
  v_mfma_f32_32x32x16_bf16 v[64:79], v[112:115], v[88:91], v[64:79]
  v_exp_f32 v42, v42
  v_exp_f32 v43, v43
  v_exp_f32 v44, v44
  v_exp_f32 v45, v45
  v_exp_f32 v46, v46
  v_exp_f32 v47, v47
  v_cvt_pk_bf16_f32 v92, v40, v41
  v_cvt_pk_bf16_f32 v93, v42, v43
  v_cvt_pk_bf16_f32 v94, v44, v45
  v_cvt_pk_bf16_f32 v95, v46, v47
  v_exp_f32 v16, v16
  v_exp_f32 v17, v17
  v_mfma_f32_32x32x16_bf16 v[64:79], v[116:119], v[92:95], v[64:79]
  v_exp_f32 v18, v18
  v_exp_f32 v19, v19
  v_exp_f32 v20, v20
  v_exp_f32 v21, v21
  v_mfma_f32_32x32x16_bf16 v[32:47], v[96:99], v[84:87], 0
  s_waitcnt lgkmcnt(0)
  buffer_load_dwordx4 v[232:235], v2, s[8:11], s32 offen offset:2048
  ds_read_b128 v[96:99], v126 offset:34816
  s_mov_b64 exec, s[20:21]
  ds_read_b128 v[112:115], v127 offset:33792
  ds_read_b128 v[116:119], v127 offset:34304
  s_mov_b64 exec, -1
  v_exp_f32 v22, v22
  v_exp_f32 v23, v23
  v_cvt_pk_bf16_f32 v88, v16, v17
  v_cvt_pk_bf16_f32 v89, v18, v19
  v_cvt_pk_bf16_f32 v90, v20, v21
  v_cvt_pk_bf16_f32 v91, v22, v23
  v_exp_f32 v24, v24
  v_exp_f32 v25, v25
  v_mfma_f32_32x32x16_bf16 v[48:63], v[104:107], v[88:91], v[48:63]
  v_exp_f32 v26, v26
  v_exp_f32 v27, v27
  v_exp_f32 v28, v28
  v_exp_f32 v29, v29
  v_exp_f32 v30, v30
  v_exp_f32 v31, v31
  v_cvt_pk_bf16_f32 v92, v24, v25
  v_cvt_pk_bf16_f32 v93, v26, v27
  v_cvt_pk_bf16_f32 v94, v28, v29
  v_cvt_pk_bf16_f32 v95, v30, v31
  v_exp_f32 v32, v32
  v_exp_f32 v33, v33
  v_mfma_f32_32x32x16_bf16 v[48:63], v[108:111], v[92:95], v[48:63]
  v_exp_f32 v34, v34
  v_exp_f32 v35, v35
  v_exp_f32 v36, v36
  v_exp_f32 v37, v37
  v_mfma_f32_32x32x16_bf16 v[16:31], v[100:103], v[80:83], 0
  v_exp_f32 v38, v38
  v_exp_f32 v39, v39
  v_cvt_pk_bf16_f32 v88, v32, v33
  v_cvt_pk_bf16_f32 v89, v34, v35
  v_cvt_pk_bf16_f32 v90, v36, v37
  v_cvt_pk_bf16_f32 v91, v38, v39
  v_exp_f32 v40, v40
  v_exp_f32 v41, v41
  v_mfma_f32_32x32x16_bf16 v[64:79], v[104:107], v[88:91], v[64:79]
  v_exp_f32 v42, v42
  v_exp_f32 v43, v43
  v_exp_f32 v44, v44
  v_exp_f32 v45, v45
  v_exp_f32 v46, v46
  v_exp_f32 v47, v47
  v_cvt_pk_bf16_f32 v92, v40, v41
  v_cvt_pk_bf16_f32 v93, v42, v43
  v_cvt_pk_bf16_f32 v94, v44, v45
  v_cvt_pk_bf16_f32 v95, v46, v47
  v_exp_f32 v16, v16
  v_exp_f32 v17, v17
  v_mfma_f32_32x32x16_bf16 v[64:79], v[108:111], v[92:95], v[64:79]
  v_exp_f32 v18, v18
  v_exp_f32 v19, v19
  v_exp_f32 v20, v20
  v_exp_f32 v21, v21
  v_mfma_f32_32x32x16_bf16 v[32:47], v[100:103], v[84:87], 0
  s_waitcnt lgkmcnt(0)
  buffer_load_dwordx4 v[236:239], v2, s[8:11], s32 offen offset:3072
  s_add_u32 s32, s32, 4096
  ds_read_b128 v[100:103], v126 offset:35840
  s_mov_b64 exec, s[20:21]
  ds_read_b128 v[104:107], v127 offset:34816
  ds_read_b128 v[108:111], v127 offset:35328
  s_mov_b64 exec, -1
  v_exp_f32 v22, v22
  v_exp_f32 v23, v23
  v_cvt_pk_bf16_f32 v88, v16, v17
  v_cvt_pk_bf16_f32 v89, v18, v19
  v_cvt_pk_bf16_f32 v90, v20, v21
  v_cvt_pk_bf16_f32 v91, v22, v23
  v_exp_f32 v24, v24
  v_exp_f32 v25, v25
  v_mfma_f32_32x32x16_bf16 v[48:63], v[112:115], v[88:91], v[48:63]
  v_exp_f32 v26, v26
  v_exp_f32 v27, v27
  v_exp_f32 v28, v28
  v_exp_f32 v29, v29
  v_exp_f32 v30, v30
  v_exp_f32 v31, v31
  v_cvt_pk_bf16_f32 v92, v24, v25
  v_cvt_pk_bf16_f32 v93, v26, v27
  v_cvt_pk_bf16_f32 v94, v28, v29
  v_cvt_pk_bf16_f32 v95, v30, v31
  v_exp_f32 v32, v32
  v_exp_f32 v33, v33
  v_mfma_f32_32x32x16_bf16 v[48:63], v[116:119], v[92:95], v[48:63]
  v_exp_f32 v34, v34
  v_exp_f32 v35, v35
  v_exp_f32 v36, v36
  v_exp_f32 v37, v37
  v_mfma_f32_32x32x16_bf16 v[16:31], v[96:99], v[80:83], 0
  v_exp_f32 v38, v38
  v_exp_f32 v39, v39
  v_cvt_pk_bf16_f32 v88, v32, v33
  v_cvt_pk_bf16_f32 v89, v34, v35
  v_cvt_pk_bf16_f32 v90, v36, v37
  v_cvt_pk_bf16_f32 v91, v38, v39
  v_exp_f32 v40, v40
  v_exp_f32 v41, v41
  v_mfma_f32_32x32x16_bf16 v[64:79], v[112:115], v[88:91], v[64:79]
  v_exp_f32 v42, v42
  v_exp_f32 v43, v43
  v_exp_f32 v44, v44
  v_exp_f32 v45, v45
  v_exp_f32 v46, v46
  v_exp_f32 v47, v47
  v_cvt_pk_bf16_f32 v92, v40, v41
  v_cvt_pk_bf16_f32 v93, v42, v43
  v_cvt_pk_bf16_f32 v94, v44, v45
  v_cvt_pk_bf16_f32 v95, v46, v47
  v_exp_f32 v16, v16
  v_exp_f32 v17, v17
  v_mfma_f32_32x32x16_bf16 v[64:79], v[116:119], v[92:95], v[64:79]
  v_exp_f32 v18, v18
  v_exp_f32 v19, v19
  v_exp_f32 v20, v20
  v_exp_f32 v21, v21
  v_mfma_f32_32x32x16_bf16 v[32:47], v[96:99], v[84:87], 0
  s_waitcnt lgkmcnt(0)
  buffer_load_dwordx4 v[240:243], v2, s[8:11], s32 offen offset:0
  buffer_load_dwordx4 v[128:131], v2, s[8:11], s46 offen offset:0
  buffer_load_dwordx4 v[132:135], v2, s[8:11], s46 offen offset:1024
  ds_read_b128 v[96:99], v126 offset:36864
  s_mov_b64 exec, s[20:21]
  ds_read_b128 v[112:115], v127 offset:35840
  ds_read_b128 v[116:119], v127 offset:36352
  s_mov_b64 exec, -1
  v_exp_f32 v22, v22
  v_exp_f32 v23, v23
  v_cvt_pk_bf16_f32 v88, v16, v17
  v_cvt_pk_bf16_f32 v89, v18, v19
  v_cvt_pk_bf16_f32 v90, v20, v21
  v_cvt_pk_bf16_f32 v91, v22, v23
  v_exp_f32 v24, v24
  v_exp_f32 v25, v25
  v_mfma_f32_32x32x16_bf16 v[48:63], v[104:107], v[88:91], v[48:63]
  v_exp_f32 v26, v26
  v_exp_f32 v27, v27
  v_exp_f32 v28, v28
  v_exp_f32 v29, v29
  v_exp_f32 v30, v30
  v_exp_f32 v31, v31
  v_cvt_pk_bf16_f32 v92, v24, v25
  v_cvt_pk_bf16_f32 v93, v26, v27
  v_cvt_pk_bf16_f32 v94, v28, v29
  v_cvt_pk_bf16_f32 v95, v30, v31
  v_exp_f32 v32, v32
  v_exp_f32 v33, v33
  v_mfma_f32_32x32x16_bf16 v[48:63], v[108:111], v[92:95], v[48:63]
  v_exp_f32 v34, v34
  v_exp_f32 v35, v35
  v_exp_f32 v36, v36
  v_exp_f32 v37, v37
  v_mfma_f32_32x32x16_bf16 v[16:31], v[100:103], v[80:83], 0
  v_exp_f32 v38, v38
  v_exp_f32 v39, v39
  v_cvt_pk_bf16_f32 v88, v32, v33
  v_cvt_pk_bf16_f32 v89, v34, v35
  v_cvt_pk_bf16_f32 v90, v36, v37
  v_cvt_pk_bf16_f32 v91, v38, v39
  v_exp_f32 v40, v40
  v_exp_f32 v41, v41
  v_mfma_f32_32x32x16_bf16 v[64:79], v[104:107], v[88:91], v[64:79]
  v_exp_f32 v42, v42
  v_exp_f32 v43, v43
  v_exp_f32 v44, v44
  v_exp_f32 v45, v45
  v_exp_f32 v46, v46
  v_exp_f32 v47, v47
  v_cvt_pk_bf16_f32 v92, v40, v41
  v_cvt_pk_bf16_f32 v93, v42, v43
  v_cvt_pk_bf16_f32 v94, v44, v45
  v_cvt_pk_bf16_f32 v95, v46, v47
  v_exp_f32 v16, v16
  v_exp_f32 v17, v17
  v_mfma_f32_32x32x16_bf16 v[64:79], v[108:111], v[92:95], v[64:79]
  v_exp_f32 v18, v18
  v_exp_f32 v19, v19
  v_exp_f32 v20, v20
  v_exp_f32 v21, v21
  v_mfma_f32_32x32x16_bf16 v[32:47], v[100:103], v[84:87], 0
  s_waitcnt lgkmcnt(0)
  buffer_load_dwordx4 v[244:247], v2, s[8:11], s32 offen offset:1024
  buffer_load_dwordx4 v[136:139], v2, s[8:11], s46 offen offset:2048
  buffer_load_dwordx4 v[140:143], v2, s[8:11], s46 offen offset:3072
  ds_read_b128 v[100:103], v126 offset:37888
  s_mov_b64 exec, s[20:21]
  ds_read_b128 v[104:107], v127 offset:36864
  ds_read_b128 v[108:111], v127 offset:37376
  s_mov_b64 exec, -1
  v_exp_f32 v22, v22
  v_exp_f32 v23, v23
  v_cvt_pk_bf16_f32 v88, v16, v17
  v_cvt_pk_bf16_f32 v89, v18, v19
  v_cvt_pk_bf16_f32 v90, v20, v21
  v_cvt_pk_bf16_f32 v91, v22, v23
  v_exp_f32 v24, v24
  v_exp_f32 v25, v25
  v_mfma_f32_32x32x16_bf16 v[48:63], v[112:115], v[88:91], v[48:63]
  v_exp_f32 v26, v26
  v_exp_f32 v27, v27
  v_exp_f32 v28, v28
  v_exp_f32 v29, v29
  v_exp_f32 v30, v30
  v_exp_f32 v31, v31
  v_cvt_pk_bf16_f32 v92, v24, v25
  v_cvt_pk_bf16_f32 v93, v26, v27
  v_cvt_pk_bf16_f32 v94, v28, v29
  v_cvt_pk_bf16_f32 v95, v30, v31
  v_exp_f32 v32, v32
  v_exp_f32 v33, v33
  v_mfma_f32_32x32x16_bf16 v[48:63], v[116:119], v[92:95], v[48:63]
  v_exp_f32 v34, v34
  v_exp_f32 v35, v35
  v_exp_f32 v36, v36
  v_exp_f32 v37, v37
  v_mfma_f32_32x32x16_bf16 v[16:31], v[96:99], v[80:83], 0
  v_exp_f32 v38, v38
  v_exp_f32 v39, v39
  v_cvt_pk_bf16_f32 v88, v32, v33
  v_cvt_pk_bf16_f32 v89, v34, v35
  v_cvt_pk_bf16_f32 v90, v36, v37
  v_cvt_pk_bf16_f32 v91, v38, v39
  v_exp_f32 v40, v40
  v_exp_f32 v41, v41
  v_mfma_f32_32x32x16_bf16 v[64:79], v[112:115], v[88:91], v[64:79]
  v_exp_f32 v42, v42
  v_exp_f32 v43, v43
  v_exp_f32 v44, v44
  v_exp_f32 v45, v45
  v_exp_f32 v46, v46
  v_exp_f32 v47, v47
  v_cvt_pk_bf16_f32 v92, v40, v41
  v_cvt_pk_bf16_f32 v93, v42, v43
  v_cvt_pk_bf16_f32 v94, v44, v45
  v_cvt_pk_bf16_f32 v95, v46, v47
  v_exp_f32 v16, v16
  v_exp_f32 v17, v17
  v_mfma_f32_32x32x16_bf16 v[64:79], v[116:119], v[92:95], v[64:79]
  v_exp_f32 v18, v18
  v_exp_f32 v19, v19
  v_exp_f32 v20, v20
  v_exp_f32 v21, v21
  v_mfma_f32_32x32x16_bf16 v[32:47], v[96:99], v[84:87], 0
  s_waitcnt lgkmcnt(0)
  buffer_load_dwordx4 v[248:251], v2, s[8:11], s32 offen offset:2048
  s_and_b32 s16, s13, 7
  s_lshr_b32 s15, s13, 3
  s_lshl_b32 s15, s15, 1
  s_lshl_b32 s19, s12, 3
  s_add_u32 s15, s15, s19
  s_and_b32 s18, s14, 1
  s_lshr_b32 s17, s14, 1
  s_lshr_b32 s49, s14, 2
  s_and_b32 s48, s17, 1
  s_add_u32 s20, s15, s49
  s_lshl_b32 s21, s16, 1
  s_and_b32 s19, s14, 1
  s_add_u32 s21, s21, s19
  s_lshl_b32 s21, s21, 1
  s_add_u32 s21, s21, s48
  s_lshl_b32 s19, s20, 5
  s_add_u32 s19, s19, s21
  s_lshl_b32 s19, s19, 10
  s_add_u32 s22, s19, 11534336
  buffer_load_dwordx4 v[120:123], v2, s[8:11], s22 offen
  s_mov_b32 s20, 0xffff0000
  s_mov_b32 s21, 0xffff0000
  ds_read_b128 v[96:99], v126 offset:38912
  s_mov_b64 exec, s[20:21]
  ds_read_b128 v[112:115], v127 offset:37888
  ds_read_b128 v[116:119], v127 offset:38400
  s_mov_b64 exec, -1
  v_exp_f32 v22, v22
  v_exp_f32 v23, v23
  v_cvt_pk_bf16_f32 v88, v16, v17
  v_cvt_pk_bf16_f32 v89, v18, v19
  v_cvt_pk_bf16_f32 v90, v20, v21
  v_cvt_pk_bf16_f32 v91, v22, v23
  v_exp_f32 v24, v24
  v_exp_f32 v25, v25
  v_mfma_f32_32x32x16_bf16 v[48:63], v[104:107], v[88:91], v[48:63]
  v_exp_f32 v26, v26
  v_exp_f32 v27, v27
  v_exp_f32 v28, v28
  v_exp_f32 v29, v29
  v_exp_f32 v30, v30
  v_exp_f32 v31, v31
  v_cvt_pk_bf16_f32 v92, v24, v25
  v_cvt_pk_bf16_f32 v93, v26, v27
  v_cvt_pk_bf16_f32 v94, v28, v29
  v_cvt_pk_bf16_f32 v95, v30, v31
  v_exp_f32 v32, v32
  v_exp_f32 v33, v33
  v_mfma_f32_32x32x16_bf16 v[48:63], v[108:111], v[92:95], v[48:63]
  v_exp_f32 v34, v34
  v_exp_f32 v35, v35
  v_exp_f32 v36, v36
  v_exp_f32 v37, v37
  v_mfma_f32_32x32x16_bf16 v[16:31], v[100:103], v[80:83], 0
  v_exp_f32 v38, v38
  v_exp_f32 v39, v39
  v_cvt_pk_bf16_f32 v88, v32, v33
  v_cvt_pk_bf16_f32 v89, v34, v35
  v_cvt_pk_bf16_f32 v90, v36, v37
  v_cvt_pk_bf16_f32 v91, v38, v39
  v_exp_f32 v40, v40
  v_exp_f32 v41, v41
  v_mfma_f32_32x32x16_bf16 v[64:79], v[104:107], v[88:91], v[64:79]
  v_exp_f32 v42, v42
  v_exp_f32 v43, v43
  v_exp_f32 v44, v44
  v_exp_f32 v45, v45
  v_exp_f32 v46, v46
  v_exp_f32 v47, v47
  v_cvt_pk_bf16_f32 v92, v40, v41
  v_cvt_pk_bf16_f32 v93, v42, v43
  v_cvt_pk_bf16_f32 v94, v44, v45
  v_cvt_pk_bf16_f32 v95, v46, v47
  v_exp_f32 v16, v16
  v_exp_f32 v17, v17
  v_mfma_f32_32x32x16_bf16 v[64:79], v[108:111], v[92:95], v[64:79]
  v_exp_f32 v18, v18
  v_exp_f32 v19, v19
  v_exp_f32 v20, v20
  v_exp_f32 v21, v21
  v_mfma_f32_32x32x16_bf16 v[32:47], v[100:103], v[84:87], 0
  s_waitcnt lgkmcnt(0)
  buffer_load_dwordx4 v[252:255], v2, s[8:11], s32 offen offset:3072
  s_add_u32 s32, s32, 4096
  ds_read_b128 v[100:103], v126 offset:39936
  s_mov_b64 exec, s[20:21]
  ds_read_b128 v[104:107], v127 offset:38912
  ds_read_b128 v[108:111], v127 offset:39424
  s_mov_b64 exec, -1
  v_exp_f32 v22, v22
  v_exp_f32 v23, v23
  v_cvt_pk_bf16_f32 v88, v16, v17
  v_cvt_pk_bf16_f32 v89, v18, v19
  v_cvt_pk_bf16_f32 v90, v20, v21
  v_cvt_pk_bf16_f32 v91, v22, v23
  v_exp_f32 v24, v24
  v_exp_f32 v25, v25
  v_mfma_f32_32x32x16_bf16 v[48:63], v[112:115], v[88:91], v[48:63]
  v_exp_f32 v26, v26
  v_exp_f32 v27, v27
  v_exp_f32 v28, v28
  v_exp_f32 v29, v29
  v_exp_f32 v30, v30
  v_exp_f32 v31, v31
  v_cvt_pk_bf16_f32 v92, v24, v25
  v_cvt_pk_bf16_f32 v93, v26, v27
  v_cvt_pk_bf16_f32 v94, v28, v29
  v_cvt_pk_bf16_f32 v95, v30, v31
  v_exp_f32 v32, v32
  v_exp_f32 v33, v33
  v_mfma_f32_32x32x16_bf16 v[48:63], v[116:119], v[92:95], v[48:63]
  v_exp_f32 v34, v34
  v_exp_f32 v35, v35
  v_exp_f32 v36, v36
  v_exp_f32 v37, v37
  v_mfma_f32_32x32x16_bf16 v[16:31], v[96:99], v[80:83], 0
  v_exp_f32 v38, v38
  v_exp_f32 v39, v39
  v_cvt_pk_bf16_f32 v88, v32, v33
  v_cvt_pk_bf16_f32 v89, v34, v35
  v_cvt_pk_bf16_f32 v90, v36, v37
  v_cvt_pk_bf16_f32 v91, v38, v39
  v_exp_f32 v40, v40
  v_exp_f32 v41, v41
  v_mfma_f32_32x32x16_bf16 v[64:79], v[112:115], v[88:91], v[64:79]
  v_exp_f32 v42, v42
  v_exp_f32 v43, v43
  v_exp_f32 v44, v44
  v_exp_f32 v45, v45
  v_exp_f32 v46, v46
  v_exp_f32 v47, v47
  v_cvt_pk_bf16_f32 v92, v40, v41
  v_cvt_pk_bf16_f32 v93, v42, v43
  v_cvt_pk_bf16_f32 v94, v44, v45
  v_cvt_pk_bf16_f32 v95, v46, v47
  v_exp_f32 v16, v16
  v_exp_f32 v17, v17
  v_mfma_f32_32x32x16_bf16 v[64:79], v[116:119], v[92:95], v[64:79]
  v_exp_f32 v18, v18
  v_exp_f32 v19, v19
  v_exp_f32 v20, v20
  v_exp_f32 v21, v21
  v_mfma_f32_32x32x16_bf16 v[32:47], v[96:99], v[84:87], 0
  s_waitcnt lgkmcnt(0)
  s_cmp_eq_u32 s38, 0
  s_cbranch_scc1 prio_62
  s_setprio 0
prio_62:
  buffer_load_dwordx4 v[96:99], v2, s[8:11], s47 offen offset:0
  s_mov_b64 exec, s[20:21]
  ds_read_b128 v[112:115], v127 offset:39936
  ds_read_b128 v[116:119], v127 offset:40448
  s_mov_b64 exec, -1
  v_exp_f32 v22, v22
  v_exp_f32 v23, v23
  v_cvt_pk_bf16_f32 v88, v16, v17
  v_cvt_pk_bf16_f32 v89, v18, v19
  v_cvt_pk_bf16_f32 v90, v20, v21
  v_cvt_pk_bf16_f32 v91, v22, v23
  v_exp_f32 v24, v24
  v_exp_f32 v25, v25
  v_mfma_f32_32x32x16_bf16 v[48:63], v[104:107], v[88:91], v[48:63]
  v_exp_f32 v26, v26
  v_exp_f32 v27, v27
  v_exp_f32 v28, v28
  v_exp_f32 v29, v29
  v_exp_f32 v30, v30
  v_exp_f32 v31, v31
  v_cvt_pk_bf16_f32 v92, v24, v25
  v_cvt_pk_bf16_f32 v93, v26, v27
  v_cvt_pk_bf16_f32 v94, v28, v29
  v_cvt_pk_bf16_f32 v95, v30, v31
  v_exp_f32 v32, v32
  v_exp_f32 v33, v33
  v_mfma_f32_32x32x16_bf16 v[48:63], v[108:111], v[92:95], v[48:63]
  v_exp_f32 v34, v34
  v_exp_f32 v35, v35
  v_exp_f32 v36, v36
  v_exp_f32 v37, v37
  v_mfma_f32_32x32x16_bf16 v[16:31], v[100:103], v[80:83], 0
  v_exp_f32 v38, v38
  v_exp_f32 v39, v39
  v_cvt_pk_bf16_f32 v88, v32, v33
  v_cvt_pk_bf16_f32 v89, v34, v35
  v_cvt_pk_bf16_f32 v90, v36, v37
  v_cvt_pk_bf16_f32 v91, v38, v39
  v_exp_f32 v40, v40
  v_exp_f32 v41, v41
  v_mfma_f32_32x32x16_bf16 v[64:79], v[104:107], v[88:91], v[64:79]
  v_exp_f32 v42, v42
  v_exp_f32 v43, v43
  v_exp_f32 v44, v44
  v_exp_f32 v45, v45
  v_exp_f32 v46, v46
  v_exp_f32 v47, v47
  v_cvt_pk_bf16_f32 v92, v40, v41
  v_cvt_pk_bf16_f32 v93, v42, v43
  v_cvt_pk_bf16_f32 v94, v44, v45
  v_cvt_pk_bf16_f32 v95, v46, v47
  v_exp_f32 v16, v16
  v_exp_f32 v17, v17
  v_mfma_f32_32x32x16_bf16 v[64:79], v[108:111], v[92:95], v[64:79]
  v_exp_f32 v18, v18
  v_exp_f32 v19, v19
  v_exp_f32 v20, v20
  v_exp_f32 v21, v21
  v_mfma_f32_32x32x16_bf16 v[32:47], v[100:103], v[84:87], 0
  s_waitcnt lgkmcnt(0)
  buffer_load_dwordx4 v[104:107], v2, s[8:11], s47 offen offset:1024
  buffer_load_dwordx4 v[108:111], v2, s[8:11], s47 offen offset:2048
  buffer_load_dwordx4 v[100:103], v2, s[8:11], s47 offen offset:3072
  v_exp_f32 v22, v22
  v_exp_f32 v23, v23
  v_cvt_pk_bf16_f32 v88, v16, v17
  v_cvt_pk_bf16_f32 v89, v18, v19
  v_cvt_pk_bf16_f32 v90, v20, v21
  v_cvt_pk_bf16_f32 v91, v22, v23
  v_exp_f32 v24, v24
  v_exp_f32 v25, v25
  v_mfma_f32_32x32x16_bf16 v[48:63], v[112:115], v[88:91], v[48:63]
  v_exp_f32 v26, v26
  v_exp_f32 v27, v27
  v_exp_f32 v28, v28
  v_exp_f32 v29, v29
  v_exp_f32 v30, v30
  v_exp_f32 v31, v31
  v_cvt_pk_bf16_f32 v92, v24, v25
  v_cvt_pk_bf16_f32 v93, v26, v27
  v_cvt_pk_bf16_f32 v94, v28, v29
  v_cvt_pk_bf16_f32 v95, v30, v31
  v_exp_f32 v32, v32
  v_exp_f32 v33, v33
  v_mfma_f32_32x32x16_bf16 v[48:63], v[116:119], v[92:95], v[48:63]
  v_exp_f32 v34, v34
  v_exp_f32 v35, v35
  v_exp_f32 v36, v36
  v_exp_f32 v37, v37
  v_exp_f32 v38, v38
  v_exp_f32 v39, v39
  v_cvt_pk_bf16_f32 v88, v32, v33
  v_cvt_pk_bf16_f32 v89, v34, v35
  v_cvt_pk_bf16_f32 v90, v36, v37
  v_cvt_pk_bf16_f32 v91, v38, v39
  v_exp_f32 v40, v40
  v_exp_f32 v41, v41
  v_mfma_f32_32x32x16_bf16 v[64:79], v[112:115], v[88:91], v[64:79]
  v_exp_f32 v42, v42
  v_exp_f32 v43, v43
  v_exp_f32 v44, v44
  v_exp_f32 v45, v45
  v_exp_f32 v46, v46
  v_exp_f32 v47, v47
  v_cvt_pk_bf16_f32 v92, v40, v41
  v_cvt_pk_bf16_f32 v93, v42, v43
  v_cvt_pk_bf16_f32 v94, v44, v45
  v_cvt_pk_bf16_f32 v95, v46, v47
  s_nop 1
att1_epi:
  v_mfma_f32_32x32x16_bf16 v[64:79], v[116:119], v[92:95], v[64:79]
  s_nop 9
  s_cmp_lg_u32 s38, 0
  s_cbranch_scc1 epib_63
  ds_write_b128 v8, v[72:75]
  ds_write_b128 v8, v[76:79] offset:1024
  ds_write_b32 v8, v64 offset:2048
  s_branch epij_64
epib_63:
  ds_write_b128 v8, v[56:59]
  ds_write_b128 v8, v[60:63] offset:1024
  ds_write_b32 v8, v48 offset:2048
  s_waitcnt lgkmcnt(0)
  v_mov_b32 v48, v64
  v_mov_b32 v56, v72
  v_mov_b32 v57, v73
  v_mov_b32 v58, v74
  v_mov_b32 v59, v75
  v_mov_b32 v60, v76
  v_mov_b32 v61, v77
  v_mov_b32 v62, v78
  v_mov_b32 v63, v79
epij_64:
  s_waitcnt lgkmcnt(0)
  s_barrier
  ds_read_b32 v16, v9 offset:2048
  ds_read_b128 v[24:27], v9
  ds_read_b128 v[28:31], v9 offset:1024
  s_lshl_b32 s22, s36, 5
  s_lshl_b32 s23, s37, 1
  s_add_u32 s22, s22, s23
  s_add_u32 s22, s22, s38
  s_lshl_b32 s22, s22, 10
  s_add_u32 s22, s22, 18874368
  s_waitcnt lgkmcnt(2)
  v_add_f32 v48, v48, v16
  v_rcp_f32 v48, v48
  s_waitcnt lgkmcnt(0)
  v_add_f32 v56, v56, v24
  v_add_f32 v57, v57, v25
  v_add_f32 v58, v58, v26
  v_add_f32 v59, v59, v27
  v_add_f32 v60, v60, v28
  v_add_f32 v61, v61, v29
  v_add_f32 v62, v62, v30
  v_add_f32 v63, v63, v31
  v_mul_f32 v56, v56, v48
  v_mul_f32 v57, v57, v48
  v_mul_f32 v58, v58, v48
  v_mul_f32 v59, v59, v48
  v_mul_f32 v60, v60, v48
  v_mul_f32 v61, v61, v48
  v_mul_f32 v62, v62, v48
  v_mul_f32 v63, v63, v48
  v_cvt_pk_bf16_f32 v88, v56, v57
  v_cvt_pk_bf16_f32 v89, v58, v59
  v_cvt_pk_bf16_f32 v90, v60, v61
  v_cvt_pk_bf16_f32 v91, v62, v63
  buffer_store_dwordx4 v[88:91], v2, s[8:11], s22 offen
  s_mov_b32 s52, 4194304
  s_mov_b32 s53, 262144
  s_mov_b32 s54, 2097152
  s_mov_b32 s55, 8388608
  s_mov_b32 s57, 1
  s_branch rest
main_end:
  s_endpgm
att0_slow:
  s_and_b32 s22, s13, 7
  s_cbranch_scc1 qsave_65
  s_add_u32 s22, s40, 0
  buffer_store_dwordx4 v[144:147], v2, s[8:11], s22 offen offset:0 sc1
  buffer_store_dwordx4 v[148:151], v2, s[8:11], s22 offen offset:1024 sc1
qsave_65:
  s_and_b32 s22, s13, 7
  s_cbranch_scc1 qsave_66
  s_add_u32 s22, s40, 2048
  buffer_store_dwordx4 v[152:155], v2, s[8:11], s22 offen offset:0 sc1
  buffer_store_dwordx4 v[156:159], v2, s[8:11], s22 offen offset:1024 sc1
qsave_66:
  s_and_b32 s22, s13, 7
  s_cbranch_scc1 qsave_67
  s_add_u32 s22, s40, 4096
  buffer_store_dwordx4 v[160:163], v2, s[8:11], s22 offen offset:0 sc1
  buffer_store_dwordx4 v[164:167], v2, s[8:11], s22 offen offset:1024 sc1
qsave_67:
  s_and_b32 s22, s13, 7
  s_cbranch_scc1 qsave_68
  s_add_u32 s22, s40, 6144
  buffer_store_dwordx4 v[168:171], v2, s[8:11], s22 offen offset:0 sc1
  buffer_store_dwordx4 v[172:175], v2, s[8:11], s22 offen offset:1024 sc1
qsave_68:
  s_and_b32 s22, s13, 7
  s_cbranch_scc1 qsave_69
  s_add_u32 s22, s40, 8192
  buffer_store_dwordx4 v[176:179], v2, s[8:11], s22 offen offset:0 sc1
  buffer_store_dwordx4 v[180:183], v2, s[8:11], s22 offen offset:1024 sc1
qsave_69:
  s_and_b32 s22, s13, 7
  s_cbranch_scc1 qsave_70
  s_add_u32 s22, s40, 10240
  buffer_store_dwordx4 v[184:187], v2, s[8:11], s22 offen offset:0 sc1
  buffer_store_dwordx4 v[188:191], v2, s[8:11], s22 offen offset:1024 sc1
qsave_70:
  s_and_b32 s22, s13, 7
  s_cbranch_scc1 qsave_71
  s_add_u32 s22, s40, 12288
  buffer_store_dwordx4 v[192:195], v2, s[8:11], s22 offen offset:0 sc1
  buffer_store_dwordx4 v[196:199], v2, s[8:11], s22 offen offset:1024 sc1
qsave_71:
  s_and_b32 s22, s13, 7
  s_cbranch_scc1 qsave_72
  s_add_u32 s22, s40, 14336
  buffer_store_dwordx4 v[200:203], v2, s[8:11], s22 offen offset:0 sc1
  buffer_store_dwordx4 v[204:207], v2, s[8:11], s22 offen offset:1024 sc1
qsave_72:
  s_and_b32 s22, s13, 7
  s_cbranch_scc1 qsave_73
  s_add_u32 s22, s40, 16384
  buffer_store_dwordx4 v[208:211], v2, s[8:11], s22 offen offset:0 sc1
qsave_73:
  s_waitcnt lgkmcnt(0)
  s_cmp_lg_u32 s14, 4
  s_cbranch_scc1 gwp_74
  v_mov_b32 v12, 94224
  ds_read_b32 v13, v12 offset:4
  s_waitcnt lgkmcnt(0)
  v_readfirstlane_b32 s22, v13
  s_cmp_eq_u32 s22, s94
  s_cbranch_scc1 gwp_74
  v_mov_b32 v12, 0
  s_getreg_b32 s28, hwreg(HW_REG_XCC_ID, 0, 3)
  s_lshl_b32 s28, s28, 7
  s_add_u32 s28, s28, 6881280
  s_waitcnt vmcnt(0)
  v_cmp_ne_u32 s[24:25], s94, v241
  v_cmp_ne_u32 vcc, s94, v243
  s_or_b64 vcc, vcc, s[24:25]
  s_cbranch_vccz gwp_74_q_p_x
  s_cmp_eq_u32 s13, 8
  s_cbranch_scc1 gwp_74_q_g
  s_mov_b32 s93, 48
gwp_74_q_l:
  buffer_load_dwordx4 v[240:243], v12, s[8:11], s28 offen sc1
  s_sub_u32 s93, s93, 1
  s_waitcnt vmcnt(0)
  v_cmp_ne_u32 s[24:25], s94, v241
  v_cmp_ne_u32 vcc, s94, v243
  s_or_b64 vcc, vcc, s[24:25]
  s_cmp_eq_u32 s93, 0
  s_cbranch_scc1 gwp_74_q_l_x
  s_cbranch_vccz gwp_74_q_l_x
  s_branch gwp_74_q_l
gwp_74_q_l_x:
  s_cbranch_vccz gwp_74_q_w
gwp_74_q_g:
  v_lshlrev_b32 v13, 7, v1
  s_mov_b32 s29, 6815744
  s_mov_b32 s93, 524288
gwp_74_q_p:
  buffer_load_dwordx4 v[240:243], v13, s[8:11], s29 offen sc1
  s_sub_u32 s93, s93, 1
  s_waitcnt vmcnt(0)
  v_cmp_ne_u32 s[24:25], s94, v241
  v_cmp_ne_u32 vcc, s94, v243
  s_or_b64 vcc, vcc, s[24:25]
  s_cmp_eq_u32 s93, 0
  s_cbranch_scc1 gwp_74_q_p_x
  s_cbranch_vccz gwp_74_q_p_x
  s_sleep 1
  s_branch gwp_74_q_p
gwp_74_q_p_x:
  v_max_u32_dpp v240, v240, v240 row_shr:1 row_mask:0xf bank_mask:0xf
  v_max_u32_dpp v242, v242, v242 row_shr:1 row_mask:0xf bank_mask:0xf
  s_nop 0
  v_max_u32_dpp v240, v240, v240 row_shr:2 row_mask:0xf bank_mask:0xf
  v_max_u32_dpp v242, v242, v242 row_shr:2 row_mask:0xf bank_mask:0xf
  s_nop 0
  v_max_u32_dpp v240, v240, v240 row_shr:4 row_mask:0xf bank_mask:0xf
  v_max_u32_dpp v242, v242, v242 row_shr:4 row_mask:0xf bank_mask:0xf
  s_nop 0
  v_max_u32_dpp v240, v240, v240 row_shr:8 row_mask:0xf bank_mask:0xf
  v_max_u32_dpp v242, v242, v242 row_shr:8 row_mask:0xf bank_mask:0xf
  s_nop 0
  v_max_u32_dpp v240, v240, v240 row_bcast:15 row_mask:0xa bank_mask:0xf
  v_max_u32_dpp v242, v242, v242 row_bcast:15 row_mask:0xa bank_mask:0xf
  s_nop 0
  v_max_u32_dpp v240, v240, v240 row_bcast:31 row_mask:0xc bank_mask:0xf
  v_max_u32_dpp v242, v242, v242 row_bcast:31 row_mask:0xc bank_mask:0xf
  s_nop 0
  v_readlane_b32 s22, v240, 63
  v_readlane_b32 s23, v242, 63
  s_nop 1
  v_mov_b32 v240, s22
  v_mov_b32 v242, s23
  s_cmp_eq_u32 s13, 8
  s_cselect_b64 exec, 1, 0
  buffer_store_dwordx4 v[240:243], v12, s[8:11], s28 offen
  s_mov_b64 exec, -1
gwp_74_q_w:
  v_mov_b32 v12, 94224
  ds_write_b128 v12, v[240:243]
gwp_74:
  v_mov_b32 v12, 94224
  s_mov_b32 s93, 0x4000000
gww_75:
  ds_read_b32 v13, v12 offset:4
  ds_read2_b32 v[120:121], v12 offset0:0 offset1:2
  s_sub_u32 s93, s93, 1
  s_waitcnt lgkmcnt(0)
  v_readfirstlane_b32 s22, v13
  s_cmp_eq_u32 s93, 0
  s_cbranch_scc1 gww_75_x
  s_cmp_lg_u32 s22, s94
  s_cbranch_scc1 gww_75
gww_75_x:
  ds_read_b128 v[96:99], v124
  ds_read_b128 v[100:103], v124 offset:1024
  s_mov_b64 exec, s[20:21]
  ds_read_b128 v[104:107], v125
  ds_read_b128 v[108:111], v125 offset:512
  s_mov_b64 exec, -1
  s_waitcnt vmcnt(0)
  v_mov_b32 v10, 0xff800000
  v_mov_b32 v11, 0xff800000
  s_mov_b32 s22, 16252928
maxloop_76:
  buffer_load_dwordx4 v[88:91], v2, s[8:11], s22 offen
  s_waitcnt vmcnt(0)
  v_mfma_f32_32x32x16_bf16 v[16:31], v[88:91], v[80:83], 0
  v_mfma_f32_32x32x16_bf16 v[32:47], v[88:91], v[84:87], 0
  s_nop 15
  v_max3_f32 v10, v16, v17, v10
  v_max3_f32 v11, v32, v33, v11
  v_max3_f32 v10, v18, v19, v10
  v_max3_f32 v11, v34, v35, v11
  v_max3_f32 v10, v20, v21, v10
  v_max3_f32 v11, v36, v37, v11
  v_max3_f32 v10, v22, v23, v10
  v_max3_f32 v11, v38, v39, v11
  v_max3_f32 v10, v24, v25, v10
  v_max3_f32 v11, v40, v41, v11
  v_max3_f32 v10, v26, v27, v10
  v_max3_f32 v11, v42, v43, v11
  v_max3_f32 v10, v28, v29, v10
  v_max3_f32 v11, v44, v45, v11
  v_max3_f32 v10, v30, v31, v10
  v_max3_f32 v11, v46, v47, v11
  s_add_u32 s22, s22, 1024
  s_cmp_lt_u32 s22, 16318464
  s_cbranch_scc1 maxloop_76
  v_mov_b32 v12, v10
  v_mov_b32 v13, v11
  s_nop 1
  v_permlane32_swap_b32 v10, v12
  v_permlane32_swap_b32 v11, v13
  s_nop 1
  v_max_f32 v10, v10, v12
  v_max_f32 v11, v11, v13
  v_sub_f32 v144, 0, v10
  v_sub_f32 v160, 0, v11
  v_sub_f32 v145, 0, v10
  v_sub_f32 v161, 0, v11
  v_sub_f32 v146, 0, v10
  v_sub_f32 v162, 0, v11
  v_sub_f32 v147, 0, v10
  v_sub_f32 v163, 0, v11
  v_sub_f32 v148, 0, v10
  v_sub_f32 v164, 0, v11
  v_sub_f32 v149, 0, v10
  v_sub_f32 v165, 0, v11
  v_sub_f32 v150, 0, v10
  v_sub_f32 v166, 0, v11
  v_sub_f32 v151, 0, v10
  v_sub_f32 v167, 0, v11
  v_sub_f32 v152, 0, v10
  v_sub_f32 v168, 0, v11
  v_sub_f32 v153, 0, v10
  v_sub_f32 v169, 0, v11
  v_sub_f32 v154, 0, v10
  v_sub_f32 v170, 0, v11
  v_sub_f32 v155, 0, v10
  v_sub_f32 v171, 0, v11
  v_sub_f32 v156, 0, v10
  v_sub_f32 v172, 0, v11
  v_sub_f32 v157, 0, v10
  v_sub_f32 v173, 0, v11
  v_sub_f32 v158, 0, v10
  v_sub_f32 v174, 0, v11
  v_sub_f32 v159, 0, v10
  v_sub_f32 v175, 0, v11
  s_nop 1
  v_mfma_f32_32x32x16_bf16 v[16:31], v[96:99], v[80:83], v[144:159]
  s_nop 11
  v_exp_f32 v16, v16
  v_exp_f32 v17, v17
  v_exp_f32 v18, v18
  v_exp_f32 v19, v19
  v_exp_f32 v20, v20
  v_exp_f32 v21, v21
  v_mfma_f32_32x32x16_bf16 v[32:47], v[96:99], v[84:87], v[160:175]
  s_waitcnt lgkmcnt(0)
  s_cmp_lg_u32 s51, 0
  s_cselect_b64 exec, -1, 0
  buffer_store_dwordx4 v[216:219], v2, s[8:11], s60 offen sc1
  buffer_store_dwordx4 v[220:223], v2, s[8:11], s61 offen sc1
  buffer_store_dwordx4 v[224:227], v2, s[8:11], s62 offen sc1
  buffer_store_dwordx4 v[228:231], v2, s[8:11], s63 offen sc1
  s_mov_b64 exec, -1
  v_lshlrev_b32 v237, 4, v3
  s_lshl_b32 s22, s38, 1
  s_sub_i32 s22, s51, s22
  s_cmp_eq_u32 s22, 2
  s_cselect_b64 exec, -1, 0
  buffer_store_dwordx2 v[244:245], v237, s[8:11], s50 offen sc1
  s_mov_b64 exec, -1
  s_cmp_eq_u32 s38, 0
  s_cbranch_scc1 prio_77
  s_setprio 1
prio_77:
  ds_read_b128 v[96:99], v124 offset:2048
  s_mov_b64 exec, s[20:21]
  ds_read_b128 v[112:115], v125 offset:1024
  ds_read_b128 v[116:119], v125 offset:1536
  s_mov_b64 exec, -1
  v_exp_f32 v22, v22
  v_exp_f32 v23, v23
  v_cvt_pk_bf16_f32 v88, v16, v17
  v_cvt_pk_bf16_f32 v89, v18, v19
  v_cvt_pk_bf16_f32 v90, v20, v21
  v_cvt_pk_bf16_f32 v91, v22, v23
  v_exp_f32 v24, v24
  v_exp_f32 v25, v25
  v_mfma_f32_32x32x16_bf16 v[48:63], v[104:107], v[88:91], 0
  v_exp_f32 v26, v26
  v_exp_f32 v27, v27
  v_exp_f32 v28, v28
  v_exp_f32 v29, v29
  v_exp_f32 v30, v30
  v_exp_f32 v31, v31
  v_cvt_pk_bf16_f32 v92, v24, v25
  v_cvt_pk_bf16_f32 v93, v26, v27
  v_cvt_pk_bf16_f32 v94, v28, v29
  v_cvt_pk_bf16_f32 v95, v30, v31
  v_exp_f32 v32, v32
  v_exp_f32 v33, v33
  v_mfma_f32_32x32x16_bf16 v[48:63], v[108:111], v[92:95], v[48:63]
  v_exp_f32 v34, v34
  v_exp_f32 v35, v35
  v_exp_f32 v36, v36
  v_exp_f32 v37, v37
  v_mfma_f32_32x32x16_bf16 v[16:31], v[100:103], v[80:83], v[144:159]
  v_exp_f32 v38, v38
  v_exp_f32 v39, v39
  v_cvt_pk_bf16_f32 v88, v32, v33
  v_cvt_pk_bf16_f32 v89, v34, v35
  v_cvt_pk_bf16_f32 v90, v36, v37
  v_cvt_pk_bf16_f32 v91, v38, v39
  v_exp_f32 v40, v40
  v_exp_f32 v41, v41
  v_mfma_f32_32x32x16_bf16 v[64:79], v[104:107], v[88:91], 0
  v_exp_f32 v42, v42
  v_exp_f32 v43, v43
  v_exp_f32 v44, v44
  v_exp_f32 v45, v45
  v_exp_f32 v46, v46
  v_exp_f32 v47, v47
  v_cvt_pk_bf16_f32 v92, v40, v41
  v_cvt_pk_bf16_f32 v93, v42, v43
  v_cvt_pk_bf16_f32 v94, v44, v45
  v_cvt_pk_bf16_f32 v95, v46, v47
  v_exp_f32 v16, v16
  v_exp_f32 v17, v17
  v_mfma_f32_32x32x16_bf16 v[64:79], v[108:111], v[92:95], v[64:79]
  v_exp_f32 v18, v18
  v_exp_f32 v19, v19
  v_exp_f32 v20, v20
  v_exp_f32 v21, v21
  v_mfma_f32_32x32x16_bf16 v[32:47], v[100:103], v[84:87], v[160:175]
  s_waitcnt lgkmcnt(0)
  s_add_u32 s28, s48, 0
  s_and_b32 s28, s28, 7
  s_lshl_b32 s28, s28, 13
  s_add_u32 s28, s28, s27
  s_add_u32 m0, s26, 0
  s_cmp_lt_u32 s39, 2
  s_cselect_b64 exec, 0, -1
  buffer_load_dwordx4 v2, s[8:11], s28 offen lds
  buffer_load_dwordx4 v2, s[8:11], s28 offen offset:1024 lds
  s_add_u32 m0, s26, 16384
  s_add_u32 s28, s28, 65536
  buffer_load_dwordx4 v2, s[8:11], s28 offen lds
  buffer_load_dwordx4 v2, s[8:11], s28 offen offset:1024 lds
  s_mov_b64 exec, -1
  s_add_u32 s28, s48, 2
  s_and_b32 s28, s28, 7
  s_lshl_b32 s28, s28, 13
  s_add_u32 s28, s28, s27
  s_add_u32 m0, s26, 32768
  s_nop 0
  buffer_load_dwordx4 v2, s[8:11], s28 offen lds
  buffer_load_dwordx4 v2, s[8:11], s28 offen offset:1024 lds
  s_add_u32 m0, s26, 49152
  s_add_u32 s28, s28, 65536
  buffer_load_dwordx4 v2, s[8:11], s28 offen lds
  buffer_load_dwordx4 v2, s[8:11], s28 offen offset:1024 lds
  ds_read_b128 v[100:103], v124 offset:3072
  s_mov_b64 exec, s[20:21]
  ds_read_b128 v[104:107], v125 offset:2048
  ds_read_b128 v[108:111], v125 offset:2560
  s_mov_b64 exec, -1
  v_exp_f32 v22, v22
  v_exp_f32 v23, v23
  v_cvt_pk_bf16_f32 v88, v16, v17
  v_cvt_pk_bf16_f32 v89, v18, v19
  v_cvt_pk_bf16_f32 v90, v20, v21
  v_cvt_pk_bf16_f32 v91, v22, v23
  v_exp_f32 v24, v24
  v_exp_f32 v25, v25
  v_mfma_f32_32x32x16_bf16 v[48:63], v[112:115], v[88:91], v[48:63]
  v_exp_f32 v26, v26
  v_exp_f32 v27, v27
  v_exp_f32 v28, v28
  v_exp_f32 v29, v29
  v_exp_f32 v30, v30
  v_exp_f32 v31, v31
  v_cvt_pk_bf16_f32 v92, v24, v25
  v_cvt_pk_bf16_f32 v93, v26, v27
  v_cvt_pk_bf16_f32 v94, v28, v29
  v_cvt_pk_bf16_f32 v95, v30, v31
  v_exp_f32 v32, v32
  v_exp_f32 v33, v33
  v_mfma_f32_32x32x16_bf16 v[48:63], v[116:119], v[92:95], v[48:63]
  v_exp_f32 v34, v34
  v_exp_f32 v35, v35
  v_exp_f32 v36, v36
  v_exp_f32 v37, v37
  v_mfma_f32_32x32x16_bf16 v[16:31], v[96:99], v[80:83], v[144:159]
  v_exp_f32 v38, v38
  v_exp_f32 v39, v39
  v_cvt_pk_bf16_f32 v88, v32, v33
  v_cvt_pk_bf16_f32 v89, v34, v35
  v_cvt_pk_bf16_f32 v90, v36, v37
  v_cvt_pk_bf16_f32 v91, v38, v39
  v_exp_f32 v40, v40
  v_exp_f32 v41, v41
  v_mfma_f32_32x32x16_bf16 v[64:79], v[112:115], v[88:91], v[64:79]
  v_exp_f32 v42, v42
  v_exp_f32 v43, v43
  v_exp_f32 v44, v44
  v_exp_f32 v45, v45
  v_exp_f32 v46, v46
  v_exp_f32 v47, v47
  v_cvt_pk_bf16_f32 v92, v40, v41
  v_cvt_pk_bf16_f32 v93, v42, v43
  v_cvt_pk_bf16_f32 v94, v44, v45
  v_cvt_pk_bf16_f32 v95, v46, v47
  v_exp_f32 v16, v16
  v_exp_f32 v17, v17
  v_mfma_f32_32x32x16_bf16 v[64:79], v[116:119], v[92:95], v[64:79]
  v_exp_f32 v18, v18
  v_exp_f32 v19, v19
  v_exp_f32 v20, v20
  v_exp_f32 v21, v21
  v_mfma_f32_32x32x16_bf16 v[32:47], v[96:99], v[84:87], v[160:175]
  s_waitcnt lgkmcnt(0)
  s_mov_b64 exec, s[20:21]
  ds_read_b128 v[112:115], v125 offset:3072
  ds_read_b128 v[116:119], v125 offset:3584
  s_mov_b64 exec, -1
  v_exp_f32 v22, v22
  v_exp_f32 v23, v23
  v_cvt_pk_bf16_f32 v88, v16, v17
  v_cvt_pk_bf16_f32 v89, v18, v19
  v_cvt_pk_bf16_f32 v90, v20, v21
  v_cvt_pk_bf16_f32 v91, v22, v23
  v_exp_f32 v24, v24
  v_exp_f32 v25, v25
  v_mfma_f32_32x32x16_bf16 v[48:63], v[104:107], v[88:91], v[48:63]
  v_exp_f32 v26, v26
  v_exp_f32 v27, v27
  v_exp_f32 v28, v28
  v_exp_f32 v29, v29
  v_exp_f32 v30, v30
  v_exp_f32 v31, v31
  v_cvt_pk_bf16_f32 v92, v24, v25
  v_cvt_pk_bf16_f32 v93, v26, v27
  v_cvt_pk_bf16_f32 v94, v28, v29
  v_cvt_pk_bf16_f32 v95, v30, v31
  v_exp_f32 v32, v32
  v_exp_f32 v33, v33
  v_mfma_f32_32x32x16_bf16 v[48:63], v[108:111], v[92:95], v[48:63]
  v_exp_f32 v34, v34
  v_exp_f32 v35, v35
  v_exp_f32 v36, v36
  v_exp_f32 v37, v37
  v_mfma_f32_32x32x16_bf16 v[16:31], v[100:103], v[80:83], v[144:159]
  v_exp_f32 v38, v38
  v_exp_f32 v39, v39
  v_cvt_pk_bf16_f32 v88, v32, v33
  v_cvt_pk_bf16_f32 v89, v34, v35
  v_cvt_pk_bf16_f32 v90, v36, v37
  v_cvt_pk_bf16_f32 v91, v38, v39
  v_exp_f32 v40, v40
  v_exp_f32 v41, v41
  v_mfma_f32_32x32x16_bf16 v[64:79], v[104:107], v[88:91], v[64:79]
  v_exp_f32 v42, v42
  v_exp_f32 v43, v43
  v_exp_f32 v44, v44
  v_exp_f32 v45, v45
  v_exp_f32 v46, v46
  v_exp_f32 v47, v47
  v_cvt_pk_bf16_f32 v92, v40, v41
  v_cvt_pk_bf16_f32 v93, v42, v43
  v_cvt_pk_bf16_f32 v94, v44, v45
  v_cvt_pk_bf16_f32 v95, v46, v47
  v_exp_f32 v16, v16
  v_exp_f32 v17, v17
  v_mfma_f32_32x32x16_bf16 v[64:79], v[108:111], v[92:95], v[64:79]
  v_exp_f32 v18, v18
  v_exp_f32 v19, v19
  v_exp_f32 v20, v20
  v_exp_f32 v21, v21
  v_mfma_f32_32x32x16_bf16 v[32:47], v[100:103], v[84:87], v[160:175]
  s_waitcnt lgkmcnt(0)
  s_waitcnt vmcnt(4)
  s_barrier
  ds_read_b128 v[96:99], v124 offset:4096
  ds_read_b128 v[100:103], v124 offset:5120
  s_mov_b64 exec, s[20:21]
  ds_read_b128 v[104:107], v125 offset:4096
  ds_read_b128 v[108:111], v125 offset:4608
  s_mov_b64 exec, -1
  v_exp_f32 v22, v22
  v_exp_f32 v23, v23
  v_cvt_pk_bf16_f32 v88, v16, v17
  v_cvt_pk_bf16_f32 v89, v18, v19
  v_cvt_pk_bf16_f32 v90, v20, v21
  v_cvt_pk_bf16_f32 v91, v22, v23
  v_exp_f32 v24, v24
  v_exp_f32 v25, v25
  v_mfma_f32_32x32x16_bf16 v[48:63], v[112:115], v[88:91], v[48:63]
  v_exp_f32 v26, v26
  v_exp_f32 v27, v27
  v_exp_f32 v28, v28
  v_exp_f32 v29, v29
  v_exp_f32 v30, v30
  v_exp_f32 v31, v31
  v_cvt_pk_bf16_f32 v92, v24, v25
  v_cvt_pk_bf16_f32 v93, v26, v27
  v_cvt_pk_bf16_f32 v94, v28, v29
  v_cvt_pk_bf16_f32 v95, v30, v31
  v_exp_f32 v32, v32
  v_exp_f32 v33, v33
  v_mfma_f32_32x32x16_bf16 v[48:63], v[116:119], v[92:95], v[48:63]
  v_exp_f32 v34, v34
  v_exp_f32 v35, v35
  v_exp_f32 v36, v36
  v_exp_f32 v37, v37
  s_waitcnt lgkmcnt(3)
  v_mfma_f32_32x32x16_bf16 v[16:31], v[96:99], v[80:83], v[144:159]
  v_exp_f32 v38, v38
  v_exp_f32 v39, v39
  v_cvt_pk_bf16_f32 v88, v32, v33
  v_cvt_pk_bf16_f32 v89, v34, v35
  v_cvt_pk_bf16_f32 v90, v36, v37
  v_cvt_pk_bf16_f32 v91, v38, v39
  v_exp_f32 v40, v40
  v_exp_f32 v41, v41
  v_mfma_f32_32x32x16_bf16 v[64:79], v[112:115], v[88:91], v[64:79]
  v_exp_f32 v42, v42
  v_exp_f32 v43, v43
  v_exp_f32 v44, v44
  v_exp_f32 v45, v45
  v_exp_f32 v46, v46
  v_exp_f32 v47, v47
  v_cvt_pk_bf16_f32 v92, v40, v41
  v_cvt_pk_bf16_f32 v93, v42, v43
  v_cvt_pk_bf16_f32 v94, v44, v45
  v_cvt_pk_bf16_f32 v95, v46, v47
  v_exp_f32 v16, v16
  v_exp_f32 v17, v17
  v_mfma_f32_32x32x16_bf16 v[64:79], v[116:119], v[92:95], v[64:79]
  v_exp_f32 v18, v18
  v_exp_f32 v19, v19
  v_exp_f32 v20, v20
  v_exp_f32 v21, v21
  v_mfma_f32_32x32x16_bf16 v[32:47], v[96:99], v[84:87], v[160:175]
  s_waitcnt lgkmcnt(0)
  s_cmp_lg_u32 s14, 5
  s_cbranch_scc1 wf_78
  v_mov_b32 v237, 0
  v_mov_b32 v232, s95
  v_mov_b32 v233, s94
  s_lshl_b32 s23, s2, 7
  s_add_u32 s23, s23, 6848512
  s_mov_b64 exec, 1
  buffer_store_dwordx2 v[232:233], v237, s[8:11], s23 offen sc1
  s_mov_b64 exec, -1
wf_78:
  s_and_b32 s16, s13, 7
  s_lshr_b32 s15, s13, 3
  s_lshl_b32 s15, s15, 1
  s_lshl_b32 s19, s12, 3
  s_add_u32 s15, s15, s19
  s_and_b32 s18, s14, 1
  s_lshr_b32 s17, s14, 1
  s_lshr_b32 s49, s14, 2
  s_and_b32 s48, s17, 1
  s_add_u32 s20, s15, s49
  s_lshl_b32 s21, s16, 1
  s_and_b32 s19, s14, 1
  s_add_u32 s21, s21, s19
  s_lshl_b32 s21, s21, 1
  s_add_u32 s21, s21, s48
  s_lshl_b32 s19, s20, 5
  s_add_u32 s19, s19, s21
  s_lshl_b32 s19, s19, 10
  s_mov_b32 s20, 0xffff0000
  s_mov_b32 s21, 0xffff0000
  s_lshl_b32 s22, s36, 5
  s_lshl_b32 s23, s37, 1
  s_add_u32 s22, s22, s23
  s_add_u32 s22, s22, s38
  s_lshl_b32 s22, s22, 10
  s_add_u32 s22, s22, 16777216
  s_lshr_b32 s25, s13, 4
  s_lshl_b32 s24, s25, 2
  s_xor_b32 s24, s24, s14
  s_lshl_b32 s23, s12, 3
  s_add_u32 s24, s24, s23
  s_mul_i32 s23, s24, 112
  s_and_b32 s24, s13, 15
  s_mul_i32 s24, s24, 7
  s_add_u32 s23, s23, s24
  s_mul_i32 s24, s25, 3
  s_add_u32 s23, s23, s24
  s_and_b32 s24, s25, s38
  s_add_u32 s23, s23, s24
  s_lshl_b32 s23, s23, 10
  s_add_u32 s23, s23, 20967424
  s_add_u32 s24, s19, 9436160
  s_add_u32 s25, s19, 11532288
  v_lshrrev_b32 v12, 3, v1
  v_mov_b32 v13, s22
  v_mov_b32 v14, s24
  v_cmp_eq_u32 vcc, 1, v12
  s_sub_u32 s22, s22, 3072
  s_nop 0
  v_cndmask_b32 v13, v13, v14, vcc
  v_mov_b32 v14, s25
  v_cmp_eq_u32 vcc, 2, v12
  s_nop 1
  v_cndmask_b32 v13, v13, v14, vcc
  v_mov_b32 v14, s22
  v_cmp_eq_u32 vcc, 3, v12
  s_nop 1
  v_cndmask_b32 v13, v13, v14, vcc
  v_mov_b32 v14, s23
  v_cmp_lt_u32 vcc, 3, v12
  s_nop 1
  v_cndmask_b32 v13, v13, v14, vcc
  v_lshl_add_u32 v13, v1, 7, v13
  v_mov_b32 v123, v13
  v_mov_b32 v11, v13
  s_lshr_b32 s48, s39, 1
  s_add_u32 s48, s48, s12
  s_mov_b32 exec_lo, 0xff
  s_mov_b32 exec_hi, 0x0
  buffer_load_dword v14, v123, s[8:11], 0 offen sc1
  s_mov_b64 exec, -1
  ds_read_b128 v[96:99], v124 offset:6144
  s_mov_b64 exec, s[20:21]
  ds_read_b128 v[112:115], v125 offset:5120
  ds_read_b128 v[116:119], v125 offset:5632
  s_mov_b64 exec, -1
  v_exp_f32 v22, v22
  v_exp_f32 v23, v23
  v_cvt_pk_bf16_f32 v88, v16, v17
  v_cvt_pk_bf16_f32 v89, v18, v19
  v_cvt_pk_bf16_f32 v90, v20, v21
  v_cvt_pk_bf16_f32 v91, v22, v23
  v_exp_f32 v24, v24
  v_exp_f32 v25, v25
  v_mfma_f32_32x32x16_bf16 v[48:63], v[104:107], v[88:91], v[48:63]
  v_exp_f32 v26, v26
  v_exp_f32 v27, v27
  v_exp_f32 v28, v28
  v_exp_f32 v29, v29
  v_exp_f32 v30, v30
  v_exp_f32 v31, v31
  v_cvt_pk_bf16_f32 v92, v24, v25
  v_cvt_pk_bf16_f32 v93, v26, v27
  v_cvt_pk_bf16_f32 v94, v28, v29
  v_cvt_pk_bf16_f32 v95, v30, v31
  v_exp_f32 v32, v32
  v_exp_f32 v33, v33
  v_mfma_f32_32x32x16_bf16 v[48:63], v[108:111], v[92:95], v[48:63]
  v_exp_f32 v34, v34
  v_exp_f32 v35, v35
  v_exp_f32 v36, v36
  v_exp_f32 v37, v37
  v_mfma_f32_32x32x16_bf16 v[16:31], v[100:103], v[80:83], v[144:159]
  v_exp_f32 v38, v38
  v_exp_f32 v39, v39
  v_cvt_pk_bf16_f32 v88, v32, v33
  v_cvt_pk_bf16_f32 v89, v34, v35
  v_cvt_pk_bf16_f32 v90, v36, v37
  v_cvt_pk_bf16_f32 v91, v38, v39
  v_exp_f32 v40, v40
  v_exp_f32 v41, v41
  v_mfma_f32_32x32x16_bf16 v[64:79], v[104:107], v[88:91], v[64:79]
  v_exp_f32 v42, v42
  v_exp_f32 v43, v43
  v_exp_f32 v44, v44
  v_exp_f32 v45, v45
  v_exp_f32 v46, v46
  v_exp_f32 v47, v47
  v_cvt_pk_bf16_f32 v92, v40, v41
  v_cvt_pk_bf16_f32 v93, v42, v43
  v_cvt_pk_bf16_f32 v94, v44, v45
  v_cvt_pk_bf16_f32 v95, v46, v47
  v_exp_f32 v16, v16
  v_exp_f32 v17, v17
  v_mfma_f32_32x32x16_bf16 v[64:79], v[108:111], v[92:95], v[64:79]
  v_exp_f32 v18, v18
  v_exp_f32 v19, v19
  v_exp_f32 v20, v20
  v_exp_f32 v21, v21
  v_mfma_f32_32x32x16_bf16 v[32:47], v[100:103], v[84:87], v[160:175]
  s_waitcnt lgkmcnt(0)
  s_cmp_eq_u32 s38, 0
  s_cbranch_scc1 prio_79
  s_setprio 0
prio_79:
  s_mov_b32 exec_lo, 0xff00
  s_mov_b32 exec_hi, 0x0
  buffer_load_dword v14, v123, s[8:11], 0 offen sc1
  s_mov_b64 exec, -1
  ds_read_b128 v[100:103], v124 offset:7168
  s_mov_b64 exec, s[20:21]
  ds_read_b128 v[104:107], v125 offset:6144
  ds_read_b128 v[108:111], v125 offset:6656
  s_mov_b64 exec, -1
  v_exp_f32 v22, v22
  v_exp_f32 v23, v23
  v_cvt_pk_bf16_f32 v88, v16, v17
  v_cvt_pk_bf16_f32 v89, v18, v19
  v_cvt_pk_bf16_f32 v90, v20, v21
  v_cvt_pk_bf16_f32 v91, v22, v23
  v_exp_f32 v24, v24
  v_exp_f32 v25, v25
  v_mfma_f32_32x32x16_bf16 v[48:63], v[112:115], v[88:91], v[48:63]
  v_exp_f32 v26, v26
  v_exp_f32 v27, v27
  v_exp_f32 v28, v28
  v_exp_f32 v29, v29
  v_exp_f32 v30, v30
  v_exp_f32 v31, v31
  v_cvt_pk_bf16_f32 v92, v24, v25
  v_cvt_pk_bf16_f32 v93, v26, v27
  v_cvt_pk_bf16_f32 v94, v28, v29
  v_cvt_pk_bf16_f32 v95, v30, v31
  v_exp_f32 v32, v32
  v_exp_f32 v33, v33
  v_mfma_f32_32x32x16_bf16 v[48:63], v[116:119], v[92:95], v[48:63]
  v_exp_f32 v34, v34
  v_exp_f32 v35, v35
  v_exp_f32 v36, v36
  v_exp_f32 v37, v37
  v_mfma_f32_32x32x16_bf16 v[16:31], v[96:99], v[80:83], v[144:159]
  v_exp_f32 v38, v38
  v_exp_f32 v39, v39
  v_cvt_pk_bf16_f32 v88, v32, v33
  v_cvt_pk_bf16_f32 v89, v34, v35
  v_cvt_pk_bf16_f32 v90, v36, v37
  v_cvt_pk_bf16_f32 v91, v38, v39
  v_exp_f32 v40, v40
  v_exp_f32 v41, v41
  v_mfma_f32_32x32x16_bf16 v[64:79], v[112:115], v[88:91], v[64:79]
  v_exp_f32 v42, v42
  v_exp_f32 v43, v43
  v_exp_f32 v44, v44
  v_exp_f32 v45, v45
  v_exp_f32 v46, v46
  v_exp_f32 v47, v47
  v_cvt_pk_bf16_f32 v92, v40, v41
  v_cvt_pk_bf16_f32 v93, v42, v43
  v_cvt_pk_bf16_f32 v94, v44, v45
  v_cvt_pk_bf16_f32 v95, v46, v47
  v_exp_f32 v16, v16
  v_exp_f32 v17, v17
  v_mfma_f32_32x32x16_bf16 v[64:79], v[116:119], v[92:95], v[64:79]
  v_exp_f32 v18, v18
  v_exp_f32 v19, v19
  v_exp_f32 v20, v20
  v_exp_f32 v21, v21
  v_mfma_f32_32x32x16_bf16 v[32:47], v[96:99], v[84:87], v[160:175]
  s_waitcnt lgkmcnt(0)
  s_cmp_eq_u32 s38, 0
  s_cbranch_scc1 prio_80
  s_setprio 1
prio_80:
  s_waitcnt vmcnt(2)
  s_barrier
  s_add_u32 s28, s48, 4
  s_and_b32 s28, s28, 7
  s_lshl_b32 s28, s28, 13
  s_add_u32 s28, s28, s27
  s_add_u32 m0, s26, 65536
  s_nop 0
  buffer_load_dwordx4 v2, s[8:11], s28 offen lds
  buffer_load_dwordx4 v2, s[8:11], s28 offen offset:1024 lds
  s_add_u32 m0, s26, 81920
  s_add_u32 s28, s28, 65536
  buffer_load_dwordx4 v2, s[8:11], s28 offen lds
  buffer_load_dwordx4 v2, s[8:11], s28 offen offset:1024 lds
  s_mov_b32 exec_lo, 0xff0000
  s_mov_b32 exec_hi, 0x0
  buffer_load_dword v14, v123, s[8:11], 0 offen sc1
  s_mov_b64 exec, -1
  ds_read_b128 v[96:99], v124 offset:32768
  s_mov_b64 exec, s[20:21]
  ds_read_b128 v[112:115], v125 offset:7168
  ds_read_b128 v[116:119], v125 offset:7680
  s_mov_b64 exec, -1
  v_exp_f32 v22, v22
  v_exp_f32 v23, v23
  v_cvt_pk_bf16_f32 v88, v16, v17
  v_cvt_pk_bf16_f32 v89, v18, v19
  v_cvt_pk_bf16_f32 v90, v20, v21
  v_cvt_pk_bf16_f32 v91, v22, v23
  v_exp_f32 v24, v24
  v_exp_f32 v25, v25
  v_mfma_f32_32x32x16_bf16 v[48:63], v[104:107], v[88:91], v[48:63]
  v_exp_f32 v26, v26
  v_exp_f32 v27, v27
  v_exp_f32 v28, v28
  v_exp_f32 v29, v29
  v_exp_f32 v30, v30
  v_exp_f32 v31, v31
  v_cvt_pk_bf16_f32 v92, v24, v25
  v_cvt_pk_bf16_f32 v93, v26, v27
  v_cvt_pk_bf16_f32 v94, v28, v29
  v_cvt_pk_bf16_f32 v95, v30, v31
  v_exp_f32 v32, v32
  v_exp_f32 v33, v33
  v_mfma_f32_32x32x16_bf16 v[48:63], v[108:111], v[92:95], v[48:63]
  v_exp_f32 v34, v34
  v_exp_f32 v35, v35
  v_exp_f32 v36, v36
  v_exp_f32 v37, v37
  v_mfma_f32_32x32x16_bf16 v[16:31], v[100:103], v[80:83], v[144:159]
  v_exp_f32 v38, v38
  v_exp_f32 v39, v39
  v_cvt_pk_bf16_f32 v88, v32, v33
  v_cvt_pk_bf16_f32 v89, v34, v35
  v_cvt_pk_bf16_f32 v90, v36, v37
  v_cvt_pk_bf16_f32 v91, v38, v39
  v_exp_f32 v40, v40
  v_exp_f32 v41, v41
  v_mfma_f32_32x32x16_bf16 v[64:79], v[104:107], v[88:91], v[64:79]
  v_exp_f32 v42, v42
  v_exp_f32 v43, v43
  v_exp_f32 v44, v44
  v_exp_f32 v45, v45
  v_exp_f32 v46, v46
  v_exp_f32 v47, v47
  v_cvt_pk_bf16_f32 v92, v40, v41
  v_cvt_pk_bf16_f32 v93, v42, v43
  v_cvt_pk_bf16_f32 v94, v44, v45
  v_cvt_pk_bf16_f32 v95, v46, v47
  v_exp_f32 v16, v16
  v_exp_f32 v17, v17
  v_mfma_f32_32x32x16_bf16 v[64:79], v[108:111], v[92:95], v[64:79]
  v_exp_f32 v18, v18
  v_exp_f32 v19, v19
  v_exp_f32 v20, v20
  v_exp_f32 v21, v21
  v_mfma_f32_32x32x16_bf16 v[32:47], v[100:103], v[84:87], v[160:175]
  s_waitcnt lgkmcnt(0)
  ds_read_b128 v[100:103], v124 offset:33792
  s_mov_b64 exec, s[20:21]
  ds_read_b128 v[104:107], v125 offset:32768
  ds_read_b128 v[108:111], v125 offset:33280
  s_mov_b64 exec, -1
  v_exp_f32 v22, v22
  v_exp_f32 v23, v23
  v_cvt_pk_bf16_f32 v88, v16, v17
  v_cvt_pk_bf16_f32 v89, v18, v19
  v_cvt_pk_bf16_f32 v90, v20, v21
  v_cvt_pk_bf16_f32 v91, v22, v23
  v_exp_f32 v24, v24
  v_exp_f32 v25, v25
  v_mfma_f32_32x32x16_bf16 v[48:63], v[112:115], v[88:91], v[48:63]
  v_exp_f32 v26, v26
  v_exp_f32 v27, v27
  v_exp_f32 v28, v28
  v_exp_f32 v29, v29
  v_exp_f32 v30, v30
  v_exp_f32 v31, v31
  v_cvt_pk_bf16_f32 v92, v24, v25
  v_cvt_pk_bf16_f32 v93, v26, v27
  v_cvt_pk_bf16_f32 v94, v28, v29
  v_cvt_pk_bf16_f32 v95, v30, v31
  v_exp_f32 v32, v32
  v_exp_f32 v33, v33
  v_mfma_f32_32x32x16_bf16 v[48:63], v[116:119], v[92:95], v[48:63]
  v_exp_f32 v34, v34
  v_exp_f32 v35, v35
  v_exp_f32 v36, v36
  v_exp_f32 v37, v37
  v_mfma_f32_32x32x16_bf16 v[16:31], v[96:99], v[80:83], v[144:159]
  v_exp_f32 v38, v38
  v_exp_f32 v39, v39
  v_cvt_pk_bf16_f32 v88, v32, v33
  v_cvt_pk_bf16_f32 v89, v34, v35
  v_cvt_pk_bf16_f32 v90, v36, v37
  v_cvt_pk_bf16_f32 v91, v38, v39
  v_exp_f32 v40, v40
  v_exp_f32 v41, v41
  v_mfma_f32_32x32x16_bf16 v[64:79], v[112:115], v[88:91], v[64:79]
  v_exp_f32 v42, v42
  v_exp_f32 v43, v43
  v_exp_f32 v44, v44
  v_exp_f32 v45, v45
  v_exp_f32 v46, v46
  v_exp_f32 v47, v47
  v_cvt_pk_bf16_f32 v92, v40, v41
  v_cvt_pk_bf16_f32 v93, v42, v43
  v_cvt_pk_bf16_f32 v94, v44, v45
  v_cvt_pk_bf16_f32 v95, v46, v47
  v_exp_f32 v16, v16
  v_exp_f32 v17, v17
  v_mfma_f32_32x32x16_bf16 v[64:79], v[116:119], v[92:95], v[64:79]
  v_exp_f32 v18, v18
  v_exp_f32 v19, v19
  v_exp_f32 v20, v20
  v_exp_f32 v21, v21
  v_mfma_f32_32x32x16_bf16 v[32:47], v[96:99], v[84:87], v[160:175]
  s_waitcnt lgkmcnt(0)
  ds_read_b128 v[96:99], v124 offset:34816
  s_mov_b64 exec, s[20:21]
  ds_read_b128 v[112:115], v125 offset:33792
  ds_read_b128 v[116:119], v125 offset:34304
  s_mov_b64 exec, -1
  v_exp_f32 v22, v22
  v_exp_f32 v23, v23
  v_cvt_pk_bf16_f32 v88, v16, v17
  v_cvt_pk_bf16_f32 v89, v18, v19
  v_cvt_pk_bf16_f32 v90, v20, v21
  v_cvt_pk_bf16_f32 v91, v22, v23
  v_exp_f32 v24, v24
  v_exp_f32 v25, v25
  v_mfma_f32_32x32x16_bf16 v[48:63], v[104:107], v[88:91], v[48:63]
  v_exp_f32 v26, v26
  v_exp_f32 v27, v27
  v_exp_f32 v28, v28
  v_exp_f32 v29, v29
  v_exp_f32 v30, v30
  v_exp_f32 v31, v31
  v_cvt_pk_bf16_f32 v92, v24, v25
  v_cvt_pk_bf16_f32 v93, v26, v27
  v_cvt_pk_bf16_f32 v94, v28, v29
  v_cvt_pk_bf16_f32 v95, v30, v31
  v_exp_f32 v32, v32
  v_exp_f32 v33, v33
  v_mfma_f32_32x32x16_bf16 v[48:63], v[108:111], v[92:95], v[48:63]
  v_exp_f32 v34, v34
  v_exp_f32 v35, v35
  v_exp_f32 v36, v36
  v_exp_f32 v37, v37
  v_mfma_f32_32x32x16_bf16 v[16:31], v[100:103], v[80:83], v[144:159]
  v_exp_f32 v38, v38
  v_exp_f32 v39, v39
  v_cvt_pk_bf16_f32 v88, v32, v33
  v_cvt_pk_bf16_f32 v89, v34, v35
  v_cvt_pk_bf16_f32 v90, v36, v37
  v_cvt_pk_bf16_f32 v91, v38, v39
  v_exp_f32 v40, v40
  v_exp_f32 v41, v41
  v_mfma_f32_32x32x16_bf16 v[64:79], v[104:107], v[88:91], v[64:79]
  v_exp_f32 v42, v42
  v_exp_f32 v43, v43
  v_exp_f32 v44, v44
  v_exp_f32 v45, v45
  v_exp_f32 v46, v46
  v_exp_f32 v47, v47
  v_cvt_pk_bf16_f32 v92, v40, v41
  v_cvt_pk_bf16_f32 v93, v42, v43
  v_cvt_pk_bf16_f32 v94, v44, v45
  v_cvt_pk_bf16_f32 v95, v46, v47
  v_exp_f32 v16, v16
  v_exp_f32 v17, v17
  v_mfma_f32_32x32x16_bf16 v[64:79], v[108:111], v[92:95], v[64:79]
  v_exp_f32 v18, v18
  v_exp_f32 v19, v19
  v_exp_f32 v20, v20
  v_exp_f32 v21, v21
  v_mfma_f32_32x32x16_bf16 v[32:47], v[100:103], v[84:87], v[160:175]
  s_waitcnt lgkmcnt(0)
  ds_read_b128 v[100:103], v124 offset:35840
  s_mov_b64 exec, s[20:21]
  ds_read_b128 v[104:107], v125 offset:34816
  ds_read_b128 v[108:111], v125 offset:35328
  s_mov_b64 exec, -1
  v_exp_f32 v22, v22
  v_exp_f32 v23, v23
  v_cvt_pk_bf16_f32 v88, v16, v17
  v_cvt_pk_bf16_f32 v89, v18, v19
  v_cvt_pk_bf16_f32 v90, v20, v21
  v_cvt_pk_bf16_f32 v91, v22, v23
  v_exp_f32 v24, v24
  v_exp_f32 v25, v25
  v_mfma_f32_32x32x16_bf16 v[48:63], v[112:115], v[88:91], v[48:63]
  v_exp_f32 v26, v26
  v_exp_f32 v27, v27
  v_exp_f32 v28, v28
  v_exp_f32 v29, v29
  v_exp_f32 v30, v30
  v_exp_f32 v31, v31
  v_cvt_pk_bf16_f32 v92, v24, v25
  v_cvt_pk_bf16_f32 v93, v26, v27
  v_cvt_pk_bf16_f32 v94, v28, v29
  v_cvt_pk_bf16_f32 v95, v30, v31
  v_exp_f32 v32, v32
  v_exp_f32 v33, v33
  v_mfma_f32_32x32x16_bf16 v[48:63], v[116:119], v[92:95], v[48:63]
  v_exp_f32 v34, v34
  v_exp_f32 v35, v35
  v_exp_f32 v36, v36
  v_exp_f32 v37, v37
  v_mfma_f32_32x32x16_bf16 v[16:31], v[96:99], v[80:83], v[144:159]
  v_exp_f32 v38, v38
  v_exp_f32 v39, v39
  v_cvt_pk_bf16_f32 v88, v32, v33
  v_cvt_pk_bf16_f32 v89, v34, v35
  v_cvt_pk_bf16_f32 v90, v36, v37
  v_cvt_pk_bf16_f32 v91, v38, v39
  v_exp_f32 v40, v40
  v_exp_f32 v41, v41
  v_mfma_f32_32x32x16_bf16 v[64:79], v[112:115], v[88:91], v[64:79]
  v_exp_f32 v42, v42
  v_exp_f32 v43, v43
  v_exp_f32 v44, v44
  v_exp_f32 v45, v45
  v_exp_f32 v46, v46
  v_exp_f32 v47, v47
  v_cvt_pk_bf16_f32 v92, v40, v41
  v_cvt_pk_bf16_f32 v93, v42, v43
  v_cvt_pk_bf16_f32 v94, v44, v45
  v_cvt_pk_bf16_f32 v95, v46, v47
  v_exp_f32 v16, v16
  v_exp_f32 v17, v17
  v_mfma_f32_32x32x16_bf16 v[64:79], v[116:119], v[92:95], v[64:79]
  v_exp_f32 v18, v18
  v_exp_f32 v19, v19
  v_exp_f32 v20, v20
  v_exp_f32 v21, v21
  v_mfma_f32_32x32x16_bf16 v[32:47], v[96:99], v[84:87], v[160:175]
  s_waitcnt lgkmcnt(0)
  ds_read_b128 v[96:99], v124 offset:36864
  s_mov_b64 exec, s[20:21]
  ds_read_b128 v[112:115], v125 offset:35840
  ds_read_b128 v[116:119], v125 offset:36352
  s_mov_b64 exec, -1
  v_exp_f32 v22, v22
  v_exp_f32 v23, v23
  v_cvt_pk_bf16_f32 v88, v16, v17
  v_cvt_pk_bf16_f32 v89, v18, v19
  v_cvt_pk_bf16_f32 v90, v20, v21
  v_cvt_pk_bf16_f32 v91, v22, v23
  v_exp_f32 v24, v24
  v_exp_f32 v25, v25
  v_mfma_f32_32x32x16_bf16 v[48:63], v[104:107], v[88:91], v[48:63]
  v_exp_f32 v26, v26
  v_exp_f32 v27, v27
  v_exp_f32 v28, v28
  v_exp_f32 v29, v29
  v_exp_f32 v30, v30
  v_exp_f32 v31, v31
  v_cvt_pk_bf16_f32 v92, v24, v25
  v_cvt_pk_bf16_f32 v93, v26, v27
  v_cvt_pk_bf16_f32 v94, v28, v29
  v_cvt_pk_bf16_f32 v95, v30, v31
  v_exp_f32 v32, v32
  v_exp_f32 v33, v33
  v_mfma_f32_32x32x16_bf16 v[48:63], v[108:111], v[92:95], v[48:63]
  v_exp_f32 v34, v34
  v_exp_f32 v35, v35
  v_exp_f32 v36, v36
  v_exp_f32 v37, v37
  v_mfma_f32_32x32x16_bf16 v[16:31], v[100:103], v[80:83], v[144:159]
  v_exp_f32 v38, v38
  v_exp_f32 v39, v39
  v_cvt_pk_bf16_f32 v88, v32, v33
  v_cvt_pk_bf16_f32 v89, v34, v35
  v_cvt_pk_bf16_f32 v90, v36, v37
  v_cvt_pk_bf16_f32 v91, v38, v39
  v_exp_f32 v40, v40
  v_exp_f32 v41, v41
  v_mfma_f32_32x32x16_bf16 v[64:79], v[104:107], v[88:91], v[64:79]
  v_exp_f32 v42, v42
  v_exp_f32 v43, v43
  v_exp_f32 v44, v44
  v_exp_f32 v45, v45
  v_exp_f32 v46, v46
  v_exp_f32 v47, v47
  v_cvt_pk_bf16_f32 v92, v40, v41
  v_cvt_pk_bf16_f32 v93, v42, v43
  v_cvt_pk_bf16_f32 v94, v44, v45
  v_cvt_pk_bf16_f32 v95, v46, v47
  v_exp_f32 v16, v16
  v_exp_f32 v17, v17
  v_mfma_f32_32x32x16_bf16 v[64:79], v[108:111], v[92:95], v[64:79]
  v_exp_f32 v18, v18
  v_exp_f32 v19, v19
  v_exp_f32 v20, v20
  v_exp_f32 v21, v21
  v_mfma_f32_32x32x16_bf16 v[32:47], v[100:103], v[84:87], v[160:175]
  s_waitcnt lgkmcnt(0)
  s_cmp_lg_u32 s14, 4
  s_cbranch_scc1 wchk_81
  s_cmp_eq_u32 s13, 8
  s_cbranch_scc0 wchk_81
  s_getreg_b32 s23, hwreg(HW_REG_XCC_ID, 0, 3)
  s_lshl_b32 s23, s23, 7
  s_add_u32 s23, s23, 6883328
  v_mov_b32 v239, 0
  v_lshlrev_b32 v237, 7, v1
  s_mov_b32 s93, 0x80000
wchk_81_p:
  s_mov_b32 s22, 6848512
  buffer_load_dwordx2 v[216:217], v237, s[8:11], s22 offen sc1
  s_mov_b32 s22, 6856704
  buffer_load_dwordx2 v[218:219], v237, s[8:11], s22 offen sc1
  s_mov_b32 s22, 6864896
  buffer_load_dwordx2 v[220:221], v237, s[8:11], s22 offen sc1
  s_mov_b32 s22, 6873088
  buffer_load_dwordx2 v[222:223], v237, s[8:11], s22 offen sc1
  s_sub_u32 s93, s93, 1
  s_waitcnt vmcnt(0)
  v_xor_b32 v217, s94, v217
  v_xor_b32 v216, s95, v216
  v_xor_b32 v219, s94, v219
  v_xor_b32 v218, s95, v218
  v_xor_b32 v221, s94, v221
  v_xor_b32 v220, s95, v220
  v_xor_b32 v223, s94, v223
  v_xor_b32 v222, s95, v222
  v_or3_b32 v217, v217, v219, v221
  v_or_b32 v217, v217, v223
  v_cmp_ne_u32 vcc, 0, v217
  s_cmp_eq_u32 s93, 0
  s_cbranch_scc1 wchk_81_px
  s_cbranch_vccz wchk_81_px
  s_sleep 8
  s_branch wchk_81_p
wchk_81_px:
  v_or3_b32 v216, v216, v218, v220
  v_or_b32 v216, v216, v222
  v_cmp_ne_u32 vcc, 0, v216
  v_mov_b32 v233, s94
  v_mov_b32 v235, s94
  s_cmp_lg_u64 vcc, 0
  s_cselect_b32 s22, 2, 1
  v_mov_b32 v232, s22
  s_mov_b64 exec, 1
  buffer_store_dwordx4 v[232:235], v239, s[8:11], s23 offen
  s_mov_b64 exec, -1
wchk_81_w:
  v_mov_b32 v237, 134144
  ds_write_b32 v237, v232
wchk_81:
  ds_read_b128 v[100:103], v124 offset:37888
  s_mov_b64 exec, s[20:21]
  ds_read_b128 v[104:107], v125 offset:36864
  ds_read_b128 v[108:111], v125 offset:37376
  s_mov_b64 exec, -1
  v_exp_f32 v22, v22
  v_exp_f32 v23, v23
  v_cvt_pk_bf16_f32 v88, v16, v17
  v_cvt_pk_bf16_f32 v89, v18, v19
  v_cvt_pk_bf16_f32 v90, v20, v21
  v_cvt_pk_bf16_f32 v91, v22, v23
  v_exp_f32 v24, v24
  v_exp_f32 v25, v25
  v_mfma_f32_32x32x16_bf16 v[48:63], v[112:115], v[88:91], v[48:63]
  v_exp_f32 v26, v26
  v_exp_f32 v27, v27
  v_exp_f32 v28, v28
  v_exp_f32 v29, v29
  v_exp_f32 v30, v30
  v_exp_f32 v31, v31
  v_cvt_pk_bf16_f32 v92, v24, v25
  v_cvt_pk_bf16_f32 v93, v26, v27
  v_cvt_pk_bf16_f32 v94, v28, v29
  v_cvt_pk_bf16_f32 v95, v30, v31
  v_exp_f32 v32, v32
  v_exp_f32 v33, v33
  v_mfma_f32_32x32x16_bf16 v[48:63], v[116:119], v[92:95], v[48:63]
  v_exp_f32 v34, v34
  v_exp_f32 v35, v35
  v_exp_f32 v36, v36
  v_exp_f32 v37, v37
  v_mfma_f32_32x32x16_bf16 v[16:31], v[96:99], v[80:83], v[144:159]
  v_exp_f32 v38, v38
  v_exp_f32 v39, v39
  v_cvt_pk_bf16_f32 v88, v32, v33
  v_cvt_pk_bf16_f32 v89, v34, v35
  v_cvt_pk_bf16_f32 v90, v36, v37
  v_cvt_pk_bf16_f32 v91, v38, v39
  v_exp_f32 v40, v40
  v_exp_f32 v41, v41
  v_mfma_f32_32x32x16_bf16 v[64:79], v[112:115], v[88:91], v[64:79]
  v_exp_f32 v42, v42
  v_exp_f32 v43, v43
  v_exp_f32 v44, v44
  v_exp_f32 v45, v45
  v_exp_f32 v46, v46
  v_exp_f32 v47, v47
  v_cvt_pk_bf16_f32 v92, v40, v41
  v_cvt_pk_bf16_f32 v93, v42, v43
  v_cvt_pk_bf16_f32 v94, v44, v45
  v_cvt_pk_bf16_f32 v95, v46, v47
  v_exp_f32 v16, v16
  v_exp_f32 v17, v17
  v_mfma_f32_32x32x16_bf16 v[64:79], v[116:119], v[92:95], v[64:79]
  v_exp_f32 v18, v18
  v_exp_f32 v19, v19
  v_exp_f32 v20, v20
  v_exp_f32 v21, v21
  v_mfma_f32_32x32x16_bf16 v[32:47], v[96:99], v[84:87], v[160:175]
  s_waitcnt lgkmcnt(0)
  s_cmp_eq_u32 s38, 0
  s_cbranch_scc1 prio_82
  s_setprio 0
prio_82:
  ds_read_b128 v[96:99], v124 offset:38912
  s_mov_b64 exec, s[20:21]
  ds_read_b128 v[112:115], v125 offset:37888
  ds_read_b128 v[116:119], v125 offset:38400
  s_mov_b64 exec, -1
  v_exp_f32 v22, v22
  v_exp_f32 v23, v23
  v_cvt_pk_bf16_f32 v88, v16, v17
  v_cvt_pk_bf16_f32 v89, v18, v19
  v_cvt_pk_bf16_f32 v90, v20, v21
  v_cvt_pk_bf16_f32 v91, v22, v23
  v_exp_f32 v24, v24
  v_exp_f32 v25, v25
  v_mfma_f32_32x32x16_bf16 v[48:63], v[104:107], v[88:91], v[48:63]
  v_exp_f32 v26, v26
  v_exp_f32 v27, v27
  v_exp_f32 v28, v28
  v_exp_f32 v29, v29
  v_exp_f32 v30, v30
  v_exp_f32 v31, v31
  v_cvt_pk_bf16_f32 v92, v24, v25
  v_cvt_pk_bf16_f32 v93, v26, v27
  v_cvt_pk_bf16_f32 v94, v28, v29
  v_cvt_pk_bf16_f32 v95, v30, v31
  v_exp_f32 v32, v32
  v_exp_f32 v33, v33
  v_mfma_f32_32x32x16_bf16 v[48:63], v[108:111], v[92:95], v[48:63]
  v_exp_f32 v34, v34
  v_exp_f32 v35, v35
  v_exp_f32 v36, v36
  v_exp_f32 v37, v37
  v_mfma_f32_32x32x16_bf16 v[16:31], v[100:103], v[80:83], v[144:159]
  v_exp_f32 v38, v38
  v_exp_f32 v39, v39
  v_cvt_pk_bf16_f32 v88, v32, v33
  v_cvt_pk_bf16_f32 v89, v34, v35
  v_cvt_pk_bf16_f32 v90, v36, v37
  v_cvt_pk_bf16_f32 v91, v38, v39
  v_exp_f32 v40, v40
  v_exp_f32 v41, v41
  v_mfma_f32_32x32x16_bf16 v[64:79], v[104:107], v[88:91], v[64:79]
  v_exp_f32 v42, v42
  v_exp_f32 v43, v43
  v_exp_f32 v44, v44
  v_exp_f32 v45, v45
  v_exp_f32 v46, v46
  v_exp_f32 v47, v47
  v_cvt_pk_bf16_f32 v92, v40, v41
  v_cvt_pk_bf16_f32 v93, v42, v43
  v_cvt_pk_bf16_f32 v94, v44, v45
  v_cvt_pk_bf16_f32 v95, v46, v47
  v_exp_f32 v16, v16
  v_exp_f32 v17, v17
  v_mfma_f32_32x32x16_bf16 v[64:79], v[108:111], v[92:95], v[64:79]
  v_exp_f32 v18, v18
  v_exp_f32 v19, v19
  v_exp_f32 v20, v20
  v_exp_f32 v21, v21
  v_mfma_f32_32x32x16_bf16 v[32:47], v[100:103], v[84:87], v[160:175]
  s_waitcnt lgkmcnt(0)
  s_cmp_lg_u32 s14, 4
  s_cbranch_scc1 wchk_83
  s_cmp_eq_u32 s13, 8
  s_cbranch_scc1 wchk_83
  s_getreg_b32 s23, hwreg(HW_REG_XCC_ID, 0, 3)
  s_lshl_b32 s23, s23, 7
  s_add_u32 s23, s23, 6883328
  v_mov_b32 v239, 0
  s_mov_b32 s93, 48
wchk_83_l:
  buffer_load_dwordx4 v[232:235], v239, s[8:11], s23 offen sc1
  s_sub_u32 s93, s93, 1
  s_waitcnt vmcnt(0)
  v_cmp_ne_u32 s[24:25], s94, v233
  v_cmp_ne_u32 vcc, s94, v235
  s_or_b64 vcc, vcc, s[24:25]
  s_cmp_eq_u32 s93, 0
  s_cbranch_scc1 wchk_83_l_x
  s_cbranch_vccz wchk_83_l_x
  s_sleep 1
  s_branch wchk_83_l
wchk_83_l_x:
  s_cbranch_vccz wchk_83_w
  v_lshlrev_b32 v237, 7, v1
  s_mov_b32 s93, 0x80000
wchk_83_p:
  s_mov_b32 s22, 6848512
  buffer_load_dwordx2 v[216:217], v237, s[8:11], s22 offen sc1
  s_mov_b32 s22, 6856704
  buffer_load_dwordx2 v[218:219], v237, s[8:11], s22 offen sc1
  s_mov_b32 s22, 6864896
  buffer_load_dwordx2 v[220:221], v237, s[8:11], s22 offen sc1
  s_mov_b32 s22, 6873088
  buffer_load_dwordx2 v[222:223], v237, s[8:11], s22 offen sc1
  s_sub_u32 s93, s93, 1
  s_waitcnt vmcnt(0)
  v_xor_b32 v217, s94, v217
  v_xor_b32 v216, s95, v216
  v_xor_b32 v219, s94, v219
  v_xor_b32 v218, s95, v218
  v_xor_b32 v221, s94, v221
  v_xor_b32 v220, s95, v220
  v_xor_b32 v223, s94, v223
  v_xor_b32 v222, s95, v222
  v_or3_b32 v217, v217, v219, v221
  v_or_b32 v217, v217, v223
  v_cmp_ne_u32 vcc, 0, v217
  s_cmp_eq_u32 s93, 0
  s_cbranch_scc1 wchk_83_px
  s_cbranch_vccz wchk_83_px
  s_sleep 8
  s_branch wchk_83_p
wchk_83_px:
  v_or3_b32 v216, v216, v218, v220
  v_or_b32 v216, v216, v222
  v_cmp_ne_u32 vcc, 0, v216
  v_mov_b32 v233, s94
  v_mov_b32 v235, s94
  s_cmp_lg_u64 vcc, 0
  s_cselect_b32 s22, 2, 1
  v_mov_b32 v232, s22
wchk_83_w:
  v_mov_b32 v237, 134144
  ds_write_b32 v237, v232
wchk_83:
  ds_read_b128 v[100:103], v124 offset:39936
  s_mov_b64 exec, s[20:21]
  ds_read_b128 v[104:107], v125 offset:38912
  ds_read_b128 v[108:111], v125 offset:39424
  s_mov_b64 exec, -1
  v_exp_f32 v22, v22
  v_exp_f32 v23, v23
  v_cvt_pk_bf16_f32 v88, v16, v17
  v_cvt_pk_bf16_f32 v89, v18, v19
  v_cvt_pk_bf16_f32 v90, v20, v21
  v_cvt_pk_bf16_f32 v91, v22, v23
  v_exp_f32 v24, v24
  v_exp_f32 v25, v25
  v_mfma_f32_32x32x16_bf16 v[48:63], v[112:115], v[88:91], v[48:63]
  v_exp_f32 v26, v26
  v_exp_f32 v27, v27
  v_exp_f32 v28, v28
  v_exp_f32 v29, v29
  v_exp_f32 v30, v30
  v_exp_f32 v31, v31
  v_cvt_pk_bf16_f32 v92, v24, v25
  v_cvt_pk_bf16_f32 v93, v26, v27
  v_cvt_pk_bf16_f32 v94, v28, v29
  v_cvt_pk_bf16_f32 v95, v30, v31
  v_exp_f32 v32, v32
  v_exp_f32 v33, v33
  v_mfma_f32_32x32x16_bf16 v[48:63], v[116:119], v[92:95], v[48:63]
  v_exp_f32 v34, v34
  v_exp_f32 v35, v35
  v_exp_f32 v36, v36
  v_exp_f32 v37, v37
  v_mfma_f32_32x32x16_bf16 v[16:31], v[96:99], v[80:83], v[144:159]
  v_exp_f32 v38, v38
  v_exp_f32 v39, v39
  v_cvt_pk_bf16_f32 v88, v32, v33
  v_cvt_pk_bf16_f32 v89, v34, v35
  v_cvt_pk_bf16_f32 v90, v36, v37
  v_cvt_pk_bf16_f32 v91, v38, v39
  v_exp_f32 v40, v40
  v_exp_f32 v41, v41
  v_mfma_f32_32x32x16_bf16 v[64:79], v[112:115], v[88:91], v[64:79]
  v_exp_f32 v42, v42
  v_exp_f32 v43, v43
  v_exp_f32 v44, v44
  v_exp_f32 v45, v45
  v_exp_f32 v46, v46
  v_exp_f32 v47, v47
  v_cvt_pk_bf16_f32 v92, v40, v41
  v_cvt_pk_bf16_f32 v93, v42, v43
  v_cvt_pk_bf16_f32 v94, v44, v45
  v_cvt_pk_bf16_f32 v95, v46, v47
  v_exp_f32 v16, v16
  v_exp_f32 v17, v17
  v_mfma_f32_32x32x16_bf16 v[64:79], v[116:119], v[92:95], v[64:79]
  v_exp_f32 v18, v18
  v_exp_f32 v19, v19
  v_exp_f32 v20, v20
  v_exp_f32 v21, v21
  v_mfma_f32_32x32x16_bf16 v[32:47], v[96:99], v[84:87], v[160:175]
  s_waitcnt lgkmcnt(0)
  v_mov_b32 v237, 134144
  s_mov_b32 s93, 0x4000000
wrdy_84:
  ds_read_b32 v236, v237
  s_sub_u32 s93, s93, 1
  s_waitcnt lgkmcnt(0)
  v_readfirstlane_b32 s92, v236
  s_cmp_eq_u32 s93, 0
  s_cbranch_scc1 wrdy_84_x
  s_cmp_eq_u32 s92, 0
  s_cbranch_scc1 wrdy_84
wrdy_84_x:
  s_sub_u32 s92, s92, 1
  s_cmp_eq_u32 s38, 0
  s_cbranch_scc1 prio_85
  s_setprio 1
prio_85:
  s_waitcnt vmcnt(1)
  s_barrier
  s_add_u32 s28, s48, 6
  s_and_b32 s28, s28, 7
  s_lshl_b32 s28, s28, 13
  s_add_u32 s28, s28, s27
  s_add_u32 m0, s26, 98304
  s_nop 0
  buffer_load_dwordx4 v2, s[8:11], s28 offen lds
  buffer_load_dwordx4 v2, s[8:11], s28 offen offset:1024 lds
  s_add_u32 m0, s26, 114688
  s_add_u32 s28, s28, 65536
  buffer_load_dwordx4 v2, s[8:11], s28 offen lds
  buffer_load_dwordx4 v2, s[8:11], s28 offen offset:1024 lds
  s_lshl_b32 s28, s14, 12
  s_add_u32 m0, s28, 0
  s_add_u32 s28, s33, 0
  buffer_load_dwordx4 v2, s[8:11], s28 offen offset:0 lds
  buffer_load_dwordx4 v2, s[8:11], s28 offen offset:1024 lds
  buffer_load_dwordx4 v2, s[8:11], s28 offen offset:2048 lds
  buffer_load_dwordx4 v2, s[8:11], s28 offen offset:3072 lds
  ds_read_b128 v[96:99], v126 offset:0
  s_mov_b64 exec, s[20:21]
  ds_read_b128 v[112:115], v125 offset:39936
  ds_read_b128 v[116:119], v125 offset:40448
  s_mov_b64 exec, -1
  v_exp_f32 v22, v22
  v_exp_f32 v23, v23
  v_cvt_pk_bf16_f32 v88, v16, v17
  v_cvt_pk_bf16_f32 v89, v18, v19
  v_cvt_pk_bf16_f32 v90, v20, v21
  v_cvt_pk_bf16_f32 v91, v22, v23
  v_exp_f32 v24, v24
  v_exp_f32 v25, v25
  v_mfma_f32_32x32x16_bf16 v[48:63], v[104:107], v[88:91], v[48:63]
  v_exp_f32 v26, v26
  v_exp_f32 v27, v27
  v_exp_f32 v28, v28
  v_exp_f32 v29, v29
  v_exp_f32 v30, v30
  v_exp_f32 v31, v31
  v_cvt_pk_bf16_f32 v92, v24, v25
  v_cvt_pk_bf16_f32 v93, v26, v27
  v_cvt_pk_bf16_f32 v94, v28, v29
  v_cvt_pk_bf16_f32 v95, v30, v31
  v_exp_f32 v32, v32
  v_exp_f32 v33, v33
  v_mfma_f32_32x32x16_bf16 v[48:63], v[108:111], v[92:95], v[48:63]
  v_exp_f32 v34, v34
  v_exp_f32 v35, v35
  v_exp_f32 v36, v36
  v_exp_f32 v37, v37
  v_mfma_f32_32x32x16_bf16 v[16:31], v[100:103], v[80:83], v[144:159]
  v_exp_f32 v38, v38
  v_exp_f32 v39, v39
  v_cvt_pk_bf16_f32 v88, v32, v33
  v_cvt_pk_bf16_f32 v89, v34, v35
  v_cvt_pk_bf16_f32 v90, v36, v37
  v_cvt_pk_bf16_f32 v91, v38, v39
  v_exp_f32 v40, v40
  v_exp_f32 v41, v41
  v_mfma_f32_32x32x16_bf16 v[64:79], v[104:107], v[88:91], v[64:79]
  v_exp_f32 v42, v42
  v_exp_f32 v43, v43
  v_exp_f32 v44, v44
  v_exp_f32 v45, v45
  v_exp_f32 v46, v46
  v_exp_f32 v47, v47
  v_cvt_pk_bf16_f32 v92, v40, v41
  v_cvt_pk_bf16_f32 v93, v42, v43
  v_cvt_pk_bf16_f32 v94, v44, v45
  v_cvt_pk_bf16_f32 v95, v46, v47
  v_exp_f32 v16, v16
  v_exp_f32 v17, v17
  v_mfma_f32_32x32x16_bf16 v[64:79], v[108:111], v[92:95], v[64:79]
  v_exp_f32 v18, v18
  v_exp_f32 v19, v19
  v_exp_f32 v20, v20
  v_exp_f32 v21, v21
  v_mfma_f32_32x32x16_bf16 v[32:47], v[100:103], v[84:87], v[160:175]
  s_waitcnt lgkmcnt(0)
  ds_read_b128 v[100:103], v126 offset:1024
  s_mov_b64 exec, s[20:21]
  ds_read_b128 v[104:107], v127 offset:0
  ds_read_b128 v[108:111], v127 offset:512
  s_mov_b64 exec, -1
  v_exp_f32 v22, v22
  v_exp_f32 v23, v23
  v_cvt_pk_bf16_f32 v88, v16, v17
  v_cvt_pk_bf16_f32 v89, v18, v19
  v_cvt_pk_bf16_f32 v90, v20, v21
  v_cvt_pk_bf16_f32 v91, v22, v23
  v_exp_f32 v24, v24
  v_exp_f32 v25, v25
  v_mfma_f32_32x32x16_bf16 v[48:63], v[112:115], v[88:91], v[48:63]
  v_exp_f32 v26, v26
  v_exp_f32 v27, v27
  v_exp_f32 v28, v28
  v_exp_f32 v29, v29
  v_exp_f32 v30, v30
  v_exp_f32 v31, v31
  v_cvt_pk_bf16_f32 v92, v24, v25
  v_cvt_pk_bf16_f32 v93, v26, v27
  v_cvt_pk_bf16_f32 v94, v28, v29
  v_cvt_pk_bf16_f32 v95, v30, v31
  v_exp_f32 v32, v32
  v_exp_f32 v33, v33
  v_mfma_f32_32x32x16_bf16 v[48:63], v[116:119], v[92:95], v[48:63]
  v_exp_f32 v34, v34
  v_exp_f32 v35, v35
  v_exp_f32 v36, v36
  v_exp_f32 v37, v37
  v_mfma_f32_32x32x16_bf16 v[16:31], v[96:99], v[80:83], v[144:159]
  v_exp_f32 v38, v38
  v_exp_f32 v39, v39
  v_cvt_pk_bf16_f32 v88, v32, v33
  v_cvt_pk_bf16_f32 v89, v34, v35
  v_cvt_pk_bf16_f32 v90, v36, v37
  v_cvt_pk_bf16_f32 v91, v38, v39
  v_exp_f32 v40, v40
  v_exp_f32 v41, v41
  v_mfma_f32_32x32x16_bf16 v[64:79], v[112:115], v[88:91], v[64:79]
  v_exp_f32 v42, v42
  v_exp_f32 v43, v43
  v_exp_f32 v44, v44
  v_exp_f32 v45, v45
  v_exp_f32 v46, v46
  v_exp_f32 v47, v47
  v_cvt_pk_bf16_f32 v92, v40, v41
  v_cvt_pk_bf16_f32 v93, v42, v43
  v_cvt_pk_bf16_f32 v94, v44, v45
  v_cvt_pk_bf16_f32 v95, v46, v47
  v_exp_f32 v16, v16
  v_exp_f32 v17, v17
  v_mfma_f32_32x32x16_bf16 v[64:79], v[116:119], v[92:95], v[64:79]
  v_exp_f32 v18, v18
  v_exp_f32 v19, v19
  v_exp_f32 v20, v20
  v_exp_f32 v21, v21
  v_mfma_f32_32x32x16_bf16 v[32:47], v[96:99], v[84:87], v[160:175]
  s_waitcnt lgkmcnt(0)
  ds_read_b128 v[96:99], v126 offset:2048
  s_mov_b64 exec, s[20:21]
  ds_read_b128 v[112:115], v127 offset:1024
  ds_read_b128 v[116:119], v127 offset:1536
  s_mov_b64 exec, -1
  v_exp_f32 v22, v22
  v_exp_f32 v23, v23
  v_cvt_pk_bf16_f32 v88, v16, v17
  v_cvt_pk_bf16_f32 v89, v18, v19
  v_cvt_pk_bf16_f32 v90, v20, v21
  v_cvt_pk_bf16_f32 v91, v22, v23
  v_exp_f32 v24, v24
  v_exp_f32 v25, v25
  v_mfma_f32_32x32x16_bf16 v[48:63], v[104:107], v[88:91], v[48:63]
  v_exp_f32 v26, v26
  v_exp_f32 v27, v27
  v_exp_f32 v28, v28
  v_exp_f32 v29, v29
  v_exp_f32 v30, v30
  v_exp_f32 v31, v31
  v_cvt_pk_bf16_f32 v92, v24, v25
  v_cvt_pk_bf16_f32 v93, v26, v27
  v_cvt_pk_bf16_f32 v94, v28, v29
  v_cvt_pk_bf16_f32 v95, v30, v31
  v_exp_f32 v32, v32
  v_exp_f32 v33, v33
  v_mfma_f32_32x32x16_bf16 v[48:63], v[108:111], v[92:95], v[48:63]
  v_exp_f32 v34, v34
  v_exp_f32 v35, v35
  v_exp_f32 v36, v36
  v_exp_f32 v37, v37
  v_mfma_f32_32x32x16_bf16 v[16:31], v[100:103], v[80:83], v[144:159]
  v_exp_f32 v38, v38
  v_exp_f32 v39, v39
  v_cvt_pk_bf16_f32 v88, v32, v33
  v_cvt_pk_bf16_f32 v89, v34, v35
  v_cvt_pk_bf16_f32 v90, v36, v37
  v_cvt_pk_bf16_f32 v91, v38, v39
  v_exp_f32 v40, v40
  v_exp_f32 v41, v41
  v_mfma_f32_32x32x16_bf16 v[64:79], v[104:107], v[88:91], v[64:79]
  v_exp_f32 v42, v42
  v_exp_f32 v43, v43
  v_exp_f32 v44, v44
  v_exp_f32 v45, v45
  v_exp_f32 v46, v46
  v_exp_f32 v47, v47
  v_cvt_pk_bf16_f32 v92, v40, v41
  v_cvt_pk_bf16_f32 v93, v42, v43
  v_cvt_pk_bf16_f32 v94, v44, v45
  v_cvt_pk_bf16_f32 v95, v46, v47
  v_exp_f32 v16, v16
  v_exp_f32 v17, v17
  v_mfma_f32_32x32x16_bf16 v[64:79], v[108:111], v[92:95], v[64:79]
  v_exp_f32 v18, v18
  v_exp_f32 v19, v19
  v_exp_f32 v20, v20
  v_exp_f32 v21, v21
  v_mfma_f32_32x32x16_bf16 v[32:47], v[100:103], v[84:87], v[160:175]
  s_waitcnt lgkmcnt(0)
  ds_read_b128 v[100:103], v126 offset:3072
  s_mov_b64 exec, s[20:21]
  ds_read_b128 v[104:107], v127 offset:2048
  ds_read_b128 v[108:111], v127 offset:2560
  s_mov_b64 exec, -1
  v_exp_f32 v22, v22
  v_exp_f32 v23, v23
  v_cvt_pk_bf16_f32 v88, v16, v17
  v_cvt_pk_bf16_f32 v89, v18, v19
  v_cvt_pk_bf16_f32 v90, v20, v21
  v_cvt_pk_bf16_f32 v91, v22, v23
  v_exp_f32 v24, v24
  v_exp_f32 v25, v25
  v_mfma_f32_32x32x16_bf16 v[48:63], v[112:115], v[88:91], v[48:63]
  v_exp_f32 v26, v26
  v_exp_f32 v27, v27
  v_exp_f32 v28, v28
  v_exp_f32 v29, v29
  v_exp_f32 v30, v30
  v_exp_f32 v31, v31
  v_cvt_pk_bf16_f32 v92, v24, v25
  v_cvt_pk_bf16_f32 v93, v26, v27
  v_cvt_pk_bf16_f32 v94, v28, v29
  v_cvt_pk_bf16_f32 v95, v30, v31
  v_exp_f32 v32, v32
  v_exp_f32 v33, v33
  v_mfma_f32_32x32x16_bf16 v[48:63], v[116:119], v[92:95], v[48:63]
  v_exp_f32 v34, v34
  v_exp_f32 v35, v35
  v_exp_f32 v36, v36
  v_exp_f32 v37, v37
  v_mfma_f32_32x32x16_bf16 v[16:31], v[96:99], v[80:83], v[144:159]
  v_exp_f32 v38, v38
  v_exp_f32 v39, v39
  v_cvt_pk_bf16_f32 v88, v32, v33
  v_cvt_pk_bf16_f32 v89, v34, v35
  v_cvt_pk_bf16_f32 v90, v36, v37
  v_cvt_pk_bf16_f32 v91, v38, v39
  v_exp_f32 v40, v40
  v_exp_f32 v41, v41
  v_mfma_f32_32x32x16_bf16 v[64:79], v[112:115], v[88:91], v[64:79]
  v_exp_f32 v42, v42
  v_exp_f32 v43, v43
  v_exp_f32 v44, v44
  v_exp_f32 v45, v45
  v_exp_f32 v46, v46
  v_exp_f32 v47, v47
  v_cvt_pk_bf16_f32 v92, v40, v41
  v_cvt_pk_bf16_f32 v93, v42, v43
  v_cvt_pk_bf16_f32 v94, v44, v45
  v_cvt_pk_bf16_f32 v95, v46, v47
  v_exp_f32 v16, v16
  v_exp_f32 v17, v17
  v_mfma_f32_32x32x16_bf16 v[64:79], v[116:119], v[92:95], v[64:79]
  v_exp_f32 v18, v18
  v_exp_f32 v19, v19
  v_exp_f32 v20, v20
  v_exp_f32 v21, v21
  v_mfma_f32_32x32x16_bf16 v[32:47], v[96:99], v[84:87], v[160:175]
  s_waitcnt lgkmcnt(0)
  ds_read_b128 v[96:99], v126 offset:4096
  s_mov_b64 exec, s[20:21]
  ds_read_b128 v[112:115], v127 offset:3072
  ds_read_b128 v[116:119], v127 offset:3584
  s_mov_b64 exec, -1
  v_exp_f32 v22, v22
  v_exp_f32 v23, v23
  v_cvt_pk_bf16_f32 v88, v16, v17
  v_cvt_pk_bf16_f32 v89, v18, v19
  v_cvt_pk_bf16_f32 v90, v20, v21
  v_cvt_pk_bf16_f32 v91, v22, v23
  v_exp_f32 v24, v24
  v_exp_f32 v25, v25
  v_mfma_f32_32x32x16_bf16 v[48:63], v[104:107], v[88:91], v[48:63]
  v_exp_f32 v26, v26
  v_exp_f32 v27, v27
  v_exp_f32 v28, v28
  v_exp_f32 v29, v29
  v_exp_f32 v30, v30
  v_exp_f32 v31, v31
  v_cvt_pk_bf16_f32 v92, v24, v25
  v_cvt_pk_bf16_f32 v93, v26, v27
  v_cvt_pk_bf16_f32 v94, v28, v29
  v_cvt_pk_bf16_f32 v95, v30, v31
  v_exp_f32 v32, v32
  v_exp_f32 v33, v33
  v_mfma_f32_32x32x16_bf16 v[48:63], v[108:111], v[92:95], v[48:63]
  v_exp_f32 v34, v34
  v_exp_f32 v35, v35
  v_exp_f32 v36, v36
  v_exp_f32 v37, v37
  v_mfma_f32_32x32x16_bf16 v[16:31], v[100:103], v[80:83], v[144:159]
  v_exp_f32 v38, v38
  v_exp_f32 v39, v39
  v_cvt_pk_bf16_f32 v88, v32, v33
  v_cvt_pk_bf16_f32 v89, v34, v35
  v_cvt_pk_bf16_f32 v90, v36, v37
  v_cvt_pk_bf16_f32 v91, v38, v39
  v_exp_f32 v40, v40
  v_exp_f32 v41, v41
  v_mfma_f32_32x32x16_bf16 v[64:79], v[104:107], v[88:91], v[64:79]
  v_exp_f32 v42, v42
  v_exp_f32 v43, v43
  v_exp_f32 v44, v44
  v_exp_f32 v45, v45
  v_exp_f32 v46, v46
  v_exp_f32 v47, v47
  v_cvt_pk_bf16_f32 v92, v40, v41
  v_cvt_pk_bf16_f32 v93, v42, v43
  v_cvt_pk_bf16_f32 v94, v44, v45
  v_cvt_pk_bf16_f32 v95, v46, v47
  v_exp_f32 v16, v16
  v_exp_f32 v17, v17
  v_mfma_f32_32x32x16_bf16 v[64:79], v[108:111], v[92:95], v[64:79]
  v_exp_f32 v18, v18
  v_exp_f32 v19, v19
  v_exp_f32 v20, v20
  v_exp_f32 v21, v21
  v_mfma_f32_32x32x16_bf16 v[32:47], v[100:103], v[84:87], v[160:175]
  s_waitcnt lgkmcnt(0)
  ds_read_b128 v[100:103], v126 offset:5120
  s_mov_b64 exec, s[20:21]
  ds_read_b128 v[104:107], v127 offset:4096
  ds_read_b128 v[108:111], v127 offset:4608
  s_mov_b64 exec, -1
  v_exp_f32 v22, v22
  v_exp_f32 v23, v23
  v_cvt_pk_bf16_f32 v88, v16, v17
  v_cvt_pk_bf16_f32 v89, v18, v19
  v_cvt_pk_bf16_f32 v90, v20, v21
  v_cvt_pk_bf16_f32 v91, v22, v23
  v_exp_f32 v24, v24
  v_exp_f32 v25, v25
  v_mfma_f32_32x32x16_bf16 v[48:63], v[112:115], v[88:91], v[48:63]
  v_exp_f32 v26, v26
  v_exp_f32 v27, v27
  v_exp_f32 v28, v28
  v_exp_f32 v29, v29
  v_exp_f32 v30, v30
  v_exp_f32 v31, v31
  v_cvt_pk_bf16_f32 v92, v24, v25
  v_cvt_pk_bf16_f32 v93, v26, v27
  v_cvt_pk_bf16_f32 v94, v28, v29
  v_cvt_pk_bf16_f32 v95, v30, v31
  v_exp_f32 v32, v32
  v_exp_f32 v33, v33
  v_mfma_f32_32x32x16_bf16 v[48:63], v[116:119], v[92:95], v[48:63]
  v_exp_f32 v34, v34
  v_exp_f32 v35, v35
  v_exp_f32 v36, v36
  v_exp_f32 v37, v37
  v_mfma_f32_32x32x16_bf16 v[16:31], v[96:99], v[80:83], v[144:159]
  v_exp_f32 v38, v38
  v_exp_f32 v39, v39
  v_cvt_pk_bf16_f32 v88, v32, v33
  v_cvt_pk_bf16_f32 v89, v34, v35
  v_cvt_pk_bf16_f32 v90, v36, v37
  v_cvt_pk_bf16_f32 v91, v38, v39
  v_exp_f32 v40, v40
  v_exp_f32 v41, v41
  v_mfma_f32_32x32x16_bf16 v[64:79], v[112:115], v[88:91], v[64:79]
  v_exp_f32 v42, v42
  v_exp_f32 v43, v43
  v_exp_f32 v44, v44
  v_exp_f32 v45, v45
  v_exp_f32 v46, v46
  v_exp_f32 v47, v47
  v_cvt_pk_bf16_f32 v92, v40, v41
  v_cvt_pk_bf16_f32 v93, v42, v43
  v_cvt_pk_bf16_f32 v94, v44, v45
  v_cvt_pk_bf16_f32 v95, v46, v47
  v_exp_f32 v16, v16
  v_exp_f32 v17, v17
  v_mfma_f32_32x32x16_bf16 v[64:79], v[116:119], v[92:95], v[64:79]
  v_exp_f32 v18, v18
  v_exp_f32 v19, v19
  v_exp_f32 v20, v20
  v_exp_f32 v21, v21
  v_mfma_f32_32x32x16_bf16 v[32:47], v[96:99], v[84:87], v[160:175]
  s_waitcnt lgkmcnt(0)
  s_cmp_eq_u32 s38, 0
  s_cbranch_scc1 prio_86
  s_setprio 0
prio_86:
  ds_read_b128 v[96:99], v126 offset:6144
  s_mov_b64 exec, s[20:21]
  ds_read_b128 v[112:115], v127 offset:5120
  ds_read_b128 v[116:119], v127 offset:5632
  s_mov_b64 exec, -1
  v_exp_f32 v22, v22
  v_exp_f32 v23, v23
  v_cvt_pk_bf16_f32 v88, v16, v17
  v_cvt_pk_bf16_f32 v89, v18, v19
  v_cvt_pk_bf16_f32 v90, v20, v21
  v_cvt_pk_bf16_f32 v91, v22, v23
  v_exp_f32 v24, v24
  v_exp_f32 v25, v25
  v_mfma_f32_32x32x16_bf16 v[48:63], v[104:107], v[88:91], v[48:63]
  v_exp_f32 v26, v26
  v_exp_f32 v27, v27
  v_exp_f32 v28, v28
  v_exp_f32 v29, v29
  v_exp_f32 v30, v30
  v_exp_f32 v31, v31
  v_cvt_pk_bf16_f32 v92, v24, v25
  v_cvt_pk_bf16_f32 v93, v26, v27
  v_cvt_pk_bf16_f32 v94, v28, v29
  v_cvt_pk_bf16_f32 v95, v30, v31
  v_exp_f32 v32, v32
  v_exp_f32 v33, v33
  v_mfma_f32_32x32x16_bf16 v[48:63], v[108:111], v[92:95], v[48:63]
  v_exp_f32 v34, v34
  v_exp_f32 v35, v35
  v_exp_f32 v36, v36
  v_exp_f32 v37, v37
  v_mfma_f32_32x32x16_bf16 v[16:31], v[100:103], v[80:83], v[144:159]
  v_exp_f32 v38, v38
  v_exp_f32 v39, v39
  v_cvt_pk_bf16_f32 v88, v32, v33
  v_cvt_pk_bf16_f32 v89, v34, v35
  v_cvt_pk_bf16_f32 v90, v36, v37
  v_cvt_pk_bf16_f32 v91, v38, v39
  v_exp_f32 v40, v40
  v_exp_f32 v41, v41
  v_mfma_f32_32x32x16_bf16 v[64:79], v[104:107], v[88:91], v[64:79]
  v_exp_f32 v42, v42
  v_exp_f32 v43, v43
  v_exp_f32 v44, v44
  v_exp_f32 v45, v45
  v_exp_f32 v46, v46
  v_exp_f32 v47, v47
  v_cvt_pk_bf16_f32 v92, v40, v41
  v_cvt_pk_bf16_f32 v93, v42, v43
  v_cvt_pk_bf16_f32 v94, v44, v45
  v_cvt_pk_bf16_f32 v95, v46, v47
  v_exp_f32 v16, v16
  v_exp_f32 v17, v17
  v_mfma_f32_32x32x16_bf16 v[64:79], v[108:111], v[92:95], v[64:79]
  v_exp_f32 v18, v18
  v_exp_f32 v19, v19
  v_exp_f32 v20, v20
  v_exp_f32 v21, v21
  v_mfma_f32_32x32x16_bf16 v[32:47], v[100:103], v[84:87], v[160:175]
  s_waitcnt lgkmcnt(0)
  ds_read_b128 v[100:103], v126 offset:7168
  s_mov_b64 exec, s[20:21]
  ds_read_b128 v[104:107], v127 offset:6144
  ds_read_b128 v[108:111], v127 offset:6656
  s_mov_b64 exec, -1
  v_exp_f32 v22, v22
  v_exp_f32 v23, v23
  v_cvt_pk_bf16_f32 v88, v16, v17
  v_cvt_pk_bf16_f32 v89, v18, v19
  v_cvt_pk_bf16_f32 v90, v20, v21
  v_cvt_pk_bf16_f32 v91, v22, v23
  v_exp_f32 v24, v24
  v_exp_f32 v25, v25
  v_mfma_f32_32x32x16_bf16 v[48:63], v[112:115], v[88:91], v[48:63]
  v_exp_f32 v26, v26
  v_exp_f32 v27, v27
  v_exp_f32 v28, v28
  v_exp_f32 v29, v29
  v_exp_f32 v30, v30
  v_exp_f32 v31, v31
  v_cvt_pk_bf16_f32 v92, v24, v25
  v_cvt_pk_bf16_f32 v93, v26, v27
  v_cvt_pk_bf16_f32 v94, v28, v29
  v_cvt_pk_bf16_f32 v95, v30, v31
  v_exp_f32 v32, v32
  v_exp_f32 v33, v33
  v_mfma_f32_32x32x16_bf16 v[48:63], v[116:119], v[92:95], v[48:63]
  v_exp_f32 v34, v34
  v_exp_f32 v35, v35
  v_exp_f32 v36, v36
  v_exp_f32 v37, v37
  v_mfma_f32_32x32x16_bf16 v[16:31], v[96:99], v[80:83], v[144:159]
  v_exp_f32 v38, v38
  v_exp_f32 v39, v39
  v_cvt_pk_bf16_f32 v88, v32, v33
  v_cvt_pk_bf16_f32 v89, v34, v35
  v_cvt_pk_bf16_f32 v90, v36, v37
  v_cvt_pk_bf16_f32 v91, v38, v39
  v_exp_f32 v40, v40
  v_exp_f32 v41, v41
  v_mfma_f32_32x32x16_bf16 v[64:79], v[112:115], v[88:91], v[64:79]
  v_exp_f32 v42, v42
  v_exp_f32 v43, v43
  v_exp_f32 v44, v44
  v_exp_f32 v45, v45
  v_exp_f32 v46, v46
  v_exp_f32 v47, v47
  v_cvt_pk_bf16_f32 v92, v40, v41
  v_cvt_pk_bf16_f32 v93, v42, v43
  v_cvt_pk_bf16_f32 v94, v44, v45
  v_cvt_pk_bf16_f32 v95, v46, v47
  v_exp_f32 v16, v16
  v_exp_f32 v17, v17
  v_mfma_f32_32x32x16_bf16 v[64:79], v[116:119], v[92:95], v[64:79]
  v_exp_f32 v18, v18
  v_exp_f32 v19, v19
  v_exp_f32 v20, v20
  v_exp_f32 v21, v21
  v_mfma_f32_32x32x16_bf16 v[32:47], v[96:99], v[84:87], v[160:175]
  s_waitcnt lgkmcnt(0)
  s_cmp_eq_u32 s38, 0
  s_cbranch_scc1 prio_87
  s_setprio 1
prio_87:
  s_waitcnt vmcnt(4)
  s_barrier
  s_lshl_b32 s28, s14, 12
  s_add_u32 m0, s28, 32768
  s_add_u32 s28, s33, 57344
  buffer_load_dwordx4 v2, s[8:11], s28 offen offset:0 lds
  buffer_load_dwordx4 v2, s[8:11], s28 offen offset:1024 lds
  buffer_load_dwordx4 v2, s[8:11], s28 offen offset:2048 lds
  buffer_load_dwordx4 v2, s[8:11], s28 offen offset:3072 lds
  ds_read_b128 v[96:99], v126 offset:32768
  s_mov_b64 exec, s[20:21]
  ds_read_b128 v[112:115], v127 offset:7168
  ds_read_b128 v[116:119], v127 offset:7680
  s_mov_b64 exec, -1
  v_exp_f32 v22, v22
  v_exp_f32 v23, v23
  v_cvt_pk_bf16_f32 v88, v16, v17
  v_cvt_pk_bf16_f32 v89, v18, v19
  v_cvt_pk_bf16_f32 v90, v20, v21
  v_cvt_pk_bf16_f32 v91, v22, v23
  v_exp_f32 v24, v24
  v_exp_f32 v25, v25
  v_mfma_f32_32x32x16_bf16 v[48:63], v[104:107], v[88:91], v[48:63]
  v_exp_f32 v26, v26
  v_exp_f32 v27, v27
  v_exp_f32 v28, v28
  v_exp_f32 v29, v29
  v_exp_f32 v30, v30
  v_exp_f32 v31, v31
  v_cvt_pk_bf16_f32 v92, v24, v25
  v_cvt_pk_bf16_f32 v93, v26, v27
  v_cvt_pk_bf16_f32 v94, v28, v29
  v_cvt_pk_bf16_f32 v95, v30, v31
  v_exp_f32 v32, v32
  v_exp_f32 v33, v33
  v_mfma_f32_32x32x16_bf16 v[48:63], v[108:111], v[92:95], v[48:63]
  v_exp_f32 v34, v34
  v_exp_f32 v35, v35
  v_exp_f32 v36, v36
  v_exp_f32 v37, v37
  v_mfma_f32_32x32x16_bf16 v[16:31], v[100:103], v[80:83], v[144:159]
  v_exp_f32 v38, v38
  v_exp_f32 v39, v39
  v_cvt_pk_bf16_f32 v88, v32, v33
  v_cvt_pk_bf16_f32 v89, v34, v35
  v_cvt_pk_bf16_f32 v90, v36, v37
  v_cvt_pk_bf16_f32 v91, v38, v39
  v_exp_f32 v40, v40
  v_exp_f32 v41, v41
  v_mfma_f32_32x32x16_bf16 v[64:79], v[104:107], v[88:91], v[64:79]
  v_exp_f32 v42, v42
  v_exp_f32 v43, v43
  v_exp_f32 v44, v44
  v_exp_f32 v45, v45
  v_exp_f32 v46, v46
  v_exp_f32 v47, v47
  v_cvt_pk_bf16_f32 v92, v40, v41
  v_cvt_pk_bf16_f32 v93, v42, v43
  v_cvt_pk_bf16_f32 v94, v44, v45
  v_cvt_pk_bf16_f32 v95, v46, v47
  v_exp_f32 v16, v16
  v_exp_f32 v17, v17
  v_mfma_f32_32x32x16_bf16 v[64:79], v[108:111], v[92:95], v[64:79]
  v_exp_f32 v18, v18
  v_exp_f32 v19, v19
  v_exp_f32 v20, v20
  v_exp_f32 v21, v21
  v_mfma_f32_32x32x16_bf16 v[32:47], v[100:103], v[84:87], v[160:175]
  s_waitcnt lgkmcnt(0)
  ds_read_b128 v[100:103], v126 offset:33792
  s_mov_b64 exec, s[20:21]
  ds_read_b128 v[104:107], v127 offset:32768
  ds_read_b128 v[108:111], v127 offset:33280
  s_mov_b64 exec, -1
  v_exp_f32 v22, v22
  v_exp_f32 v23, v23
  v_cvt_pk_bf16_f32 v88, v16, v17
  v_cvt_pk_bf16_f32 v89, v18, v19
  v_cvt_pk_bf16_f32 v90, v20, v21
  v_cvt_pk_bf16_f32 v91, v22, v23
  v_exp_f32 v24, v24
  v_exp_f32 v25, v25
  v_mfma_f32_32x32x16_bf16 v[48:63], v[112:115], v[88:91], v[48:63]
  v_exp_f32 v26, v26
  v_exp_f32 v27, v27
  v_exp_f32 v28, v28
  v_exp_f32 v29, v29
  v_exp_f32 v30, v30
  v_exp_f32 v31, v31
  v_cvt_pk_bf16_f32 v92, v24, v25
  v_cvt_pk_bf16_f32 v93, v26, v27
  v_cvt_pk_bf16_f32 v94, v28, v29
  v_cvt_pk_bf16_f32 v95, v30, v31
  v_exp_f32 v32, v32
  v_exp_f32 v33, v33
  v_mfma_f32_32x32x16_bf16 v[48:63], v[116:119], v[92:95], v[48:63]
  v_exp_f32 v34, v34
  v_exp_f32 v35, v35
  v_exp_f32 v36, v36
  v_exp_f32 v37, v37
  v_mfma_f32_32x32x16_bf16 v[16:31], v[96:99], v[80:83], v[144:159]
  v_exp_f32 v38, v38
  v_exp_f32 v39, v39
  v_cvt_pk_bf16_f32 v88, v32, v33
  v_cvt_pk_bf16_f32 v89, v34, v35
  v_cvt_pk_bf16_f32 v90, v36, v37
  v_cvt_pk_bf16_f32 v91, v38, v39
  v_exp_f32 v40, v40
  v_exp_f32 v41, v41
  v_mfma_f32_32x32x16_bf16 v[64:79], v[112:115], v[88:91], v[64:79]
  v_exp_f32 v42, v42
  v_exp_f32 v43, v43
  v_exp_f32 v44, v44
  v_exp_f32 v45, v45
  v_exp_f32 v46, v46
  v_exp_f32 v47, v47
  v_cvt_pk_bf16_f32 v92, v40, v41
  v_cvt_pk_bf16_f32 v93, v42, v43
  v_cvt_pk_bf16_f32 v94, v44, v45
  v_cvt_pk_bf16_f32 v95, v46, v47
  v_exp_f32 v16, v16
  v_exp_f32 v17, v17
  v_mfma_f32_32x32x16_bf16 v[64:79], v[116:119], v[92:95], v[64:79]
  v_exp_f32 v18, v18
  v_exp_f32 v19, v19
  v_exp_f32 v20, v20
  v_exp_f32 v21, v21
  v_mfma_f32_32x32x16_bf16 v[32:47], v[96:99], v[84:87], v[160:175]
  s_waitcnt lgkmcnt(0)
  ds_read_b128 v[96:99], v126 offset:34816
  s_mov_b64 exec, s[20:21]
  ds_read_b128 v[112:115], v127 offset:33792
  ds_read_b128 v[116:119], v127 offset:34304
  s_mov_b64 exec, -1
  v_exp_f32 v22, v22
  v_exp_f32 v23, v23
  v_cvt_pk_bf16_f32 v88, v16, v17
  v_cvt_pk_bf16_f32 v89, v18, v19
  v_cvt_pk_bf16_f32 v90, v20, v21
  v_cvt_pk_bf16_f32 v91, v22, v23
  v_exp_f32 v24, v24
  v_exp_f32 v25, v25
  v_mfma_f32_32x32x16_bf16 v[48:63], v[104:107], v[88:91], v[48:63]
  v_exp_f32 v26, v26
  v_exp_f32 v27, v27
  v_exp_f32 v28, v28
  v_exp_f32 v29, v29
  v_exp_f32 v30, v30
  v_exp_f32 v31, v31
  v_cvt_pk_bf16_f32 v92, v24, v25
  v_cvt_pk_bf16_f32 v93, v26, v27
  v_cvt_pk_bf16_f32 v94, v28, v29
  v_cvt_pk_bf16_f32 v95, v30, v31
  v_exp_f32 v32, v32
  v_exp_f32 v33, v33
  v_mfma_f32_32x32x16_bf16 v[48:63], v[108:111], v[92:95], v[48:63]
  v_exp_f32 v34, v34
  v_exp_f32 v35, v35
  v_exp_f32 v36, v36
  v_exp_f32 v37, v37
  v_mfma_f32_32x32x16_bf16 v[16:31], v[100:103], v[80:83], v[144:159]
  v_exp_f32 v38, v38
  v_exp_f32 v39, v39
  v_cvt_pk_bf16_f32 v88, v32, v33
  v_cvt_pk_bf16_f32 v89, v34, v35
  v_cvt_pk_bf16_f32 v90, v36, v37
  v_cvt_pk_bf16_f32 v91, v38, v39
  v_exp_f32 v40, v40
  v_exp_f32 v41, v41
  v_mfma_f32_32x32x16_bf16 v[64:79], v[104:107], v[88:91], v[64:79]
  v_exp_f32 v42, v42
  v_exp_f32 v43, v43
  v_exp_f32 v44, v44
  v_exp_f32 v45, v45
  v_exp_f32 v46, v46
  v_exp_f32 v47, v47
  v_cvt_pk_bf16_f32 v92, v40, v41
  v_cvt_pk_bf16_f32 v93, v42, v43
  v_cvt_pk_bf16_f32 v94, v44, v45
  v_cvt_pk_bf16_f32 v95, v46, v47
  v_exp_f32 v16, v16
  v_exp_f32 v17, v17
  v_mfma_f32_32x32x16_bf16 v[64:79], v[108:111], v[92:95], v[64:79]
  v_exp_f32 v18, v18
  v_exp_f32 v19, v19
  v_exp_f32 v20, v20
  v_exp_f32 v21, v21
  v_mfma_f32_32x32x16_bf16 v[32:47], v[100:103], v[84:87], v[160:175]
  s_waitcnt lgkmcnt(0)
  ds_read_b128 v[100:103], v126 offset:35840
  s_mov_b64 exec, s[20:21]
  ds_read_b128 v[104:107], v127 offset:34816
  ds_read_b128 v[108:111], v127 offset:35328
  s_mov_b64 exec, -1
  v_exp_f32 v22, v22
  v_exp_f32 v23, v23
  v_cvt_pk_bf16_f32 v88, v16, v17
  v_cvt_pk_bf16_f32 v89, v18, v19
  v_cvt_pk_bf16_f32 v90, v20, v21
  v_cvt_pk_bf16_f32 v91, v22, v23
  v_exp_f32 v24, v24
  v_exp_f32 v25, v25
  v_mfma_f32_32x32x16_bf16 v[48:63], v[112:115], v[88:91], v[48:63]
  v_exp_f32 v26, v26
  v_exp_f32 v27, v27
  v_exp_f32 v28, v28
  v_exp_f32 v29, v29
  v_exp_f32 v30, v30
  v_exp_f32 v31, v31
  v_cvt_pk_bf16_f32 v92, v24, v25
  v_cvt_pk_bf16_f32 v93, v26, v27
  v_cvt_pk_bf16_f32 v94, v28, v29
  v_cvt_pk_bf16_f32 v95, v30, v31
  v_exp_f32 v32, v32
  v_exp_f32 v33, v33
  v_mfma_f32_32x32x16_bf16 v[48:63], v[116:119], v[92:95], v[48:63]
  v_exp_f32 v34, v34
  v_exp_f32 v35, v35
  v_exp_f32 v36, v36
  v_exp_f32 v37, v37
  v_mfma_f32_32x32x16_bf16 v[16:31], v[96:99], v[80:83], v[144:159]
  v_exp_f32 v38, v38
  v_exp_f32 v39, v39
  v_cvt_pk_bf16_f32 v88, v32, v33
  v_cvt_pk_bf16_f32 v89, v34, v35
  v_cvt_pk_bf16_f32 v90, v36, v37
  v_cvt_pk_bf16_f32 v91, v38, v39
  v_exp_f32 v40, v40
  v_exp_f32 v41, v41
  v_mfma_f32_32x32x16_bf16 v[64:79], v[112:115], v[88:91], v[64:79]
  v_exp_f32 v42, v42
  v_exp_f32 v43, v43
  v_exp_f32 v44, v44
  v_exp_f32 v45, v45
  v_exp_f32 v46, v46
  v_exp_f32 v47, v47
  v_cvt_pk_bf16_f32 v92, v40, v41
  v_cvt_pk_bf16_f32 v93, v42, v43
  v_cvt_pk_bf16_f32 v94, v44, v45
  v_cvt_pk_bf16_f32 v95, v46, v47
  v_exp_f32 v16, v16
  v_exp_f32 v17, v17
  v_mfma_f32_32x32x16_bf16 v[64:79], v[116:119], v[92:95], v[64:79]
  v_exp_f32 v18, v18
  v_exp_f32 v19, v19
  v_exp_f32 v20, v20
  v_exp_f32 v21, v21
  v_mfma_f32_32x32x16_bf16 v[32:47], v[96:99], v[84:87], v[160:175]
  s_waitcnt lgkmcnt(0)
  buffer_load_dwordx4 v[128:131], v2, s[8:11], s46 offen offset:0
  buffer_load_dwordx4 v[132:135], v2, s[8:11], s46 offen offset:1024
  ds_read_b128 v[96:99], v126 offset:36864
  s_mov_b64 exec, s[20:21]
  ds_read_b128 v[112:115], v127 offset:35840
  ds_read_b128 v[116:119], v127 offset:36352
  s_mov_b64 exec, -1
  v_exp_f32 v22, v22
  v_exp_f32 v23, v23
  v_cvt_pk_bf16_f32 v88, v16, v17
  v_cvt_pk_bf16_f32 v89, v18, v19
  v_cvt_pk_bf16_f32 v90, v20, v21
  v_cvt_pk_bf16_f32 v91, v22, v23
  v_exp_f32 v24, v24
  v_exp_f32 v25, v25
  v_mfma_f32_32x32x16_bf16 v[48:63], v[104:107], v[88:91], v[48:63]
  v_exp_f32 v26, v26
  v_exp_f32 v27, v27
  v_exp_f32 v28, v28
  v_exp_f32 v29, v29
  v_exp_f32 v30, v30
  v_exp_f32 v31, v31
  v_cvt_pk_bf16_f32 v92, v24, v25
  v_cvt_pk_bf16_f32 v93, v26, v27
  v_cvt_pk_bf16_f32 v94, v28, v29
  v_cvt_pk_bf16_f32 v95, v30, v31
  v_exp_f32 v32, v32
  v_exp_f32 v33, v33
  v_mfma_f32_32x32x16_bf16 v[48:63], v[108:111], v[92:95], v[48:63]
  v_exp_f32 v34, v34
  v_exp_f32 v35, v35
  v_exp_f32 v36, v36
  v_exp_f32 v37, v37
  v_mfma_f32_32x32x16_bf16 v[16:31], v[100:103], v[80:83], v[144:159]
  v_exp_f32 v38, v38
  v_exp_f32 v39, v39
  v_cvt_pk_bf16_f32 v88, v32, v33
  v_cvt_pk_bf16_f32 v89, v34, v35
  v_cvt_pk_bf16_f32 v90, v36, v37
  v_cvt_pk_bf16_f32 v91, v38, v39
  v_exp_f32 v40, v40
  v_exp_f32 v41, v41
  v_mfma_f32_32x32x16_bf16 v[64:79], v[104:107], v[88:91], v[64:79]
  v_exp_f32 v42, v42
  v_exp_f32 v43, v43
  v_exp_f32 v44, v44
  v_exp_f32 v45, v45
  v_exp_f32 v46, v46
  v_exp_f32 v47, v47
  v_cvt_pk_bf16_f32 v92, v40, v41
  v_cvt_pk_bf16_f32 v93, v42, v43
  v_cvt_pk_bf16_f32 v94, v44, v45
  v_cvt_pk_bf16_f32 v95, v46, v47
  v_exp_f32 v16, v16
  v_exp_f32 v17, v17
  v_mfma_f32_32x32x16_bf16 v[64:79], v[108:111], v[92:95], v[64:79]
  v_exp_f32 v18, v18
  v_exp_f32 v19, v19
  v_exp_f32 v20, v20
  v_exp_f32 v21, v21
  v_mfma_f32_32x32x16_bf16 v[32:47], v[100:103], v[84:87], v[160:175]
  s_waitcnt lgkmcnt(0)
  buffer_load_dwordx4 v[136:139], v2, s[8:11], s46 offen offset:2048
  buffer_load_dwordx4 v[140:143], v2, s[8:11], s46 offen offset:3072
  ds_read_b128 v[100:103], v126 offset:37888
  s_mov_b64 exec, s[20:21]
  ds_read_b128 v[104:107], v127 offset:36864
  ds_read_b128 v[108:111], v127 offset:37376
  s_mov_b64 exec, -1
  v_exp_f32 v22, v22
  v_exp_f32 v23, v23
  v_cvt_pk_bf16_f32 v88, v16, v17
  v_cvt_pk_bf16_f32 v89, v18, v19
  v_cvt_pk_bf16_f32 v90, v20, v21
  v_cvt_pk_bf16_f32 v91, v22, v23
  v_exp_f32 v24, v24
  v_exp_f32 v25, v25
  v_mfma_f32_32x32x16_bf16 v[48:63], v[112:115], v[88:91], v[48:63]
  v_exp_f32 v26, v26
  v_exp_f32 v27, v27
  v_exp_f32 v28, v28
  v_exp_f32 v29, v29
  v_exp_f32 v30, v30
  v_exp_f32 v31, v31
  v_cvt_pk_bf16_f32 v92, v24, v25
  v_cvt_pk_bf16_f32 v93, v26, v27
  v_cvt_pk_bf16_f32 v94, v28, v29
  v_cvt_pk_bf16_f32 v95, v30, v31
  v_exp_f32 v32, v32
  v_exp_f32 v33, v33
  v_mfma_f32_32x32x16_bf16 v[48:63], v[116:119], v[92:95], v[48:63]
  v_exp_f32 v34, v34
  v_exp_f32 v35, v35
  v_exp_f32 v36, v36
  v_exp_f32 v37, v37
  v_mfma_f32_32x32x16_bf16 v[16:31], v[96:99], v[80:83], v[144:159]
  v_exp_f32 v38, v38
  v_exp_f32 v39, v39
  v_cvt_pk_bf16_f32 v88, v32, v33
  v_cvt_pk_bf16_f32 v89, v34, v35
  v_cvt_pk_bf16_f32 v90, v36, v37
  v_cvt_pk_bf16_f32 v91, v38, v39
  v_exp_f32 v40, v40
  v_exp_f32 v41, v41
  v_mfma_f32_32x32x16_bf16 v[64:79], v[112:115], v[88:91], v[64:79]
  v_exp_f32 v42, v42
  v_exp_f32 v43, v43
  v_exp_f32 v44, v44
  v_exp_f32 v45, v45
  v_exp_f32 v46, v46
  v_exp_f32 v47, v47
  v_cvt_pk_bf16_f32 v92, v40, v41
  v_cvt_pk_bf16_f32 v93, v42, v43
  v_cvt_pk_bf16_f32 v94, v44, v45
  v_cvt_pk_bf16_f32 v95, v46, v47
  v_exp_f32 v16, v16
  v_exp_f32 v17, v17
  v_mfma_f32_32x32x16_bf16 v[64:79], v[116:119], v[92:95], v[64:79]
  v_exp_f32 v18, v18
  v_exp_f32 v19, v19
  v_exp_f32 v20, v20
  v_exp_f32 v21, v21
  v_mfma_f32_32x32x16_bf16 v[32:47], v[96:99], v[84:87], v[160:175]
  s_waitcnt lgkmcnt(0)
  s_and_b32 s16, s13, 7
  s_lshr_b32 s15, s13, 3
  s_lshl_b32 s15, s15, 1
  s_lshl_b32 s19, s12, 3
  s_add_u32 s15, s15, s19
  s_and_b32 s18, s14, 1
  s_lshr_b32 s17, s14, 1
  s_lshr_b32 s49, s14, 2
  s_and_b32 s48, s17, 1
  s_add_u32 s20, s15, s49
  s_lshl_b32 s21, s16, 1
  s_and_b32 s19, s14, 1
  s_add_u32 s21, s21, s19
  s_lshl_b32 s21, s21, 1
  s_add_u32 s21, s21, s48
  s_lshl_b32 s19, s20, 5
  s_add_u32 s19, s19, s21
  s_lshl_b32 s19, s19, 10
  v_lshlrev_b32 v12, 10, v3
  v_lshl_add_u32 v12, v4, 4, v12
  s_lshl_b32 s22, s20, 15
  s_lshl_b32 s23, s21, 5
  s_add_u32 s22, s22, s23
  buffer_load_dwordx4 v[120:123], v12, s[80:83], s22 offen
  s_mov_b32 s20, 0xffff0000
  s_mov_b32 s21, 0xffff0000
  ds_read_b128 v[96:99], v126 offset:38912
  s_mov_b64 exec, s[20:21]
  ds_read_b128 v[112:115], v127 offset:37888
  ds_read_b128 v[116:119], v127 offset:38400
  s_mov_b64 exec, -1
  v_exp_f32 v22, v22
  v_exp_f32 v23, v23
  v_cvt_pk_bf16_f32 v88, v16, v17
  v_cvt_pk_bf16_f32 v89, v18, v19
  v_cvt_pk_bf16_f32 v90, v20, v21
  v_cvt_pk_bf16_f32 v91, v22, v23
  v_exp_f32 v24, v24
  v_exp_f32 v25, v25
  v_mfma_f32_32x32x16_bf16 v[48:63], v[104:107], v[88:91], v[48:63]
  v_exp_f32 v26, v26
  v_exp_f32 v27, v27
  v_exp_f32 v28, v28
  v_exp_f32 v29, v29
  v_exp_f32 v30, v30
  v_exp_f32 v31, v31
  v_cvt_pk_bf16_f32 v92, v24, v25
  v_cvt_pk_bf16_f32 v93, v26, v27
  v_cvt_pk_bf16_f32 v94, v28, v29
  v_cvt_pk_bf16_f32 v95, v30, v31
  v_exp_f32 v32, v32
  v_exp_f32 v33, v33
  v_mfma_f32_32x32x16_bf16 v[48:63], v[108:111], v[92:95], v[48:63]
  v_exp_f32 v34, v34
  v_exp_f32 v35, v35
  v_exp_f32 v36, v36
  v_exp_f32 v37, v37
  v_mfma_f32_32x32x16_bf16 v[16:31], v[100:103], v[80:83], v[144:159]
  v_exp_f32 v38, v38
  v_exp_f32 v39, v39
  v_cvt_pk_bf16_f32 v88, v32, v33
  v_cvt_pk_bf16_f32 v89, v34, v35
  v_cvt_pk_bf16_f32 v90, v36, v37
  v_cvt_pk_bf16_f32 v91, v38, v39
  v_exp_f32 v40, v40
  v_exp_f32 v41, v41
  v_mfma_f32_32x32x16_bf16 v[64:79], v[104:107], v[88:91], v[64:79]
  v_exp_f32 v42, v42
  v_exp_f32 v43, v43
  v_exp_f32 v44, v44
  v_exp_f32 v45, v45
  v_exp_f32 v46, v46
  v_exp_f32 v47, v47
  v_cvt_pk_bf16_f32 v92, v40, v41
  v_cvt_pk_bf16_f32 v93, v42, v43
  v_cvt_pk_bf16_f32 v94, v44, v45
  v_cvt_pk_bf16_f32 v95, v46, v47
  v_exp_f32 v16, v16
  v_exp_f32 v17, v17
  v_mfma_f32_32x32x16_bf16 v[64:79], v[108:111], v[92:95], v[64:79]
  v_exp_f32 v18, v18
  v_exp_f32 v19, v19
  v_exp_f32 v20, v20
  v_exp_f32 v21, v21
  v_mfma_f32_32x32x16_bf16 v[32:47], v[100:103], v[84:87], v[160:175]
  s_waitcnt lgkmcnt(0)
  ds_read_b128 v[100:103], v126 offset:39936
  s_mov_b64 exec, s[20:21]
  ds_read_b128 v[104:107], v127 offset:38912
  ds_read_b128 v[108:111], v127 offset:39424
  s_mov_b64 exec, -1
  v_exp_f32 v22, v22
  v_exp_f32 v23, v23
  v_cvt_pk_bf16_f32 v88, v16, v17
  v_cvt_pk_bf16_f32 v89, v18, v19
  v_cvt_pk_bf16_f32 v90, v20, v21
  v_cvt_pk_bf16_f32 v91, v22, v23
  v_exp_f32 v24, v24
  v_exp_f32 v25, v25
  v_mfma_f32_32x32x16_bf16 v[48:63], v[112:115], v[88:91], v[48:63]
  v_exp_f32 v26, v26
  v_exp_f32 v27, v27
  v_exp_f32 v28, v28
  v_exp_f32 v29, v29
  v_exp_f32 v30, v30
  v_exp_f32 v31, v31
  v_cvt_pk_bf16_f32 v92, v24, v25
  v_cvt_pk_bf16_f32 v93, v26, v27
  v_cvt_pk_bf16_f32 v94, v28, v29
  v_cvt_pk_bf16_f32 v95, v30, v31
  v_exp_f32 v32, v32
  v_exp_f32 v33, v33
  v_mfma_f32_32x32x16_bf16 v[48:63], v[116:119], v[92:95], v[48:63]
  v_exp_f32 v34, v34
  v_exp_f32 v35, v35
  v_exp_f32 v36, v36
  v_exp_f32 v37, v37
  v_mfma_f32_32x32x16_bf16 v[16:31], v[96:99], v[80:83], v[144:159]
  v_exp_f32 v38, v38
  v_exp_f32 v39, v39
  v_cvt_pk_bf16_f32 v88, v32, v33
  v_cvt_pk_bf16_f32 v89, v34, v35
  v_cvt_pk_bf16_f32 v90, v36, v37
  v_cvt_pk_bf16_f32 v91, v38, v39
  v_exp_f32 v40, v40
  v_exp_f32 v41, v41
  v_mfma_f32_32x32x16_bf16 v[64:79], v[112:115], v[88:91], v[64:79]
  v_exp_f32 v42, v42
  v_exp_f32 v43, v43
  v_exp_f32 v44, v44
  v_exp_f32 v45, v45
  v_exp_f32 v46, v46
  v_exp_f32 v47, v47
  v_cvt_pk_bf16_f32 v92, v40, v41
  v_cvt_pk_bf16_f32 v93, v42, v43
  v_cvt_pk_bf16_f32 v94, v44, v45
  v_cvt_pk_bf16_f32 v95, v46, v47
  v_exp_f32 v16, v16
  v_exp_f32 v17, v17
  v_mfma_f32_32x32x16_bf16 v[64:79], v[116:119], v[92:95], v[64:79]
  v_exp_f32 v18, v18
  v_exp_f32 v19, v19
  v_exp_f32 v20, v20
  v_exp_f32 v21, v21
  v_mfma_f32_32x32x16_bf16 v[32:47], v[96:99], v[84:87], v[160:175]
  s_waitcnt lgkmcnt(0)
  s_cmp_eq_u32 s38, 0
  s_cbranch_scc1 prio_88
  s_setprio 0
prio_88:
  buffer_load_dwordx4 v[96:99], v2, s[8:11], s47 offen offset:0
  s_mov_b64 exec, s[20:21]
  ds_read_b128 v[112:115], v127 offset:39936
  ds_read_b128 v[116:119], v127 offset:40448
  s_mov_b64 exec, -1
  v_exp_f32 v22, v22
  v_exp_f32 v23, v23
  v_cvt_pk_bf16_f32 v88, v16, v17
  v_cvt_pk_bf16_f32 v89, v18, v19
  v_cvt_pk_bf16_f32 v90, v20, v21
  v_cvt_pk_bf16_f32 v91, v22, v23
  v_exp_f32 v24, v24
  v_exp_f32 v25, v25
  v_mfma_f32_32x32x16_bf16 v[48:63], v[104:107], v[88:91], v[48:63]
  v_exp_f32 v26, v26
  v_exp_f32 v27, v27
  v_exp_f32 v28, v28
  v_exp_f32 v29, v29
  v_exp_f32 v30, v30
  v_exp_f32 v31, v31
  v_cvt_pk_bf16_f32 v92, v24, v25
  v_cvt_pk_bf16_f32 v93, v26, v27
  v_cvt_pk_bf16_f32 v94, v28, v29
  v_cvt_pk_bf16_f32 v95, v30, v31
  v_exp_f32 v32, v32
  v_exp_f32 v33, v33
  v_mfma_f32_32x32x16_bf16 v[48:63], v[108:111], v[92:95], v[48:63]
  v_exp_f32 v34, v34
  v_exp_f32 v35, v35
  v_exp_f32 v36, v36
  v_exp_f32 v37, v37
  v_mfma_f32_32x32x16_bf16 v[16:31], v[100:103], v[80:83], v[144:159]
  v_exp_f32 v38, v38
  v_exp_f32 v39, v39
  v_cvt_pk_bf16_f32 v88, v32, v33
  v_cvt_pk_bf16_f32 v89, v34, v35
  v_cvt_pk_bf16_f32 v90, v36, v37
  v_cvt_pk_bf16_f32 v91, v38, v39
  v_exp_f32 v40, v40
  v_exp_f32 v41, v41
  v_mfma_f32_32x32x16_bf16 v[64:79], v[104:107], v[88:91], v[64:79]
  v_exp_f32 v42, v42
  v_exp_f32 v43, v43
  v_exp_f32 v44, v44
  v_exp_f32 v45, v45
  v_exp_f32 v46, v46
  v_exp_f32 v47, v47
  v_cvt_pk_bf16_f32 v92, v40, v41
  v_cvt_pk_bf16_f32 v93, v42, v43
  v_cvt_pk_bf16_f32 v94, v44, v45
  v_cvt_pk_bf16_f32 v95, v46, v47
  v_exp_f32 v16, v16
  v_exp_f32 v17, v17
  v_mfma_f32_32x32x16_bf16 v[64:79], v[108:111], v[92:95], v[64:79]
  v_exp_f32 v18, v18
  v_exp_f32 v19, v19
  v_exp_f32 v20, v20
  v_exp_f32 v21, v21
  v_mfma_f32_32x32x16_bf16 v[32:47], v[100:103], v[84:87], v[160:175]
  s_waitcnt lgkmcnt(0)
  buffer_load_dwordx4 v[104:107], v2, s[8:11], s47 offen offset:1024
  buffer_load_dwordx4 v[108:111], v2, s[8:11], s47 offen offset:2048
  buffer_load_dwordx4 v[100:103], v2, s[8:11], s47 offen offset:3072
  v_exp_f32 v22, v22
  v_exp_f32 v23, v23
  v_cvt_pk_bf16_f32 v88, v16, v17
  v_cvt_pk_bf16_f32 v89, v18, v19
  v_cvt_pk_bf16_f32 v90, v20, v21
  v_cvt_pk_bf16_f32 v91, v22, v23
  v_exp_f32 v24, v24
  v_exp_f32 v25, v25
  v_mfma_f32_32x32x16_bf16 v[48:63], v[112:115], v[88:91], v[48:63]
  v_exp_f32 v26, v26
  v_exp_f32 v27, v27
  v_exp_f32 v28, v28
  v_exp_f32 v29, v29
  v_exp_f32 v30, v30
  v_exp_f32 v31, v31
  v_cvt_pk_bf16_f32 v92, v24, v25
  v_cvt_pk_bf16_f32 v93, v26, v27
  v_cvt_pk_bf16_f32 v94, v28, v29
  v_cvt_pk_bf16_f32 v95, v30, v31
  v_exp_f32 v32, v32
  v_exp_f32 v33, v33
  v_mfma_f32_32x32x16_bf16 v[48:63], v[116:119], v[92:95], v[48:63]
  v_exp_f32 v34, v34
  v_exp_f32 v35, v35
  v_exp_f32 v36, v36
  v_exp_f32 v37, v37
  v_exp_f32 v38, v38
  v_exp_f32 v39, v39
  v_cvt_pk_bf16_f32 v88, v32, v33
  v_cvt_pk_bf16_f32 v89, v34, v35
  v_cvt_pk_bf16_f32 v90, v36, v37
  v_cvt_pk_bf16_f32 v91, v38, v39
  v_exp_f32 v40, v40
  v_exp_f32 v41, v41
  v_mfma_f32_32x32x16_bf16 v[64:79], v[112:115], v[88:91], v[64:79]
  v_exp_f32 v42, v42
  v_exp_f32 v43, v43
  v_exp_f32 v44, v44
  v_exp_f32 v45, v45
  v_exp_f32 v46, v46
  v_exp_f32 v47, v47
  v_cvt_pk_bf16_f32 v92, v40, v41
  v_cvt_pk_bf16_f32 v93, v42, v43
  v_cvt_pk_bf16_f32 v94, v44, v45
  v_cvt_pk_bf16_f32 v95, v46, v47
  s_nop 1
  s_nop 15
  buffer_load_dwordx4 v[144:147], v2, s[8:11], s32 offen offset:0
  buffer_load_dwordx4 v[148:151], v2, s[8:11], s32 offen offset:1024
  buffer_load_dwordx4 v[152:155], v2, s[8:11], s32 offen offset:2048
  buffer_load_dwordx4 v[156:159], v2, s[8:11], s32 offen offset:3072
  s_add_u32 s32, s32, 4096
  buffer_load_dwordx4 v[160:163], v2, s[8:11], s32 offen offset:0
  buffer_load_dwordx4 v[164:167], v2, s[8:11], s32 offen offset:1024
  buffer_load_dwordx4 v[168:171], v2, s[8:11], s32 offen offset:2048
  buffer_load_dwordx4 v[172:175], v2, s[8:11], s32 offen offset:3072
  s_add_u32 s32, s32, 4096
  buffer_load_dwordx4 v[176:179], v2, s[8:11], s32 offen offset:0
  buffer_load_dwordx4 v[180:183], v2, s[8:11], s32 offen offset:1024
  buffer_load_dwordx4 v[184:187], v2, s[8:11], s32 offen offset:2048
  buffer_load_dwordx4 v[188:191], v2, s[8:11], s32 offen offset:3072
  s_add_u32 s32, s32, 4096
  buffer_load_dwordx4 v[192:195], v2, s[8:11], s32 offen offset:0
  buffer_load_dwordx4 v[196:199], v2, s[8:11], s32 offen offset:1024
  buffer_load_dwordx4 v[200:203], v2, s[8:11], s32 offen offset:2048
  buffer_load_dwordx4 v[204:207], v2, s[8:11], s32 offen offset:3072
  s_add_u32 s32, s32, 4096
  buffer_load_dwordx4 v[208:211], v2, s[8:11], s32 offen offset:0
  buffer_load_dwordx4 v[212:215], v2, s[8:11], s32 offen offset:1024
  buffer_load_dwordx4 v[216:219], v2, s[8:11], s32 offen offset:2048
  buffer_load_dwordx4 v[220:223], v2, s[8:11], s32 offen offset:3072
  s_add_u32 s32, s32, 4096
  buffer_load_dwordx4 v[224:227], v2, s[8:11], s32 offen offset:0
  buffer_load_dwordx4 v[228:231], v2, s[8:11], s32 offen offset:1024
  buffer_load_dwordx4 v[232:235], v2, s[8:11], s32 offen offset:2048
  buffer_load_dwordx4 v[236:239], v2, s[8:11], s32 offen offset:3072
  s_add_u32 s32, s32, 4096
  buffer_load_dwordx4 v[240:243], v2, s[8:11], s32 offen offset:0
  buffer_load_dwordx4 v[244:247], v2, s[8:11], s32 offen offset:1024
  buffer_load_dwordx4 v[248:251], v2, s[8:11], s32 offen offset:2048
  buffer_load_dwordx4 v[252:255], v2, s[8:11], s32 offen offset:3072
  s_add_u32 s32, s32, 4096
  s_waitcnt vmcnt(0)
  s_branch att0_epi
att1_slow:
  s_waitcnt lgkmcnt(0)
  s_cmp_lg_u32 s14, 4
  s_cbranch_scc1 gwp_89
  v_mov_b32 v12, 94224
  ds_read_b32 v13, v12 offset:4
  s_waitcnt lgkmcnt(0)
  v_readfirstlane_b32 s22, v13
  s_cmp_eq_u32 s22, s94
  s_cbranch_scc1 gwp_89
  v_mov_b32 v12, 0
  s_getreg_b32 s28, hwreg(HW_REG_XCC_ID, 0, 3)
  s_lshl_b32 s28, s28, 7
  s_add_u32 s28, s28, 6882304
  s_waitcnt vmcnt(0)
  v_cmp_ne_u32 s[24:25], s94, v241
  v_cmp_ne_u32 vcc, s94, v243
  s_or_b64 vcc, vcc, s[24:25]
  s_cbranch_vccz gwp_89_q_p_x
  s_cmp_eq_u32 s13, 8
  s_cbranch_scc1 gwp_89_q_g
  s_mov_b32 s93, 48
gwp_89_q_l:
  buffer_load_dwordx4 v[240:243], v12, s[8:11], s28 offen sc1
  s_sub_u32 s93, s93, 1
  s_waitcnt vmcnt(0)
  v_cmp_ne_u32 s[24:25], s94, v241
  v_cmp_ne_u32 vcc, s94, v243
  s_or_b64 vcc, vcc, s[24:25]
  s_cmp_eq_u32 s93, 0
  s_cbranch_scc1 gwp_89_q_l_x
  s_cbranch_vccz gwp_89_q_l_x
  s_branch gwp_89_q_l
gwp_89_q_l_x:
  s_cbranch_vccz gwp_89_q_w
gwp_89_q_g:
  v_lshlrev_b32 v13, 7, v1
  s_mov_b32 s29, 6823936
  s_mov_b32 s93, 524288
gwp_89_q_p:
  buffer_load_dwordx4 v[240:243], v13, s[8:11], s29 offen sc1
  s_sub_u32 s93, s93, 1
  s_waitcnt vmcnt(0)
  v_cmp_ne_u32 s[24:25], s94, v241
  v_cmp_ne_u32 vcc, s94, v243
  s_or_b64 vcc, vcc, s[24:25]
  s_cmp_eq_u32 s93, 0
  s_cbranch_scc1 gwp_89_q_p_x
  s_cbranch_vccz gwp_89_q_p_x
  s_sleep 1
  s_branch gwp_89_q_p
gwp_89_q_p_x:
  v_max_u32_dpp v240, v240, v240 row_shr:1 row_mask:0xf bank_mask:0xf
  v_max_u32_dpp v242, v242, v242 row_shr:1 row_mask:0xf bank_mask:0xf
  s_nop 0
  v_max_u32_dpp v240, v240, v240 row_shr:2 row_mask:0xf bank_mask:0xf
  v_max_u32_dpp v242, v242, v242 row_shr:2 row_mask:0xf bank_mask:0xf
  s_nop 0
  v_max_u32_dpp v240, v240, v240 row_shr:4 row_mask:0xf bank_mask:0xf
  v_max_u32_dpp v242, v242, v242 row_shr:4 row_mask:0xf bank_mask:0xf
  s_nop 0
  v_max_u32_dpp v240, v240, v240 row_shr:8 row_mask:0xf bank_mask:0xf
  v_max_u32_dpp v242, v242, v242 row_shr:8 row_mask:0xf bank_mask:0xf
  s_nop 0
  v_max_u32_dpp v240, v240, v240 row_bcast:15 row_mask:0xa bank_mask:0xf
  v_max_u32_dpp v242, v242, v242 row_bcast:15 row_mask:0xa bank_mask:0xf
  s_nop 0
  v_max_u32_dpp v240, v240, v240 row_bcast:31 row_mask:0xc bank_mask:0xf
  v_max_u32_dpp v242, v242, v242 row_bcast:31 row_mask:0xc bank_mask:0xf
  s_nop 0
  v_readlane_b32 s22, v240, 63
  v_readlane_b32 s23, v242, 63
  s_nop 1
  v_mov_b32 v240, s22
  v_mov_b32 v242, s23
  s_cmp_eq_u32 s13, 8
  s_cselect_b64 exec, 1, 0
  buffer_store_dwordx4 v[240:243], v12, s[8:11], s28 offen
  s_mov_b64 exec, -1
gwp_89_q_w:
  v_mov_b32 v12, 94224
  ds_write_b128 v12, v[240:243]
gwp_89:
  v_mov_b32 v12, 94224
  s_mov_b32 s93, 0x4000000
gww_90:
  ds_read_b32 v13, v12 offset:4
  ds_read2_b32 v[120:121], v12 offset0:0 offset1:2
  s_sub_u32 s93, s93, 1
  s_waitcnt lgkmcnt(0)
  v_readfirstlane_b32 s22, v13
  s_cmp_eq_u32 s93, 0
  s_cbranch_scc1 gww_90_x
  s_cmp_lg_u32 s22, s94
  s_cbranch_scc1 gww_90
gww_90_x:
  ds_read_b128 v[96:99], v124
  ds_read_b128 v[100:103], v124 offset:1024
  s_mov_b64 exec, s[20:21]
  ds_read_b128 v[104:107], v125
  ds_read_b128 v[108:111], v125 offset:512
  s_mov_b64 exec, -1
  s_waitcnt vmcnt(0)
  v_mov_b32 v10, 0xff800000
  v_mov_b32 v11, 0xff800000
  s_mov_b32 s22, 16515072
maxloop_91:
  buffer_load_dwordx4 v[88:91], v2, s[8:11], s22 offen
  s_waitcnt vmcnt(0)
  v_mfma_f32_32x32x16_bf16 v[16:31], v[88:91], v[80:83], 0
  v_mfma_f32_32x32x16_bf16 v[32:47], v[88:91], v[84:87], 0
  s_nop 15
  v_max3_f32 v10, v16, v17, v10
  v_max3_f32 v11, v32, v33, v11
  v_max3_f32 v10, v18, v19, v10
  v_max3_f32 v11, v34, v35, v11
  v_max3_f32 v10, v20, v21, v10
  v_max3_f32 v11, v36, v37, v11
  v_max3_f32 v10, v22, v23, v10
  v_max3_f32 v11, v38, v39, v11
  v_max3_f32 v10, v24, v25, v10
  v_max3_f32 v11, v40, v41, v11
  v_max3_f32 v10, v26, v27, v10
  v_max3_f32 v11, v42, v43, v11
  v_max3_f32 v10, v28, v29, v10
  v_max3_f32 v11, v44, v45, v11
  v_max3_f32 v10, v30, v31, v10
  v_max3_f32 v11, v46, v47, v11
  s_add_u32 s22, s22, 1024
  s_cmp_lt_u32 s22, 16580608
  s_cbranch_scc1 maxloop_91
  v_mov_b32 v12, v10
  v_mov_b32 v13, v11
  s_nop 1
  v_permlane32_swap_b32 v10, v12
  v_permlane32_swap_b32 v11, v13
  s_nop 1
  v_max_f32 v10, v10, v12
  v_max_f32 v11, v11, v13
  v_sub_f32 v144, 0, v10
  v_sub_f32 v160, 0, v11
  v_sub_f32 v145, 0, v10
  v_sub_f32 v161, 0, v11
  v_sub_f32 v146, 0, v10
  v_sub_f32 v162, 0, v11
  v_sub_f32 v147, 0, v10
  v_sub_f32 v163, 0, v11
  v_sub_f32 v148, 0, v10
  v_sub_f32 v164, 0, v11
  v_sub_f32 v149, 0, v10
  v_sub_f32 v165, 0, v11
  v_sub_f32 v150, 0, v10
  v_sub_f32 v166, 0, v11
  v_sub_f32 v151, 0, v10
  v_sub_f32 v167, 0, v11
  v_sub_f32 v152, 0, v10
  v_sub_f32 v168, 0, v11
  v_sub_f32 v153, 0, v10
  v_sub_f32 v169, 0, v11
  v_sub_f32 v154, 0, v10
  v_sub_f32 v170, 0, v11
  v_sub_f32 v155, 0, v10
  v_sub_f32 v171, 0, v11
  v_sub_f32 v156, 0, v10
  v_sub_f32 v172, 0, v11
  v_sub_f32 v157, 0, v10
  v_sub_f32 v173, 0, v11
  v_sub_f32 v158, 0, v10
  v_sub_f32 v174, 0, v11
  v_sub_f32 v159, 0, v10
  v_sub_f32 v175, 0, v11
  s_nop 1
  v_mfma_f32_32x32x16_bf16 v[16:31], v[96:99], v[80:83], v[144:159]
  s_nop 11
  v_exp_f32 v16, v16
  v_exp_f32 v17, v17
  v_exp_f32 v18, v18
  v_exp_f32 v19, v19
  v_exp_f32 v20, v20
  v_exp_f32 v21, v21
  v_mfma_f32_32x32x16_bf16 v[32:47], v[96:99], v[84:87], v[160:175]
  s_waitcnt lgkmcnt(0)
  s_cmp_eq_u32 s38, 0
  s_cbranch_scc1 prio_92
  s_setprio 1
prio_92:
  ds_read_b128 v[96:99], v124 offset:2048
  s_mov_b64 exec, s[20:21]
  ds_read_b128 v[112:115], v125 offset:1024
  ds_read_b128 v[116:119], v125 offset:1536
  s_mov_b64 exec, -1
  v_exp_f32 v22, v22
  v_exp_f32 v23, v23
  v_cvt_pk_bf16_f32 v88, v16, v17
  v_cvt_pk_bf16_f32 v89, v18, v19
  v_cvt_pk_bf16_f32 v90, v20, v21
  v_cvt_pk_bf16_f32 v91, v22, v23
  v_exp_f32 v24, v24
  v_exp_f32 v25, v25
  v_mfma_f32_32x32x16_bf16 v[48:63], v[104:107], v[88:91], 0
  v_exp_f32 v26, v26
  v_exp_f32 v27, v27
  v_exp_f32 v28, v28
  v_exp_f32 v29, v29
  v_exp_f32 v30, v30
  v_exp_f32 v31, v31
  v_cvt_pk_bf16_f32 v92, v24, v25
  v_cvt_pk_bf16_f32 v93, v26, v27
  v_cvt_pk_bf16_f32 v94, v28, v29
  v_cvt_pk_bf16_f32 v95, v30, v31
  v_exp_f32 v32, v32
  v_exp_f32 v33, v33
  v_mfma_f32_32x32x16_bf16 v[48:63], v[108:111], v[92:95], v[48:63]
  v_exp_f32 v34, v34
  v_exp_f32 v35, v35
  v_exp_f32 v36, v36
  v_exp_f32 v37, v37
  v_mfma_f32_32x32x16_bf16 v[16:31], v[100:103], v[80:83], v[144:159]
  v_exp_f32 v38, v38
  v_exp_f32 v39, v39
  v_cvt_pk_bf16_f32 v88, v32, v33
  v_cvt_pk_bf16_f32 v89, v34, v35
  v_cvt_pk_bf16_f32 v90, v36, v37
  v_cvt_pk_bf16_f32 v91, v38, v39
  v_exp_f32 v40, v40
  v_exp_f32 v41, v41
  v_mfma_f32_32x32x16_bf16 v[64:79], v[104:107], v[88:91], 0
  v_exp_f32 v42, v42
  v_exp_f32 v43, v43
  v_exp_f32 v44, v44
  v_exp_f32 v45, v45
  v_exp_f32 v46, v46
  v_exp_f32 v47, v47
  v_cvt_pk_bf16_f32 v92, v40, v41
  v_cvt_pk_bf16_f32 v93, v42, v43
  v_cvt_pk_bf16_f32 v94, v44, v45
  v_cvt_pk_bf16_f32 v95, v46, v47
  v_exp_f32 v16, v16
  v_exp_f32 v17, v17
  v_mfma_f32_32x32x16_bf16 v[64:79], v[108:111], v[92:95], v[64:79]
  v_exp_f32 v18, v18
  v_exp_f32 v19, v19
  v_exp_f32 v20, v20
  v_exp_f32 v21, v21
  v_mfma_f32_32x32x16_bf16 v[32:47], v[100:103], v[84:87], v[160:175]
  s_waitcnt lgkmcnt(0)
  s_add_u32 s28, s48, 0
  s_and_b32 s28, s28, 7
  s_lshl_b32 s28, s28, 13
  s_add_u32 s28, s28, s27
  s_add_u32 m0, s26, 0
  s_cmp_lt_u32 s39, 2
  s_cselect_b64 exec, 0, -1
  buffer_load_dwordx4 v2, s[8:11], s28 offen lds
  buffer_load_dwordx4 v2, s[8:11], s28 offen offset:1024 lds
  s_add_u32 m0, s26, 16384
  s_add_u32 s28, s28, 65536
  buffer_load_dwordx4 v2, s[8:11], s28 offen lds
  buffer_load_dwordx4 v2, s[8:11], s28 offen offset:1024 lds
  s_mov_b64 exec, -1
  s_add_u32 s28, s48, 2
  s_and_b32 s28, s28, 7
  s_lshl_b32 s28, s28, 13
  s_add_u32 s28, s28, s27
  s_add_u32 m0, s26, 32768
  s_nop 0
  buffer_load_dwordx4 v2, s[8:11], s28 offen lds
  buffer_load_dwordx4 v2, s[8:11], s28 offen offset:1024 lds
  s_add_u32 m0, s26, 49152
  s_add_u32 s28, s28, 65536
  buffer_load_dwordx4 v2, s[8:11], s28 offen lds
  buffer_load_dwordx4 v2, s[8:11], s28 offen offset:1024 lds
  ds_read_b128 v[100:103], v124 offset:3072
  s_mov_b64 exec, s[20:21]
  ds_read_b128 v[104:107], v125 offset:2048
  ds_read_b128 v[108:111], v125 offset:2560
  s_mov_b64 exec, -1
  v_exp_f32 v22, v22
  v_exp_f32 v23, v23
  v_cvt_pk_bf16_f32 v88, v16, v17
  v_cvt_pk_bf16_f32 v89, v18, v19
  v_cvt_pk_bf16_f32 v90, v20, v21
  v_cvt_pk_bf16_f32 v91, v22, v23
  v_exp_f32 v24, v24
  v_exp_f32 v25, v25
  v_mfma_f32_32x32x16_bf16 v[48:63], v[112:115], v[88:91], v[48:63]
  v_exp_f32 v26, v26
  v_exp_f32 v27, v27
  v_exp_f32 v28, v28
  v_exp_f32 v29, v29
  v_exp_f32 v30, v30
  v_exp_f32 v31, v31
  v_cvt_pk_bf16_f32 v92, v24, v25
  v_cvt_pk_bf16_f32 v93, v26, v27
  v_cvt_pk_bf16_f32 v94, v28, v29
  v_cvt_pk_bf16_f32 v95, v30, v31
  v_exp_f32 v32, v32
  v_exp_f32 v33, v33
  v_mfma_f32_32x32x16_bf16 v[48:63], v[116:119], v[92:95], v[48:63]
  v_exp_f32 v34, v34
  v_exp_f32 v35, v35
  v_exp_f32 v36, v36
  v_exp_f32 v37, v37
  v_mfma_f32_32x32x16_bf16 v[16:31], v[96:99], v[80:83], v[144:159]
  v_exp_f32 v38, v38
  v_exp_f32 v39, v39
  v_cvt_pk_bf16_f32 v88, v32, v33
  v_cvt_pk_bf16_f32 v89, v34, v35
  v_cvt_pk_bf16_f32 v90, v36, v37
  v_cvt_pk_bf16_f32 v91, v38, v39
  v_exp_f32 v40, v40
  v_exp_f32 v41, v41
  v_mfma_f32_32x32x16_bf16 v[64:79], v[112:115], v[88:91], v[64:79]
  v_exp_f32 v42, v42
  v_exp_f32 v43, v43
  v_exp_f32 v44, v44
  v_exp_f32 v45, v45
  v_exp_f32 v46, v46
  v_exp_f32 v47, v47
  v_cvt_pk_bf16_f32 v92, v40, v41
  v_cvt_pk_bf16_f32 v93, v42, v43
  v_cvt_pk_bf16_f32 v94, v44, v45
  v_cvt_pk_bf16_f32 v95, v46, v47
  v_exp_f32 v16, v16
  v_exp_f32 v17, v17
  v_mfma_f32_32x32x16_bf16 v[64:79], v[116:119], v[92:95], v[64:79]
  v_exp_f32 v18, v18
  v_exp_f32 v19, v19
  v_exp_f32 v20, v20
  v_exp_f32 v21, v21
  v_mfma_f32_32x32x16_bf16 v[32:47], v[96:99], v[84:87], v[160:175]
  s_waitcnt lgkmcnt(0)
  s_mov_b64 exec, s[20:21]
  ds_read_b128 v[112:115], v125 offset:3072
  ds_read_b128 v[116:119], v125 offset:3584
  s_mov_b64 exec, -1
  v_exp_f32 v22, v22
  v_exp_f32 v23, v23
  v_cvt_pk_bf16_f32 v88, v16, v17
  v_cvt_pk_bf16_f32 v89, v18, v19
  v_cvt_pk_bf16_f32 v90, v20, v21
  v_cvt_pk_bf16_f32 v91, v22, v23
  v_exp_f32 v24, v24
  v_exp_f32 v25, v25
  v_mfma_f32_32x32x16_bf16 v[48:63], v[104:107], v[88:91], v[48:63]
  v_exp_f32 v26, v26
  v_exp_f32 v27, v27
  v_exp_f32 v28, v28
  v_exp_f32 v29, v29
  v_exp_f32 v30, v30
  v_exp_f32 v31, v31
  v_cvt_pk_bf16_f32 v92, v24, v25
  v_cvt_pk_bf16_f32 v93, v26, v27
  v_cvt_pk_bf16_f32 v94, v28, v29
  v_cvt_pk_bf16_f32 v95, v30, v31
  v_exp_f32 v32, v32
  v_exp_f32 v33, v33
  v_mfma_f32_32x32x16_bf16 v[48:63], v[108:111], v[92:95], v[48:63]
  v_exp_f32 v34, v34
  v_exp_f32 v35, v35
  v_exp_f32 v36, v36
  v_exp_f32 v37, v37
  v_mfma_f32_32x32x16_bf16 v[16:31], v[100:103], v[80:83], v[144:159]
  v_exp_f32 v38, v38
  v_exp_f32 v39, v39
  v_cvt_pk_bf16_f32 v88, v32, v33
  v_cvt_pk_bf16_f32 v89, v34, v35
  v_cvt_pk_bf16_f32 v90, v36, v37
  v_cvt_pk_bf16_f32 v91, v38, v39
  v_exp_f32 v40, v40
  v_exp_f32 v41, v41
  v_mfma_f32_32x32x16_bf16 v[64:79], v[104:107], v[88:91], v[64:79]
  v_exp_f32 v42, v42
  v_exp_f32 v43, v43
  v_exp_f32 v44, v44
  v_exp_f32 v45, v45
  v_exp_f32 v46, v46
  v_exp_f32 v47, v47
  v_cvt_pk_bf16_f32 v92, v40, v41
  v_cvt_pk_bf16_f32 v93, v42, v43
  v_cvt_pk_bf16_f32 v94, v44, v45
  v_cvt_pk_bf16_f32 v95, v46, v47
  v_exp_f32 v16, v16
  v_exp_f32 v17, v17
  v_mfma_f32_32x32x16_bf16 v[64:79], v[108:111], v[92:95], v[64:79]
  v_exp_f32 v18, v18
  v_exp_f32 v19, v19
  v_exp_f32 v20, v20
  v_exp_f32 v21, v21
  v_mfma_f32_32x32x16_bf16 v[32:47], v[100:103], v[84:87], v[160:175]
  s_waitcnt lgkmcnt(0)
  s_waitcnt vmcnt(4)
  s_barrier
  ds_read_b128 v[96:99], v124 offset:4096
  ds_read_b128 v[100:103], v124 offset:5120
  s_mov_b64 exec, s[20:21]
  ds_read_b128 v[104:107], v125 offset:4096
  ds_read_b128 v[108:111], v125 offset:4608
  s_mov_b64 exec, -1
  v_exp_f32 v22, v22
  v_exp_f32 v23, v23
  v_cvt_pk_bf16_f32 v88, v16, v17
  v_cvt_pk_bf16_f32 v89, v18, v19
  v_cvt_pk_bf16_f32 v90, v20, v21
  v_cvt_pk_bf16_f32 v91, v22, v23
  v_exp_f32 v24, v24
  v_exp_f32 v25, v25
  v_mfma_f32_32x32x16_bf16 v[48:63], v[112:115], v[88:91], v[48:63]
  v_exp_f32 v26, v26
  v_exp_f32 v27, v27
  v_exp_f32 v28, v28
  v_exp_f32 v29, v29
  v_exp_f32 v30, v30
  v_exp_f32 v31, v31
  v_cvt_pk_bf16_f32 v92, v24, v25
  v_cvt_pk_bf16_f32 v93, v26, v27
  v_cvt_pk_bf16_f32 v94, v28, v29
  v_cvt_pk_bf16_f32 v95, v30, v31
  v_exp_f32 v32, v32
  v_exp_f32 v33, v33
  v_mfma_f32_32x32x16_bf16 v[48:63], v[116:119], v[92:95], v[48:63]
  v_exp_f32 v34, v34
  v_exp_f32 v35, v35
  v_exp_f32 v36, v36
  v_exp_f32 v37, v37
  s_waitcnt lgkmcnt(3)
  v_mfma_f32_32x32x16_bf16 v[16:31], v[96:99], v[80:83], v[144:159]
  v_exp_f32 v38, v38
  v_exp_f32 v39, v39
  v_cvt_pk_bf16_f32 v88, v32, v33
  v_cvt_pk_bf16_f32 v89, v34, v35
  v_cvt_pk_bf16_f32 v90, v36, v37
  v_cvt_pk_bf16_f32 v91, v38, v39
  v_exp_f32 v40, v40
  v_exp_f32 v41, v41
  v_mfma_f32_32x32x16_bf16 v[64:79], v[112:115], v[88:91], v[64:79]
  v_exp_f32 v42, v42
  v_exp_f32 v43, v43
  v_exp_f32 v44, v44
  v_exp_f32 v45, v45
  v_exp_f32 v46, v46
  v_exp_f32 v47, v47
  v_cvt_pk_bf16_f32 v92, v40, v41
  v_cvt_pk_bf16_f32 v93, v42, v43
  v_cvt_pk_bf16_f32 v94, v44, v45
  v_cvt_pk_bf16_f32 v95, v46, v47
  v_exp_f32 v16, v16
  v_exp_f32 v17, v17
  v_mfma_f32_32x32x16_bf16 v[64:79], v[116:119], v[92:95], v[64:79]
  v_exp_f32 v18, v18
  v_exp_f32 v19, v19
  v_exp_f32 v20, v20
  v_exp_f32 v21, v21
  v_mfma_f32_32x32x16_bf16 v[32:47], v[96:99], v[84:87], v[160:175]
  s_waitcnt lgkmcnt(0)
  s_and_b32 s16, s13, 7
  s_lshr_b32 s15, s13, 3
  s_lshl_b32 s15, s15, 1
  s_lshl_b32 s19, s12, 3
  s_add_u32 s15, s15, s19
  s_and_b32 s18, s14, 1
  s_lshr_b32 s17, s14, 1
  s_lshr_b32 s49, s14, 2
  s_and_b32 s48, s17, 1
  s_add_u32 s20, s15, s49
  s_lshl_b32 s21, s16, 1
  s_and_b32 s19, s14, 1
  s_add_u32 s21, s21, s19
  s_lshl_b32 s21, s21, 1
  s_add_u32 s21, s21, s48
  s_lshl_b32 s19, s20, 5
  s_add_u32 s19, s19, s21
  s_lshl_b32 s19, s19, 10
  s_mov_b32 s20, 0xffff0000
  s_mov_b32 s21, 0xffff0000
  s_lshl_b32 s22, s36, 5
  s_lshl_b32 s23, s37, 1
  s_add_u32 s22, s22, s23
  s_add_u32 s22, s22, s38
  s_lshl_b32 s22, s22, 10
  s_add_u32 s22, s22, 18874368
  s_lshr_b32 s25, s13, 4
  s_lshl_b32 s24, s25, 2
  s_xor_b32 s24, s24, s14
  s_lshl_b32 s23, s12, 3
  s_add_u32 s24, s24, s23
  s_mul_i32 s23, s24, 112
  s_and_b32 s24, s13, 15
  s_mul_i32 s24, s24, 7
  s_add_u32 s23, s23, s24
  s_mul_i32 s24, s25, 3
  s_add_u32 s23, s23, s24
  s_and_b32 s24, s25, s38
  s_add_u32 s23, s23, s24
  s_lshl_b32 s23, s23, 10
  s_add_u32 s23, s23, 29356032
  s_add_u32 s24, s19, 13630464
  s_sub_u32 s25, s22, 2048
  v_lshrrev_b32 v12, 3, v1
  v_mov_b32 v13, s22
  v_mov_b32 v14, s24
  v_cmp_eq_u32 vcc, 1, v12
  s_sub_u32 s22, s22, 3072
  s_nop 0
  v_cndmask_b32 v13, v13, v14, vcc
  v_mov_b32 v14, s25
  v_cmp_eq_u32 vcc, 2, v12
  s_nop 1
  v_cndmask_b32 v13, v13, v14, vcc
  v_mov_b32 v14, s22
  v_cmp_eq_u32 vcc, 3, v12
  s_nop 1
  v_cndmask_b32 v13, v13, v14, vcc
  v_mov_b32 v14, s23
  v_cmp_lt_u32 vcc, 3, v12
  s_nop 1
  v_cndmask_b32 v13, v13, v14, vcc
  v_lshl_add_u32 v13, v1, 7, v13
  v_mov_b32 v123, v13
  v_mov_b32 v11, v13
  s_lshr_b32 s48, s39, 1
  s_add_u32 s48, s48, s12
  s_mov_b32 exec_lo, 0xff
  s_mov_b32 exec_hi, 0x0
  buffer_load_dword v14, v123, s[8:11], 0 offen sc1
  s_mov_b64 exec, -1
  ds_read_b128 v[96:99], v124 offset:6144
  s_mov_b64 exec, s[20:21]
  ds_read_b128 v[112:115], v125 offset:5120
  ds_read_b128 v[116:119], v125 offset:5632
  s_mov_b64 exec, -1
  v_exp_f32 v22, v22
  v_exp_f32 v23, v23
  v_cvt_pk_bf16_f32 v88, v16, v17
  v_cvt_pk_bf16_f32 v89, v18, v19
  v_cvt_pk_bf16_f32 v90, v20, v21
  v_cvt_pk_bf16_f32 v91, v22, v23
  v_exp_f32 v24, v24
  v_exp_f32 v25, v25
  v_mfma_f32_32x32x16_bf16 v[48:63], v[104:107], v[88:91], v[48:63]
  v_exp_f32 v26, v26
  v_exp_f32 v27, v27
  v_exp_f32 v28, v28
  v_exp_f32 v29, v29
  v_exp_f32 v30, v30
  v_exp_f32 v31, v31
  v_cvt_pk_bf16_f32 v92, v24, v25
  v_cvt_pk_bf16_f32 v93, v26, v27
  v_cvt_pk_bf16_f32 v94, v28, v29
  v_cvt_pk_bf16_f32 v95, v30, v31
  v_exp_f32 v32, v32
  v_exp_f32 v33, v33
  v_mfma_f32_32x32x16_bf16 v[48:63], v[108:111], v[92:95], v[48:63]
  v_exp_f32 v34, v34
  v_exp_f32 v35, v35
  v_exp_f32 v36, v36
  v_exp_f32 v37, v37
  v_mfma_f32_32x32x16_bf16 v[16:31], v[100:103], v[80:83], v[144:159]
  v_exp_f32 v38, v38
  v_exp_f32 v39, v39
  v_cvt_pk_bf16_f32 v88, v32, v33
  v_cvt_pk_bf16_f32 v89, v34, v35
  v_cvt_pk_bf16_f32 v90, v36, v37
  v_cvt_pk_bf16_f32 v91, v38, v39
  v_exp_f32 v40, v40
  v_exp_f32 v41, v41
  v_mfma_f32_32x32x16_bf16 v[64:79], v[104:107], v[88:91], v[64:79]
  v_exp_f32 v42, v42
  v_exp_f32 v43, v43
  v_exp_f32 v44, v44
  v_exp_f32 v45, v45
  v_exp_f32 v46, v46
  v_exp_f32 v47, v47
  v_cvt_pk_bf16_f32 v92, v40, v41
  v_cvt_pk_bf16_f32 v93, v42, v43
  v_cvt_pk_bf16_f32 v94, v44, v45
  v_cvt_pk_bf16_f32 v95, v46, v47
  v_exp_f32 v16, v16
  v_exp_f32 v17, v17
  v_mfma_f32_32x32x16_bf16 v[64:79], v[108:111], v[92:95], v[64:79]
  v_exp_f32 v18, v18
  v_exp_f32 v19, v19
  v_exp_f32 v20, v20
  v_exp_f32 v21, v21
  v_mfma_f32_32x32x16_bf16 v[32:47], v[100:103], v[84:87], v[160:175]
  s_waitcnt lgkmcnt(0)
  s_cmp_eq_u32 s38, 0
  s_cbranch_scc1 prio_93
  s_setprio 0
prio_93:
  s_mov_b32 exec_lo, 0xff00
  s_mov_b32 exec_hi, 0x0
  buffer_load_dword v14, v123, s[8:11], 0 offen sc1
  s_mov_b64 exec, -1
  ds_read_b128 v[100:103], v124 offset:7168
  s_mov_b64 exec, s[20:21]
  ds_read_b128 v[104:107], v125 offset:6144
  ds_read_b128 v[108:111], v125 offset:6656
  s_mov_b64 exec, -1
  v_exp_f32 v22, v22
  v_exp_f32 v23, v23
  v_cvt_pk_bf16_f32 v88, v16, v17
  v_cvt_pk_bf16_f32 v89, v18, v19
  v_cvt_pk_bf16_f32 v90, v20, v21
  v_cvt_pk_bf16_f32 v91, v22, v23
  v_exp_f32 v24, v24
  v_exp_f32 v25, v25
  v_mfma_f32_32x32x16_bf16 v[48:63], v[112:115], v[88:91], v[48:63]
  v_exp_f32 v26, v26
  v_exp_f32 v27, v27
  v_exp_f32 v28, v28
  v_exp_f32 v29, v29
  v_exp_f32 v30, v30
  v_exp_f32 v31, v31
  v_cvt_pk_bf16_f32 v92, v24, v25
  v_cvt_pk_bf16_f32 v93, v26, v27
  v_cvt_pk_bf16_f32 v94, v28, v29
  v_cvt_pk_bf16_f32 v95, v30, v31
  v_exp_f32 v32, v32
  v_exp_f32 v33, v33
  v_mfma_f32_32x32x16_bf16 v[48:63], v[116:119], v[92:95], v[48:63]
  v_exp_f32 v34, v34
  v_exp_f32 v35, v35
  v_exp_f32 v36, v36
  v_exp_f32 v37, v37
  v_mfma_f32_32x32x16_bf16 v[16:31], v[96:99], v[80:83], v[144:159]
  v_exp_f32 v38, v38
  v_exp_f32 v39, v39
  v_cvt_pk_bf16_f32 v88, v32, v33
  v_cvt_pk_bf16_f32 v89, v34, v35
  v_cvt_pk_bf16_f32 v90, v36, v37
  v_cvt_pk_bf16_f32 v91, v38, v39
  v_exp_f32 v40, v40
  v_exp_f32 v41, v41
  v_mfma_f32_32x32x16_bf16 v[64:79], v[112:115], v[88:91], v[64:79]
  v_exp_f32 v42, v42
  v_exp_f32 v43, v43
  v_exp_f32 v44, v44
  v_exp_f32 v45, v45
  v_exp_f32 v46, v46
  v_exp_f32 v47, v47
  v_cvt_pk_bf16_f32 v92, v40, v41
  v_cvt_pk_bf16_f32 v93, v42, v43
  v_cvt_pk_bf16_f32 v94, v44, v45
  v_cvt_pk_bf16_f32 v95, v46, v47
  v_exp_f32 v16, v16
  v_exp_f32 v17, v17
  v_mfma_f32_32x32x16_bf16 v[64:79], v[116:119], v[92:95], v[64:79]
  v_exp_f32 v18, v18
  v_exp_f32 v19, v19
  v_exp_f32 v20, v20
  v_exp_f32 v21, v21
  v_mfma_f32_32x32x16_bf16 v[32:47], v[96:99], v[84:87], v[160:175]
  s_waitcnt lgkmcnt(0)
  s_cmp_eq_u32 s38, 0
  s_cbranch_scc1 prio_94
  s_setprio 1
prio_94:
  s_waitcnt vmcnt(2)
  s_barrier
  s_add_u32 s28, s48, 4
  s_and_b32 s28, s28, 7
  s_lshl_b32 s28, s28, 13
  s_add_u32 s28, s28, s27
  s_add_u32 m0, s26, 65536
  s_nop 0
  buffer_load_dwordx4 v2, s[8:11], s28 offen lds
  buffer_load_dwordx4 v2, s[8:11], s28 offen offset:1024 lds
  s_add_u32 m0, s26, 81920
  s_add_u32 s28, s28, 65536
  buffer_load_dwordx4 v2, s[8:11], s28 offen lds
  buffer_load_dwordx4 v2, s[8:11], s28 offen offset:1024 lds
  ds_read_b128 v[96:99], v124 offset:32768
  s_mov_b64 exec, s[20:21]
  ds_read_b128 v[112:115], v125 offset:7168
  ds_read_b128 v[116:119], v125 offset:7680
  s_mov_b64 exec, -1
  v_exp_f32 v22, v22
  v_exp_f32 v23, v23
  v_cvt_pk_bf16_f32 v88, v16, v17
  v_cvt_pk_bf16_f32 v89, v18, v19
  v_cvt_pk_bf16_f32 v90, v20, v21
  v_cvt_pk_bf16_f32 v91, v22, v23
  v_exp_f32 v24, v24
  v_exp_f32 v25, v25
  v_mfma_f32_32x32x16_bf16 v[48:63], v[104:107], v[88:91], v[48:63]
  v_exp_f32 v26, v26
  v_exp_f32 v27, v27
  v_exp_f32 v28, v28
  v_exp_f32 v29, v29
  v_exp_f32 v30, v30
  v_exp_f32 v31, v31
  v_cvt_pk_bf16_f32 v92, v24, v25
  v_cvt_pk_bf16_f32 v93, v26, v27
  v_cvt_pk_bf16_f32 v94, v28, v29
  v_cvt_pk_bf16_f32 v95, v30, v31
  v_exp_f32 v32, v32
  v_exp_f32 v33, v33
  v_mfma_f32_32x32x16_bf16 v[48:63], v[108:111], v[92:95], v[48:63]
  v_exp_f32 v34, v34
  v_exp_f32 v35, v35
  v_exp_f32 v36, v36
  v_exp_f32 v37, v37
  v_mfma_f32_32x32x16_bf16 v[16:31], v[100:103], v[80:83], v[144:159]
  v_exp_f32 v38, v38
  v_exp_f32 v39, v39
  v_cvt_pk_bf16_f32 v88, v32, v33
  v_cvt_pk_bf16_f32 v89, v34, v35
  v_cvt_pk_bf16_f32 v90, v36, v37
  v_cvt_pk_bf16_f32 v91, v38, v39
  v_exp_f32 v40, v40
  v_exp_f32 v41, v41
  v_mfma_f32_32x32x16_bf16 v[64:79], v[104:107], v[88:91], v[64:79]
  v_exp_f32 v42, v42
  v_exp_f32 v43, v43
  v_exp_f32 v44, v44
  v_exp_f32 v45, v45
  v_exp_f32 v46, v46
  v_exp_f32 v47, v47
  v_cvt_pk_bf16_f32 v92, v40, v41
  v_cvt_pk_bf16_f32 v93, v42, v43
  v_cvt_pk_bf16_f32 v94, v44, v45
  v_cvt_pk_bf16_f32 v95, v46, v47
  v_exp_f32 v16, v16
  v_exp_f32 v17, v17
  v_mfma_f32_32x32x16_bf16 v[64:79], v[108:111], v[92:95], v[64:79]
  v_exp_f32 v18, v18
  v_exp_f32 v19, v19
  v_exp_f32 v20, v20
  v_exp_f32 v21, v21
  v_mfma_f32_32x32x16_bf16 v[32:47], v[100:103], v[84:87], v[160:175]
  s_waitcnt lgkmcnt(0)
  ds_read_b128 v[100:103], v124 offset:33792
  s_mov_b64 exec, s[20:21]
  ds_read_b128 v[104:107], v125 offset:32768
  ds_read_b128 v[108:111], v125 offset:33280
  s_mov_b64 exec, -1
  v_exp_f32 v22, v22
  v_exp_f32 v23, v23
  v_cvt_pk_bf16_f32 v88, v16, v17
  v_cvt_pk_bf16_f32 v89, v18, v19
  v_cvt_pk_bf16_f32 v90, v20, v21
  v_cvt_pk_bf16_f32 v91, v22, v23
  v_exp_f32 v24, v24
  v_exp_f32 v25, v25
  v_mfma_f32_32x32x16_bf16 v[48:63], v[112:115], v[88:91], v[48:63]
  v_exp_f32 v26, v26
  v_exp_f32 v27, v27
  v_exp_f32 v28, v28
  v_exp_f32 v29, v29
  v_exp_f32 v30, v30
  v_exp_f32 v31, v31
  v_cvt_pk_bf16_f32 v92, v24, v25
  v_cvt_pk_bf16_f32 v93, v26, v27
  v_cvt_pk_bf16_f32 v94, v28, v29
  v_cvt_pk_bf16_f32 v95, v30, v31
  v_exp_f32 v32, v32
  v_exp_f32 v33, v33
  v_mfma_f32_32x32x16_bf16 v[48:63], v[116:119], v[92:95], v[48:63]
  v_exp_f32 v34, v34
  v_exp_f32 v35, v35
  v_exp_f32 v36, v36
  v_exp_f32 v37, v37
  v_mfma_f32_32x32x16_bf16 v[16:31], v[96:99], v[80:83], v[144:159]
  v_exp_f32 v38, v38
  v_exp_f32 v39, v39
  v_cvt_pk_bf16_f32 v88, v32, v33
  v_cvt_pk_bf16_f32 v89, v34, v35
  v_cvt_pk_bf16_f32 v90, v36, v37
  v_cvt_pk_bf16_f32 v91, v38, v39
  v_exp_f32 v40, v40
  v_exp_f32 v41, v41
  v_mfma_f32_32x32x16_bf16 v[64:79], v[112:115], v[88:91], v[64:79]
  v_exp_f32 v42, v42
  v_exp_f32 v43, v43
  v_exp_f32 v44, v44
  v_exp_f32 v45, v45
  v_exp_f32 v46, v46
  v_exp_f32 v47, v47
  v_cvt_pk_bf16_f32 v92, v40, v41
  v_cvt_pk_bf16_f32 v93, v42, v43
  v_cvt_pk_bf16_f32 v94, v44, v45
  v_cvt_pk_bf16_f32 v95, v46, v47
  v_exp_f32 v16, v16
  v_exp_f32 v17, v17
  v_mfma_f32_32x32x16_bf16 v[64:79], v[116:119], v[92:95], v[64:79]
  v_exp_f32 v18, v18
  v_exp_f32 v19, v19
  v_exp_f32 v20, v20
  v_exp_f32 v21, v21
  v_mfma_f32_32x32x16_bf16 v[32:47], v[96:99], v[84:87], v[160:175]
  s_waitcnt lgkmcnt(0)
  ds_read_b128 v[96:99], v124 offset:34816
  s_mov_b64 exec, s[20:21]
  ds_read_b128 v[112:115], v125 offset:33792
  ds_read_b128 v[116:119], v125 offset:34304
  s_mov_b64 exec, -1
  v_exp_f32 v22, v22
  v_exp_f32 v23, v23
  v_cvt_pk_bf16_f32 v88, v16, v17
  v_cvt_pk_bf16_f32 v89, v18, v19
  v_cvt_pk_bf16_f32 v90, v20, v21
  v_cvt_pk_bf16_f32 v91, v22, v23
  v_exp_f32 v24, v24
  v_exp_f32 v25, v25
  v_mfma_f32_32x32x16_bf16 v[48:63], v[104:107], v[88:91], v[48:63]
  v_exp_f32 v26, v26
  v_exp_f32 v27, v27
  v_exp_f32 v28, v28
  v_exp_f32 v29, v29
  v_exp_f32 v30, v30
  v_exp_f32 v31, v31
  v_cvt_pk_bf16_f32 v92, v24, v25
  v_cvt_pk_bf16_f32 v93, v26, v27
  v_cvt_pk_bf16_f32 v94, v28, v29
  v_cvt_pk_bf16_f32 v95, v30, v31
  v_exp_f32 v32, v32
  v_exp_f32 v33, v33
  v_mfma_f32_32x32x16_bf16 v[48:63], v[108:111], v[92:95], v[48:63]
  v_exp_f32 v34, v34
  v_exp_f32 v35, v35
  v_exp_f32 v36, v36
  v_exp_f32 v37, v37
  v_mfma_f32_32x32x16_bf16 v[16:31], v[100:103], v[80:83], v[144:159]
  v_exp_f32 v38, v38
  v_exp_f32 v39, v39
  v_cvt_pk_bf16_f32 v88, v32, v33
  v_cvt_pk_bf16_f32 v89, v34, v35
  v_cvt_pk_bf16_f32 v90, v36, v37
  v_cvt_pk_bf16_f32 v91, v38, v39
  v_exp_f32 v40, v40
  v_exp_f32 v41, v41
  v_mfma_f32_32x32x16_bf16 v[64:79], v[104:107], v[88:91], v[64:79]
  v_exp_f32 v42, v42
  v_exp_f32 v43, v43
  v_exp_f32 v44, v44
  v_exp_f32 v45, v45
  v_exp_f32 v46, v46
  v_exp_f32 v47, v47
  v_cvt_pk_bf16_f32 v92, v40, v41
  v_cvt_pk_bf16_f32 v93, v42, v43
  v_cvt_pk_bf16_f32 v94, v44, v45
  v_cvt_pk_bf16_f32 v95, v46, v47
  v_exp_f32 v16, v16
  v_exp_f32 v17, v17
  v_mfma_f32_32x32x16_bf16 v[64:79], v[108:111], v[92:95], v[64:79]
  v_exp_f32 v18, v18
  v_exp_f32 v19, v19
  v_exp_f32 v20, v20
  v_exp_f32 v21, v21
  v_mfma_f32_32x32x16_bf16 v[32:47], v[100:103], v[84:87], v[160:175]
  s_waitcnt lgkmcnt(0)
  ds_read_b128 v[100:103], v124 offset:35840
  s_mov_b64 exec, s[20:21]
  ds_read_b128 v[104:107], v125 offset:34816
  ds_read_b128 v[108:111], v125 offset:35328
  s_mov_b64 exec, -1
  v_exp_f32 v22, v22
  v_exp_f32 v23, v23
  v_cvt_pk_bf16_f32 v88, v16, v17
  v_cvt_pk_bf16_f32 v89, v18, v19
  v_cvt_pk_bf16_f32 v90, v20, v21
  v_cvt_pk_bf16_f32 v91, v22, v23
  v_exp_f32 v24, v24
  v_exp_f32 v25, v25
  v_mfma_f32_32x32x16_bf16 v[48:63], v[112:115], v[88:91], v[48:63]
  v_exp_f32 v26, v26
  v_exp_f32 v27, v27
  v_exp_f32 v28, v28
  v_exp_f32 v29, v29
  v_exp_f32 v30, v30
  v_exp_f32 v31, v31
  v_cvt_pk_bf16_f32 v92, v24, v25
  v_cvt_pk_bf16_f32 v93, v26, v27
  v_cvt_pk_bf16_f32 v94, v28, v29
  v_cvt_pk_bf16_f32 v95, v30, v31
  v_exp_f32 v32, v32
  v_exp_f32 v33, v33
  v_mfma_f32_32x32x16_bf16 v[48:63], v[116:119], v[92:95], v[48:63]
  v_exp_f32 v34, v34
  v_exp_f32 v35, v35
  v_exp_f32 v36, v36
  v_exp_f32 v37, v37
  v_mfma_f32_32x32x16_bf16 v[16:31], v[96:99], v[80:83], v[144:159]
  v_exp_f32 v38, v38
  v_exp_f32 v39, v39
  v_cvt_pk_bf16_f32 v88, v32, v33
  v_cvt_pk_bf16_f32 v89, v34, v35
  v_cvt_pk_bf16_f32 v90, v36, v37
  v_cvt_pk_bf16_f32 v91, v38, v39
  v_exp_f32 v40, v40
  v_exp_f32 v41, v41
  v_mfma_f32_32x32x16_bf16 v[64:79], v[112:115], v[88:91], v[64:79]
  v_exp_f32 v42, v42
  v_exp_f32 v43, v43
  v_exp_f32 v44, v44
  v_exp_f32 v45, v45
  v_exp_f32 v46, v46
  v_exp_f32 v47, v47
  v_cvt_pk_bf16_f32 v92, v40, v41
  v_cvt_pk_bf16_f32 v93, v42, v43
  v_cvt_pk_bf16_f32 v94, v44, v45
  v_cvt_pk_bf16_f32 v95, v46, v47
  v_exp_f32 v16, v16
  v_exp_f32 v17, v17
  v_mfma_f32_32x32x16_bf16 v[64:79], v[116:119], v[92:95], v[64:79]
  v_exp_f32 v18, v18
  v_exp_f32 v19, v19
  v_exp_f32 v20, v20
  v_exp_f32 v21, v21
  v_mfma_f32_32x32x16_bf16 v[32:47], v[96:99], v[84:87], v[160:175]
  s_waitcnt lgkmcnt(0)
  ds_read_b128 v[96:99], v124 offset:36864
  s_mov_b64 exec, s[20:21]
  ds_read_b128 v[112:115], v125 offset:35840
  ds_read_b128 v[116:119], v125 offset:36352
  s_mov_b64 exec, -1
  v_exp_f32 v22, v22
  v_exp_f32 v23, v23
  v_cvt_pk_bf16_f32 v88, v16, v17
  v_cvt_pk_bf16_f32 v89, v18, v19
  v_cvt_pk_bf16_f32 v90, v20, v21
  v_cvt_pk_bf16_f32 v91, v22, v23
  v_exp_f32 v24, v24
  v_exp_f32 v25, v25
  v_mfma_f32_32x32x16_bf16 v[48:63], v[104:107], v[88:91], v[48:63]
  v_exp_f32 v26, v26
  v_exp_f32 v27, v27
  v_exp_f32 v28, v28
  v_exp_f32 v29, v29
  v_exp_f32 v30, v30
  v_exp_f32 v31, v31
  v_cvt_pk_bf16_f32 v92, v24, v25
  v_cvt_pk_bf16_f32 v93, v26, v27
  v_cvt_pk_bf16_f32 v94, v28, v29
  v_cvt_pk_bf16_f32 v95, v30, v31
  v_exp_f32 v32, v32
  v_exp_f32 v33, v33
  v_mfma_f32_32x32x16_bf16 v[48:63], v[108:111], v[92:95], v[48:63]
  v_exp_f32 v34, v34
  v_exp_f32 v35, v35
  v_exp_f32 v36, v36
  v_exp_f32 v37, v37
  v_mfma_f32_32x32x16_bf16 v[16:31], v[100:103], v[80:83], v[144:159]
  v_exp_f32 v38, v38
  v_exp_f32 v39, v39
  v_cvt_pk_bf16_f32 v88, v32, v33
  v_cvt_pk_bf16_f32 v89, v34, v35
  v_cvt_pk_bf16_f32 v90, v36, v37
  v_cvt_pk_bf16_f32 v91, v38, v39
  v_exp_f32 v40, v40
  v_exp_f32 v41, v41
  v_mfma_f32_32x32x16_bf16 v[64:79], v[104:107], v[88:91], v[64:79]
  v_exp_f32 v42, v42
  v_exp_f32 v43, v43
  v_exp_f32 v44, v44
  v_exp_f32 v45, v45
  v_exp_f32 v46, v46
  v_exp_f32 v47, v47
  v_cvt_pk_bf16_f32 v92, v40, v41
  v_cvt_pk_bf16_f32 v93, v42, v43
  v_cvt_pk_bf16_f32 v94, v44, v45
  v_cvt_pk_bf16_f32 v95, v46, v47
  v_exp_f32 v16, v16
  v_exp_f32 v17, v17
  v_mfma_f32_32x32x16_bf16 v[64:79], v[108:111], v[92:95], v[64:79]
  v_exp_f32 v18, v18
  v_exp_f32 v19, v19
  v_exp_f32 v20, v20
  v_exp_f32 v21, v21
  v_mfma_f32_32x32x16_bf16 v[32:47], v[100:103], v[84:87], v[160:175]
  s_waitcnt lgkmcnt(0)
  ds_read_b128 v[100:103], v124 offset:37888
  s_mov_b64 exec, s[20:21]
  ds_read_b128 v[104:107], v125 offset:36864
  ds_read_b128 v[108:111], v125 offset:37376
  s_mov_b64 exec, -1
  v_exp_f32 v22, v22
  v_exp_f32 v23, v23
  v_cvt_pk_bf16_f32 v88, v16, v17
  v_cvt_pk_bf16_f32 v89, v18, v19
  v_cvt_pk_bf16_f32 v90, v20, v21
  v_cvt_pk_bf16_f32 v91, v22, v23
  v_exp_f32 v24, v24
  v_exp_f32 v25, v25
  v_mfma_f32_32x32x16_bf16 v[48:63], v[112:115], v[88:91], v[48:63]
  v_exp_f32 v26, v26
  v_exp_f32 v27, v27
  v_exp_f32 v28, v28
  v_exp_f32 v29, v29
  v_exp_f32 v30, v30
  v_exp_f32 v31, v31
  v_cvt_pk_bf16_f32 v92, v24, v25
  v_cvt_pk_bf16_f32 v93, v26, v27
  v_cvt_pk_bf16_f32 v94, v28, v29
  v_cvt_pk_bf16_f32 v95, v30, v31
  v_exp_f32 v32, v32
  v_exp_f32 v33, v33
  v_mfma_f32_32x32x16_bf16 v[48:63], v[116:119], v[92:95], v[48:63]
  v_exp_f32 v34, v34
  v_exp_f32 v35, v35
  v_exp_f32 v36, v36
  v_exp_f32 v37, v37
  v_mfma_f32_32x32x16_bf16 v[16:31], v[96:99], v[80:83], v[144:159]
  v_exp_f32 v38, v38
  v_exp_f32 v39, v39
  v_cvt_pk_bf16_f32 v88, v32, v33
  v_cvt_pk_bf16_f32 v89, v34, v35
  v_cvt_pk_bf16_f32 v90, v36, v37
  v_cvt_pk_bf16_f32 v91, v38, v39
  v_exp_f32 v40, v40
  v_exp_f32 v41, v41
  v_mfma_f32_32x32x16_bf16 v[64:79], v[112:115], v[88:91], v[64:79]
  v_exp_f32 v42, v42
  v_exp_f32 v43, v43
  v_exp_f32 v44, v44
  v_exp_f32 v45, v45
  v_exp_f32 v46, v46
  v_exp_f32 v47, v47
  v_cvt_pk_bf16_f32 v92, v40, v41
  v_cvt_pk_bf16_f32 v93, v42, v43
  v_cvt_pk_bf16_f32 v94, v44, v45
  v_cvt_pk_bf16_f32 v95, v46, v47
  v_exp_f32 v16, v16
  v_exp_f32 v17, v17
  v_mfma_f32_32x32x16_bf16 v[64:79], v[116:119], v[92:95], v[64:79]
  v_exp_f32 v18, v18
  v_exp_f32 v19, v19
  v_exp_f32 v20, v20
  v_exp_f32 v21, v21
  v_mfma_f32_32x32x16_bf16 v[32:47], v[96:99], v[84:87], v[160:175]
  s_waitcnt lgkmcnt(0)
  s_cmp_eq_u32 s38, 0
  s_cbranch_scc1 prio_95
  s_setprio 0
prio_95:
  ds_read_b128 v[96:99], v124 offset:38912
  s_mov_b64 exec, s[20:21]
  ds_read_b128 v[112:115], v125 offset:37888
  ds_read_b128 v[116:119], v125 offset:38400
  s_mov_b64 exec, -1
  v_exp_f32 v22, v22
  v_exp_f32 v23, v23
  v_cvt_pk_bf16_f32 v88, v16, v17
  v_cvt_pk_bf16_f32 v89, v18, v19
  v_cvt_pk_bf16_f32 v90, v20, v21
  v_cvt_pk_bf16_f32 v91, v22, v23
  v_exp_f32 v24, v24
  v_exp_f32 v25, v25
  v_mfma_f32_32x32x16_bf16 v[48:63], v[104:107], v[88:91], v[48:63]
  v_exp_f32 v26, v26
  v_exp_f32 v27, v27
  v_exp_f32 v28, v28
  v_exp_f32 v29, v29
  v_exp_f32 v30, v30
  v_exp_f32 v31, v31
  v_cvt_pk_bf16_f32 v92, v24, v25
  v_cvt_pk_bf16_f32 v93, v26, v27
  v_cvt_pk_bf16_f32 v94, v28, v29
  v_cvt_pk_bf16_f32 v95, v30, v31
  v_exp_f32 v32, v32
  v_exp_f32 v33, v33
  v_mfma_f32_32x32x16_bf16 v[48:63], v[108:111], v[92:95], v[48:63]
  v_exp_f32 v34, v34
  v_exp_f32 v35, v35
  v_exp_f32 v36, v36
  v_exp_f32 v37, v37
  v_mfma_f32_32x32x16_bf16 v[16:31], v[100:103], v[80:83], v[144:159]
  v_exp_f32 v38, v38
  v_exp_f32 v39, v39
  v_cvt_pk_bf16_f32 v88, v32, v33
  v_cvt_pk_bf16_f32 v89, v34, v35
  v_cvt_pk_bf16_f32 v90, v36, v37
  v_cvt_pk_bf16_f32 v91, v38, v39
  v_exp_f32 v40, v40
  v_exp_f32 v41, v41
  v_mfma_f32_32x32x16_bf16 v[64:79], v[104:107], v[88:91], v[64:79]
  v_exp_f32 v42, v42
  v_exp_f32 v43, v43
  v_exp_f32 v44, v44
  v_exp_f32 v45, v45
  v_exp_f32 v46, v46
  v_exp_f32 v47, v47
  v_cvt_pk_bf16_f32 v92, v40, v41
  v_cvt_pk_bf16_f32 v93, v42, v43
  v_cvt_pk_bf16_f32 v94, v44, v45
  v_cvt_pk_bf16_f32 v95, v46, v47
  v_exp_f32 v16, v16
  v_exp_f32 v17, v17
  v_mfma_f32_32x32x16_bf16 v[64:79], v[108:111], v[92:95], v[64:79]
  v_exp_f32 v18, v18
  v_exp_f32 v19, v19
  v_exp_f32 v20, v20
  v_exp_f32 v21, v21
  v_mfma_f32_32x32x16_bf16 v[32:47], v[100:103], v[84:87], v[160:175]
  s_waitcnt lgkmcnt(0)
  ds_read_b128 v[100:103], v124 offset:39936
  s_mov_b64 exec, s[20:21]
  ds_read_b128 v[104:107], v125 offset:38912
  ds_read_b128 v[108:111], v125 offset:39424
  s_mov_b64 exec, -1
  v_exp_f32 v22, v22
  v_exp_f32 v23, v23
  v_cvt_pk_bf16_f32 v88, v16, v17
  v_cvt_pk_bf16_f32 v89, v18, v19
  v_cvt_pk_bf16_f32 v90, v20, v21
  v_cvt_pk_bf16_f32 v91, v22, v23
  v_exp_f32 v24, v24
  v_exp_f32 v25, v25
  v_mfma_f32_32x32x16_bf16 v[48:63], v[112:115], v[88:91], v[48:63]
  v_exp_f32 v26, v26
  v_exp_f32 v27, v27
  v_exp_f32 v28, v28
  v_exp_f32 v29, v29
  v_exp_f32 v30, v30
  v_exp_f32 v31, v31
  v_cvt_pk_bf16_f32 v92, v24, v25
  v_cvt_pk_bf16_f32 v93, v26, v27
  v_cvt_pk_bf16_f32 v94, v28, v29
  v_cvt_pk_bf16_f32 v95, v30, v31
  v_exp_f32 v32, v32
  v_exp_f32 v33, v33
  v_mfma_f32_32x32x16_bf16 v[48:63], v[116:119], v[92:95], v[48:63]
  v_exp_f32 v34, v34
  v_exp_f32 v35, v35
  v_exp_f32 v36, v36
  v_exp_f32 v37, v37
  v_mfma_f32_32x32x16_bf16 v[16:31], v[96:99], v[80:83], v[144:159]
  v_exp_f32 v38, v38
  v_exp_f32 v39, v39
  v_cvt_pk_bf16_f32 v88, v32, v33
  v_cvt_pk_bf16_f32 v89, v34, v35
  v_cvt_pk_bf16_f32 v90, v36, v37
  v_cvt_pk_bf16_f32 v91, v38, v39
  v_exp_f32 v40, v40
  v_exp_f32 v41, v41
  v_mfma_f32_32x32x16_bf16 v[64:79], v[112:115], v[88:91], v[64:79]
  v_exp_f32 v42, v42
  v_exp_f32 v43, v43
  v_exp_f32 v44, v44
  v_exp_f32 v45, v45
  v_exp_f32 v46, v46
  v_exp_f32 v47, v47
  v_cvt_pk_bf16_f32 v92, v40, v41
  v_cvt_pk_bf16_f32 v93, v42, v43
  v_cvt_pk_bf16_f32 v94, v44, v45
  v_cvt_pk_bf16_f32 v95, v46, v47
  v_exp_f32 v16, v16
  v_exp_f32 v17, v17
  v_mfma_f32_32x32x16_bf16 v[64:79], v[116:119], v[92:95], v[64:79]
  v_exp_f32 v18, v18
  v_exp_f32 v19, v19
  v_exp_f32 v20, v20
  v_exp_f32 v21, v21
  v_mfma_f32_32x32x16_bf16 v[32:47], v[96:99], v[84:87], v[160:175]
  s_waitcnt lgkmcnt(0)
  s_cmp_eq_u32 s38, 0
  s_cbranch_scc1 prio_96
  s_setprio 1
prio_96:
  s_waitcnt vmcnt(0)
  s_barrier
  s_add_u32 s28, s48, 6
  s_and_b32 s28, s28, 7
  s_lshl_b32 s28, s28, 13
  s_add_u32 s28, s28, s27
  s_add_u32 m0, s26, 98304
  s_nop 0
  buffer_load_dwordx4 v2, s[8:11], s28 offen lds
  buffer_load_dwordx4 v2, s[8:11], s28 offen offset:1024 lds
  s_add_u32 m0, s26, 114688
  s_add_u32 s28, s28, 65536
  buffer_load_dwordx4 v2, s[8:11], s28 offen lds
  buffer_load_dwordx4 v2, s[8:11], s28 offen offset:1024 lds
  s_lshl_b32 s28, s14, 12
  s_add_u32 m0, s28, 0
  s_add_u32 s28, s33, 0
  buffer_load_dwordx4 v2, s[8:11], s28 offen offset:0 lds
  buffer_load_dwordx4 v2, s[8:11], s28 offen offset:1024 lds
  buffer_load_dwordx4 v2, s[8:11], s28 offen offset:2048 lds
  buffer_load_dwordx4 v2, s[8:11], s28 offen offset:3072 lds
  ds_read_b128 v[96:99], v126 offset:0
  s_mov_b64 exec, s[20:21]
  ds_read_b128 v[112:115], v125 offset:39936
  ds_read_b128 v[116:119], v125 offset:40448
  s_mov_b64 exec, -1
  v_exp_f32 v22, v22
  v_exp_f32 v23, v23
  v_cvt_pk_bf16_f32 v88, v16, v17
  v_cvt_pk_bf16_f32 v89, v18, v19
  v_cvt_pk_bf16_f32 v90, v20, v21
  v_cvt_pk_bf16_f32 v91, v22, v23
  v_exp_f32 v24, v24
  v_exp_f32 v25, v25
  v_mfma_f32_32x32x16_bf16 v[48:63], v[104:107], v[88:91], v[48:63]
  v_exp_f32 v26, v26
  v_exp_f32 v27, v27
  v_exp_f32 v28, v28
  v_exp_f32 v29, v29
  v_exp_f32 v30, v30
  v_exp_f32 v31, v31
  v_cvt_pk_bf16_f32 v92, v24, v25
  v_cvt_pk_bf16_f32 v93, v26, v27
  v_cvt_pk_bf16_f32 v94, v28, v29
  v_cvt_pk_bf16_f32 v95, v30, v31
  v_exp_f32 v32, v32
  v_exp_f32 v33, v33
  v_mfma_f32_32x32x16_bf16 v[48:63], v[108:111], v[92:95], v[48:63]
  v_exp_f32 v34, v34
  v_exp_f32 v35, v35
  v_exp_f32 v36, v36
  v_exp_f32 v37, v37
  v_mfma_f32_32x32x16_bf16 v[16:31], v[100:103], v[80:83], v[144:159]
  v_exp_f32 v38, v38
  v_exp_f32 v39, v39
  v_cvt_pk_bf16_f32 v88, v32, v33
  v_cvt_pk_bf16_f32 v89, v34, v35
  v_cvt_pk_bf16_f32 v90, v36, v37
  v_cvt_pk_bf16_f32 v91, v38, v39
  v_exp_f32 v40, v40
  v_exp_f32 v41, v41
  v_mfma_f32_32x32x16_bf16 v[64:79], v[104:107], v[88:91], v[64:79]
  v_exp_f32 v42, v42
  v_exp_f32 v43, v43
  v_exp_f32 v44, v44
  v_exp_f32 v45, v45
  v_exp_f32 v46, v46
  v_exp_f32 v47, v47
  v_cvt_pk_bf16_f32 v92, v40, v41
  v_cvt_pk_bf16_f32 v93, v42, v43
  v_cvt_pk_bf16_f32 v94, v44, v45
  v_cvt_pk_bf16_f32 v95, v46, v47
  v_exp_f32 v16, v16
  v_exp_f32 v17, v17
  v_mfma_f32_32x32x16_bf16 v[64:79], v[108:111], v[92:95], v[64:79]
  v_exp_f32 v18, v18
  v_exp_f32 v19, v19
  v_exp_f32 v20, v20
  v_exp_f32 v21, v21
  v_mfma_f32_32x32x16_bf16 v[32:47], v[100:103], v[84:87], v[160:175]
  s_waitcnt lgkmcnt(0)
  ds_read_b128 v[100:103], v126 offset:1024
  s_mov_b64 exec, s[20:21]
  ds_read_b128 v[104:107], v127 offset:0
  ds_read_b128 v[108:111], v127 offset:512
  s_mov_b64 exec, -1
  v_exp_f32 v22, v22
  v_exp_f32 v23, v23
  v_cvt_pk_bf16_f32 v88, v16, v17
  v_cvt_pk_bf16_f32 v89, v18, v19
  v_cvt_pk_bf16_f32 v90, v20, v21
  v_cvt_pk_bf16_f32 v91, v22, v23
  v_exp_f32 v24, v24
  v_exp_f32 v25, v25
  v_mfma_f32_32x32x16_bf16 v[48:63], v[112:115], v[88:91], v[48:63]
  v_exp_f32 v26, v26
  v_exp_f32 v27, v27
  v_exp_f32 v28, v28
  v_exp_f32 v29, v29
  v_exp_f32 v30, v30
  v_exp_f32 v31, v31
  v_cvt_pk_bf16_f32 v92, v24, v25
  v_cvt_pk_bf16_f32 v93, v26, v27
  v_cvt_pk_bf16_f32 v94, v28, v29
  v_cvt_pk_bf16_f32 v95, v30, v31
  v_exp_f32 v32, v32
  v_exp_f32 v33, v33
  v_mfma_f32_32x32x16_bf16 v[48:63], v[116:119], v[92:95], v[48:63]
  v_exp_f32 v34, v34
  v_exp_f32 v35, v35
  v_exp_f32 v36, v36
  v_exp_f32 v37, v37
  v_mfma_f32_32x32x16_bf16 v[16:31], v[96:99], v[80:83], v[144:159]
  v_exp_f32 v38, v38
  v_exp_f32 v39, v39
  v_cvt_pk_bf16_f32 v88, v32, v33
  v_cvt_pk_bf16_f32 v89, v34, v35
  v_cvt_pk_bf16_f32 v90, v36, v37
  v_cvt_pk_bf16_f32 v91, v38, v39
  v_exp_f32 v40, v40
  v_exp_f32 v41, v41
  v_mfma_f32_32x32x16_bf16 v[64:79], v[112:115], v[88:91], v[64:79]
  v_exp_f32 v42, v42
  v_exp_f32 v43, v43
  v_exp_f32 v44, v44
  v_exp_f32 v45, v45
  v_exp_f32 v46, v46
  v_exp_f32 v47, v47
  v_cvt_pk_bf16_f32 v92, v40, v41
  v_cvt_pk_bf16_f32 v93, v42, v43
  v_cvt_pk_bf16_f32 v94, v44, v45
  v_cvt_pk_bf16_f32 v95, v46, v47
  v_exp_f32 v16, v16
  v_exp_f32 v17, v17
  v_mfma_f32_32x32x16_bf16 v[64:79], v[116:119], v[92:95], v[64:79]
  v_exp_f32 v18, v18
  v_exp_f32 v19, v19
  v_exp_f32 v20, v20
  v_exp_f32 v21, v21
  v_mfma_f32_32x32x16_bf16 v[32:47], v[96:99], v[84:87], v[160:175]
  s_waitcnt lgkmcnt(0)
  ds_read_b128 v[96:99], v126 offset:2048
  s_mov_b64 exec, s[20:21]
  ds_read_b128 v[112:115], v127 offset:1024
  ds_read_b128 v[116:119], v127 offset:1536
  s_mov_b64 exec, -1
  v_exp_f32 v22, v22
  v_exp_f32 v23, v23
  v_cvt_pk_bf16_f32 v88, v16, v17
  v_cvt_pk_bf16_f32 v89, v18, v19
  v_cvt_pk_bf16_f32 v90, v20, v21
  v_cvt_pk_bf16_f32 v91, v22, v23
  v_exp_f32 v24, v24
  v_exp_f32 v25, v25
  v_mfma_f32_32x32x16_bf16 v[48:63], v[104:107], v[88:91], v[48:63]
  v_exp_f32 v26, v26
  v_exp_f32 v27, v27
  v_exp_f32 v28, v28
  v_exp_f32 v29, v29
  v_exp_f32 v30, v30
  v_exp_f32 v31, v31
  v_cvt_pk_bf16_f32 v92, v24, v25
  v_cvt_pk_bf16_f32 v93, v26, v27
  v_cvt_pk_bf16_f32 v94, v28, v29
  v_cvt_pk_bf16_f32 v95, v30, v31
  v_exp_f32 v32, v32
  v_exp_f32 v33, v33
  v_mfma_f32_32x32x16_bf16 v[48:63], v[108:111], v[92:95], v[48:63]
  v_exp_f32 v34, v34
  v_exp_f32 v35, v35
  v_exp_f32 v36, v36
  v_exp_f32 v37, v37
  v_mfma_f32_32x32x16_bf16 v[16:31], v[100:103], v[80:83], v[144:159]
  v_exp_f32 v38, v38
  v_exp_f32 v39, v39
  v_cvt_pk_bf16_f32 v88, v32, v33
  v_cvt_pk_bf16_f32 v89, v34, v35
  v_cvt_pk_bf16_f32 v90, v36, v37
  v_cvt_pk_bf16_f32 v91, v38, v39
  v_exp_f32 v40, v40
  v_exp_f32 v41, v41
  v_mfma_f32_32x32x16_bf16 v[64:79], v[104:107], v[88:91], v[64:79]
  v_exp_f32 v42, v42
  v_exp_f32 v43, v43
  v_exp_f32 v44, v44
  v_exp_f32 v45, v45
  v_exp_f32 v46, v46
  v_exp_f32 v47, v47
  v_cvt_pk_bf16_f32 v92, v40, v41
  v_cvt_pk_bf16_f32 v93, v42, v43
  v_cvt_pk_bf16_f32 v94, v44, v45
  v_cvt_pk_bf16_f32 v95, v46, v47
  v_exp_f32 v16, v16
  v_exp_f32 v17, v17
  v_mfma_f32_32x32x16_bf16 v[64:79], v[108:111], v[92:95], v[64:79]
  v_exp_f32 v18, v18
  v_exp_f32 v19, v19
  v_exp_f32 v20, v20
  v_exp_f32 v21, v21
  v_mfma_f32_32x32x16_bf16 v[32:47], v[100:103], v[84:87], v[160:175]
  s_waitcnt lgkmcnt(0)
  ds_read_b128 v[100:103], v126 offset:3072
  s_mov_b64 exec, s[20:21]
  ds_read_b128 v[104:107], v127 offset:2048
  ds_read_b128 v[108:111], v127 offset:2560
  s_mov_b64 exec, -1
  v_exp_f32 v22, v22
  v_exp_f32 v23, v23
  v_cvt_pk_bf16_f32 v88, v16, v17
  v_cvt_pk_bf16_f32 v89, v18, v19
  v_cvt_pk_bf16_f32 v90, v20, v21
  v_cvt_pk_bf16_f32 v91, v22, v23
  v_exp_f32 v24, v24
  v_exp_f32 v25, v25
  v_mfma_f32_32x32x16_bf16 v[48:63], v[112:115], v[88:91], v[48:63]
  v_exp_f32 v26, v26
  v_exp_f32 v27, v27
  v_exp_f32 v28, v28
  v_exp_f32 v29, v29
  v_exp_f32 v30, v30
  v_exp_f32 v31, v31
  v_cvt_pk_bf16_f32 v92, v24, v25
  v_cvt_pk_bf16_f32 v93, v26, v27
  v_cvt_pk_bf16_f32 v94, v28, v29
  v_cvt_pk_bf16_f32 v95, v30, v31
  v_exp_f32 v32, v32
  v_exp_f32 v33, v33
  v_mfma_f32_32x32x16_bf16 v[48:63], v[116:119], v[92:95], v[48:63]
  v_exp_f32 v34, v34
  v_exp_f32 v35, v35
  v_exp_f32 v36, v36
  v_exp_f32 v37, v37
  v_mfma_f32_32x32x16_bf16 v[16:31], v[96:99], v[80:83], v[144:159]
  v_exp_f32 v38, v38
  v_exp_f32 v39, v39
  v_cvt_pk_bf16_f32 v88, v32, v33
  v_cvt_pk_bf16_f32 v89, v34, v35
  v_cvt_pk_bf16_f32 v90, v36, v37
  v_cvt_pk_bf16_f32 v91, v38, v39
  v_exp_f32 v40, v40
  v_exp_f32 v41, v41
  v_mfma_f32_32x32x16_bf16 v[64:79], v[112:115], v[88:91], v[64:79]
  v_exp_f32 v42, v42
  v_exp_f32 v43, v43
  v_exp_f32 v44, v44
  v_exp_f32 v45, v45
  v_exp_f32 v46, v46
  v_exp_f32 v47, v47
  v_cvt_pk_bf16_f32 v92, v40, v41
  v_cvt_pk_bf16_f32 v93, v42, v43
  v_cvt_pk_bf16_f32 v94, v44, v45
  v_cvt_pk_bf16_f32 v95, v46, v47
  v_exp_f32 v16, v16
  v_exp_f32 v17, v17
  v_mfma_f32_32x32x16_bf16 v[64:79], v[116:119], v[92:95], v[64:79]
  v_exp_f32 v18, v18
  v_exp_f32 v19, v19
  v_exp_f32 v20, v20
  v_exp_f32 v21, v21
  v_mfma_f32_32x32x16_bf16 v[32:47], v[96:99], v[84:87], v[160:175]
  s_waitcnt lgkmcnt(0)
  ds_read_b128 v[96:99], v126 offset:4096
  s_mov_b64 exec, s[20:21]
  ds_read_b128 v[112:115], v127 offset:3072
  ds_read_b128 v[116:119], v127 offset:3584
  s_mov_b64 exec, -1
  v_exp_f32 v22, v22
  v_exp_f32 v23, v23
  v_cvt_pk_bf16_f32 v88, v16, v17
  v_cvt_pk_bf16_f32 v89, v18, v19
  v_cvt_pk_bf16_f32 v90, v20, v21
  v_cvt_pk_bf16_f32 v91, v22, v23
  v_exp_f32 v24, v24
  v_exp_f32 v25, v25
  v_mfma_f32_32x32x16_bf16 v[48:63], v[104:107], v[88:91], v[48:63]
  v_exp_f32 v26, v26
  v_exp_f32 v27, v27
  v_exp_f32 v28, v28
  v_exp_f32 v29, v29
  v_exp_f32 v30, v30
  v_exp_f32 v31, v31
  v_cvt_pk_bf16_f32 v92, v24, v25
  v_cvt_pk_bf16_f32 v93, v26, v27
  v_cvt_pk_bf16_f32 v94, v28, v29
  v_cvt_pk_bf16_f32 v95, v30, v31
  v_exp_f32 v32, v32
  v_exp_f32 v33, v33
  v_mfma_f32_32x32x16_bf16 v[48:63], v[108:111], v[92:95], v[48:63]
  v_exp_f32 v34, v34
  v_exp_f32 v35, v35
  v_exp_f32 v36, v36
  v_exp_f32 v37, v37
  v_mfma_f32_32x32x16_bf16 v[16:31], v[100:103], v[80:83], v[144:159]
  v_exp_f32 v38, v38
  v_exp_f32 v39, v39
  v_cvt_pk_bf16_f32 v88, v32, v33
  v_cvt_pk_bf16_f32 v89, v34, v35
  v_cvt_pk_bf16_f32 v90, v36, v37
  v_cvt_pk_bf16_f32 v91, v38, v39
  v_exp_f32 v40, v40
  v_exp_f32 v41, v41
  v_mfma_f32_32x32x16_bf16 v[64:79], v[104:107], v[88:91], v[64:79]
  v_exp_f32 v42, v42
  v_exp_f32 v43, v43
  v_exp_f32 v44, v44
  v_exp_f32 v45, v45
  v_exp_f32 v46, v46
  v_exp_f32 v47, v47
  v_cvt_pk_bf16_f32 v92, v40, v41
  v_cvt_pk_bf16_f32 v93, v42, v43
  v_cvt_pk_bf16_f32 v94, v44, v45
  v_cvt_pk_bf16_f32 v95, v46, v47
  v_exp_f32 v16, v16
  v_exp_f32 v17, v17
  v_mfma_f32_32x32x16_bf16 v[64:79], v[108:111], v[92:95], v[64:79]
  v_exp_f32 v18, v18
  v_exp_f32 v19, v19
  v_exp_f32 v20, v20
  v_exp_f32 v21, v21
  v_mfma_f32_32x32x16_bf16 v[32:47], v[100:103], v[84:87], v[160:175]
  s_waitcnt lgkmcnt(0)
  ds_read_b128 v[100:103], v126 offset:5120
  s_mov_b64 exec, s[20:21]
  ds_read_b128 v[104:107], v127 offset:4096
  ds_read_b128 v[108:111], v127 offset:4608
  s_mov_b64 exec, -1
  v_exp_f32 v22, v22
  v_exp_f32 v23, v23
  v_cvt_pk_bf16_f32 v88, v16, v17
  v_cvt_pk_bf16_f32 v89, v18, v19
  v_cvt_pk_bf16_f32 v90, v20, v21
  v_cvt_pk_bf16_f32 v91, v22, v23
  v_exp_f32 v24, v24
  v_exp_f32 v25, v25
  v_mfma_f32_32x32x16_bf16 v[48:63], v[112:115], v[88:91], v[48:63]
  v_exp_f32 v26, v26
  v_exp_f32 v27, v27
  v_exp_f32 v28, v28
  v_exp_f32 v29, v29
  v_exp_f32 v30, v30
  v_exp_f32 v31, v31
  v_cvt_pk_bf16_f32 v92, v24, v25
  v_cvt_pk_bf16_f32 v93, v26, v27
  v_cvt_pk_bf16_f32 v94, v28, v29
  v_cvt_pk_bf16_f32 v95, v30, v31
  v_exp_f32 v32, v32
  v_exp_f32 v33, v33
  v_mfma_f32_32x32x16_bf16 v[48:63], v[116:119], v[92:95], v[48:63]
  v_exp_f32 v34, v34
  v_exp_f32 v35, v35
  v_exp_f32 v36, v36
  v_exp_f32 v37, v37
  v_mfma_f32_32x32x16_bf16 v[16:31], v[96:99], v[80:83], v[144:159]
  v_exp_f32 v38, v38
  v_exp_f32 v39, v39
  v_cvt_pk_bf16_f32 v88, v32, v33
  v_cvt_pk_bf16_f32 v89, v34, v35
  v_cvt_pk_bf16_f32 v90, v36, v37
  v_cvt_pk_bf16_f32 v91, v38, v39
  v_exp_f32 v40, v40
  v_exp_f32 v41, v41
  v_mfma_f32_32x32x16_bf16 v[64:79], v[112:115], v[88:91], v[64:79]
  v_exp_f32 v42, v42
  v_exp_f32 v43, v43
  v_exp_f32 v44, v44
  v_exp_f32 v45, v45
  v_exp_f32 v46, v46
  v_exp_f32 v47, v47
  v_cvt_pk_bf16_f32 v92, v40, v41
  v_cvt_pk_bf16_f32 v93, v42, v43
  v_cvt_pk_bf16_f32 v94, v44, v45
  v_cvt_pk_bf16_f32 v95, v46, v47
  v_exp_f32 v16, v16
  v_exp_f32 v17, v17
  v_mfma_f32_32x32x16_bf16 v[64:79], v[116:119], v[92:95], v[64:79]
  v_exp_f32 v18, v18
  v_exp_f32 v19, v19
  v_exp_f32 v20, v20
  v_exp_f32 v21, v21
  v_mfma_f32_32x32x16_bf16 v[32:47], v[96:99], v[84:87], v[160:175]
  s_waitcnt lgkmcnt(0)
  s_cmp_eq_u32 s38, 0
  s_cbranch_scc1 prio_97
  s_setprio 0
prio_97:
  ds_read_b128 v[96:99], v126 offset:6144
  s_mov_b64 exec, s[20:21]
  ds_read_b128 v[112:115], v127 offset:5120
  ds_read_b128 v[116:119], v127 offset:5632
  s_mov_b64 exec, -1
  v_exp_f32 v22, v22
  v_exp_f32 v23, v23
  v_cvt_pk_bf16_f32 v88, v16, v17
  v_cvt_pk_bf16_f32 v89, v18, v19
  v_cvt_pk_bf16_f32 v90, v20, v21
  v_cvt_pk_bf16_f32 v91, v22, v23
  v_exp_f32 v24, v24
  v_exp_f32 v25, v25
  v_mfma_f32_32x32x16_bf16 v[48:63], v[104:107], v[88:91], v[48:63]
  v_exp_f32 v26, v26
  v_exp_f32 v27, v27
  v_exp_f32 v28, v28
  v_exp_f32 v29, v29
  v_exp_f32 v30, v30
  v_exp_f32 v31, v31
  v_cvt_pk_bf16_f32 v92, v24, v25
  v_cvt_pk_bf16_f32 v93, v26, v27
  v_cvt_pk_bf16_f32 v94, v28, v29
  v_cvt_pk_bf16_f32 v95, v30, v31
  v_exp_f32 v32, v32
  v_exp_f32 v33, v33
  v_mfma_f32_32x32x16_bf16 v[48:63], v[108:111], v[92:95], v[48:63]
  v_exp_f32 v34, v34
  v_exp_f32 v35, v35
  v_exp_f32 v36, v36
  v_exp_f32 v37, v37
  v_mfma_f32_32x32x16_bf16 v[16:31], v[100:103], v[80:83], v[144:159]
  v_exp_f32 v38, v38
  v_exp_f32 v39, v39
  v_cvt_pk_bf16_f32 v88, v32, v33
  v_cvt_pk_bf16_f32 v89, v34, v35
  v_cvt_pk_bf16_f32 v90, v36, v37
  v_cvt_pk_bf16_f32 v91, v38, v39
  v_exp_f32 v40, v40
  v_exp_f32 v41, v41
  v_mfma_f32_32x32x16_bf16 v[64:79], v[104:107], v[88:91], v[64:79]
  v_exp_f32 v42, v42
  v_exp_f32 v43, v43
  v_exp_f32 v44, v44
  v_exp_f32 v45, v45
  v_exp_f32 v46, v46
  v_exp_f32 v47, v47
  v_cvt_pk_bf16_f32 v92, v40, v41
  v_cvt_pk_bf16_f32 v93, v42, v43
  v_cvt_pk_bf16_f32 v94, v44, v45
  v_cvt_pk_bf16_f32 v95, v46, v47
  v_exp_f32 v16, v16
  v_exp_f32 v17, v17
  v_mfma_f32_32x32x16_bf16 v[64:79], v[108:111], v[92:95], v[64:79]
  v_exp_f32 v18, v18
  v_exp_f32 v19, v19
  v_exp_f32 v20, v20
  v_exp_f32 v21, v21
  v_mfma_f32_32x32x16_bf16 v[32:47], v[100:103], v[84:87], v[160:175]
  s_waitcnt lgkmcnt(0)
  ds_read_b128 v[100:103], v126 offset:7168
  s_mov_b64 exec, s[20:21]
  ds_read_b128 v[104:107], v127 offset:6144
  ds_read_b128 v[108:111], v127 offset:6656
  s_mov_b64 exec, -1
  v_exp_f32 v22, v22
  v_exp_f32 v23, v23
  v_cvt_pk_bf16_f32 v88, v16, v17
  v_cvt_pk_bf16_f32 v89, v18, v19
  v_cvt_pk_bf16_f32 v90, v20, v21
  v_cvt_pk_bf16_f32 v91, v22, v23
  v_exp_f32 v24, v24
  v_exp_f32 v25, v25
  v_mfma_f32_32x32x16_bf16 v[48:63], v[112:115], v[88:91], v[48:63]
  v_exp_f32 v26, v26
  v_exp_f32 v27, v27
  v_exp_f32 v28, v28
  v_exp_f32 v29, v29
  v_exp_f32 v30, v30
  v_exp_f32 v31, v31
  v_cvt_pk_bf16_f32 v92, v24, v25
  v_cvt_pk_bf16_f32 v93, v26, v27
  v_cvt_pk_bf16_f32 v94, v28, v29
  v_cvt_pk_bf16_f32 v95, v30, v31
  v_exp_f32 v32, v32
  v_exp_f32 v33, v33
  v_mfma_f32_32x32x16_bf16 v[48:63], v[116:119], v[92:95], v[48:63]
  v_exp_f32 v34, v34
  v_exp_f32 v35, v35
  v_exp_f32 v36, v36
  v_exp_f32 v37, v37
  v_mfma_f32_32x32x16_bf16 v[16:31], v[96:99], v[80:83], v[144:159]
  v_exp_f32 v38, v38
  v_exp_f32 v39, v39
  v_cvt_pk_bf16_f32 v88, v32, v33
  v_cvt_pk_bf16_f32 v89, v34, v35
  v_cvt_pk_bf16_f32 v90, v36, v37
  v_cvt_pk_bf16_f32 v91, v38, v39
  v_exp_f32 v40, v40
  v_exp_f32 v41, v41
  v_mfma_f32_32x32x16_bf16 v[64:79], v[112:115], v[88:91], v[64:79]
  v_exp_f32 v42, v42
  v_exp_f32 v43, v43
  v_exp_f32 v44, v44
  v_exp_f32 v45, v45
  v_exp_f32 v46, v46
  v_exp_f32 v47, v47
  v_cvt_pk_bf16_f32 v92, v40, v41
  v_cvt_pk_bf16_f32 v93, v42, v43
  v_cvt_pk_bf16_f32 v94, v44, v45
  v_cvt_pk_bf16_f32 v95, v46, v47
  v_exp_f32 v16, v16
  v_exp_f32 v17, v17
  v_mfma_f32_32x32x16_bf16 v[64:79], v[116:119], v[92:95], v[64:79]
  v_exp_f32 v18, v18
  v_exp_f32 v19, v19
  v_exp_f32 v20, v20
  v_exp_f32 v21, v21
  v_mfma_f32_32x32x16_bf16 v[32:47], v[96:99], v[84:87], v[160:175]
  s_waitcnt lgkmcnt(0)
  s_cmp_eq_u32 s38, 0
  s_cbranch_scc1 prio_98
  s_setprio 1
prio_98:
  s_waitcnt vmcnt(4)
  s_barrier
  s_lshl_b32 s28, s14, 12
  s_add_u32 m0, s28, 32768
  s_add_u32 s28, s33, 57344
  buffer_load_dwordx4 v2, s[8:11], s28 offen offset:0 lds
  buffer_load_dwordx4 v2, s[8:11], s28 offen offset:1024 lds
  buffer_load_dwordx4 v2, s[8:11], s28 offen offset:2048 lds
  buffer_load_dwordx4 v2, s[8:11], s28 offen offset:3072 lds
  ds_read_b128 v[96:99], v126 offset:32768
  s_mov_b64 exec, s[20:21]
  ds_read_b128 v[112:115], v127 offset:7168
  ds_read_b128 v[116:119], v127 offset:7680
  s_mov_b64 exec, -1
  v_exp_f32 v22, v22
  v_exp_f32 v23, v23
  v_cvt_pk_bf16_f32 v88, v16, v17
  v_cvt_pk_bf16_f32 v89, v18, v19
  v_cvt_pk_bf16_f32 v90, v20, v21
  v_cvt_pk_bf16_f32 v91, v22, v23
  v_exp_f32 v24, v24
  v_exp_f32 v25, v25
  v_mfma_f32_32x32x16_bf16 v[48:63], v[104:107], v[88:91], v[48:63]
  v_exp_f32 v26, v26
  v_exp_f32 v27, v27
  v_exp_f32 v28, v28
  v_exp_f32 v29, v29
  v_exp_f32 v30, v30
  v_exp_f32 v31, v31
  v_cvt_pk_bf16_f32 v92, v24, v25
  v_cvt_pk_bf16_f32 v93, v26, v27
  v_cvt_pk_bf16_f32 v94, v28, v29
  v_cvt_pk_bf16_f32 v95, v30, v31
  v_exp_f32 v32, v32
  v_exp_f32 v33, v33
  v_mfma_f32_32x32x16_bf16 v[48:63], v[108:111], v[92:95], v[48:63]
  v_exp_f32 v34, v34
  v_exp_f32 v35, v35
  v_exp_f32 v36, v36
  v_exp_f32 v37, v37
  v_mfma_f32_32x32x16_bf16 v[16:31], v[100:103], v[80:83], v[144:159]
  v_exp_f32 v38, v38
  v_exp_f32 v39, v39
  v_cvt_pk_bf16_f32 v88, v32, v33
  v_cvt_pk_bf16_f32 v89, v34, v35
  v_cvt_pk_bf16_f32 v90, v36, v37
  v_cvt_pk_bf16_f32 v91, v38, v39
  v_exp_f32 v40, v40
  v_exp_f32 v41, v41
  v_mfma_f32_32x32x16_bf16 v[64:79], v[104:107], v[88:91], v[64:79]
  v_exp_f32 v42, v42
  v_exp_f32 v43, v43
  v_exp_f32 v44, v44
  v_exp_f32 v45, v45
  v_exp_f32 v46, v46
  v_exp_f32 v47, v47
  v_cvt_pk_bf16_f32 v92, v40, v41
  v_cvt_pk_bf16_f32 v93, v42, v43
  v_cvt_pk_bf16_f32 v94, v44, v45
  v_cvt_pk_bf16_f32 v95, v46, v47
  v_exp_f32 v16, v16
  v_exp_f32 v17, v17
  v_mfma_f32_32x32x16_bf16 v[64:79], v[108:111], v[92:95], v[64:79]
  v_exp_f32 v18, v18
  v_exp_f32 v19, v19
  v_exp_f32 v20, v20
  v_exp_f32 v21, v21
  v_mfma_f32_32x32x16_bf16 v[32:47], v[100:103], v[84:87], v[160:175]
  s_waitcnt lgkmcnt(0)
  ds_read_b128 v[100:103], v126 offset:33792
  s_mov_b64 exec, s[20:21]
  ds_read_b128 v[104:107], v127 offset:32768
  ds_read_b128 v[108:111], v127 offset:33280
  s_mov_b64 exec, -1
  v_exp_f32 v22, v22
  v_exp_f32 v23, v23
  v_cvt_pk_bf16_f32 v88, v16, v17
  v_cvt_pk_bf16_f32 v89, v18, v19
  v_cvt_pk_bf16_f32 v90, v20, v21
  v_cvt_pk_bf16_f32 v91, v22, v23
  v_exp_f32 v24, v24
  v_exp_f32 v25, v25
  v_mfma_f32_32x32x16_bf16 v[48:63], v[112:115], v[88:91], v[48:63]
  v_exp_f32 v26, v26
  v_exp_f32 v27, v27
  v_exp_f32 v28, v28
  v_exp_f32 v29, v29
  v_exp_f32 v30, v30
  v_exp_f32 v31, v31
  v_cvt_pk_bf16_f32 v92, v24, v25
  v_cvt_pk_bf16_f32 v93, v26, v27
  v_cvt_pk_bf16_f32 v94, v28, v29
  v_cvt_pk_bf16_f32 v95, v30, v31
  v_exp_f32 v32, v32
  v_exp_f32 v33, v33
  v_mfma_f32_32x32x16_bf16 v[48:63], v[116:119], v[92:95], v[48:63]
  v_exp_f32 v34, v34
  v_exp_f32 v35, v35
  v_exp_f32 v36, v36
  v_exp_f32 v37, v37
  v_mfma_f32_32x32x16_bf16 v[16:31], v[96:99], v[80:83], v[144:159]
  v_exp_f32 v38, v38
  v_exp_f32 v39, v39
  v_cvt_pk_bf16_f32 v88, v32, v33
  v_cvt_pk_bf16_f32 v89, v34, v35
  v_cvt_pk_bf16_f32 v90, v36, v37
  v_cvt_pk_bf16_f32 v91, v38, v39
  v_exp_f32 v40, v40
  v_exp_f32 v41, v41
  v_mfma_f32_32x32x16_bf16 v[64:79], v[112:115], v[88:91], v[64:79]
  v_exp_f32 v42, v42
  v_exp_f32 v43, v43
  v_exp_f32 v44, v44
  v_exp_f32 v45, v45
  v_exp_f32 v46, v46
  v_exp_f32 v47, v47
  v_cvt_pk_bf16_f32 v92, v40, v41
  v_cvt_pk_bf16_f32 v93, v42, v43
  v_cvt_pk_bf16_f32 v94, v44, v45
  v_cvt_pk_bf16_f32 v95, v46, v47
  v_exp_f32 v16, v16
  v_exp_f32 v17, v17
  v_mfma_f32_32x32x16_bf16 v[64:79], v[116:119], v[92:95], v[64:79]
  v_exp_f32 v18, v18
  v_exp_f32 v19, v19
  v_exp_f32 v20, v20
  v_exp_f32 v21, v21
  v_mfma_f32_32x32x16_bf16 v[32:47], v[96:99], v[84:87], v[160:175]
  s_waitcnt lgkmcnt(0)
  ds_read_b128 v[96:99], v126 offset:34816
  s_mov_b64 exec, s[20:21]
  ds_read_b128 v[112:115], v127 offset:33792
  ds_read_b128 v[116:119], v127 offset:34304
  s_mov_b64 exec, -1
  v_exp_f32 v22, v22
  v_exp_f32 v23, v23
  v_cvt_pk_bf16_f32 v88, v16, v17
  v_cvt_pk_bf16_f32 v89, v18, v19
  v_cvt_pk_bf16_f32 v90, v20, v21
  v_cvt_pk_bf16_f32 v91, v22, v23
  v_exp_f32 v24, v24
  v_exp_f32 v25, v25
  v_mfma_f32_32x32x16_bf16 v[48:63], v[104:107], v[88:91], v[48:63]
  v_exp_f32 v26, v26
  v_exp_f32 v27, v27
  v_exp_f32 v28, v28
  v_exp_f32 v29, v29
  v_exp_f32 v30, v30
  v_exp_f32 v31, v31
  v_cvt_pk_bf16_f32 v92, v24, v25
  v_cvt_pk_bf16_f32 v93, v26, v27
  v_cvt_pk_bf16_f32 v94, v28, v29
  v_cvt_pk_bf16_f32 v95, v30, v31
  v_exp_f32 v32, v32
  v_exp_f32 v33, v33
  v_mfma_f32_32x32x16_bf16 v[48:63], v[108:111], v[92:95], v[48:63]
  v_exp_f32 v34, v34
  v_exp_f32 v35, v35
  v_exp_f32 v36, v36
  v_exp_f32 v37, v37
  v_mfma_f32_32x32x16_bf16 v[16:31], v[100:103], v[80:83], v[144:159]
  v_exp_f32 v38, v38
  v_exp_f32 v39, v39
  v_cvt_pk_bf16_f32 v88, v32, v33
  v_cvt_pk_bf16_f32 v89, v34, v35
  v_cvt_pk_bf16_f32 v90, v36, v37
  v_cvt_pk_bf16_f32 v91, v38, v39
  v_exp_f32 v40, v40
  v_exp_f32 v41, v41
  v_mfma_f32_32x32x16_bf16 v[64:79], v[104:107], v[88:91], v[64:79]
  v_exp_f32 v42, v42
  v_exp_f32 v43, v43
  v_exp_f32 v44, v44
  v_exp_f32 v45, v45
  v_exp_f32 v46, v46
  v_exp_f32 v47, v47
  v_cvt_pk_bf16_f32 v92, v40, v41
  v_cvt_pk_bf16_f32 v93, v42, v43
  v_cvt_pk_bf16_f32 v94, v44, v45
  v_cvt_pk_bf16_f32 v95, v46, v47
  v_exp_f32 v16, v16
  v_exp_f32 v17, v17
  v_mfma_f32_32x32x16_bf16 v[64:79], v[108:111], v[92:95], v[64:79]
  v_exp_f32 v18, v18
  v_exp_f32 v19, v19
  v_exp_f32 v20, v20
  v_exp_f32 v21, v21
  v_mfma_f32_32x32x16_bf16 v[32:47], v[100:103], v[84:87], v[160:175]
  s_waitcnt lgkmcnt(0)
  ds_read_b128 v[100:103], v126 offset:35840
  s_mov_b64 exec, s[20:21]
  ds_read_b128 v[104:107], v127 offset:34816
  ds_read_b128 v[108:111], v127 offset:35328
  s_mov_b64 exec, -1
  v_exp_f32 v22, v22
  v_exp_f32 v23, v23
  v_cvt_pk_bf16_f32 v88, v16, v17
  v_cvt_pk_bf16_f32 v89, v18, v19
  v_cvt_pk_bf16_f32 v90, v20, v21
  v_cvt_pk_bf16_f32 v91, v22, v23
  v_exp_f32 v24, v24
  v_exp_f32 v25, v25
  v_mfma_f32_32x32x16_bf16 v[48:63], v[112:115], v[88:91], v[48:63]
  v_exp_f32 v26, v26
  v_exp_f32 v27, v27
  v_exp_f32 v28, v28
  v_exp_f32 v29, v29
  v_exp_f32 v30, v30
  v_exp_f32 v31, v31
  v_cvt_pk_bf16_f32 v92, v24, v25
  v_cvt_pk_bf16_f32 v93, v26, v27
  v_cvt_pk_bf16_f32 v94, v28, v29
  v_cvt_pk_bf16_f32 v95, v30, v31
  v_exp_f32 v32, v32
  v_exp_f32 v33, v33
  v_mfma_f32_32x32x16_bf16 v[48:63], v[116:119], v[92:95], v[48:63]
  v_exp_f32 v34, v34
  v_exp_f32 v35, v35
  v_exp_f32 v36, v36
  v_exp_f32 v37, v37
  v_mfma_f32_32x32x16_bf16 v[16:31], v[96:99], v[80:83], v[144:159]
  v_exp_f32 v38, v38
  v_exp_f32 v39, v39
  v_cvt_pk_bf16_f32 v88, v32, v33
  v_cvt_pk_bf16_f32 v89, v34, v35
  v_cvt_pk_bf16_f32 v90, v36, v37
  v_cvt_pk_bf16_f32 v91, v38, v39
  v_exp_f32 v40, v40
  v_exp_f32 v41, v41
  v_mfma_f32_32x32x16_bf16 v[64:79], v[112:115], v[88:91], v[64:79]
  v_exp_f32 v42, v42
  v_exp_f32 v43, v43
  v_exp_f32 v44, v44
  v_exp_f32 v45, v45
  v_exp_f32 v46, v46
  v_exp_f32 v47, v47
  v_cvt_pk_bf16_f32 v92, v40, v41
  v_cvt_pk_bf16_f32 v93, v42, v43
  v_cvt_pk_bf16_f32 v94, v44, v45
  v_cvt_pk_bf16_f32 v95, v46, v47
  v_exp_f32 v16, v16
  v_exp_f32 v17, v17
  v_mfma_f32_32x32x16_bf16 v[64:79], v[116:119], v[92:95], v[64:79]
  v_exp_f32 v18, v18
  v_exp_f32 v19, v19
  v_exp_f32 v20, v20
  v_exp_f32 v21, v21
  v_mfma_f32_32x32x16_bf16 v[32:47], v[96:99], v[84:87], v[160:175]
  s_waitcnt lgkmcnt(0)
  buffer_load_dwordx4 v[128:131], v2, s[8:11], s46 offen offset:0
  buffer_load_dwordx4 v[132:135], v2, s[8:11], s46 offen offset:1024
  ds_read_b128 v[96:99], v126 offset:36864
  s_mov_b64 exec, s[20:21]
  ds_read_b128 v[112:115], v127 offset:35840
  ds_read_b128 v[116:119], v127 offset:36352
  s_mov_b64 exec, -1
  v_exp_f32 v22, v22
  v_exp_f32 v23, v23
  v_cvt_pk_bf16_f32 v88, v16, v17
  v_cvt_pk_bf16_f32 v89, v18, v19
  v_cvt_pk_bf16_f32 v90, v20, v21
  v_cvt_pk_bf16_f32 v91, v22, v23
  v_exp_f32 v24, v24
  v_exp_f32 v25, v25
  v_mfma_f32_32x32x16_bf16 v[48:63], v[104:107], v[88:91], v[48:63]
  v_exp_f32 v26, v26
  v_exp_f32 v27, v27
  v_exp_f32 v28, v28
  v_exp_f32 v29, v29
  v_exp_f32 v30, v30
  v_exp_f32 v31, v31
  v_cvt_pk_bf16_f32 v92, v24, v25
  v_cvt_pk_bf16_f32 v93, v26, v27
  v_cvt_pk_bf16_f32 v94, v28, v29
  v_cvt_pk_bf16_f32 v95, v30, v31
  v_exp_f32 v32, v32
  v_exp_f32 v33, v33
  v_mfma_f32_32x32x16_bf16 v[48:63], v[108:111], v[92:95], v[48:63]
  v_exp_f32 v34, v34
  v_exp_f32 v35, v35
  v_exp_f32 v36, v36
  v_exp_f32 v37, v37
  v_mfma_f32_32x32x16_bf16 v[16:31], v[100:103], v[80:83], v[144:159]
  v_exp_f32 v38, v38
  v_exp_f32 v39, v39
  v_cvt_pk_bf16_f32 v88, v32, v33
  v_cvt_pk_bf16_f32 v89, v34, v35
  v_cvt_pk_bf16_f32 v90, v36, v37
  v_cvt_pk_bf16_f32 v91, v38, v39
  v_exp_f32 v40, v40
  v_exp_f32 v41, v41
  v_mfma_f32_32x32x16_bf16 v[64:79], v[104:107], v[88:91], v[64:79]
  v_exp_f32 v42, v42
  v_exp_f32 v43, v43
  v_exp_f32 v44, v44
  v_exp_f32 v45, v45
  v_exp_f32 v46, v46
  v_exp_f32 v47, v47
  v_cvt_pk_bf16_f32 v92, v40, v41
  v_cvt_pk_bf16_f32 v93, v42, v43
  v_cvt_pk_bf16_f32 v94, v44, v45
  v_cvt_pk_bf16_f32 v95, v46, v47
  v_exp_f32 v16, v16
  v_exp_f32 v17, v17
  v_mfma_f32_32x32x16_bf16 v[64:79], v[108:111], v[92:95], v[64:79]
  v_exp_f32 v18, v18
  v_exp_f32 v19, v19
  v_exp_f32 v20, v20
  v_exp_f32 v21, v21
  v_mfma_f32_32x32x16_bf16 v[32:47], v[100:103], v[84:87], v[160:175]
  s_waitcnt lgkmcnt(0)
  buffer_load_dwordx4 v[136:139], v2, s[8:11], s46 offen offset:2048
  buffer_load_dwordx4 v[140:143], v2, s[8:11], s46 offen offset:3072
  ds_read_b128 v[100:103], v126 offset:37888
  s_mov_b64 exec, s[20:21]
  ds_read_b128 v[104:107], v127 offset:36864
  ds_read_b128 v[108:111], v127 offset:37376
  s_mov_b64 exec, -1
  v_exp_f32 v22, v22
  v_exp_f32 v23, v23
  v_cvt_pk_bf16_f32 v88, v16, v17
  v_cvt_pk_bf16_f32 v89, v18, v19
  v_cvt_pk_bf16_f32 v90, v20, v21
  v_cvt_pk_bf16_f32 v91, v22, v23
  v_exp_f32 v24, v24
  v_exp_f32 v25, v25
  v_mfma_f32_32x32x16_bf16 v[48:63], v[112:115], v[88:91], v[48:63]
  v_exp_f32 v26, v26
  v_exp_f32 v27, v27
  v_exp_f32 v28, v28
  v_exp_f32 v29, v29
  v_exp_f32 v30, v30
  v_exp_f32 v31, v31
  v_cvt_pk_bf16_f32 v92, v24, v25
  v_cvt_pk_bf16_f32 v93, v26, v27
  v_cvt_pk_bf16_f32 v94, v28, v29
  v_cvt_pk_bf16_f32 v95, v30, v31
  v_exp_f32 v32, v32
  v_exp_f32 v33, v33
  v_mfma_f32_32x32x16_bf16 v[48:63], v[116:119], v[92:95], v[48:63]
  v_exp_f32 v34, v34
  v_exp_f32 v35, v35
  v_exp_f32 v36, v36
  v_exp_f32 v37, v37
  v_mfma_f32_32x32x16_bf16 v[16:31], v[96:99], v[80:83], v[144:159]
  v_exp_f32 v38, v38
  v_exp_f32 v39, v39
  v_cvt_pk_bf16_f32 v88, v32, v33
  v_cvt_pk_bf16_f32 v89, v34, v35
  v_cvt_pk_bf16_f32 v90, v36, v37
  v_cvt_pk_bf16_f32 v91, v38, v39
  v_exp_f32 v40, v40
  v_exp_f32 v41, v41
  v_mfma_f32_32x32x16_bf16 v[64:79], v[112:115], v[88:91], v[64:79]
  v_exp_f32 v42, v42
  v_exp_f32 v43, v43
  v_exp_f32 v44, v44
  v_exp_f32 v45, v45
  v_exp_f32 v46, v46
  v_exp_f32 v47, v47
  v_cvt_pk_bf16_f32 v92, v40, v41
  v_cvt_pk_bf16_f32 v93, v42, v43
  v_cvt_pk_bf16_f32 v94, v44, v45
  v_cvt_pk_bf16_f32 v95, v46, v47
  v_exp_f32 v16, v16
  v_exp_f32 v17, v17
  v_mfma_f32_32x32x16_bf16 v[64:79], v[116:119], v[92:95], v[64:79]
  v_exp_f32 v18, v18
  v_exp_f32 v19, v19
  v_exp_f32 v20, v20
  v_exp_f32 v21, v21
  v_mfma_f32_32x32x16_bf16 v[32:47], v[96:99], v[84:87], v[160:175]
  s_waitcnt lgkmcnt(0)
  s_and_b32 s16, s13, 7
  s_lshr_b32 s15, s13, 3
  s_lshl_b32 s15, s15, 1
  s_lshl_b32 s19, s12, 3
  s_add_u32 s15, s15, s19
  s_and_b32 s18, s14, 1
  s_lshr_b32 s17, s14, 1
  s_lshr_b32 s49, s14, 2
  s_and_b32 s48, s17, 1
  s_add_u32 s20, s15, s49
  s_lshl_b32 s21, s16, 1
  s_and_b32 s19, s14, 1
  s_add_u32 s21, s21, s19
  s_lshl_b32 s21, s21, 1
  s_add_u32 s21, s21, s48
  s_lshl_b32 s19, s20, 5
  s_add_u32 s19, s19, s21
  s_lshl_b32 s19, s19, 10
  s_add_u32 s22, s19, 11534336
  buffer_load_dwordx4 v[120:123], v2, s[8:11], s22 offen
  s_mov_b32 s20, 0xffff0000
  s_mov_b32 s21, 0xffff0000
  ds_read_b128 v[96:99], v126 offset:38912
  s_mov_b64 exec, s[20:21]
  ds_read_b128 v[112:115], v127 offset:37888
  ds_read_b128 v[116:119], v127 offset:38400
  s_mov_b64 exec, -1
  v_exp_f32 v22, v22
  v_exp_f32 v23, v23
  v_cvt_pk_bf16_f32 v88, v16, v17
  v_cvt_pk_bf16_f32 v89, v18, v19
  v_cvt_pk_bf16_f32 v90, v20, v21
  v_cvt_pk_bf16_f32 v91, v22, v23
  v_exp_f32 v24, v24
  v_exp_f32 v25, v25
  v_mfma_f32_32x32x16_bf16 v[48:63], v[104:107], v[88:91], v[48:63]
  v_exp_f32 v26, v26
  v_exp_f32 v27, v27
  v_exp_f32 v28, v28
  v_exp_f32 v29, v29
  v_exp_f32 v30, v30
  v_exp_f32 v31, v31
  v_cvt_pk_bf16_f32 v92, v24, v25
  v_cvt_pk_bf16_f32 v93, v26, v27
  v_cvt_pk_bf16_f32 v94, v28, v29
  v_cvt_pk_bf16_f32 v95, v30, v31
  v_exp_f32 v32, v32
  v_exp_f32 v33, v33
  v_mfma_f32_32x32x16_bf16 v[48:63], v[108:111], v[92:95], v[48:63]
  v_exp_f32 v34, v34
  v_exp_f32 v35, v35
  v_exp_f32 v36, v36
  v_exp_f32 v37, v37
  v_mfma_f32_32x32x16_bf16 v[16:31], v[100:103], v[80:83], v[144:159]
  v_exp_f32 v38, v38
  v_exp_f32 v39, v39
  v_cvt_pk_bf16_f32 v88, v32, v33
  v_cvt_pk_bf16_f32 v89, v34, v35
  v_cvt_pk_bf16_f32 v90, v36, v37
  v_cvt_pk_bf16_f32 v91, v38, v39
  v_exp_f32 v40, v40
  v_exp_f32 v41, v41
  v_mfma_f32_32x32x16_bf16 v[64:79], v[104:107], v[88:91], v[64:79]
  v_exp_f32 v42, v42
  v_exp_f32 v43, v43
  v_exp_f32 v44, v44
  v_exp_f32 v45, v45
  v_exp_f32 v46, v46
  v_exp_f32 v47, v47
  v_cvt_pk_bf16_f32 v92, v40, v41
  v_cvt_pk_bf16_f32 v93, v42, v43
  v_cvt_pk_bf16_f32 v94, v44, v45
  v_cvt_pk_bf16_f32 v95, v46, v47
  v_exp_f32 v16, v16
  v_exp_f32 v17, v17
  v_mfma_f32_32x32x16_bf16 v[64:79], v[108:111], v[92:95], v[64:79]
  v_exp_f32 v18, v18
  v_exp_f32 v19, v19
  v_exp_f32 v20, v20
  v_exp_f32 v21, v21
  v_mfma_f32_32x32x16_bf16 v[32:47], v[100:103], v[84:87], v[160:175]
  s_waitcnt lgkmcnt(0)
  ds_read_b128 v[100:103], v126 offset:39936
  s_mov_b64 exec, s[20:21]
  ds_read_b128 v[104:107], v127 offset:38912
  ds_read_b128 v[108:111], v127 offset:39424
  s_mov_b64 exec, -1
  v_exp_f32 v22, v22
  v_exp_f32 v23, v23
  v_cvt_pk_bf16_f32 v88, v16, v17
  v_cvt_pk_bf16_f32 v89, v18, v19
  v_cvt_pk_bf16_f32 v90, v20, v21
  v_cvt_pk_bf16_f32 v91, v22, v23
  v_exp_f32 v24, v24
  v_exp_f32 v25, v25
  v_mfma_f32_32x32x16_bf16 v[48:63], v[112:115], v[88:91], v[48:63]
  v_exp_f32 v26, v26
  v_exp_f32 v27, v27
  v_exp_f32 v28, v28
  v_exp_f32 v29, v29
  v_exp_f32 v30, v30
  v_exp_f32 v31, v31
  v_cvt_pk_bf16_f32 v92, v24, v25
  v_cvt_pk_bf16_f32 v93, v26, v27
  v_cvt_pk_bf16_f32 v94, v28, v29
  v_cvt_pk_bf16_f32 v95, v30, v31
  v_exp_f32 v32, v32
  v_exp_f32 v33, v33
  v_mfma_f32_32x32x16_bf16 v[48:63], v[116:119], v[92:95], v[48:63]
  v_exp_f32 v34, v34
  v_exp_f32 v35, v35
  v_exp_f32 v36, v36
  v_exp_f32 v37, v37
  v_mfma_f32_32x32x16_bf16 v[16:31], v[96:99], v[80:83], v[144:159]
  v_exp_f32 v38, v38
  v_exp_f32 v39, v39
  v_cvt_pk_bf16_f32 v88, v32, v33
  v_cvt_pk_bf16_f32 v89, v34, v35
  v_cvt_pk_bf16_f32 v90, v36, v37
  v_cvt_pk_bf16_f32 v91, v38, v39
  v_exp_f32 v40, v40
  v_exp_f32 v41, v41
  v_mfma_f32_32x32x16_bf16 v[64:79], v[112:115], v[88:91], v[64:79]
  v_exp_f32 v42, v42
  v_exp_f32 v43, v43
  v_exp_f32 v44, v44
  v_exp_f32 v45, v45
  v_exp_f32 v46, v46
  v_exp_f32 v47, v47
  v_cvt_pk_bf16_f32 v92, v40, v41
  v_cvt_pk_bf16_f32 v93, v42, v43
  v_cvt_pk_bf16_f32 v94, v44, v45
  v_cvt_pk_bf16_f32 v95, v46, v47
  v_exp_f32 v16, v16
  v_exp_f32 v17, v17
  v_mfma_f32_32x32x16_bf16 v[64:79], v[116:119], v[92:95], v[64:79]
  v_exp_f32 v18, v18
  v_exp_f32 v19, v19
  v_exp_f32 v20, v20
  v_exp_f32 v21, v21
  v_mfma_f32_32x32x16_bf16 v[32:47], v[96:99], v[84:87], v[160:175]
  s_waitcnt lgkmcnt(0)
  s_cmp_eq_u32 s38, 0
  s_cbranch_scc1 prio_99
  s_setprio 0
prio_99:
  buffer_load_dwordx4 v[96:99], v2, s[8:11], s47 offen offset:0
  s_mov_b64 exec, s[20:21]
  ds_read_b128 v[112:115], v127 offset:39936
  ds_read_b128 v[116:119], v127 offset:40448
  s_mov_b64 exec, -1
  v_exp_f32 v22, v22
  v_exp_f32 v23, v23
  v_cvt_pk_bf16_f32 v88, v16, v17
  v_cvt_pk_bf16_f32 v89, v18, v19
  v_cvt_pk_bf16_f32 v90, v20, v21
  v_cvt_pk_bf16_f32 v91, v22, v23
  v_exp_f32 v24, v24
  v_exp_f32 v25, v25
  v_mfma_f32_32x32x16_bf16 v[48:63], v[104:107], v[88:91], v[48:63]
  v_exp_f32 v26, v26
  v_exp_f32 v27, v27
  v_exp_f32 v28, v28
  v_exp_f32 v29, v29
  v_exp_f32 v30, v30
  v_exp_f32 v31, v31
  v_cvt_pk_bf16_f32 v92, v24, v25
  v_cvt_pk_bf16_f32 v93, v26, v27
  v_cvt_pk_bf16_f32 v94, v28, v29
  v_cvt_pk_bf16_f32 v95, v30, v31
  v_exp_f32 v32, v32
  v_exp_f32 v33, v33
  v_mfma_f32_32x32x16_bf16 v[48:63], v[108:111], v[92:95], v[48:63]
  v_exp_f32 v34, v34
  v_exp_f32 v35, v35
  v_exp_f32 v36, v36
  v_exp_f32 v37, v37
  v_mfma_f32_32x32x16_bf16 v[16:31], v[100:103], v[80:83], v[144:159]
  v_exp_f32 v38, v38
  v_exp_f32 v39, v39
  v_cvt_pk_bf16_f32 v88, v32, v33
  v_cvt_pk_bf16_f32 v89, v34, v35
  v_cvt_pk_bf16_f32 v90, v36, v37
  v_cvt_pk_bf16_f32 v91, v38, v39
  v_exp_f32 v40, v40
  v_exp_f32 v41, v41
  v_mfma_f32_32x32x16_bf16 v[64:79], v[104:107], v[88:91], v[64:79]
  v_exp_f32 v42, v42
  v_exp_f32 v43, v43
  v_exp_f32 v44, v44
  v_exp_f32 v45, v45
  v_exp_f32 v46, v46
  v_exp_f32 v47, v47
  v_cvt_pk_bf16_f32 v92, v40, v41
  v_cvt_pk_bf16_f32 v93, v42, v43
  v_cvt_pk_bf16_f32 v94, v44, v45
  v_cvt_pk_bf16_f32 v95, v46, v47
  v_exp_f32 v16, v16
  v_exp_f32 v17, v17
  v_mfma_f32_32x32x16_bf16 v[64:79], v[108:111], v[92:95], v[64:79]
  v_exp_f32 v18, v18
  v_exp_f32 v19, v19
  v_exp_f32 v20, v20
  v_exp_f32 v21, v21
  v_mfma_f32_32x32x16_bf16 v[32:47], v[100:103], v[84:87], v[160:175]
  s_waitcnt lgkmcnt(0)
  buffer_load_dwordx4 v[104:107], v2, s[8:11], s47 offen offset:1024
  buffer_load_dwordx4 v[108:111], v2, s[8:11], s47 offen offset:2048
  buffer_load_dwordx4 v[100:103], v2, s[8:11], s47 offen offset:3072
  v_exp_f32 v22, v22
  v_exp_f32 v23, v23
  v_cvt_pk_bf16_f32 v88, v16, v17
  v_cvt_pk_bf16_f32 v89, v18, v19
  v_cvt_pk_bf16_f32 v90, v20, v21
  v_cvt_pk_bf16_f32 v91, v22, v23
  v_exp_f32 v24, v24
  v_exp_f32 v25, v25
  v_mfma_f32_32x32x16_bf16 v[48:63], v[112:115], v[88:91], v[48:63]
  v_exp_f32 v26, v26
  v_exp_f32 v27, v27
  v_exp_f32 v28, v28
  v_exp_f32 v29, v29
  v_exp_f32 v30, v30
  v_exp_f32 v31, v31
  v_cvt_pk_bf16_f32 v92, v24, v25
  v_cvt_pk_bf16_f32 v93, v26, v27
  v_cvt_pk_bf16_f32 v94, v28, v29
  v_cvt_pk_bf16_f32 v95, v30, v31
  v_exp_f32 v32, v32
  v_exp_f32 v33, v33
  v_mfma_f32_32x32x16_bf16 v[48:63], v[116:119], v[92:95], v[48:63]
  v_exp_f32 v34, v34
  v_exp_f32 v35, v35
  v_exp_f32 v36, v36
  v_exp_f32 v37, v37
  v_exp_f32 v38, v38
  v_exp_f32 v39, v39
  v_cvt_pk_bf16_f32 v88, v32, v33
  v_cvt_pk_bf16_f32 v89, v34, v35
  v_cvt_pk_bf16_f32 v90, v36, v37
  v_cvt_pk_bf16_f32 v91, v38, v39
  v_exp_f32 v40, v40
  v_exp_f32 v41, v41
  v_mfma_f32_32x32x16_bf16 v[64:79], v[112:115], v[88:91], v[64:79]
  v_exp_f32 v42, v42
  v_exp_f32 v43, v43
  v_exp_f32 v44, v44
  v_exp_f32 v45, v45
  v_exp_f32 v46, v46
  v_exp_f32 v47, v47
  v_cvt_pk_bf16_f32 v92, v40, v41
  v_cvt_pk_bf16_f32 v93, v42, v43
  v_cvt_pk_bf16_f32 v94, v44, v45
  v_cvt_pk_bf16_f32 v95, v46, v47
  s_nop 1
  s_nop 15
  buffer_load_dwordx4 v[144:147], v2, s[8:11], s32 offen offset:0
  buffer_load_dwordx4 v[148:151], v2, s[8:11], s32 offen offset:1024
  buffer_load_dwordx4 v[152:155], v2, s[8:11], s32 offen offset:2048
  buffer_load_dwordx4 v[156:159], v2, s[8:11], s32 offen offset:3072
  s_add_u32 s32, s32, 4096
  buffer_load_dwordx4 v[160:163], v2, s[8:11], s32 offen offset:0
  buffer_load_dwordx4 v[164:167], v2, s[8:11], s32 offen offset:1024
  buffer_load_dwordx4 v[168:171], v2, s[8:11], s32 offen offset:2048
  buffer_load_dwordx4 v[172:175], v2, s[8:11], s32 offen offset:3072
  s_add_u32 s32, s32, 4096
  buffer_load_dwordx4 v[176:179], v2, s[8:11], s32 offen offset:0
  buffer_load_dwordx4 v[180:183], v2, s[8:11], s32 offen offset:1024
  buffer_load_dwordx4 v[184:187], v2, s[8:11], s32 offen offset:2048
  buffer_load_dwordx4 v[188:191], v2, s[8:11], s32 offen offset:3072
  s_add_u32 s32, s32, 4096
  buffer_load_dwordx4 v[192:195], v2, s[8:11], s32 offen offset:0
  buffer_load_dwordx4 v[196:199], v2, s[8:11], s32 offen offset:1024
  buffer_load_dwordx4 v[200:203], v2, s[8:11], s32 offen offset:2048
  buffer_load_dwordx4 v[204:207], v2, s[8:11], s32 offen offset:3072
  s_add_u32 s32, s32, 4096
  buffer_load_dwordx4 v[208:211], v2, s[8:11], s32 offen offset:0
  buffer_load_dwordx4 v[212:215], v2, s[8:11], s32 offen offset:1024
  buffer_load_dwordx4 v[216:219], v2, s[8:11], s32 offen offset:2048
  buffer_load_dwordx4 v[220:223], v2, s[8:11], s32 offen offset:3072
  s_add_u32 s32, s32, 4096
  buffer_load_dwordx4 v[224:227], v2, s[8:11], s32 offen offset:0
  buffer_load_dwordx4 v[228:231], v2, s[8:11], s32 offen offset:1024
  buffer_load_dwordx4 v[232:235], v2, s[8:11], s32 offen offset:2048
  buffer_load_dwordx4 v[236:239], v2, s[8:11], s32 offen offset:3072
  s_add_u32 s32, s32, 4096
  buffer_load_dwordx4 v[240:243], v2, s[8:11], s32 offen offset:0
  buffer_load_dwordx4 v[244:247], v2, s[8:11], s32 offen offset:1024
  buffer_load_dwordx4 v[248:251], v2, s[8:11], s32 offen offset:2048
  buffer_load_dwordx4 v[252:255], v2, s[8:11], s32 offen offset:3072
  s_add_u32 s32, s32, 4096
  s_waitcnt vmcnt(0)
  s_branch att1_epi
.section .rodata,"a"
.p2align 6
.amdhsa_kernel interleave_layers__grouped_kv_mqa__glu_gated_swiglu__prompt_kernel
  .amdhsa_next_free_vgpr 256
  .amdhsa_next_free_sgpr 100
  .amdhsa_accum_offset 256
  .amdhsa_group_segment_fixed_size 0
  .amdhsa_kernarg_size 96
  .amdhsa_user_sgpr_count 2
  .amdhsa_user_sgpr_kernarg_segment_ptr 1
  .amdhsa_system_sgpr_workgroup_id_x 1
.end_amdhsa_kernel
```
